```python
import torch

def _softmax(x, axis=-1):
    return torch.softmax(x, dim=axis)

def _gelu(x):
    return torch.nn.functional.gelu(x, approximate='tanh')

def _silu(x):
    return torch.nn.functional.silu(x)

def _sigmoid(x):
    return torch.sigmoid(x)

def _layernorm(x, axis=-1, eps=1e-05):
    m = x.mean(dim=axis, keepdim=True)
    v = x.var(dim=axis, keepdim=True, unbiased=False)
    return (x - m) / torch.sqrt(v + eps)

def _scatter_add(tgt, idx, src, axis=0):
    return tgt.clone().index_add_(axis, idx, src)

def _segment_sum(src, seg, n):
    out = torch.zeros((n,) + src.shape[1:], dtype=src.dtype)
    return out.index_add_(0, seg, src)

def _pad(x, pw):
    flat = tuple((v for pair in reversed(pw) for v in pair))
    return torch.nn.functional.pad(x, flat)
kernel_name = 'interleave_layers__linear_attn_block__mixer_gmlp__prompt'

def setup_inputs():

    _w = lambda a: (lambda t: t.to(torch.bfloat16) if t.is_floating_point() else t)(torch.as_tensor(a))

    def _A_setup():
        B, S, D = (1, 2048, 1024)
        return {'x': _w((lambda *s: torch.randn(*s, dtype=torch.bfloat16) * 0.05)(B, S, D)), 'wqkv': _w((lambda *s: torch.randn(*s, dtype=torch.bfloat16) * 0.05)(D, 3 * D)), 'wo': _w((lambda *s: torch.randn(*s, dtype=torch.bfloat16) * 0.05)(D, D))}
    _A_in = _A_setup()

    def _B_setup():
        B, S, D, F = (1, 2048, 1024, 3584)
        Fh = F // 2
        return {'x': _w((lambda *s: torch.randn(*s, dtype=torch.bfloat16) * 0.05)(B, S, D)), 'w_in': _w((lambda *s: torch.randn(*s, dtype=torch.bfloat16) * 0.2)(D, 2 * Fh)), 'w_sp': _w(0.01 * (lambda *s: torch.randn(*s, dtype=torch.bfloat16) * 0.2)(S, S)), 'b_sp': _w(1.0 + 0.01 * (lambda *s: torch.randn(*s, dtype=torch.bfloat16) * 0.05)(S)), 'w_out': _w((lambda *s: torch.randn(*s, dtype=torch.bfloat16) * 0.05)(Fh, D))}
    _B_in = _B_setup()
    return {'A_x': _A_in['x'], 'A_wqkv': _A_in['wqkv'], 'A_wo': _A_in['wo'], 'B_x': _B_in['x'], 'B_w_in': _B_in['w_in'], 'B_w_sp': _B_in['w_sp'], 'B_b_sp': _B_in['b_sp'], 'B_w_out': _B_in['w_out']}

def reference(A_x, A_wqkv, A_wo, B_x, B_w_in, B_w_sp, B_b_sp, B_w_out):

    def _A_ref(x, wqkv, wo):
        B, S, D = x.shape
        H = 32
        Dh = D // H
        qkv = (lambda x, *d: x.permute(*d))((x @ wqkv).reshape(B, S, 3, H, Dh), 2, 0, 3, 1, 4)
        q, k, v = (qkv[0], qkv[1], qkv[2])
        phi = lambda t: torch.where(t > 0, t + 1, torch.exp(t)) + 1e-06
        pq, pk = (phi(q), phi(k))
        kv = torch.einsum('bhsd,bhse->bhde', pk, v)
        z = torch.einsum('bhsd->bhd', pk)
        num = torch.einsum('bhqd,bhde->bhqe', pq, kv)
        den = torch.einsum('bhqd,bhd->bhq', pq, z)[..., None] + 1e-06
        o = num / den
        return (lambda x, *d: x.permute(*d))(o, 0, 2, 1, 3).reshape(B, S, D) @ wo

    def _B_ref(x, w_in, w_sp, b_sp, w_out):
        B, S, D = x.shape
        F = w_in.shape[-1]
        Fh = F // 2
        z = _gelu(torch.einsum('bsd,df->bsf', x, w_in))
        z1 = z[..., :Fh].clone()
        z2 = _layernorm(z[..., Fh:], axis=-1)
        g = torch.einsum('ts,bsf->btf', w_sp, z2) + b_sp[None, :, None]
        return torch.einsum('bsf,fd->bsd', z1 * g, w_out)
    x = A_x
    x = x + _A_ref(_layernorm(x, axis=-1), A_wqkv, A_wo)
    x = x + _B_ref(_layernorm(x, axis=-1), B_w_in, B_w_sp, B_b_sp, B_w_out)
    x = x + _A_ref(_layernorm(x, axis=-1), A_wqkv, A_wo)
    x = x + _B_ref(_layernorm(x, axis=-1), B_w_in, B_w_sp, B_b_sp, B_w_out)
    return x
```

```asm
; @launch grid=(256,1,1) block=(256,1,1) lds=163840
.amdgcn_target "amdgcn-amd-amdhsa--gfx950"
.text
.globl interleave_layers__linear_attn_block__mixer_gmlp__prompt_kernel
.p2align 8
.type interleave_layers__linear_attn_block__mixer_gmlp__prompt_kernel,@function
interleave_layers__linear_attn_block__mixer_gmlp__prompt_kernel:
 s_cmp_ge_u32 s2, 256
 s_cbranch_scc1 mk_end
 s_load_dwordx4 s[84:87], s[0:1], 8
 s_load_dwordx8 s[88:95], s[0:1], 32
 s_load_dwordx2 s[96:97], s[0:1], 0
 s_load_dwordx2 s[100:101], s[0:1], 80
 s_and_b32 s66, s2, 7
 s_lshr_b32 s67, s2, 3
 s_lshr_b32 s36, s66, 1
 s_lshl_b32 s36, s36, 2
 s_lshr_b32 s68, s67, 3
 s_add_u32 s36, s36, s68
 s_and_b32 s37, s66, 1
 s_lshl_b32 s37, s37, 3
 s_and_b32 s68, s67, 7
 s_add_u32 s37, s37, s68
 v_lshrrev_b32 v2, 6, v0
 s_nop 0
 v_readfirstlane_b32 s38, v2
 v_and_b32 v0, 63, v0
 s_lshl_b32 s39, s36, 2
 s_add_u32 s39, s39, s38
 s_getpc_b64 s[66:67]
mk_pc:
 s_lshl_b32 s68, s2, 2
 s_add_u32 s68, s68, s38
 s_lshl_b32 s68, s68, 7
 s_min_u32 s68, s68, mk_end-mk_pc
 v_mov_b32 v226, s68
 global_load_dword v255, v226, s[66:67]
 s_lshl_b32 s66, s39, 16
 s_lshl_b32 s67, s37, 7
 s_add_u32 s53, s66, s67
 v_and_b32 v58, 15, v0
 v_lshlrev_b32 v58, 11, v58
 v_bfe_u32 v59, v0, 4, 1
 v_lshl_add_u32 v58, v59, 5, v58
 v_lshrrev_b32 v59, 5, v0
 v_lshl_add_u32 v58, v59, 4, v58
 s_add_u32 s67, s53, 0x8000
 s_waitcnt lgkmcnt(0)
 s_mov_b32 s28, s96
 s_mov_b32 s29, s97
 s_mov_b32 s30, 0x400000
 s_mov_b32 s31, 0x00020000
 buffer_load_dwordx4 v[96:99], v58, s[28:31], s53 offen offset:0
 buffer_load_dwordx4 v[100:103], v58, s[28:31], s67 offen offset:0
 buffer_load_dwordx4 v[104:107], v58, s[28:31], s53 offen offset:64
 buffer_load_dwordx4 v[108:111], v58, s[28:31], s67 offen offset:64
 s_lshl_b32 s67, s37, 7
 v_lshrrev_b32 v224, 3, v0
 v_and_b32 v225, 7, v0
 v_and_b32 v226, 6, v224
 v_xor_b32 v226, v226, v225
 v_lshlrev_b32 v226, 4, v226
 s_and_b32 s66, s38, 1
 s_lshl_b32 s66, s66, 5
 v_add_u32 v227, s66, v224
 v_mul_u32_u24 v3, 6144, v227
 v_add3_u32 v3, v3, v226, s67
 v_add_u32 v4, 0xbc00, v3
 v_add_u32 v5, 0x17800, v3
 v_add_u32 v6, 0x23400, v3
 v_mul_u32_u24 v7, 2048, v227
 v_add3_u32 v7, v7, v226, s67
 v_add_u32 v8, 0x3c00, v7
 v_add_u32 v9, 0x7800, v7
 v_add_u32 v10, 0xb400, v7
 s_lshr_b32 s66, s38, 1
 s_add_u32 s67, s66, 1
 s_lshl_b32 s61, s67, 11
 s_lshl_b32 s60, s38, 12
 s_mov_b32 s8, s84
 s_mov_b32 s9, s85
 s_mov_b32 s10, 0x600000
 s_mov_b32 s11, 0x00020000
 s_add_u32 m0, s60, 0x14000
 s_mul_i32 s65, s36, 0x60000
 s_add_u32 s65, s65, s61
 buffer_load_dwordx4 v3, s[8:11], s65 offen offset:0 lds
 buffer_load_dwordx4 v4, s[8:11], s65 offen offset:1024 lds
 buffer_load_dwordx4 v5, s[8:11], s65 offen offset:2048 lds
 buffer_load_dwordx4 v6, s[8:11], s65 offen offset:3072 lds
 s_lshr_b32 s66, s38, 1
 s_lshl_b32 s66, s66, 30
 s_add_u32 m0, s60, 0x18000
 s_mul_i32 s65, s36, 0x60000
 s_add_u32 s65, s65, s66
 buffer_load_dwordx4 v3, s[8:11], s65 offen offset:0 lds
 buffer_load_dwordx4 v4, s[8:11], s65 offen offset:1024 lds
 buffer_load_dwordx4 v5, s[8:11], s65 offen offset:2048 lds
 buffer_load_dwordx4 v6, s[8:11], s65 offen offset:3072 lds
 s_mov_b32 s4, s100
 s_mov_b32 s5, s101
 s_mov_b32 s6, 0x10000000
 s_mov_b32 s7, 0x00020000
 s_add_u32 s100, s100, 0xc280000
 s_addc_u32 s101, s101, 0
 s_load_dword s96, s[100:101], 0
 s_lshl_b32 s42, s39, 12
 s_lshl_b32 s3, s39, 13
 s_lshl_b32 s66, s37, 19
 s_add_u32 s43, s3, s66
 s_lshl_b32 s67, s37, 8
 s_add_u32 s51, s42, s67
 s_mov_b32 s78, 0xffff0000
 s_lshl_b32 s66, s37, 2
 s_add_u32 s66, s66, s38
 s_mul_i32 s83, s66, 4352
 v_lshlrev_b32 v1, 4, v0
 v_lshlrev_b32 v2, 2, v0
 v_lshrrev_b32 v226, 3, v0
 v_lshlrev_b32 v226, 8, v226
 v_and_b32 v227, 7, v0
 v_lshl_add_u32 v11, v227, 4, v226
 v_add_u32 v14, 0x1000, v11
 s_waitcnt vmcnt(8)
 v_lshrrev_b32 v112, 3, v0
 v_lshlrev_b32 v112, 8, v112
 v_and_b32 v113, 7, v0
 v_lshl_add_u32 v112, v113, 4, v112
 v_mov_b32 v116, 0
 v_mov_b32 v117, 0
 v_mov_b32 v118, 0
 v_mov_b32 v119, 0
 s_cmp_lg_u32 s37, 0
 s_cbranch_scc1 mk_z1
 s_mul_i32 s66, s39, 4352
 s_add_u32 s66, s66, 0xc100000
 buffer_store_dwordx4 v[116:119], v112, s[4:7], s66 offen sc1
 buffer_store_dwordx4 v[116:119], v112, s[4:7], s66 offen offset:2048 sc1
mk_z1:
 s_cmp_lg_u32 s36, 0
 s_cbranch_scc1 mk_z2
 s_add_u32 s66, s83, 0xc144000
 buffer_store_dwordx4 v[116:119], v112, s[4:7], s66 offen sc1
 buffer_store_dwordx4 v[116:119], v112, s[4:7], s66 offen offset:2048 sc1
 s_mul_i32 s66, s37, 4352
 s_add_u32 s66, s66, 0xc188000
 buffer_store_dwordx4 v[116:119], v112, s[4:7], s66 offen sc1
 buffer_store_dwordx4 v[116:119], v112, s[4:7], s66 offen offset:2048 sc1
mk_z2:
 v_permlane16_swap_b32 v96, v98
 v_permlane16_swap_b32 v97, v99
 v_permlane16_swap_b32 v100, v102
 v_permlane16_swap_b32 v101, v103
 v_permlane16_swap_b32 v104, v106
 v_permlane16_swap_b32 v105, v107
 v_permlane16_swap_b32 v108, v110
 v_permlane16_swap_b32 v109, v111
 buffer_store_dwordx4 v[96:99], v11, s[4:7], s43 offen offset:0 sc1
 buffer_store_dwordx4 v[100:103], v11, s[4:7], s43 offen offset:2048 sc1
 buffer_store_dwordx4 v[104:107], v14, s[4:7], s43 offen offset:0 sc1
 buffer_store_dwordx4 v[108:111], v14, s[4:7], s43 offen offset:2048 sc1
 v_accvgpr_write_b32 a0, v96
 v_accvgpr_write_b32 a1, v97
 v_accvgpr_write_b32 a2, v98
 v_accvgpr_write_b32 a3, v99
 v_accvgpr_write_b32 a4, v100
 v_accvgpr_write_b32 a5, v101
 v_accvgpr_write_b32 a6, v102
 v_accvgpr_write_b32 a7, v103
 v_accvgpr_write_b32 a8, v104
 v_accvgpr_write_b32 a9, v105
 v_accvgpr_write_b32 a10, v106
 v_accvgpr_write_b32 a11, v107
 v_accvgpr_write_b32 a12, v108
 v_accvgpr_write_b32 a13, v109
 v_accvgpr_write_b32 a14, v110
 v_accvgpr_write_b32 a15, v111
 v_mov_b32 v116, 0
 v_mov_b32 v117, 0
 v_mov_b32 v118, 0
 v_mov_b32 v119, 0
 v_lshlrev_b32 v120, 16, v96
 v_and_b32 v121, s78, v96
 v_add_f32 v116, v116, v120
 v_fmac_f32 v118, v120, v120
 v_add_f32 v116, v116, v121
 v_fmac_f32 v118, v121, v121
 v_lshlrev_b32 v120, 16, v97
 v_and_b32 v121, s78, v97
 v_add_f32 v116, v116, v120
 v_fmac_f32 v118, v120, v120
 v_add_f32 v116, v116, v121
 v_fmac_f32 v118, v121, v121
 v_lshlrev_b32 v120, 16, v98
 v_and_b32 v121, s78, v98
 v_add_f32 v116, v116, v120
 v_fmac_f32 v118, v120, v120
 v_add_f32 v116, v116, v121
 v_fmac_f32 v118, v121, v121
 v_lshlrev_b32 v120, 16, v99
 v_and_b32 v121, s78, v99
 v_add_f32 v116, v116, v120
 v_fmac_f32 v118, v120, v120
 v_add_f32 v116, v116, v121
 v_fmac_f32 v118, v121, v121
 v_lshlrev_b32 v120, 16, v100
 v_and_b32 v121, s78, v100
 v_add_f32 v117, v117, v120
 v_fmac_f32 v119, v120, v120
 v_add_f32 v117, v117, v121
 v_fmac_f32 v119, v121, v121
 v_lshlrev_b32 v120, 16, v101
 v_and_b32 v121, s78, v101
 v_add_f32 v117, v117, v120
 v_fmac_f32 v119, v120, v120
 v_add_f32 v117, v117, v121
 v_fmac_f32 v119, v121, v121
 v_lshlrev_b32 v120, 16, v102
 v_and_b32 v121, s78, v102
 v_add_f32 v117, v117, v120
 v_fmac_f32 v119, v120, v120
 v_add_f32 v117, v117, v121
 v_fmac_f32 v119, v121, v121
 v_lshlrev_b32 v120, 16, v103
 v_and_b32 v121, s78, v103
 v_add_f32 v117, v117, v120
 v_fmac_f32 v119, v120, v120
 v_add_f32 v117, v117, v121
 v_fmac_f32 v119, v121, v121
 v_lshlrev_b32 v120, 16, v104
 v_and_b32 v121, s78, v104
 v_add_f32 v116, v116, v120
 v_fmac_f32 v118, v120, v120
 v_add_f32 v116, v116, v121
 v_fmac_f32 v118, v121, v121
 v_lshlrev_b32 v120, 16, v105
 v_and_b32 v121, s78, v105
 v_add_f32 v116, v116, v120
 v_fmac_f32 v118, v120, v120
 v_add_f32 v116, v116, v121
 v_fmac_f32 v118, v121, v121
 v_lshlrev_b32 v120, 16, v106
 v_and_b32 v121, s78, v106
 v_add_f32 v116, v116, v120
 v_fmac_f32 v118, v120, v120
 v_add_f32 v116, v116, v121
 v_fmac_f32 v118, v121, v121
 v_lshlrev_b32 v120, 16, v107
 v_and_b32 v121, s78, v107
 v_add_f32 v116, v116, v120
 v_fmac_f32 v118, v120, v120
 v_add_f32 v116, v116, v121
 v_fmac_f32 v118, v121, v121
 v_lshlrev_b32 v120, 16, v108
 v_and_b32 v121, s78, v108
 v_add_f32 v117, v117, v120
 v_fmac_f32 v119, v120, v120
 v_add_f32 v117, v117, v121
 v_fmac_f32 v119, v121, v121
 v_lshlrev_b32 v120, 16, v109
 v_and_b32 v121, s78, v109
 v_add_f32 v117, v117, v120
 v_fmac_f32 v119, v120, v120
 v_add_f32 v117, v117, v121
 v_fmac_f32 v119, v121, v121
 v_lshlrev_b32 v120, 16, v110
 v_and_b32 v121, s78, v110
 v_add_f32 v117, v117, v120
 v_fmac_f32 v119, v120, v120
 v_add_f32 v117, v117, v121
 v_fmac_f32 v119, v121, v121
 v_lshlrev_b32 v120, 16, v111
 v_and_b32 v121, s78, v111
 v_add_f32 v117, v117, v120
 v_fmac_f32 v119, v120, v120
 v_add_f32 v117, v117, v121
 v_fmac_f32 v119, v121, v121
 s_nop 0
 v_permlane16_swap_b32 v116, v117
 v_permlane16_swap_b32 v118, v119
 v_add_f32 v116, v116, v117
 v_add_f32 v118, v118, v119
 s_nop 1
 v_permlane32_swap_b32 v116, v118
 v_add_f32 v116, v116, v118
 s_add_u32 s69, s51, 0x3800000
 v_and_b32 v60, 15, v0
 v_lshlrev_b32 v60, 4, v60
 v_lshrrev_b32 v61, 4, v0
 v_lshl_add_u32 v60, v61, 2, v60
 buffer_store_dword v116, v60, s[4:7], s69 offen sc1
 s_mov_b32 s16, s88
 s_mov_b32 s17, s89
 s_mov_b32 s18, 0x700000
 s_mov_b32 s19, 0x00020000
 s_lshr_b32 s66, s38, 1
 s_and_b32 s67, s38, 1
 s_mul_i32 s67, s67, 7
 s_lshl_b32 s68, s66, 14
 s_lshl_b32 s69, s67, 10
 s_add_u32 s68, s68, s69
 s_add_u32 s68, s68, 0x1c000
 s_lshl_b32 s67, s67, 6
 s_mul_i32 s65, s36, 458752
 s_mul_i32 s69, s37, 224
 s_add_u32 s65, s65, s69
 s_cmp_eq_u32 s66, 0
 s_cselect_b32 s69, 3584, 0
 s_add_u32 s65, s65, s69
 v_add_u32 v122, s67, v0
 v_add_u32 v122, 0, v122
 v_mul_u32_u24 v123, 4682, v122
 v_lshrrev_b32 v123, 16, v123
 v_lshlrev_b32 v122, 4, v122
 v_mul_u32_u24 v123, 6944, v123
 v_add_u32 v122, v122, v123
 s_add_u32 m0, s68, 0
 s_nop 0
 buffer_load_dwordx4 v122, s[16:19], s65 offen lds
 v_add_u32 v122, s67, v0
 v_add_u32 v122, 64, v122
 v_mul_u32_u24 v123, 4682, v122
 v_lshrrev_b32 v123, 16, v123
 v_lshlrev_b32 v122, 4, v122
 v_mul_u32_u24 v123, 6944, v123
 v_add_u32 v122, v122, v123
 s_add_u32 m0, s68, 1024
 s_nop 0
 buffer_load_dwordx4 v122, s[16:19], s65 offen lds
 v_add_u32 v122, s67, v0
 v_add_u32 v122, 128, v122
 v_mul_u32_u24 v123, 4682, v122
 v_lshrrev_b32 v123, 16, v123
 v_lshlrev_b32 v122, 4, v122
 v_mul_u32_u24 v123, 6944, v123
 v_add_u32 v122, v122, v123
 s_add_u32 m0, s68, 2048
 s_nop 0
 buffer_load_dwordx4 v122, s[16:19], s65 offen lds
 v_add_u32 v122, s67, v0
 v_add_u32 v122, 192, v122
 v_mul_u32_u24 v123, 4682, v122
 v_lshrrev_b32 v123, 16, v123
 v_lshlrev_b32 v122, 4, v122
 v_mul_u32_u24 v123, 6944, v123
 v_add_u32 v122, v122, v123
 s_add_u32 m0, s68, 3072
 s_nop 0
 buffer_load_dwordx4 v122, s[16:19], s65 offen lds
 v_add_u32 v122, s67, v0
 v_add_u32 v122, 256, v122
 v_mul_u32_u24 v123, 4682, v122
 v_lshrrev_b32 v123, 16, v123
 v_lshlrev_b32 v122, 4, v122
 v_mul_u32_u24 v123, 6944, v123
 v_add_u32 v122, v122, v123
 s_add_u32 m0, s68, 4096
 s_nop 0
 buffer_load_dwordx4 v122, s[16:19], s65 offen lds
 v_add_u32 v122, s67, v0
 v_add_u32 v122, 320, v122
 v_mul_u32_u24 v123, 4682, v122
 v_lshrrev_b32 v123, 16, v123
 v_lshlrev_b32 v122, 4, v122
 v_mul_u32_u24 v123, 6944, v123
 v_add_u32 v122, v122, v123
 s_add_u32 m0, s68, 5120
 s_nop 0
 buffer_load_dwordx4 v122, s[16:19], s65 offen lds
 v_add_u32 v122, s67, v0
 v_add_u32 v122, 384, v122
 v_mul_u32_u24 v123, 4682, v122
 v_lshrrev_b32 v123, 16, v123
 v_lshlrev_b32 v122, 4, v122
 v_mul_u32_u24 v123, 6944, v123
 v_add_u32 v122, v122, v123
 s_add_u32 m0, s68, 6144
 s_nop 0
 buffer_load_dwordx4 v122, s[16:19], s65 offen lds
 s_mov_b32 s12, s86
 s_mov_b32 s13, s87
 s_mov_b32 s14, 0x200000
 s_mov_b32 s15, 0x00020000
 s_mov_b32 s20, s90
 s_mov_b32 s21, s91
 s_mov_b32 s22, 0x800000
 s_mov_b32 s23, 0x00020000
 s_mov_b32 s32, s92
 s_mov_b32 s33, s93
 s_mov_b32 s34, 0x1000
 s_mov_b32 s35, 0x00020000
 s_mov_b32 s24, s94
 s_mov_b32 s25, s95
 s_mov_b32 s26, 0x380000
 s_mov_b32 s27, 0x00020000
 s_mul_i32 s67, s36, 1
 s_add_u32 s69, s37, s67
 s_and_b32 s69, s69, 3
 s_mov_b32 s84, 0x65832140
 s_mov_b32 s85, 0xfedba9c7
 s_mov_b32 s86, 0x87614320
 s_mov_b32 s87, 0xfed9cba5
 s_cmp_eq_u32 s69, 1
 s_cselect_b32 s84, 0x69432501, s84
 s_cselect_b32 s85, 0xfecbad87, s85
 s_cselect_b32 s86, 0x87254301, s86
 s_cselect_b32 s87, 0xfeadcb69, s87
 s_cmp_eq_u32 s69, 2
 s_cselect_b32 s84, 0xa5436102, s84
 s_cselect_b32 s85, 0xfdcbe987, s85
 s_cselect_b32 s86, 0x83654021, s86
 s_cselect_b32 s87, 0xfbedc7a9, s87
 s_cmp_eq_u32 s69, 3
 s_cselect_b32 s84, 0x65472103, s84
 s_cselect_b32 s85, 0xedcfa98b, s85
 s_cselect_b32 s86, 0x47650321, s86
 s_cselect_b32 s87, 0xcfed8ba9, s87
 s_lshl_b32 s68, s37, 2
 s_lshr_b64 s[66:67], s[86:87], s68
 s_and_b32 s68, s66, 15
 s_lshl_b32 s68, s68, 2
 s_lshl_b64 s[66:67], -1, s68
 s_andn2_b64 s[80:81], s[84:85], s[66:67]
 s_lshl_b64 s[66:67], s[66:67], 4
 s_and_b64 s[84:85], s[84:85], s[66:67]
 s_lshl_b64 s[80:81], s[80:81], 4
 s_or_b64 s[84:85], s[84:85], s[80:81]
 s_or_b32 s84, s84, s37
 s_lshr_b32 s67, s38, 1
 s_lshl_b32 s67, s67, 2
 s_lshr_b64 s[86:87], s[84:85], s67
 v_and_b32 v59, 15, v0
 v_lshlrev_b32 v59, 1, v59
 s_lshl_b32 s68, s39, 6
 buffer_load_ushort v56, v59, s[32:35], s68 offen offset:0
 buffer_load_ushort v57, v59, s[32:35], s68 offen offset:32
 s_load_dwordx2 s[28:29], s[0:1], 64
 s_waitcnt lgkmcnt(0)
 s_mul_i32 s96, s96, 0x9e3779b1
 s_add_u32 s96, s96, 0x7f4a7c15
 v_mov_b32 v115, s96
 s_waitcnt vmcnt(9)
 s_add_u32 s69, s51, 0xc200000
 buffer_store_dword v115, v2, s[4:7], s69 offen sc1
 v_lshrrev_b32 v226, 2, v0
 v_lshlrev_b32 v226, 7, v226
 v_bfe_u32 v227, v0, 3, 2
 v_lshl_add_u32 v226, v227, 5, v226
 v_and_b32 v227, 3, v0
 v_lshl_add_u32 v19, v227, 3, v226
 v_xor_b32 v20, 32, v19
 v_xor_b32 v21, 64, v19
 v_xor_b32 v22, 96, v19
 s_mov_b32 s41, 0
 s_mov_b32 s94, 0xffff
 s_mov_b32 s95, 0xffff
 s_mov_b32 s93, 1
 s_mul_i32 s66, s37, 917504
 s_add_u32 m0, s60, 0x0
 s_bfe_u32 s65, s84, 0x40000
 s_mul_i32 s65, s65, 0x60000
 s_add_u32 s65, s65, s61
 buffer_load_dwordx4 v3, s[8:11], s65 offen offset:0  lds
 s_mul_i32 s67, s39, 14336
 s_add_u32 s44, s66, s67
 s_lshl_b32 s67, s38, 13
 s_add_u32 s45, s66, s67
 s_add_u32 s40, s45, 0x9000000
 s_add_u32 s45, s45, 0x1800000
 s_lshl_b32 s66, s37, 2
 s_add_u32 s66, s66, s38
 s_lshl_b32 s47, s66, 15
 s_lshl_b32 s67, s36, 11
 s_add_u32 s46, s47, s67
 s_lshl_b32 s49, s66, 12
 s_lshl_b32 s67, s36, 8
 s_add_u32 s48, s49, s67
 buffer_load_dwordx4 v4, s[8:11], s65 offen offset:1024  lds
 s_lshr_b32 s66, s38, 1
 s_lshl_b32 s63, s66, 17
 s_mov_b32 s70, 0x358637bd
 s_mov_b32 s71, 0x358637bd
 s_mov_b32 s72, 0x3fb8aa3b
 s_mov_b32 s73, 0x3fb8aa3b
 s_mov_b32 s74, 0x3f800000
 s_mov_b32 s75, 0x3f800000
 s_mov_b32 s76, 0xffff
 s_mov_b32 s77, 0
 s_lshl_b32 s66, s39, 17
 v_lshrrev_b32 v226, 1, v224
 v_add_u32 v226, 0, v226
 v_and_b32 v226, 7, v226
 buffer_load_dwordx4 v5, s[8:11], s65 offen offset:2048  lds
 v_xor_b32 v226, v226, v225
 v_lshlrev_b32 v227, 12, v224
 v_lshl_add_u32 v227, v226, 4, v227
 v_add_u32 v227, 0x0, v227
 v_add_u32 v15, s66, v227
 v_lshrrev_b32 v226, 1, v224
 v_add_u32 v226, 4, v226
 v_and_b32 v226, 7, v226
 v_xor_b32 v226, v226, v225
 v_lshlrev_b32 v227, 12, v224
 v_lshl_add_u32 v227, v226, 4, v227
 v_add_u32 v227, 0x7c00, v227
 v_add_u32 v16, s66, v227
 v_lshrrev_b32 v226, 1, v224
 buffer_load_dwordx4 v6, s[8:11], s65 offen offset:3072  lds
 v_add_u32 v226, 8, v226
 v_and_b32 v226, 7, v226
 v_xor_b32 v226, v226, v225
 v_lshlrev_b32 v227, 12, v224
 v_lshl_add_u32 v227, v226, 4, v227
 v_add_u32 v227, 0xf800, v227
 v_add_u32 v17, s66, v227
 v_lshrrev_b32 v226, 1, v224
 v_add_u32 v226, 12, v226
 v_and_b32 v226, 7, v226
 v_xor_b32 v226, v226, v225
 v_lshlrev_b32 v227, 12, v224
 v_lshl_add_u32 v227, v226, 4, v227
 v_add_u32 v227, 0x17400, v227
 s_add_u32 m0, s60, 0x4000
 s_bfe_u32 s65, s84, 0x40004
 s_mul_i32 s65, s65, 0x60000
 s_add_u32 s65, s65, s61
 buffer_load_dwordx4 v3, s[8:11], s65 offen offset:0  lds
 v_add_u32 v18, s66, v227
 v_lshrrev_b32 v226, 5, v0
 v_lshlrev_b32 v226, 9, v226
 v_bfe_u32 v227, v0, 4, 1
 v_lshl_add_u32 v226, v227, 7, v226
 v_bfe_u32 v227, v0, 1, 1
 v_lshl_add_u32 v226, v227, 6, v226
 v_bfe_u32 v227, v0, 2, 2
 v_lshl_add_u32 v226, v227, 4, v226
 v_and_b32 v227, 1, v0
 v_lshl_add_u32 v31, v227, 3, v226
 v_and_b32 v226, 15, v0
 v_bfe_u32 v227, v0, 1, 3
 v_lshrrev_b32 v228, 4, v0
 buffer_load_dwordx4 v4, s[8:11], s65 offen offset:1024  lds
 v_xor_b32 v227, v227, v228
 v_lshlrev_b32 v226, 7, v226
 v_lshl_add_u32 v226, v227, 4, v226
 v_add_u32 v34, s60, v226
 v_xor_b32 v35, 64, v34
 v_add_u32 v23, 0x10000, v19
 v_add_u32 v24, 0x10000, v20
 v_add_u32 v25, 0x10000, v21
 v_add_u32 v26, 0x10000, v22
 v_add_u32 v32, 0x10000, v31
 v_add_u32 v36, 0x10000, v34
 v_add_u32 v37, 0x10000, v35
 v_add_u32 v27, 0x20000, v19
 v_add_u32 v28, 0x20000, v20
 buffer_load_dwordx4 v5, s[8:11], s65 offen offset:2048  lds
 v_add_u32 v29, 0x20000, v21
 v_add_u32 v30, 0x20000, v22
 v_add_u32 v33, 0x20000, v31
 v_add_u32 v38, 0x20000, v34
 v_add_u32 v39, 0x20000, v35
 v_mov_b32 v50, 0
 v_mov_b32 v51, 0
 v_mov_b32 v54, 0
 v_mov_b32 v55, 0
 v_mov_b32 v216, 0
 s_sub_u32 s66, 2, s38
 s_and_b32 s66, s66, 0x7fff0000
 v_add_u32 v252, 0x400, v11
 s_add_u32 s67, s66, 2048
 buffer_load_dwordx4 v6, s[8:11], s65 offen offset:3072  lds
 v_add_u32 v253, s67, v11
 s_add_u32 s67, s66, 3072
 v_add_u32 v254, s67, v11
 s_and_b32 s66, s38, 1
 s_mul_i32 s66, s66, 0x7fff0000
 s_add_u32 s66, s66, 3072
 v_add_u32 v251, s66, v11
 v_add_u32 v250, 0x800, v11
 v_add_u32 v12, 0x10000, v1
 v_add_u32 v13, 0x20000, v1
 s_lshr_b32 s66, s37, 1
 s_mul_i32 s66, s66, 7
 s_and_b32 s67, s37, 1
 s_lshl_b32 s67, s67, 2
 s_add_u32 m0, s60, 0x8000
 s_bfe_u32 s65, s84, 0x40008
 s_mul_i32 s65, s65, 0x60000
 s_add_u32 s65, s65, s61
 buffer_load_dwordx4 v3, s[8:11], s65 offen offset:0  lds
 s_add_u32 s67, s67, s66
 s_add_u32 s68, s67, 0
 s_lshr_b32 s69, s68, 1
 s_lshl_b32 s69, s69, 19
 s_and_b32 s68, s68, 1
 s_lshl_b32 s68, s68, 12
 s_add_u32 s69, s69, s68
 s_add_u32 s69, s69, s3
 s_add_u32 s50, s69, 0x2800000
 s_add_u32 s68, s67, 1
 s_lshr_b32 s69, s68, 1
 s_lshl_b32 s69, s69, 19
 s_and_b32 s68, s68, 1
 s_lshl_b32 s68, s68, 12
 buffer_load_dwordx4 v4, s[8:11], s65 offen offset:1024  lds
 s_add_u32 s69, s69, s68
 s_add_u32 s69, s69, s3
 s_add_u32 s52, s69, 0x2800000
 s_add_u32 s68, s67, 2
 s_lshr_b32 s69, s68, 1
 s_lshl_b32 s69, s69, 19
 s_and_b32 s68, s68, 1
 s_lshl_b32 s68, s68, 12
 s_add_u32 s69, s69, s68
 s_add_u32 s69, s69, s3
 s_add_u32 s98, s69, 0x2800000
 s_add_u32 s68, s66, 3
 s_lshr_b32 s69, s68, 1
 s_lshl_b32 s69, s69, 19
 buffer_load_dwordx4 v5, s[8:11], s65 offen offset:2048  lds
 s_and_b32 s68, s68, 1
 s_lshl_b32 s68, s68, 12
 s_add_u32 s69, s69, s68
 s_add_u32 s69, s69, s3
 s_add_u32 s99, s69, 0x2800000
 s_and_b32 s67, s37, 1
 s_lshl_b32 s67, s67, 11
 s_add_u32 s99, s99, s67
 buffer_load_dwordx4 v6, s[8:11], s65 offen offset:3072  lds
 v_mov_b32 v124, 0x3f803f80
 v_mov_b32 v125, 0x3f803f80
 v_mov_b32 v126, 0x3f803f80
 v_mov_b32 v127, 0x3f803f80
 s_lshl_b32 s66, s38, 5
 v_xor_b32 v114, s66, v19
 v_add_u32 v114, 0x14000, v114
 s_barrier
 ds_read_b64_tr_b16 v[64:65], v114 offset:0
 ds_read_b64_tr_b16 v[66:67], v114 offset:2048
 ds_read_b64_tr_b16 v[68:69], v114 offset:4096
 ds_read_b64_tr_b16 v[70:71], v114 offset:6144
 ds_read_b64_tr_b16 v[72:73], v114 offset:8192
 ds_read_b64_tr_b16 v[74:75], v114 offset:10240
 ds_read_b64_tr_b16 v[76:77], v114 offset:12288
 ds_read_b64_tr_b16 v[78:79], v114 offset:14336
 ds_read_b64_tr_b16 v[80:81], v114 offset:16384
 ds_read_b64_tr_b16 v[82:83], v114 offset:18432
 ds_read_b64_tr_b16 v[84:85], v114 offset:20480
 ds_read_b64_tr_b16 v[86:87], v114 offset:22528
 s_waitcnt lgkmcnt(8)
 v_mfma_f32_16x16x32_bf16 v[160:163], v[124:127], v[64:67], 0
 v_mfma_f32_16x16x32_bf16 v[160:163], v[124:127], v[68:71], v[160:163]
 s_waitcnt lgkmcnt(4)
 v_mfma_f32_16x16x32_bf16 v[164:167], v[124:127], v[72:75], 0
 v_mfma_f32_16x16x32_bf16 v[164:167], v[124:127], v[76:79], v[164:167]
 s_waitcnt lgkmcnt(0)
 v_mfma_f32_16x16x32_bf16 v[168:171], v[124:127], v[80:83], 0
 v_mfma_f32_16x16x32_bf16 v[168:171], v[124:127], v[84:87], v[168:171]
 s_barrier
 s_waitcnt vmcnt(13)
 v_lshlrev_b32 v56, 16, v56
 v_lshlrev_b32 v57, 16, v57
 s_add_u32 s66, s4, 0xc100000
 s_addc_u32 s67, s5, 0
 s_mul_i32 s68, s39, 4352
 s_add_u32 s54, s66, s68
 s_addc_u32 s55, s67, 0
 s_add_u32 s68, s83, 278528
 s_add_u32 s56, s66, s68
 s_addc_u32 s57, s67, 0
 s_mul_i32 s68, s37, 4352
 s_add_u32 s68, s68, 557056
 s_add_u32 s58, s66, s68
 s_addc_u32 s59, s67, 0
 s_mul_i32 s67, s36, 1
 s_add_u32 s69, s37, s67
 s_and_b32 s69, s69, 3
 s_getpc_b64 s[18:19]
mk_pc2:
 s_add_u32 s18, s18, mk_top-mk_pc2
 s_addc_u32 s19, s19, 0
 s_lshr_b32 s66, s2, 3
 s_lshl_b32 s66, s66, 2
 s_add_u32 s66, s66, s38
 s_lshl_b32 s66, s66, 7
 v_mov_b32 v249, s66
 s_mov_b32 s90, 0x65832140
 s_mov_b32 s91, 0xdba9c7
 s_mov_b32 s32, 0x10004028
 s_mov_b32 s33, 0x120408
 s_cmp_eq_u32 s69, 1
 s_cselect_b32 s90, 0x69432501, s90
 s_cselect_b32 s91, 0xcbad87, s91
 s_cselect_b32 s32, 0x14204080, s32
 s_cselect_b32 s33, 0x20108, s33
 s_cmp_eq_u32 s69, 2
 s_cselect_b32 s90, 0xa5436102, s90
 s_cselect_b32 s91, 0xdcb987, s91
 s_cselect_b32 s32, 0x201084, s32
 s_cselect_b32 s33, 0x102408, s33
 s_cmp_eq_u32 s69, 3
 s_cselect_b32 s90, 0x65472103, s90
 s_cselect_b32 s91, 0xdca98b, s91
 s_cselect_b32 s32, 0x10284080, s32
 s_cselect_b32 s33, 0x100402, s33
 s_barrier
 v_mov_b32 v124, 0x3f803f80
 v_mov_b32 v125, 0x3f803f80
 v_mov_b32 v126, 0x3f803f80
 v_mov_b32 v127, 0x3f803f80
 v_lshrrev_b32 v122, 2, v0
 v_mul_u32_u24 v122, 224, v122
 v_and_b32 v123, 3, v0
 v_lshl_add_u32 v122, v123, 3, v122
 s_waitcnt lgkmcnt(0)
 s_add_u32 s66, s38, 0
 s_min_u32 s67, s66, 13
 s_cmp_ge_u32 s67, 7
 s_cselect_b32 s68, 7, 0
 s_cselect_b32 s92, 1, 0
 s_sub_u32 s67, s67, s68
 s_and_b32 s68, s37, 1
 s_add_u32 s68, s68, s67
 s_cmp_eq_u32 s68, 7
 s_cselect_b32 s68, 0, s68
 s_lshl_b32 s68, s68, 5
 s_lshl_b32 s92, s92, 14
 s_add_u32 s68, s68, s92
 s_add_u32 s68, s68, 0x1c000
 v_add_u32 v123, s68, v122
 ds_read_b64_tr_b16 v[192:193], v123 offset:0
 ds_read_b64_tr_b16 v[194:195], v123 offset:3584
 ds_read_b64_tr_b16 v[196:197], v123 offset:7168
 ds_read_b64_tr_b16 v[198:199], v123 offset:10752
 s_add_u32 s66, s38, 4
 s_min_u32 s67, s66, 13
 s_cmp_ge_u32 s67, 7
 s_cselect_b32 s68, 7, 0
 s_cselect_b32 s92, 1, 0
 s_sub_u32 s67, s67, s68
 s_and_b32 s68, s37, 1
 s_add_u32 s68, s68, s67
 s_cmp_eq_u32 s68, 7
 s_cselect_b32 s68, 0, s68
 s_lshl_b32 s68, s68, 5
 s_lshl_b32 s92, s92, 14
 s_add_u32 s68, s68, s92
 s_add_u32 s68, s68, 0x1c000
 v_add_u32 v123, s68, v122
 ds_read_b64_tr_b16 v[200:201], v123 offset:0
 ds_read_b64_tr_b16 v[202:203], v123 offset:3584
 ds_read_b64_tr_b16 v[204:205], v123 offset:7168
 ds_read_b64_tr_b16 v[206:207], v123 offset:10752
 s_add_u32 s66, s38, 8
 s_min_u32 s67, s66, 13
 s_cmp_ge_u32 s67, 7
 s_cselect_b32 s68, 7, 0
 s_cselect_b32 s92, 1, 0
 s_sub_u32 s67, s67, s68
 s_and_b32 s68, s37, 1
 s_add_u32 s68, s68, s67
 s_cmp_eq_u32 s68, 7
 s_cselect_b32 s68, 0, s68
 s_lshl_b32 s68, s68, 5
 s_lshl_b32 s92, s92, 14
 s_add_u32 s68, s68, s92
 s_add_u32 s68, s68, 0x1c000
 v_add_u32 v123, s68, v122
 ds_read_b64_tr_b16 v[208:209], v123 offset:0
 ds_read_b64_tr_b16 v[210:211], v123 offset:3584
 ds_read_b64_tr_b16 v[212:213], v123 offset:7168
 ds_read_b64_tr_b16 v[214:215], v123 offset:10752
 s_add_u32 s66, s38, 12
 s_min_u32 s67, s66, 13
 s_cmp_ge_u32 s67, 7
 s_cselect_b32 s68, 7, 0
 s_cselect_b32 s92, 1, 0
 s_sub_u32 s67, s67, s68
 s_and_b32 s68, s37, 1
 s_add_u32 s68, s68, s67
 s_cmp_eq_u32 s68, 7
 s_cselect_b32 s68, 0, s68
 s_lshl_b32 s68, s68, 5
 s_lshl_b32 s92, s92, 14
 s_add_u32 s68, s68, s92
 s_add_u32 s68, s68, 0x1c000
 v_add_u32 v123, s68, v122
 s_waitcnt lgkmcnt(8)
 ds_read_b64_tr_b16 v[216:217], v123 offset:0
 ds_read_b64_tr_b16 v[218:219], v123 offset:3584
 ds_read_b64_tr_b16 v[220:221], v123 offset:7168
 ds_read_b64_tr_b16 v[222:223], v123 offset:10752
 s_add_u32 s66, s38, 0
 s_min_u32 s67, s66, 13
 s_cmp_ge_u32 s67, 7
 s_cselect_b32 s68, 7, 0
 s_cselect_b32 s92, 1, 0
 s_sub_u32 s67, s67, s68
 s_mul_i32 s68, s92, 458752
 s_lshl_b32 s67, s67, 11
 s_add_u32 s67, s67, s68
 s_mul_i32 s68, s36, 28672
 s_add_u32 s67, s67, s68
 s_add_u32 s67, s67, s40
 s_sub_u32 s67, s67, s60
 s_sub_u32 s67, s67, s60
 s_cmp_lt_u32 s66, 14
 s_cselect_b32 s67, s67, 0x7ff00000
 s_add_u32 s68, s67, 14336
 s_waitcnt lgkmcnt(12)
 v_mfma_f32_16x16x32_bf16 v[172:175], v[124:127], v[192:195], 0
 buffer_store_dwordx4 v[192:195], v11, s[4:7], s67 offen sc1
 v_mfma_f32_16x16x32_bf16 v[172:175], v[124:127], v[196:199], v[172:175]
 buffer_store_dwordx4 v[196:199], v11, s[4:7], s68 offen sc1
 s_add_u32 s66, s38, 4
 s_min_u32 s67, s66, 13
 s_cmp_ge_u32 s67, 7
 s_cselect_b32 s68, 7, 0
 s_cselect_b32 s92, 1, 0
 s_sub_u32 s67, s67, s68
 s_mul_i32 s68, s92, 458752
 s_lshl_b32 s67, s67, 11
 s_add_u32 s67, s67, s68
 s_mul_i32 s68, s36, 28672
 s_add_u32 s67, s67, s68
 s_add_u32 s67, s67, s40
 s_sub_u32 s67, s67, s60
 s_sub_u32 s67, s67, s60
 s_cmp_lt_u32 s66, 14
 s_cselect_b32 s67, s67, 0x7ff00000
 s_add_u32 s68, s67, 14336
 s_waitcnt lgkmcnt(8)
 v_mfma_f32_16x16x32_bf16 v[176:179], v[124:127], v[200:203], 0
 buffer_store_dwordx4 v[200:203], v11, s[4:7], s67 offen sc1
 v_mfma_f32_16x16x32_bf16 v[176:179], v[124:127], v[204:207], v[176:179]
 buffer_store_dwordx4 v[204:207], v11, s[4:7], s68 offen sc1
 s_add_u32 s66, s38, 8
 s_min_u32 s67, s66, 13
 s_cmp_ge_u32 s67, 7
 s_cselect_b32 s68, 7, 0
 s_cselect_b32 s92, 1, 0
 s_sub_u32 s67, s67, s68
 s_mul_i32 s68, s92, 458752
 s_lshl_b32 s67, s67, 11
 s_add_u32 s67, s67, s68
 s_mul_i32 s68, s36, 28672
 s_add_u32 s67, s67, s68
 s_add_u32 s67, s67, s40
 s_sub_u32 s67, s67, s60
 s_sub_u32 s67, s67, s60
 s_cmp_lt_u32 s66, 14
 s_cselect_b32 s67, s67, 0x7ff00000
 s_add_u32 s68, s67, 14336
 s_waitcnt lgkmcnt(4)
 v_mfma_f32_16x16x32_bf16 v[180:183], v[124:127], v[208:211], 0
 buffer_store_dwordx4 v[208:211], v11, s[4:7], s67 offen sc1
 v_mfma_f32_16x16x32_bf16 v[180:183], v[124:127], v[212:215], v[180:183]
 buffer_store_dwordx4 v[212:215], v11, s[4:7], s68 offen sc1
 s_add_u32 s66, s38, 12
 s_min_u32 s67, s66, 13
 s_cmp_ge_u32 s67, 7
 s_cselect_b32 s68, 7, 0
 s_cselect_b32 s92, 1, 0
 s_sub_u32 s67, s67, s68
 s_mul_i32 s68, s92, 458752
 s_lshl_b32 s67, s67, 11
 s_add_u32 s67, s67, s68
 s_mul_i32 s68, s36, 28672
 s_add_u32 s67, s67, s68
 s_add_u32 s67, s67, s40
 s_sub_u32 s67, s67, s60
 s_sub_u32 s67, s67, s60
 s_cmp_lt_u32 s66, 14
 s_cselect_b32 s67, s67, 0x7ff00000
 s_add_u32 s68, s67, 14336
 s_waitcnt lgkmcnt(0)
 v_mfma_f32_16x16x32_bf16 v[184:187], v[124:127], v[216:219], 0
 buffer_store_dwordx4 v[216:219], v11, s[4:7], s67 offen sc1
 v_mfma_f32_16x16x32_bf16 v[184:187], v[124:127], v[220:223], v[184:187]
 buffer_store_dwordx4 v[220:223], v11, s[4:7], s68 offen sc1
 v_lshrrev_b32 v115, 4, v0
 v_lshlrev_b32 v122, 12, v115
 v_and_b32 v116, 0x3c, v2
 v_add_u32 v122, v122, v116
 s_lshl_b32 s66, s37, 15
 s_lshl_b32 s67, s36, 8
 s_add_u32 s66, s66, s67
 s_lshl_b32 s67, s38, 6
 s_add_u32 s66, s66, s67
 s_add_u32 s66, s66, 0xc000000
 v_cmp_eq_u32 vcc, 1, v115
 s_nop 1
 v_cndmask_b32 v160, v160, v164, vcc
 v_cmp_eq_u32 vcc, 2, v115
 s_nop 1
 v_cndmask_b32 v160, v160, v168, vcc
 v_cmp_eq_u32 vcc, 3, v115
 s_nop 1
 v_cndmask_b32 v160, v160, v172, vcc
 buffer_store_dword v160, v122, s[4:7], s66 offen sc1
 s_add_u32 s66, s66, 16384
 v_cmp_eq_u32 vcc, 1, v115
 s_nop 1
 v_cndmask_b32 v176, v176, v180, vcc
 v_cmp_eq_u32 vcc, 2, v115
 s_nop 1
 v_cndmask_b32 v176, v176, v184, vcc
 buffer_store_dword v176, v122, s[4:7], s66 offen sc1
 s_add_u32 s66, s66, 16384
 s_barrier
 v_and_b32 v120, 15, v0
 v_lshlrev_b32 v120, 8, v120
 s_add_u32 s92, s42, 0xc200000
 buffer_load_dword v121, v120, s[4:7], s92 offen sc1
 s_waitcnt vmcnt(0)
 s_mov_b32 s67, 0
mk_w3:
 v_cmp_ne_u32 vcc, s96, v121
 s_add_u32 s67, s67, 1
 s_cbranch_vccz mk_d4
 buffer_load_dword v121, v120, s[4:7], s92 offen sc1
 s_waitcnt vmcnt(0)
 s_cmp_lt_u32 s67, 0x8000
 s_cbranch_scc1 mk_w3
mk_d4:
 s_mov_b32 s79, 16
 s_add_u32 s17, s40, 458752
mk_top:
 s_waitcnt vmcnt(8)
 s_barrier
 ds_read_b64_tr_b16 v[64:65], v19 offset:0
 ds_read_b64_tr_b16 v[66:67], v19 offset:2048
 ds_read_b64_tr_b16 v[68:69], v20 offset:0
 ds_read_b64_tr_b16 v[70:71], v20 offset:2048
 ds_read_b64_tr_b16 v[72:73], v21 offset:0
 ds_read_b64_tr_b16 v[74:75], v21 offset:2048
 ds_read_b64_tr_b16 v[76:77], v22 offset:0
 ds_read_b64_tr_b16 v[78:79], v22 offset:2048
 ds_read_b64_tr_b16 v[80:81], v19 offset:8192
 ds_read_b64_tr_b16 v[82:83], v19 offset:10240
 ds_read_b64_tr_b16 v[84:85], v20 offset:8192
 ds_read_b64_tr_b16 v[86:87], v20 offset:10240
 ds_read_b64_tr_b16 v[88:89], v21 offset:8192
 ds_read_b64_tr_b16 v[90:91], v21 offset:10240
 s_mov_b32 s67, 0
mk_w5:
 s_waitcnt lgkmcnt(0)
 s_cmp_ge_u32 s79, 16
 s_cbranch_scc1 mk_d6
 s_mov_b32 s79, 0
 s_atomic_add s79, s[54:55], -1024 glc
 s_add_u32 s67, s67, 1
 s_cmp_lt_u32 s67, 0x8000
 s_cbranch_scc1 mk_w5
mk_d6:
 s_add_u32 s16, s3, 0x0
 s_bfe_u32 s64, s84, 0x40004
 s_mul_i32 s64, s64, 0x80000
 s_add_u32 s64, s64, s16
 buffer_load_dwordx4 a[16:19], v11, s[4:7], s64 offen offset:0 sc1
 buffer_load_dwordx4 a[20:23], v11, s[4:7], s64 offen offset:2048 sc1
 buffer_load_dwordx4 a[24:27], v14, s[4:7], s64 offen offset:0 sc1
 buffer_load_dwordx4 a[28:31], v14, s[4:7], s64 offen offset:2048 sc1
 s_bfe_u32 s64, s84, 0x40008
 s_mul_i32 s64, s64, 0x80000
 s_add_u32 s64, s64, s16
 buffer_load_dwordx4 a[32:35], v11, s[4:7], s64 offen offset:0 sc1
 buffer_load_dwordx4 a[36:39], v11, s[4:7], s64 offen offset:2048 sc1
 buffer_load_dwordx4 a[40:43], v14, s[4:7], s64 offen offset:0 sc1
 buffer_load_dwordx4 a[44:47], v14, s[4:7], s64 offen offset:2048 sc1
 v_mfma_f32_16x16x32_bf16 v[96:99], a[0:3], v[64:67], 0
 s_add_u32 m0, s60, 0xc000
 ds_read_b64_tr_b16 v[92:93], v22 offset:8192
 ds_read_b64_tr_b16 v[94:95], v22 offset:10240
 v_mfma_f32_16x16x32_bf16 v[100:103], a[4:7], v[64:67], 0
 s_bfe_u32 s65, s84, 0x4000c
 s_mul_i32 s65, s65, 0x60000
 s_add_u32 s65, s65, s61
 v_mfma_f32_16x16x32_bf16 v[104:107], a[0:3], v[68:71], 0
 ds_read_b64_tr_b16 v[64:65], v19 offset:4096
 ds_read_b64_tr_b16 v[66:67], v19 offset:6144
 v_mfma_f32_16x16x32_bf16 v[108:111], a[4:7], v[68:71], 0
 buffer_load_dwordx4 v3, s[8:11], s65 offen offset:0  lds
 v_mfma_f32_16x16x32_bf16 v[112:115], a[0:3], v[72:75], 0
 ds_read_b64_tr_b16 v[68:69], v20 offset:4096
 ds_read_b64_tr_b16 v[70:71], v20 offset:6144
 v_mfma_f32_16x16x32_bf16 v[116:119], a[4:7], v[72:75], 0
 v_mfma_f32_16x16x32_bf16 v[120:123], a[0:3], v[76:79], 0
 ds_read_b64_tr_b16 v[72:73], v21 offset:4096
 ds_read_b64_tr_b16 v[74:75], v21 offset:6144
 v_mfma_f32_16x16x32_bf16 v[124:127], a[4:7], v[76:79], 0
 buffer_load_dwordx4 v4, s[8:11], s65 offen offset:1024  lds
 v_mfma_f32_16x16x32_bf16 v[128:131], a[0:3], v[80:83], 0
 ds_read_b64_tr_b16 v[76:77], v22 offset:4096
 ds_read_b64_tr_b16 v[78:79], v22 offset:6144
 v_mfma_f32_16x16x32_bf16 v[132:135], a[4:7], v[80:83], 0
 v_mfma_f32_16x16x32_bf16 v[136:139], a[0:3], v[84:87], 0
 s_waitcnt lgkmcnt(6)
 ds_read_b64_tr_b16 v[80:81], v19 offset:12288
 ds_read_b64_tr_b16 v[82:83], v19 offset:14336
 v_mfma_f32_16x16x32_bf16 v[140:143], a[4:7], v[84:87], 0
 buffer_load_dwordx4 v5, s[8:11], s65 offen offset:2048  lds
 v_mfma_f32_16x16x32_bf16 v[144:147], a[0:3], v[88:91], 0
 ds_read_b64_tr_b16 v[84:85], v20 offset:12288
 ds_read_b64_tr_b16 v[86:87], v20 offset:14336
 v_mfma_f32_16x16x32_bf16 v[148:151], a[4:7], v[88:91], 0
 v_mfma_f32_16x16x32_bf16 v[152:155], a[0:3], v[92:95], 0
 ds_read_b64_tr_b16 v[88:89], v21 offset:12288
 ds_read_b64_tr_b16 v[90:91], v21 offset:14336
 v_mfma_f32_16x16x32_bf16 v[156:159], a[4:7], v[92:95], 0
 buffer_load_dwordx4 v6, s[8:11], s65 offen offset:3072  lds
 v_mfma_f32_16x16x32_bf16 v[96:99], a[8:11], v[64:67], v[96:99]
 s_waitcnt lgkmcnt(6)
 ds_read_b64_tr_b16 v[92:93], v22 offset:12288
 ds_read_b64_tr_b16 v[94:95], v22 offset:14336
 v_mfma_f32_16x16x32_bf16 v[100:103], a[12:15], v[64:67], v[100:103]
 s_bfe_u32 s64, s84, 0x4000c
 s_mul_i32 s64, s64, 0x80000
 s_add_u32 s64, s64, s16
 v_mfma_f32_16x16x32_bf16 v[104:107], a[8:11], v[68:71], v[104:107]
 s_waitcnt vmcnt(16)
 s_barrier
 ds_read_b64_tr_b16 v[64:65], v19 offset:16384
 ds_read_b64_tr_b16 v[66:67], v19 offset:18432
 v_mfma_f32_16x16x32_bf16 v[108:111], a[12:15], v[68:71], v[108:111]
 buffer_load_dwordx4 a[48:51], v11, s[4:7], s64 offen offset:0 sc1
 v_mfma_f32_16x16x32_bf16 v[112:115], a[8:11], v[72:75], v[112:115]
 ds_read_b64_tr_b16 v[68:69], v20 offset:16384
 ds_read_b64_tr_b16 v[70:71], v20 offset:18432
 v_mfma_f32_16x16x32_bf16 v[116:119], a[12:15], v[72:75], v[116:119]
 v_mfma_f32_16x16x32_bf16 v[120:123], a[8:11], v[76:79], v[120:123]
 s_waitcnt lgkmcnt(6)
 ds_read_b64_tr_b16 v[72:73], v21 offset:16384
 ds_read_b64_tr_b16 v[74:75], v21 offset:18432
 v_mfma_f32_16x16x32_bf16 v[124:127], a[12:15], v[76:79], v[124:127]
 buffer_load_dwordx4 a[52:55], v11, s[4:7], s64 offen offset:2048 sc1
 v_mfma_f32_16x16x32_bf16 v[128:131], a[8:11], v[80:83], v[128:131]
 ds_read_b64_tr_b16 v[76:77], v22 offset:16384
 ds_read_b64_tr_b16 v[78:79], v22 offset:18432
 v_mfma_f32_16x16x32_bf16 v[132:135], a[12:15], v[80:83], v[132:135]
 v_mfma_f32_16x16x32_bf16 v[136:139], a[8:11], v[84:87], v[136:139]
 ds_read_b64_tr_b16 v[80:81], v19 offset:24576
 ds_read_b64_tr_b16 v[82:83], v19 offset:26624
 v_mfma_f32_16x16x32_bf16 v[140:143], a[12:15], v[84:87], v[140:143]
 buffer_load_dwordx4 a[56:59], v14, s[4:7], s64 offen offset:0 sc1
 v_mfma_f32_16x16x32_bf16 v[144:147], a[8:11], v[88:91], v[144:147]
 s_waitcnt lgkmcnt(6)
 ds_read_b64_tr_b16 v[84:85], v20 offset:24576
 ds_read_b64_tr_b16 v[86:87], v20 offset:26624
 v_mfma_f32_16x16x32_bf16 v[148:151], a[12:15], v[88:91], v[148:151]
 v_mfma_f32_16x16x32_bf16 v[152:155], a[8:11], v[92:95], v[152:155]
 s_waitcnt vmcnt(13)
 ds_read_b64_tr_b16 v[88:89], v21 offset:24576
 ds_read_b64_tr_b16 v[90:91], v21 offset:26624
 v_mfma_f32_16x16x32_bf16 v[156:159], a[12:15], v[92:95], v[156:159]
 buffer_load_dwordx4 a[60:63], v14, s[4:7], s64 offen offset:2048 sc1
 v_mfma_f32_16x16x32_bf16 v[96:99], a[16:19], v[64:67], v[96:99]
 s_add_u32 m0, s60, 0x10000
 ds_read_b64_tr_b16 v[92:93], v22 offset:24576
 ds_read_b64_tr_b16 v[94:95], v22 offset:26624
 v_mfma_f32_16x16x32_bf16 v[100:103], a[20:23], v[64:67], v[100:103]
 s_bfe_u32 s65, s84, 0x40010
 s_mul_i32 s65, s65, 0x60000
 s_add_u32 s65, s65, s61
 v_mfma_f32_16x16x32_bf16 v[104:107], a[16:19], v[68:71], v[104:107]
 s_waitcnt lgkmcnt(6)
 ds_read_b64_tr_b16 v[64:65], v19 offset:20480
 ds_read_b64_tr_b16 v[66:67], v19 offset:22528
 v_mfma_f32_16x16x32_bf16 v[108:111], a[20:23], v[68:71], v[108:111]
 buffer_load_dwordx4 v3, s[8:11], s65 offen offset:0  lds
 v_mfma_f32_16x16x32_bf16 v[112:115], a[16:19], v[72:75], v[112:115]
 ds_read_b64_tr_b16 v[68:69], v20 offset:20480
 ds_read_b64_tr_b16 v[70:71], v20 offset:22528
 v_mfma_f32_16x16x32_bf16 v[116:119], a[20:23], v[72:75], v[116:119]
 v_mfma_f32_16x16x32_bf16 v[120:123], a[16:19], v[76:79], v[120:123]
 ds_read_b64_tr_b16 v[72:73], v21 offset:20480
 ds_read_b64_tr_b16 v[74:75], v21 offset:22528
 v_mfma_f32_16x16x32_bf16 v[124:127], a[20:23], v[76:79], v[124:127]
 buffer_load_dwordx4 v4, s[8:11], s65 offen offset:1024  lds
 v_mfma_f32_16x16x32_bf16 v[128:131], a[16:19], v[80:83], v[128:131]
 s_waitcnt lgkmcnt(6)
 ds_read_b64_tr_b16 v[76:77], v22 offset:20480
 ds_read_b64_tr_b16 v[78:79], v22 offset:22528
 v_mfma_f32_16x16x32_bf16 v[132:135], a[20:23], v[80:83], v[132:135]
 s_cmp_lg_u32 s41, 0
 s_cbranch_scc1 mk_c7
 s_lshl_b32 s66, s37, 14
 s_lshl_b32 s67, s39, 8
 s_add_u32 s66, s66, s67
 s_add_u32 s66, s66, 0xc240000
 v_mov_b32 v217, s96
 buffer_store_dword v217, v2, s[4:7], s66 offen sc1
 s_nop 1
mk_c7:
 v_mfma_f32_16x16x32_bf16 v[136:139], a[16:19], v[84:87], v[136:139]
 ds_read_b64_tr_b16 v[80:81], v19 offset:28672
 ds_read_b64_tr_b16 v[82:83], v19 offset:30720
 v_mfma_f32_16x16x32_bf16 v[140:143], a[20:23], v[84:87], v[140:143]
 buffer_load_dwordx4 v5, s[8:11], s65 offen offset:2048  lds
 v_mfma_f32_16x16x32_bf16 v[144:147], a[16:19], v[88:91], v[144:147]
 s_waitcnt vmcnt(15)
 ds_read_b64_tr_b16 v[84:85], v20 offset:28672
 ds_read_b64_tr_b16 v[86:87], v20 offset:30720
 v_mfma_f32_16x16x32_bf16 v[148:151], a[20:23], v[88:91], v[148:151]
 v_mfma_f32_16x16x32_bf16 v[152:155], a[16:19], v[92:95], v[152:155]
 s_waitcnt lgkmcnt(6)
 ds_read_b64_tr_b16 v[88:89], v21 offset:28672
 ds_read_b64_tr_b16 v[90:91], v21 offset:30720
 v_mfma_f32_16x16x32_bf16 v[156:159], a[20:23], v[92:95], v[156:159]
 buffer_load_dwordx4 v6, s[8:11], s65 offen offset:3072  lds
 v_mfma_f32_16x16x32_bf16 v[96:99], a[24:27], v[64:67], v[96:99]
 s_bfe_u32 s64, s84, 0x40010
 ds_read_b64_tr_b16 v[92:93], v22 offset:28672
 ds_read_b64_tr_b16 v[94:95], v22 offset:30720
 v_mfma_f32_16x16x32_bf16 v[100:103], a[28:31], v[64:67], v[100:103]
 s_mul_i32 s64, s64, 0x80000
 s_add_u32 s64, s64, s16
 v_mfma_f32_16x16x32_bf16 v[104:107], a[24:27], v[68:71], v[104:107]
 s_barrier
 ds_read_b64_tr_b16 v[64:65], v19 offset:32768
 ds_read_b64_tr_b16 v[66:67], v19 offset:34816
 v_mfma_f32_16x16x32_bf16 v[108:111], a[28:31], v[68:71], v[108:111]
 buffer_load_dwordx4 a[64:67], v11, s[4:7], s64 offen offset:0 sc1
 v_mfma_f32_16x16x32_bf16 v[112:115], a[24:27], v[72:75], v[112:115]
 s_waitcnt lgkmcnt(6)
 ds_read_b64_tr_b16 v[68:69], v20 offset:32768
 ds_read_b64_tr_b16 v[70:71], v20 offset:34816
 v_mfma_f32_16x16x32_bf16 v[116:119], a[28:31], v[72:75], v[116:119]
 v_mfma_f32_16x16x32_bf16 v[120:123], a[24:27], v[76:79], v[120:123]
 ds_read_b64_tr_b16 v[72:73], v21 offset:32768
 ds_read_b64_tr_b16 v[74:75], v21 offset:34816
 v_mfma_f32_16x16x32_bf16 v[124:127], a[28:31], v[76:79], v[124:127]
 buffer_load_dwordx4 a[68:71], v11, s[4:7], s64 offen offset:2048 sc1
 v_mfma_f32_16x16x32_bf16 v[128:131], a[24:27], v[80:83], v[128:131]
 ds_read_b64_tr_b16 v[76:77], v22 offset:32768
 ds_read_b64_tr_b16 v[78:79], v22 offset:34816
 v_mfma_f32_16x16x32_bf16 v[132:135], a[28:31], v[80:83], v[132:135]
 v_mfma_f32_16x16x32_bf16 v[136:139], a[24:27], v[84:87], v[136:139]
 s_waitcnt lgkmcnt(6)
 ds_read_b64_tr_b16 v[80:81], v19 offset:40960
 ds_read_b64_tr_b16 v[82:83], v19 offset:43008
 v_mfma_f32_16x16x32_bf16 v[140:143], a[28:31], v[84:87], v[140:143]
 buffer_load_dwordx4 a[72:75], v14, s[4:7], s64 offen offset:0 sc1
 v_mfma_f32_16x16x32_bf16 v[144:147], a[24:27], v[88:91], v[144:147]
 s_waitcnt vmcnt(17)
 ds_read_b64_tr_b16 v[84:85], v20 offset:40960
 ds_read_b64_tr_b16 v[86:87], v20 offset:43008
 v_mfma_f32_16x16x32_bf16 v[148:151], a[28:31], v[88:91], v[148:151]
 v_mfma_f32_16x16x32_bf16 v[152:155], a[24:27], v[92:95], v[152:155]
 ds_read_b64_tr_b16 v[88:89], v21 offset:40960
 ds_read_b64_tr_b16 v[90:91], v21 offset:43008
 v_mfma_f32_16x16x32_bf16 v[156:159], a[28:31], v[92:95], v[156:159]
 buffer_load_dwordx4 a[76:79], v14, s[4:7], s64 offen offset:2048 sc1
 v_mfma_f32_16x16x32_bf16 v[96:99], a[32:35], v[64:67], v[96:99]
 s_waitcnt lgkmcnt(6)
 ds_read_b64_tr_b16 v[92:93], v22 offset:40960
 ds_read_b64_tr_b16 v[94:95], v22 offset:43008
 v_mfma_f32_16x16x32_bf16 v[100:103], a[36:39], v[64:67], v[100:103]
 s_add_u32 m0, s60, 0x14000
 s_bfe_u32 s65, s84, 0x40014
 s_mul_i32 s65, s65, 0x60000
 v_mfma_f32_16x16x32_bf16 v[104:107], a[32:35], v[68:71], v[104:107]
 s_add_u32 s65, s65, s61
 ds_read_b64_tr_b16 v[64:65], v19 offset:36864
 ds_read_b64_tr_b16 v[66:67], v19 offset:38912
 v_mfma_f32_16x16x32_bf16 v[108:111], a[36:39], v[68:71], v[108:111]
 buffer_load_dwordx4 v3, s[8:11], s65 offen offset:0  lds
 v_mfma_f32_16x16x32_bf16 v[112:115], a[32:35], v[72:75], v[112:115]
 ds_read_b64_tr_b16 v[68:69], v20 offset:36864
 ds_read_b64_tr_b16 v[70:71], v20 offset:38912
 v_mfma_f32_16x16x32_bf16 v[116:119], a[36:39], v[72:75], v[116:119]
 v_mfma_f32_16x16x32_bf16 v[120:123], a[32:35], v[76:79], v[120:123]
 s_waitcnt lgkmcnt(6)
 ds_read_b64_tr_b16 v[72:73], v21 offset:36864
 ds_read_b64_tr_b16 v[74:75], v21 offset:38912
 v_mfma_f32_16x16x32_bf16 v[124:127], a[36:39], v[76:79], v[124:127]
 buffer_load_dwordx4 v4, s[8:11], s65 offen offset:1024  lds
 v_mfma_f32_16x16x32_bf16 v[128:131], a[32:35], v[80:83], v[128:131]
 ds_read_b64_tr_b16 v[76:77], v22 offset:36864
 ds_read_b64_tr_b16 v[78:79], v22 offset:38912
 v_mfma_f32_16x16x32_bf16 v[132:135], a[36:39], v[80:83], v[132:135]
 v_mfma_f32_16x16x32_bf16 v[136:139], a[32:35], v[84:87], v[136:139]
 ds_read_b64_tr_b16 v[80:81], v19 offset:45056
 ds_read_b64_tr_b16 v[82:83], v19 offset:47104
 v_mfma_f32_16x16x32_bf16 v[140:143], a[36:39], v[84:87], v[140:143]
 buffer_load_dwordx4 v5, s[8:11], s65 offen offset:2048  lds
 v_mfma_f32_16x16x32_bf16 v[144:147], a[32:35], v[88:91], v[144:147]
 s_waitcnt lgkmcnt(6)
 ds_read_b64_tr_b16 v[84:85], v20 offset:45056
 ds_read_b64_tr_b16 v[86:87], v20 offset:47104
 v_mfma_f32_16x16x32_bf16 v[148:151], a[36:39], v[88:91], v[148:151]
 v_mfma_f32_16x16x32_bf16 v[152:155], a[32:35], v[92:95], v[152:155]
 s_waitcnt vmcnt(19)
 ds_read_b64_tr_b16 v[88:89], v21 offset:45056
 ds_read_b64_tr_b16 v[90:91], v21 offset:47104
 v_mfma_f32_16x16x32_bf16 v[156:159], a[36:39], v[92:95], v[156:159]
 buffer_load_dwordx4 v6, s[8:11], s65 offen offset:3072  lds
 v_mfma_f32_16x16x32_bf16 v[96:99], a[40:43], v[64:67], v[96:99]
 s_bfe_u32 s64, s84, 0x40014
 ds_read_b64_tr_b16 v[92:93], v22 offset:45056
 ds_read_b64_tr_b16 v[94:95], v22 offset:47104
 v_mfma_f32_16x16x32_bf16 v[100:103], a[44:47], v[64:67], v[100:103]
 s_mul_i32 s64, s64, 0x80000
 s_add_u32 s64, s64, s16
 v_mfma_f32_16x16x32_bf16 v[104:107], a[40:43], v[68:71], v[104:107]
 s_waitcnt lgkmcnt(6)
 s_waitcnt vmcnt(16)
 s_barrier
 ds_read_b64_tr_b16 v[64:65], v19 offset:49152
 ds_read_b64_tr_b16 v[66:67], v19 offset:51200
 v_mfma_f32_16x16x32_bf16 v[108:111], a[44:47], v[68:71], v[108:111]
 buffer_load_dwordx4 a[80:83], v11, s[4:7], s64 offen offset:0 sc1
 v_mfma_f32_16x16x32_bf16 v[112:115], a[40:43], v[72:75], v[112:115]
 ds_read_b64_tr_b16 v[68:69], v20 offset:49152
 ds_read_b64_tr_b16 v[70:71], v20 offset:51200
 v_mfma_f32_16x16x32_bf16 v[116:119], a[44:47], v[72:75], v[116:119]
 v_mfma_f32_16x16x32_bf16 v[120:123], a[40:43], v[76:79], v[120:123]
 ds_read_b64_tr_b16 v[72:73], v21 offset:49152
 ds_read_b64_tr_b16 v[74:75], v21 offset:51200
 v_mfma_f32_16x16x32_bf16 v[124:127], a[44:47], v[76:79], v[124:127]
 buffer_load_dwordx4 a[84:87], v11, s[4:7], s64 offen offset:2048 sc1
 v_mfma_f32_16x16x32_bf16 v[128:131], a[40:43], v[80:83], v[128:131]
 s_waitcnt lgkmcnt(6)
 ds_read_b64_tr_b16 v[76:77], v22 offset:49152
 ds_read_b64_tr_b16 v[78:79], v22 offset:51200
 v_mfma_f32_16x16x32_bf16 v[132:135], a[44:47], v[80:83], v[132:135]
 v_mfma_f32_16x16x32_bf16 v[136:139], a[40:43], v[84:87], v[136:139]
 ds_read_b64_tr_b16 v[80:81], v19 offset:57344
 ds_read_b64_tr_b16 v[82:83], v19 offset:59392
 v_mfma_f32_16x16x32_bf16 v[140:143], a[44:47], v[84:87], v[140:143]
 buffer_load_dwordx4 a[88:91], v14, s[4:7], s64 offen offset:0 sc1
 v_mfma_f32_16x16x32_bf16 v[144:147], a[40:43], v[88:91], v[144:147]
 s_waitcnt vmcnt(17)
 ds_read_b64_tr_b16 v[84:85], v20 offset:57344
 ds_read_b64_tr_b16 v[86:87], v20 offset:59392
 v_mfma_f32_16x16x32_bf16 v[148:151], a[44:47], v[88:91], v[148:151]
 v_mfma_f32_16x16x32_bf16 v[152:155], a[40:43], v[92:95], v[152:155]
 s_waitcnt lgkmcnt(6)
 ds_read_b64_tr_b16 v[88:89], v21 offset:57344
 ds_read_b64_tr_b16 v[90:91], v21 offset:59392
 v_mfma_f32_16x16x32_bf16 v[156:159], a[44:47], v[92:95], v[156:159]
 buffer_load_dwordx4 a[92:95], v14, s[4:7], s64 offen offset:2048 sc1
 v_mfma_f32_16x16x32_bf16 v[96:99], a[48:51], v[64:67], v[96:99]
 s_add_u32 m0, s60, 0x18000
 ds_read_b64_tr_b16 v[92:93], v22 offset:57344
 ds_read_b64_tr_b16 v[94:95], v22 offset:59392
 v_mfma_f32_16x16x32_bf16 v[100:103], a[52:55], v[64:67], v[100:103]
 s_bfe_u32 s65, s84, 0x40018
 s_mul_i32 s65, s65, 0x60000
 s_add_u32 s65, s65, s61
 v_mfma_f32_16x16x32_bf16 v[104:107], a[48:51], v[68:71], v[104:107]
 ds_read_b64_tr_b16 v[64:65], v19 offset:53248
 ds_read_b64_tr_b16 v[66:67], v19 offset:55296
 v_mfma_f32_16x16x32_bf16 v[108:111], a[52:55], v[68:71], v[108:111]
 buffer_load_dwordx4 v3, s[8:11], s65 offen offset:0  lds
 v_mfma_f32_16x16x32_bf16 v[112:115], a[48:51], v[72:75], v[112:115]
 s_waitcnt lgkmcnt(6)
 ds_read_b64_tr_b16 v[68:69], v20 offset:53248
 ds_read_b64_tr_b16 v[70:71], v20 offset:55296
 v_mfma_f32_16x16x32_bf16 v[116:119], a[52:55], v[72:75], v[116:119]
 v_mfma_f32_16x16x32_bf16 v[120:123], a[48:51], v[76:79], v[120:123]
 ds_read_b64_tr_b16 v[72:73], v21 offset:53248
 ds_read_b64_tr_b16 v[74:75], v21 offset:55296
 v_mfma_f32_16x16x32_bf16 v[124:127], a[52:55], v[76:79], v[124:127]
 buffer_load_dwordx4 v4, s[8:11], s65 offen offset:1024  lds
 v_mfma_f32_16x16x32_bf16 v[128:131], a[48:51], v[80:83], v[128:131]
 ds_read_b64_tr_b16 v[76:77], v22 offset:53248
 ds_read_b64_tr_b16 v[78:79], v22 offset:55296
 v_mfma_f32_16x16x32_bf16 v[132:135], a[52:55], v[80:83], v[132:135]
 v_mfma_f32_16x16x32_bf16 v[136:139], a[48:51], v[84:87], v[136:139]
 s_waitcnt lgkmcnt(6)
 ds_read_b64_tr_b16 v[80:81], v19 offset:61440
 ds_read_b64_tr_b16 v[82:83], v19 offset:63488
 v_mfma_f32_16x16x32_bf16 v[140:143], a[52:55], v[84:87], v[140:143]
 buffer_load_dwordx4 v5, s[8:11], s65 offen offset:2048  lds
 v_mfma_f32_16x16x32_bf16 v[144:147], a[48:51], v[88:91], v[144:147]
 s_waitcnt vmcnt(19)
 ds_read_b64_tr_b16 v[84:85], v20 offset:61440
 ds_read_b64_tr_b16 v[86:87], v20 offset:63488
 v_mfma_f32_16x16x32_bf16 v[148:151], a[52:55], v[88:91], v[148:151]
 v_mfma_f32_16x16x32_bf16 v[152:155], a[48:51], v[92:95], v[152:155]
 ds_read_b64_tr_b16 v[88:89], v21 offset:61440
 ds_read_b64_tr_b16 v[90:91], v21 offset:63488
 v_mfma_f32_16x16x32_bf16 v[156:159], a[52:55], v[92:95], v[156:159]
 buffer_load_dwordx4 v6, s[8:11], s65 offen offset:3072  lds
 v_mfma_f32_16x16x32_bf16 v[96:99], a[56:59], v[64:67], v[96:99]
 s_waitcnt lgkmcnt(6)
 ds_read_b64_tr_b16 v[92:93], v22 offset:61440
 ds_read_b64_tr_b16 v[94:95], v22 offset:63488
 v_mfma_f32_16x16x32_bf16 v[100:103], a[60:63], v[64:67], v[100:103]
 s_bfe_u32 s64, s84, 0x40018
 s_mul_i32 s64, s64, 0x80000
 s_add_u32 s64, s64, s16
 v_mfma_f32_16x16x32_bf16 v[104:107], a[56:59], v[68:71], v[104:107]
 s_waitcnt vmcnt(16)
 s_barrier
 ds_read_b64_tr_b16 v[64:65], v23 offset:0
 ds_read_b64_tr_b16 v[66:67], v23 offset:2048
 v_mfma_f32_16x16x32_bf16 v[108:111], a[60:63], v[68:71], v[108:111]
 buffer_load_dwordx4 a[96:99], v11, s[4:7], s64 offen offset:0 sc1
 v_mfma_f32_16x16x32_bf16 v[112:115], a[56:59], v[72:75], v[112:115]
 ds_read_b64_tr_b16 v[68:69], v24 offset:0
 ds_read_b64_tr_b16 v[70:71], v24 offset:2048
 v_mfma_f32_16x16x32_bf16 v[116:119], a[60:63], v[72:75], v[116:119]
 v_mfma_f32_16x16x32_bf16 v[120:123], a[56:59], v[76:79], v[120:123]
 s_waitcnt lgkmcnt(6)
 ds_read_b64_tr_b16 v[72:73], v25 offset:0
 ds_read_b64_tr_b16 v[74:75], v25 offset:2048
 v_mfma_f32_16x16x32_bf16 v[124:127], a[60:63], v[76:79], v[124:127]
 buffer_load_dwordx4 a[100:103], v11, s[4:7], s64 offen offset:2048 sc1
 v_mfma_f32_16x16x32_bf16 v[128:131], a[56:59], v[80:83], v[128:131]
 ds_read_b64_tr_b16 v[76:77], v26 offset:0
 ds_read_b64_tr_b16 v[78:79], v26 offset:2048
 v_mfma_f32_16x16x32_bf16 v[132:135], a[60:63], v[80:83], v[132:135]
 v_add_u32 v61, mk_k1-mk_top+0, v249
 v_min_u32 v61, mk_end-mk_top, v61
 global_load_dword v255, v61, s[18:19]
 v_mfma_f32_16x16x32_bf16 v[136:139], a[56:59], v[84:87], v[136:139]
 ds_read_b64_tr_b16 v[80:81], v23 offset:8192
 ds_read_b64_tr_b16 v[82:83], v23 offset:10240
 v_mfma_f32_16x16x32_bf16 v[140:143], a[60:63], v[84:87], v[140:143]
 buffer_load_dwordx4 a[104:107], v14, s[4:7], s64 offen offset:0 sc1
 v_mfma_f32_16x16x32_bf16 v[144:147], a[56:59], v[88:91], v[144:147]
 s_waitcnt lgkmcnt(6)
 ds_read_b64_tr_b16 v[84:85], v24 offset:8192
 ds_read_b64_tr_b16 v[86:87], v24 offset:10240
 v_mfma_f32_16x16x32_bf16 v[148:151], a[60:63], v[88:91], v[148:151]
 v_mfma_f32_16x16x32_bf16 v[152:155], a[56:59], v[92:95], v[152:155]
 s_waitcnt vmcnt(18)
 ds_read_b64_tr_b16 v[88:89], v25 offset:8192
 ds_read_b64_tr_b16 v[90:91], v25 offset:10240
 v_mfma_f32_16x16x32_bf16 v[156:159], a[60:63], v[92:95], v[156:159]
 buffer_load_dwordx4 a[108:111], v14, s[4:7], s64 offen offset:2048 sc1
 v_mfma_f32_16x16x32_bf16 v[96:99], a[64:67], v[64:67], v[96:99]
 s_add_u32 m0, s60, 0x1c000
 ds_read_b64_tr_b16 v[92:93], v26 offset:8192
 ds_read_b64_tr_b16 v[94:95], v26 offset:10240
 v_mfma_f32_16x16x32_bf16 v[100:103], a[68:71], v[64:67], v[100:103]
 s_bfe_u32 s65, s84, 0x4001c
 s_mul_i32 s65, s65, 0x60000
 s_add_u32 s65, s65, s61
 v_mfma_f32_16x16x32_bf16 v[104:107], a[64:67], v[68:71], v[104:107]
 s_waitcnt lgkmcnt(6)
 ds_read_b64_tr_b16 v[64:65], v23 offset:4096
 ds_read_b64_tr_b16 v[66:67], v23 offset:6144
 v_mfma_f32_16x16x32_bf16 v[108:111], a[68:71], v[68:71], v[108:111]
 buffer_load_dwordx4 v3, s[8:11], s65 offen offset:0  lds
 v_mfma_f32_16x16x32_bf16 v[112:115], a[64:67], v[72:75], v[112:115]
 ds_read_b64_tr_b16 v[68:69], v24 offset:4096
 ds_read_b64_tr_b16 v[70:71], v24 offset:6144
 v_mfma_f32_16x16x32_bf16 v[116:119], a[68:71], v[72:75], v[116:119]
 v_mfma_f32_16x16x32_bf16 v[120:123], a[64:67], v[76:79], v[120:123]
 ds_read_b64_tr_b16 v[72:73], v25 offset:4096
 ds_read_b64_tr_b16 v[74:75], v25 offset:6144
 v_mfma_f32_16x16x32_bf16 v[124:127], a[68:71], v[76:79], v[124:127]
 buffer_load_dwordx4 v4, s[8:11], s65 offen offset:1024  lds
 v_mfma_f32_16x16x32_bf16 v[128:131], a[64:67], v[80:83], v[128:131]
 s_waitcnt lgkmcnt(6)
 ds_read_b64_tr_b16 v[76:77], v26 offset:4096
 ds_read_b64_tr_b16 v[78:79], v26 offset:6144
 v_mfma_f32_16x16x32_bf16 v[132:135], a[68:71], v[80:83], v[132:135]
 v_mfma_f32_16x16x32_bf16 v[136:139], a[64:67], v[84:87], v[136:139]
 ds_read_b64_tr_b16 v[80:81], v23 offset:12288
 ds_read_b64_tr_b16 v[82:83], v23 offset:14336
 v_mfma_f32_16x16x32_bf16 v[140:143], a[68:71], v[84:87], v[140:143]
 buffer_load_dwordx4 v5, s[8:11], s65 offen offset:2048  lds
 v_mfma_f32_16x16x32_bf16 v[144:147], a[64:67], v[88:91], v[144:147]
 s_waitcnt vmcnt(20)
 ds_read_b64_tr_b16 v[84:85], v24 offset:12288
 ds_read_b64_tr_b16 v[86:87], v24 offset:14336
 v_mfma_f32_16x16x32_bf16 v[148:151], a[68:71], v[88:91], v[148:151]
 v_mfma_f32_16x16x32_bf16 v[152:155], a[64:67], v[92:95], v[152:155]
 s_waitcnt lgkmcnt(6)
 ds_read_b64_tr_b16 v[88:89], v25 offset:12288
 ds_read_b64_tr_b16 v[90:91], v25 offset:14336
 v_mfma_f32_16x16x32_bf16 v[156:159], a[68:71], v[92:95], v[156:159]
 buffer_load_dwordx4 v6, s[8:11], s65 offen offset:3072  lds
 v_mfma_f32_16x16x32_bf16 v[96:99], a[72:75], v[64:67], v[96:99]
 s_bfe_u32 s64, s84, 0x4001c
 ds_read_b64_tr_b16 v[92:93], v26 offset:12288
 ds_read_b64_tr_b16 v[94:95], v26 offset:14336
 v_mfma_f32_16x16x32_bf16 v[100:103], a[76:79], v[64:67], v[100:103]
 s_mul_i32 s64, s64, 0x80000
 s_add_u32 s64, s64, s16
 v_mfma_f32_16x16x32_bf16 v[104:107], a[72:75], v[68:71], v[104:107]
 s_waitcnt vmcnt(17)
 s_barrier
 ds_read_b64_tr_b16 v[64:65], v23 offset:16384
 ds_read_b64_tr_b16 v[66:67], v23 offset:18432
 v_mfma_f32_16x16x32_bf16 v[108:111], a[76:79], v[68:71], v[108:111]
 buffer_load_dwordx4 a[112:115], v11, s[4:7], s64 offen offset:0 sc1
 v_mfma_f32_16x16x32_bf16 v[112:115], a[72:75], v[72:75], v[112:115]
 s_waitcnt lgkmcnt(6)
 ds_read_b64_tr_b16 v[68:69], v24 offset:16384
 ds_read_b64_tr_b16 v[70:71], v24 offset:18432
 v_mfma_f32_16x16x32_bf16 v[116:119], a[76:79], v[72:75], v[116:119]
 v_mfma_f32_16x16x32_bf16 v[120:123], a[72:75], v[76:79], v[120:123]
 ds_read_b64_tr_b16 v[72:73], v25 offset:16384
 ds_read_b64_tr_b16 v[74:75], v25 offset:18432
 v_mfma_f32_16x16x32_bf16 v[124:127], a[76:79], v[76:79], v[124:127]
 buffer_load_dwordx4 a[116:119], v11, s[4:7], s64 offen offset:2048 sc1
 v_mfma_f32_16x16x32_bf16 v[128:131], a[72:75], v[80:83], v[128:131]
 ds_read_b64_tr_b16 v[76:77], v26 offset:16384
 ds_read_b64_tr_b16 v[78:79], v26 offset:18432
 v_mfma_f32_16x16x32_bf16 v[132:135], a[76:79], v[80:83], v[132:135]
 v_mfma_f32_16x16x32_bf16 v[136:139], a[72:75], v[84:87], v[136:139]
 s_waitcnt lgkmcnt(6)
 ds_read_b64_tr_b16 v[80:81], v23 offset:24576
 ds_read_b64_tr_b16 v[82:83], v23 offset:26624
 v_mfma_f32_16x16x32_bf16 v[140:143], a[76:79], v[84:87], v[140:143]
 buffer_load_dwordx4 a[120:123], v14, s[4:7], s64 offen offset:0 sc1
 v_mfma_f32_16x16x32_bf16 v[144:147], a[72:75], v[88:91], v[144:147]
 s_waitcnt vmcnt(18)
 ds_read_b64_tr_b16 v[84:85], v24 offset:24576
 ds_read_b64_tr_b16 v[86:87], v24 offset:26624
 v_mfma_f32_16x16x32_bf16 v[148:151], a[76:79], v[88:91], v[148:151]
 v_mfma_f32_16x16x32_bf16 v[152:155], a[72:75], v[92:95], v[152:155]
 ds_read_b64_tr_b16 v[88:89], v25 offset:24576
 ds_read_b64_tr_b16 v[90:91], v25 offset:26624
 v_mfma_f32_16x16x32_bf16 v[156:159], a[76:79], v[92:95], v[156:159]
 buffer_load_dwordx4 a[124:127], v14, s[4:7], s64 offen offset:2048 sc1
 v_mfma_f32_16x16x32_bf16 v[96:99], a[80:83], v[64:67], v[96:99]
 s_waitcnt lgkmcnt(6)
 ds_read_b64_tr_b16 v[92:93], v26 offset:24576
 ds_read_b64_tr_b16 v[94:95], v26 offset:26624
 v_mfma_f32_16x16x32_bf16 v[100:103], a[84:87], v[64:67], v[100:103]
 s_add_u32 m0, s60, 0x20000
 s_bfe_u32 s65, s85, 0x40000
 s_mul_i32 s65, s65, 0x60000
 v_mfma_f32_16x16x32_bf16 v[104:107], a[80:83], v[68:71], v[104:107]
 s_add_u32 s65, s65, s61
 ds_read_b64_tr_b16 v[64:65], v23 offset:20480
 ds_read_b64_tr_b16 v[66:67], v23 offset:22528
 v_mfma_f32_16x16x32_bf16 v[108:111], a[84:87], v[68:71], v[108:111]
 buffer_load_dwordx4 v3, s[8:11], s65 offen offset:0  lds
 v_mfma_f32_16x16x32_bf16 v[112:115], a[80:83], v[72:75], v[112:115]
 ds_read_b64_tr_b16 v[68:69], v24 offset:20480
 ds_read_b64_tr_b16 v[70:71], v24 offset:22528
 v_mfma_f32_16x16x32_bf16 v[116:119], a[84:87], v[72:75], v[116:119]
 v_mfma_f32_16x16x32_bf16 v[120:123], a[80:83], v[76:79], v[120:123]
 s_waitcnt lgkmcnt(6)
 ds_read_b64_tr_b16 v[72:73], v25 offset:20480
 ds_read_b64_tr_b16 v[74:75], v25 offset:22528
 v_mfma_f32_16x16x32_bf16 v[124:127], a[84:87], v[76:79], v[124:127]
 buffer_load_dwordx4 v4, s[8:11], s65 offen offset:1024  lds
 v_mfma_f32_16x16x32_bf16 v[128:131], a[80:83], v[80:83], v[128:131]
 ds_read_b64_tr_b16 v[76:77], v26 offset:20480
 ds_read_b64_tr_b16 v[78:79], v26 offset:22528
 v_mfma_f32_16x16x32_bf16 v[132:135], a[84:87], v[80:83], v[132:135]
 v_mfma_f32_16x16x32_bf16 v[136:139], a[80:83], v[84:87], v[136:139]
 ds_read_b64_tr_b16 v[80:81], v23 offset:28672
 ds_read_b64_tr_b16 v[82:83], v23 offset:30720
 v_mfma_f32_16x16x32_bf16 v[140:143], a[84:87], v[84:87], v[140:143]
 buffer_load_dwordx4 v5, s[8:11], s65 offen offset:2048  lds
 v_mfma_f32_16x16x32_bf16 v[144:147], a[80:83], v[88:91], v[144:147]
 s_waitcnt lgkmcnt(6)
 ds_read_b64_tr_b16 v[84:85], v24 offset:28672
 ds_read_b64_tr_b16 v[86:87], v24 offset:30720
 v_mfma_f32_16x16x32_bf16 v[148:151], a[84:87], v[88:91], v[148:151]
 v_mfma_f32_16x16x32_bf16 v[152:155], a[80:83], v[92:95], v[152:155]
 s_waitcnt vmcnt(20)
 ds_read_b64_tr_b16 v[88:89], v25 offset:28672
 ds_read_b64_tr_b16 v[90:91], v25 offset:30720
 v_mfma_f32_16x16x32_bf16 v[156:159], a[84:87], v[92:95], v[156:159]
 buffer_load_dwordx4 v6, s[8:11], s65 offen offset:3072  lds
 v_mfma_f32_16x16x32_bf16 v[96:99], a[88:91], v[64:67], v[96:99]
 s_bfe_u32 s64, s85, 0x40000
 ds_read_b64_tr_b16 v[92:93], v26 offset:28672
 ds_read_b64_tr_b16 v[94:95], v26 offset:30720
 v_mfma_f32_16x16x32_bf16 v[100:103], a[92:95], v[64:67], v[100:103]
 s_mul_i32 s64, s64, 0x80000
 s_add_u32 s64, s64, s16
 v_mfma_f32_16x16x32_bf16 v[104:107], a[88:91], v[68:71], v[104:107]
 s_waitcnt lgkmcnt(6)
 s_waitcnt vmcnt(17)
 s_barrier
 ds_read_b64_tr_b16 v[64:65], v23 offset:32768
 ds_read_b64_tr_b16 v[66:67], v23 offset:34816
 v_mfma_f32_16x16x32_bf16 v[108:111], a[92:95], v[68:71], v[108:111]
 buffer_load_dwordx4 a[128:131], v11, s[4:7], s64 offen offset:0 sc1
 v_mfma_f32_16x16x32_bf16 v[112:115], a[88:91], v[72:75], v[112:115]
 ds_read_b64_tr_b16 v[68:69], v24 offset:32768
 ds_read_b64_tr_b16 v[70:71], v24 offset:34816
 v_mfma_f32_16x16x32_bf16 v[116:119], a[92:95], v[72:75], v[116:119]
 v_mfma_f32_16x16x32_bf16 v[120:123], a[88:91], v[76:79], v[120:123]
 ds_read_b64_tr_b16 v[72:73], v25 offset:32768
 ds_read_b64_tr_b16 v[74:75], v25 offset:34816
 v_mfma_f32_16x16x32_bf16 v[124:127], a[92:95], v[76:79], v[124:127]
 buffer_load_dwordx4 a[132:135], v11, s[4:7], s64 offen offset:2048 sc1
 v_mfma_f32_16x16x32_bf16 v[128:131], a[88:91], v[80:83], v[128:131]
 s_waitcnt lgkmcnt(6)
 ds_read_b64_tr_b16 v[76:77], v26 offset:32768
 ds_read_b64_tr_b16 v[78:79], v26 offset:34816
 v_mfma_f32_16x16x32_bf16 v[132:135], a[92:95], v[80:83], v[132:135]
 v_mfma_f32_16x16x32_bf16 v[136:139], a[88:91], v[84:87], v[136:139]
 ds_read_b64_tr_b16 v[80:81], v23 offset:40960
 ds_read_b64_tr_b16 v[82:83], v23 offset:43008
 v_mfma_f32_16x16x32_bf16 v[140:143], a[92:95], v[84:87], v[140:143]
 buffer_load_dwordx4 a[136:139], v14, s[4:7], s64 offen offset:0 sc1
 v_mfma_f32_16x16x32_bf16 v[144:147], a[88:91], v[88:91], v[144:147]
 s_waitcnt vmcnt(18)
 ds_read_b64_tr_b16 v[84:85], v24 offset:40960
 ds_read_b64_tr_b16 v[86:87], v24 offset:43008
 v_mfma_f32_16x16x32_bf16 v[148:151], a[92:95], v[88:91], v[148:151]
 v_mfma_f32_16x16x32_bf16 v[152:155], a[88:91], v[92:95], v[152:155]
 s_waitcnt lgkmcnt(6)
 ds_read_b64_tr_b16 v[88:89], v25 offset:40960
 ds_read_b64_tr_b16 v[90:91], v25 offset:43008
 v_mfma_f32_16x16x32_bf16 v[156:159], a[92:95], v[92:95], v[156:159]
 buffer_load_dwordx4 a[140:143], v14, s[4:7], s64 offen offset:2048 sc1
 v_mfma_f32_16x16x32_bf16 v[96:99], a[96:99], v[64:67], v[96:99]
 s_add_u32 m0, s60, 0x0
 ds_read_b64_tr_b16 v[92:93], v26 offset:40960
 ds_read_b64_tr_b16 v[94:95], v26 offset:43008
 v_mfma_f32_16x16x32_bf16 v[100:103], a[100:103], v[64:67], v[100:103]
 s_bfe_u32 s65, s85, 0x40004
 s_mul_i32 s65, s65, 0x60000
 s_add_u32 s65, s65, s61
 v_mfma_f32_16x16x32_bf16 v[104:107], a[96:99], v[68:71], v[104:107]
 ds_read_b64_tr_b16 v[64:65], v23 offset:36864
 ds_read_b64_tr_b16 v[66:67], v23 offset:38912
 v_mfma_f32_16x16x32_bf16 v[108:111], a[100:103], v[68:71], v[108:111]
 buffer_load_dwordx4 v3, s[8:11], s65 offen offset:0  lds
 v_mfma_f32_16x16x32_bf16 v[112:115], a[96:99], v[72:75], v[112:115]
 s_waitcnt lgkmcnt(6)
 ds_read_b64_tr_b16 v[68:69], v24 offset:36864
 ds_read_b64_tr_b16 v[70:71], v24 offset:38912
 v_mfma_f32_16x16x32_bf16 v[116:119], a[100:103], v[72:75], v[116:119]
 v_mfma_f32_16x16x32_bf16 v[120:123], a[96:99], v[76:79], v[120:123]
 ds_read_b64_tr_b16 v[72:73], v25 offset:36864
 ds_read_b64_tr_b16 v[74:75], v25 offset:38912
 v_mfma_f32_16x16x32_bf16 v[124:127], a[100:103], v[76:79], v[124:127]
 buffer_load_dwordx4 v4, s[8:11], s65 offen offset:1024  lds
 v_mfma_f32_16x16x32_bf16 v[128:131], a[96:99], v[80:83], v[128:131]
 ds_read_b64_tr_b16 v[76:77], v26 offset:36864
 ds_read_b64_tr_b16 v[78:79], v26 offset:38912
 v_mfma_f32_16x16x32_bf16 v[132:135], a[100:103], v[80:83], v[132:135]
 v_mfma_f32_16x16x32_bf16 v[136:139], a[96:99], v[84:87], v[136:139]
 s_waitcnt lgkmcnt(6)
 ds_read_b64_tr_b16 v[80:81], v23 offset:45056
 ds_read_b64_tr_b16 v[82:83], v23 offset:47104
 v_mfma_f32_16x16x32_bf16 v[140:143], a[100:103], v[84:87], v[140:143]
 buffer_load_dwordx4 v5, s[8:11], s65 offen offset:2048  lds
 v_mfma_f32_16x16x32_bf16 v[144:147], a[96:99], v[88:91], v[144:147]
 s_waitcnt vmcnt(19)
 ds_read_b64_tr_b16 v[84:85], v24 offset:45056
 ds_read_b64_tr_b16 v[86:87], v24 offset:47104
 v_mfma_f32_16x16x32_bf16 v[148:151], a[100:103], v[88:91], v[148:151]
 v_mfma_f32_16x16x32_bf16 v[152:155], a[96:99], v[92:95], v[152:155]
 ds_read_b64_tr_b16 v[88:89], v25 offset:45056
 ds_read_b64_tr_b16 v[90:91], v25 offset:47104
 v_mfma_f32_16x16x32_bf16 v[156:159], a[100:103], v[92:95], v[156:159]
 buffer_load_dwordx4 v6, s[8:11], s65 offen offset:3072  lds
 v_mfma_f32_16x16x32_bf16 v[96:99], a[104:107], v[64:67], v[96:99]
 s_waitcnt lgkmcnt(6)
 ds_read_b64_tr_b16 v[92:93], v26 offset:45056
 ds_read_b64_tr_b16 v[94:95], v26 offset:47104
 v_mfma_f32_16x16x32_bf16 v[100:103], a[108:111], v[64:67], v[100:103]
 s_bfe_u32 s64, s85, 0x40004
 s_mul_i32 s64, s64, 0x80000
 s_add_u32 s64, s64, s16
 v_mfma_f32_16x16x32_bf16 v[104:107], a[104:107], v[68:71], v[104:107]
 s_waitcnt vmcnt(16)
 s_barrier
 ds_read_b64_tr_b16 v[64:65], v23 offset:49152
 ds_read_b64_tr_b16 v[66:67], v23 offset:51200
 v_mfma_f32_16x16x32_bf16 v[108:111], a[108:111], v[68:71], v[108:111]
 buffer_load_dwordx4 a[144:147], v11, s[4:7], s64 offen offset:0 sc1
 v_mfma_f32_16x16x32_bf16 v[112:115], a[104:107], v[72:75], v[112:115]
 ds_read_b64_tr_b16 v[68:69], v24 offset:49152
 ds_read_b64_tr_b16 v[70:71], v24 offset:51200
 v_mfma_f32_16x16x32_bf16 v[116:119], a[108:111], v[72:75], v[116:119]
 v_mfma_f32_16x16x32_bf16 v[120:123], a[104:107], v[76:79], v[120:123]
 s_waitcnt lgkmcnt(6)
 ds_read_b64_tr_b16 v[72:73], v25 offset:49152
 ds_read_b64_tr_b16 v[74:75], v25 offset:51200
 v_mfma_f32_16x16x32_bf16 v[124:127], a[108:111], v[76:79], v[124:127]
 buffer_load_dwordx4 a[148:151], v11, s[4:7], s64 offen offset:2048 sc1
 v_mfma_f32_16x16x32_bf16 v[128:131], a[104:107], v[80:83], v[128:131]
 ds_read_b64_tr_b16 v[76:77], v26 offset:49152
 ds_read_b64_tr_b16 v[78:79], v26 offset:51200
 v_mfma_f32_16x16x32_bf16 v[132:135], a[108:111], v[80:83], v[132:135]
 v_mfma_f32_16x16x32_bf16 v[136:139], a[104:107], v[84:87], v[136:139]
 ds_read_b64_tr_b16 v[80:81], v23 offset:57344
 ds_read_b64_tr_b16 v[82:83], v23 offset:59392
 v_mfma_f32_16x16x32_bf16 v[140:143], a[108:111], v[84:87], v[140:143]
 buffer_load_dwordx4 a[152:155], v14, s[4:7], s64 offen offset:0 sc1
 v_mfma_f32_16x16x32_bf16 v[144:147], a[104:107], v[88:91], v[144:147]
 s_waitcnt lgkmcnt(6)
 ds_read_b64_tr_b16 v[84:85], v24 offset:57344
 ds_read_b64_tr_b16 v[86:87], v24 offset:59392
 v_mfma_f32_16x16x32_bf16 v[148:151], a[108:111], v[88:91], v[148:151]
 v_mfma_f32_16x16x32_bf16 v[152:155], a[104:107], v[92:95], v[152:155]
 s_waitcnt vmcnt(17)
 ds_read_b64_tr_b16 v[88:89], v25 offset:57344
 ds_read_b64_tr_b16 v[90:91], v25 offset:59392
 v_mfma_f32_16x16x32_bf16 v[156:159], a[108:111], v[92:95], v[156:159]
 buffer_load_dwordx4 a[156:159], v14, s[4:7], s64 offen offset:2048 sc1
 v_mfma_f32_16x16x32_bf16 v[96:99], a[112:115], v[64:67], v[96:99]
 s_add_u32 m0, s60, 0x4000
 ds_read_b64_tr_b16 v[92:93], v26 offset:57344
 ds_read_b64_tr_b16 v[94:95], v26 offset:59392
 v_mfma_f32_16x16x32_bf16 v[100:103], a[116:119], v[64:67], v[100:103]
 s_bfe_u32 s65, s85, 0x40008
 s_mul_i32 s65, s65, 0x60000
 s_add_u32 s65, s65, s61
 v_mfma_f32_16x16x32_bf16 v[104:107], a[112:115], v[68:71], v[104:107]
 s_waitcnt lgkmcnt(6)
 ds_read_b64_tr_b16 v[64:65], v23 offset:53248
 ds_read_b64_tr_b16 v[66:67], v23 offset:55296
 v_mfma_f32_16x16x32_bf16 v[108:111], a[116:119], v[68:71], v[108:111]
 buffer_load_dwordx4 v3, s[8:11], s65 offen offset:0  lds
 v_mfma_f32_16x16x32_bf16 v[112:115], a[112:115], v[72:75], v[112:115]
 ds_read_b64_tr_b16 v[68:69], v24 offset:53248
 ds_read_b64_tr_b16 v[70:71], v24 offset:55296
 v_mfma_f32_16x16x32_bf16 v[116:119], a[116:119], v[72:75], v[116:119]
 v_mfma_f32_16x16x32_bf16 v[120:123], a[112:115], v[76:79], v[120:123]
 ds_read_b64_tr_b16 v[72:73], v25 offset:53248
 ds_read_b64_tr_b16 v[74:75], v25 offset:55296
 v_mfma_f32_16x16x32_bf16 v[124:127], a[116:119], v[76:79], v[124:127]
 buffer_load_dwordx4 v4, s[8:11], s65 offen offset:1024  lds
 v_mfma_f32_16x16x32_bf16 v[128:131], a[112:115], v[80:83], v[128:131]
 s_waitcnt lgkmcnt(6)
 ds_read_b64_tr_b16 v[76:77], v26 offset:53248
 ds_read_b64_tr_b16 v[78:79], v26 offset:55296
 v_mfma_f32_16x16x32_bf16 v[132:135], a[116:119], v[80:83], v[132:135]
 v_mfma_f32_16x16x32_bf16 v[136:139], a[112:115], v[84:87], v[136:139]
 ds_read_b64_tr_b16 v[80:81], v23 offset:61440
 ds_read_b64_tr_b16 v[82:83], v23 offset:63488
 v_mfma_f32_16x16x32_bf16 v[140:143], a[116:119], v[84:87], v[140:143]
 buffer_load_dwordx4 v5, s[8:11], s65 offen offset:2048  lds
 v_mfma_f32_16x16x32_bf16 v[144:147], a[112:115], v[88:91], v[144:147]
 s_waitcnt vmcnt(19)
 ds_read_b64_tr_b16 v[84:85], v24 offset:61440
 ds_read_b64_tr_b16 v[86:87], v24 offset:63488
 v_mfma_f32_16x16x32_bf16 v[148:151], a[116:119], v[88:91], v[148:151]
 v_mfma_f32_16x16x32_bf16 v[152:155], a[112:115], v[92:95], v[152:155]
 s_waitcnt lgkmcnt(6)
 ds_read_b64_tr_b16 v[88:89], v25 offset:61440
 ds_read_b64_tr_b16 v[90:91], v25 offset:63488
 v_mfma_f32_16x16x32_bf16 v[156:159], a[116:119], v[92:95], v[156:159]
 buffer_load_dwordx4 v6, s[8:11], s65 offen offset:3072  lds
 v_mfma_f32_16x16x32_bf16 v[96:99], a[120:123], v[64:67], v[96:99]
 s_bfe_u32 s64, s85, 0x40008
 ds_read_b64_tr_b16 v[92:93], v26 offset:61440
 ds_read_b64_tr_b16 v[94:95], v26 offset:63488
 v_mfma_f32_16x16x32_bf16 v[100:103], a[124:127], v[64:67], v[100:103]
 s_mul_i32 s64, s64, 0x80000
 s_add_u32 s64, s64, s16
 v_mfma_f32_16x16x32_bf16 v[104:107], a[120:123], v[68:71], v[104:107]
 s_waitcnt vmcnt(16)
 s_barrier
 ds_read_b64_tr_b16 v[64:65], v27 offset:0
 ds_read_b64_tr_b16 v[66:67], v27 offset:2048
 v_mfma_f32_16x16x32_bf16 v[108:111], a[124:127], v[68:71], v[108:111]
 buffer_load_dwordx4 a[160:163], v11, s[4:7], s64 offen offset:0 sc1
 v_mfma_f32_16x16x32_bf16 v[112:115], a[120:123], v[72:75], v[112:115]
 s_waitcnt lgkmcnt(6)
 ds_read_b64_tr_b16 v[68:69], v28 offset:0
 ds_read_b64_tr_b16 v[70:71], v28 offset:2048
 v_mfma_f32_16x16x32_bf16 v[116:119], a[124:127], v[72:75], v[116:119]
 v_mfma_f32_16x16x32_bf16 v[120:123], a[120:123], v[76:79], v[120:123]
 ds_read_b64_tr_b16 v[72:73], v29 offset:0
 ds_read_b64_tr_b16 v[74:75], v29 offset:2048
 v_mfma_f32_16x16x32_bf16 v[124:127], a[124:127], v[76:79], v[124:127]
 buffer_load_dwordx4 a[164:167], v11, s[4:7], s64 offen offset:2048 sc1
 v_mfma_f32_16x16x32_bf16 v[128:131], a[120:123], v[80:83], v[128:131]
 ds_read_b64_tr_b16 v[76:77], v30 offset:0
 ds_read_b64_tr_b16 v[78:79], v30 offset:2048
 v_mfma_f32_16x16x32_bf16 v[132:135], a[124:127], v[80:83], v[132:135]
 v_mfma_f32_16x16x32_bf16 v[136:139], a[120:123], v[84:87], v[136:139]
 s_waitcnt lgkmcnt(6)
 ds_read_b64_tr_b16 v[80:81], v27 offset:8192
 ds_read_b64_tr_b16 v[82:83], v27 offset:10240
 v_mfma_f32_16x16x32_bf16 v[140:143], a[124:127], v[84:87], v[140:143]
 buffer_load_dwordx4 a[168:171], v14, s[4:7], s64 offen offset:0 sc1
 v_mfma_f32_16x16x32_bf16 v[144:147], a[120:123], v[88:91], v[144:147]
 s_waitcnt vmcnt(17)
 ds_read_b64_tr_b16 v[84:85], v28 offset:8192
 ds_read_b64_tr_b16 v[86:87], v28 offset:10240
 v_mfma_f32_16x16x32_bf16 v[148:151], a[124:127], v[88:91], v[148:151]
 v_mfma_f32_16x16x32_bf16 v[152:155], a[120:123], v[92:95], v[152:155]
 ds_read_b64_tr_b16 v[88:89], v29 offset:8192
 ds_read_b64_tr_b16 v[90:91], v29 offset:10240
 v_mfma_f32_16x16x32_bf16 v[156:159], a[124:127], v[92:95], v[156:159]
 buffer_load_dwordx4 a[172:175], v14, s[4:7], s64 offen offset:2048 sc1
 v_mfma_f32_16x16x32_bf16 v[96:99], a[128:131], v[64:67], v[96:99]
 s_waitcnt lgkmcnt(6)
 ds_read_b64_tr_b16 v[92:93], v30 offset:8192
 ds_read_b64_tr_b16 v[94:95], v30 offset:10240
 v_mfma_f32_16x16x32_bf16 v[100:103], a[132:135], v[64:67], v[100:103]
 s_add_u32 m0, s60, 0x8000
 s_bfe_u32 s65, s85, 0x4000c
 s_mul_i32 s65, s65, 0x60000
 v_mfma_f32_16x16x32_bf16 v[104:107], a[128:131], v[68:71], v[104:107]
 s_add_u32 s65, s65, s61
 ds_read_b64_tr_b16 v[64:65], v27 offset:4096
 ds_read_b64_tr_b16 v[66:67], v27 offset:6144
 v_mfma_f32_16x16x32_bf16 v[108:111], a[132:135], v[68:71], v[108:111]
 buffer_load_dwordx4 v3, s[8:11], s65 offen offset:0  lds
 v_mfma_f32_16x16x32_bf16 v[112:115], a[128:131], v[72:75], v[112:115]
 ds_read_b64_tr_b16 v[68:69], v28 offset:4096
 ds_read_b64_tr_b16 v[70:71], v28 offset:6144
 v_mfma_f32_16x16x32_bf16 v[116:119], a[132:135], v[72:75], v[116:119]
 v_mfma_f32_16x16x32_bf16 v[120:123], a[128:131], v[76:79], v[120:123]
 s_waitcnt lgkmcnt(6)
 ds_read_b64_tr_b16 v[72:73], v29 offset:4096
 ds_read_b64_tr_b16 v[74:75], v29 offset:6144
 v_mfma_f32_16x16x32_bf16 v[124:127], a[132:135], v[76:79], v[124:127]
 buffer_load_dwordx4 v4, s[8:11], s65 offen offset:1024  lds
 v_mfma_f32_16x16x32_bf16 v[128:131], a[128:131], v[80:83], v[128:131]
 ds_read_b64_tr_b16 v[76:77], v30 offset:4096
 ds_read_b64_tr_b16 v[78:79], v30 offset:6144
 v_mfma_f32_16x16x32_bf16 v[132:135], a[132:135], v[80:83], v[132:135]
 v_mfma_f32_16x16x32_bf16 v[136:139], a[128:131], v[84:87], v[136:139]
 ds_read_b64_tr_b16 v[80:81], v27 offset:12288
 ds_read_b64_tr_b16 v[82:83], v27 offset:14336
 v_mfma_f32_16x16x32_bf16 v[140:143], a[132:135], v[84:87], v[140:143]
 buffer_load_dwordx4 v5, s[8:11], s65 offen offset:2048  lds
 v_mfma_f32_16x16x32_bf16 v[144:147], a[128:131], v[88:91], v[144:147]
 s_waitcnt lgkmcnt(6)
 ds_read_b64_tr_b16 v[84:85], v28 offset:12288
 ds_read_b64_tr_b16 v[86:87], v28 offset:14336
 v_mfma_f32_16x16x32_bf16 v[148:151], a[132:135], v[88:91], v[148:151]
 v_mfma_f32_16x16x32_bf16 v[152:155], a[128:131], v[92:95], v[152:155]
 s_waitcnt vmcnt(19)
 ds_read_b64_tr_b16 v[88:89], v29 offset:12288
 ds_read_b64_tr_b16 v[90:91], v29 offset:14336
 v_mfma_f32_16x16x32_bf16 v[156:159], a[132:135], v[92:95], v[156:159]
 buffer_load_dwordx4 v6, s[8:11], s65 offen offset:3072  lds
 v_mfma_f32_16x16x32_bf16 v[96:99], a[136:139], v[64:67], v[96:99]
 s_add_u32 s69, s42, 0x3800000
 ds_read_b64_tr_b16 v[92:93], v30 offset:12288
 ds_read_b64_tr_b16 v[94:95], v30 offset:14336
 v_mfma_f32_16x16x32_bf16 v[100:103], a[140:143], v[64:67], v[100:103]
 v_mfma_f32_16x16x32_bf16 v[104:107], a[136:139], v[68:71], v[104:107]
 s_waitcnt lgkmcnt(6)
 s_waitcnt vmcnt(16)
 s_barrier
 ds_read_b64_tr_b16 v[64:65], v19 offset:0
 ds_read_b64_tr_b16 v[66:67], v19 offset:2048
 v_mfma_f32_16x16x32_bf16 v[108:111], a[140:143], v[68:71], v[108:111]
 buffer_load_dwordx4 v[224:227], v1, s[4:7], s69 offen offset:0 sc1
 v_mfma_f32_16x16x32_bf16 v[112:115], a[136:139], v[72:75], v[112:115]
 ds_read_b64_tr_b16 v[68:69], v20 offset:0
 ds_read_b64_tr_b16 v[70:71], v20 offset:2048
 v_mfma_f32_16x16x32_bf16 v[116:119], a[140:143], v[72:75], v[116:119]
 v_mfma_f32_16x16x32_bf16 v[120:123], a[136:139], v[76:79], v[120:123]
 ds_read_b64_tr_b16 v[72:73], v21 offset:0
 ds_read_b64_tr_b16 v[74:75], v21 offset:2048
 v_mfma_f32_16x16x32_bf16 v[124:127], a[140:143], v[76:79], v[124:127]
 buffer_load_dwordx4 v[228:231], v1, s[4:7], s69 offen offset:1024 sc1
 v_mfma_f32_16x16x32_bf16 v[128:131], a[136:139], v[80:83], v[128:131]
 s_waitcnt lgkmcnt(6)
 ds_read_b64_tr_b16 v[76:77], v22 offset:0
 ds_read_b64_tr_b16 v[78:79], v22 offset:2048
 v_mfma_f32_16x16x32_bf16 v[132:135], a[140:143], v[80:83], v[132:135]
 s_cmp_lg_u32 s41, 0
 s_cbranch_scc1 mk_c8
 s_lshl_b32 s92, s37, 14
 s_add_u32 s92, s92, 0xc240000
 v_lshlrev_b32 v216, 8, v0
 buffer_load_dword v217, v216, s[4:7], s92 offen sc1
 s_nop 1
mk_c8:
 v_mfma_f32_16x16x32_bf16 v[136:139], a[136:139], v[84:87], v[136:139]
 ds_read_b64_tr_b16 v[80:81], v19 offset:8192
 ds_read_b64_tr_b16 v[82:83], v19 offset:10240
 v_mfma_f32_16x16x32_bf16 v[140:143], a[140:143], v[84:87], v[140:143]
 buffer_load_dwordx4 v[232:235], v1, s[4:7], s69 offen offset:2048 sc1
 v_mfma_f32_16x16x32_bf16 v[144:147], a[136:139], v[88:91], v[144:147]
 s_waitcnt vmcnt(17)
 ds_read_b64_tr_b16 v[84:85], v20 offset:8192
 ds_read_b64_tr_b16 v[86:87], v20 offset:10240
 v_mfma_f32_16x16x32_bf16 v[148:151], a[140:143], v[88:91], v[148:151]
 v_mfma_f32_16x16x32_bf16 v[152:155], a[136:139], v[92:95], v[152:155]
 s_waitcnt lgkmcnt(6)
 ds_read_b64_tr_b16 v[88:89], v21 offset:8192
 ds_read_b64_tr_b16 v[90:91], v21 offset:10240
 v_mfma_f32_16x16x32_bf16 v[156:159], a[140:143], v[92:95], v[156:159]
 buffer_load_dwordx4 v[236:239], v1, s[4:7], s69 offen offset:3072 sc1
 v_mfma_f32_16x16x32_bf16 v[96:99], a[144:147], v[64:67], v[96:99]
 s_bfe_u32 s64, s85, 0x4000c
 ds_read_b64_tr_b16 v[92:93], v22 offset:8192
 ds_read_b64_tr_b16 v[94:95], v22 offset:10240
 v_mfma_f32_16x16x32_bf16 v[100:103], a[148:151], v[64:67], v[100:103]
 s_mul_i32 s64, s64, 0x80000
 s_add_u32 s64, s64, s16
 v_mfma_f32_16x16x32_bf16 v[104:107], a[144:147], v[68:71], v[104:107]
 ds_read_b64_tr_b16 v[64:65], v19 offset:4096
 ds_read_b64_tr_b16 v[66:67], v19 offset:6144
 v_mfma_f32_16x16x32_bf16 v[108:111], a[148:151], v[68:71], v[108:111]
 buffer_load_dwordx4 a[176:179], v11, s[4:7], s64 offen offset:0 sc1
 v_mfma_f32_16x16x32_bf16 v[112:115], a[144:147], v[72:75], v[112:115]
 s_waitcnt lgkmcnt(6)
 ds_read_b64_tr_b16 v[68:69], v20 offset:4096
 ds_read_b64_tr_b16 v[70:71], v20 offset:6144
 v_mfma_f32_16x16x32_bf16 v[116:119], a[148:151], v[72:75], v[116:119]
 v_mfma_f32_16x16x32_bf16 v[120:123], a[144:147], v[76:79], v[120:123]
 ds_read_b64_tr_b16 v[72:73], v21 offset:4096
 ds_read_b64_tr_b16 v[74:75], v21 offset:6144
 v_mfma_f32_16x16x32_bf16 v[124:127], a[148:151], v[76:79], v[124:127]
 buffer_load_dwordx4 a[180:183], v11, s[4:7], s64 offen offset:2048 sc1
 v_mfma_f32_16x16x32_bf16 v[128:131], a[144:147], v[80:83], v[128:131]
 ds_read_b64_tr_b16 v[76:77], v22 offset:4096
 ds_read_b64_tr_b16 v[78:79], v22 offset:6144
 v_mfma_f32_16x16x32_bf16 v[132:135], a[148:151], v[80:83], v[132:135]
 v_mfma_f32_16x16x32_bf16 v[136:139], a[144:147], v[84:87], v[136:139]
 s_waitcnt lgkmcnt(6)
 ds_read_b64_tr_b16 v[80:81], v19 offset:12288
 ds_read_b64_tr_b16 v[82:83], v19 offset:14336
 v_mfma_f32_16x16x32_bf16 v[140:143], a[148:151], v[84:87], v[140:143]
 buffer_load_dwordx4 a[184:187], v14, s[4:7], s64 offen offset:0 sc1
 v_mfma_f32_16x16x32_bf16 v[144:147], a[144:147], v[88:91], v[144:147]
 s_waitcnt vmcnt(19)
 ds_read_b64_tr_b16 v[84:85], v20 offset:12288
 ds_read_b64_tr_b16 v[86:87], v20 offset:14336
 v_mfma_f32_16x16x32_bf16 v[148:151], a[148:151], v[88:91], v[148:151]
 v_and_b32 v58, 0x3c, v2
 v_add_u32 v58, 0x24000, v58
 v_and_b32 v202, 1, v0
 v_lshlrev_b32 v202, 4, v202
 v_mov_b32 v203, 0x3f80
 v_lshlrev_b32 v202, v202, v203
 v_bfe_u32 v203, v0, 1, 3
 v_lshrrev_b32 v204, 4, v0
 v_lshlrev_b32 v204, 1, v204
 v_cmp_eq_u32 vcc, v203, v204
 v_or_b32 v204, 1, v204
 s_nop 0
 v_cndmask_b32 v200, 0, v202, vcc
 v_cmp_eq_u32 vcc, v203, v204
 v_mov_b32 v204, v200
 v_mov_b32 v203, 0
 v_cndmask_b32 v201, 0, v202, vcc
 v_mov_b32 v202, 0
 v_mov_b32 v205, v201
 v_and_b32 v59, 0x7c, v2
 s_lshl_b32 s66, s38, 7
 s_add_u32 s66, s66, 0x24800
 v_add_u32 v59, s66, v59
 v_lshrrev_b32 v60, 4, v0
 v_lshl_add_u32 v60, v60, 4, s66
 v_mfma_f32_16x16x32_bf16 v[152:155], a[144:147], v[92:95], v[152:155]
 ds_read_b64_tr_b16 v[88:89], v21 offset:12288
 ds_read_b64_tr_b16 v[90:91], v21 offset:14336
 v_mfma_f32_16x16x32_bf16 v[156:159], a[148:151], v[92:95], v[156:159]
 buffer_load_dwordx4 a[188:191], v14, s[4:7], s64 offen offset:2048 sc1
 v_mfma_f32_16x16x32_bf16 v[96:99], a[152:155], v[64:67], v[96:99]
 s_waitcnt lgkmcnt(6)
 ds_read_b64_tr_b16 v[92:93], v22 offset:12288
 ds_read_b64_tr_b16 v[94:95], v22 offset:14336
 v_mfma_f32_16x16x32_bf16 v[100:103], a[156:159], v[64:67], v[100:103]
 s_add_u32 m0, s60, 0xc000
 s_bfe_u32 s65, s85, 0x40010
 s_mul_i32 s65, s65, 0x60000
 v_mfma_f32_16x16x32_bf16 v[104:107], a[152:155], v[68:71], v[104:107]
 s_add_u32 s65, s65, s61
 s_waitcnt vmcnt(16)
 s_barrier
 ds_read_b64_tr_b16 v[64:65], v19 offset:16384
 ds_read_b64_tr_b16 v[66:67], v19 offset:18432
 v_mfma_f32_16x16x32_bf16 v[108:111], a[156:159], v[68:71], v[108:111]
 buffer_load_dwordx4 v3, s[8:11], s65 offen offset:0  lds
 v_mfma_f32_16x16x32_bf16 v[112:115], a[152:155], v[72:75], v[112:115]
 ds_read_b64_tr_b16 v[68:69], v20 offset:16384
 ds_read_b64_tr_b16 v[70:71], v20 offset:18432
 v_mfma_f32_16x16x32_bf16 v[116:119], a[156:159], v[72:75], v[116:119]
 v_mfma_f32_16x16x32_bf16 v[120:123], a[152:155], v[76:79], v[120:123]
 s_waitcnt lgkmcnt(6)
 ds_read_b64_tr_b16 v[72:73], v21 offset:16384
 ds_read_b64_tr_b16 v[74:75], v21 offset:18432
 v_mfma_f32_16x16x32_bf16 v[124:127], a[156:159], v[76:79], v[124:127]
 buffer_load_dwordx4 v4, s[8:11], s65 offen offset:1024  lds
 v_mfma_f32_16x16x32_bf16 v[128:131], a[152:155], v[80:83], v[128:131]
 ds_read_b64_tr_b16 v[76:77], v22 offset:16384
 ds_read_b64_tr_b16 v[78:79], v22 offset:18432
 v_mfma_f32_16x16x32_bf16 v[132:135], a[156:159], v[80:83], v[132:135]
 v_mfma_f32_16x16x32_bf16 v[136:139], a[152:155], v[84:87], v[136:139]
 ds_read_b64_tr_b16 v[80:81], v19 offset:24576
 ds_read_b64_tr_b16 v[82:83], v19 offset:26624
 v_mfma_f32_16x16x32_bf16 v[140:143], a[156:159], v[84:87], v[140:143]
 buffer_load_dwordx4 v5, s[8:11], s65 offen offset:2048  lds
 v_mfma_f32_16x16x32_bf16 v[144:147], a[152:155], v[88:91], v[144:147]
 s_waitcnt lgkmcnt(6)
 ds_read_b64_tr_b16 v[84:85], v20 offset:24576
 ds_read_b64_tr_b16 v[86:87], v20 offset:26624
 v_mfma_f32_16x16x32_bf16 v[148:151], a[156:159], v[88:91], v[148:151]
 v_mfma_f32_16x16x32_bf16 v[152:155], a[152:155], v[92:95], v[152:155]
 s_waitcnt vmcnt(17)
 ds_read_b64_tr_b16 v[88:89], v21 offset:24576
 ds_read_b64_tr_b16 v[90:91], v21 offset:26624
 v_mfma_f32_16x16x32_bf16 v[156:159], a[156:159], v[92:95], v[156:159]
 buffer_load_dwordx4 v6, s[8:11], s65 offen offset:3072  lds
 v_mfma_f32_16x16x32_bf16 v[96:99], a[160:163], v[64:67], v[96:99]
 s_bfe_u32 s64, s85, 0x40010
 ds_read_b64_tr_b16 v[92:93], v22 offset:24576
 ds_read_b64_tr_b16 v[94:95], v22 offset:26624
 v_mfma_f32_16x16x32_bf16 v[100:103], a[164:167], v[64:67], v[100:103]
 s_mul_i32 s64, s64, 0x80000
 s_add_u32 s64, s64, s16
 v_mfma_f32_16x16x32_bf16 v[104:107], a[160:163], v[68:71], v[104:107]
 s_waitcnt lgkmcnt(6)
 ds_read_b64_tr_b16 v[64:65], v19 offset:20480
 ds_read_b64_tr_b16 v[66:67], v19 offset:22528
 v_mfma_f32_16x16x32_bf16 v[108:111], a[164:167], v[68:71], v[108:111]
 buffer_load_dwordx4 a[192:195], v11, s[4:7], s64 offen offset:0 sc1
 v_mfma_f32_16x16x32_bf16 v[112:115], a[160:163], v[72:75], v[112:115]
 ds_read_b64_tr_b16 v[68:69], v20 offset:20480
 ds_read_b64_tr_b16 v[70:71], v20 offset:22528
 v_mfma_f32_16x16x32_bf16 v[116:119], a[164:167], v[72:75], v[116:119]
 v_mfma_f32_16x16x32_bf16 v[120:123], a[160:163], v[76:79], v[120:123]
 ds_read_b64_tr_b16 v[72:73], v21 offset:20480
 ds_read_b64_tr_b16 v[74:75], v21 offset:22528
 v_mfma_f32_16x16x32_bf16 v[124:127], a[164:167], v[76:79], v[124:127]
 buffer_load_dwordx4 a[196:199], v11, s[4:7], s64 offen offset:2048 sc1
 v_mfma_f32_16x16x32_bf16 v[128:131], a[160:163], v[80:83], v[128:131]
 s_waitcnt lgkmcnt(6)
 ds_read_b64_tr_b16 v[76:77], v22 offset:20480
 ds_read_b64_tr_b16 v[78:79], v22 offset:22528
 v_mfma_f32_16x16x32_bf16 v[132:135], a[164:167], v[80:83], v[132:135]
 v_mfma_f32_16x16x32_bf16 v[136:139], a[160:163], v[84:87], v[136:139]
 ds_read_b64_tr_b16 v[80:81], v19 offset:28672
 ds_read_b64_tr_b16 v[82:83], v19 offset:30720
 v_mfma_f32_16x16x32_bf16 v[140:143], a[164:167], v[84:87], v[140:143]
 buffer_load_dwordx4 a[200:203], v14, s[4:7], s64 offen offset:0 sc1
 v_mfma_f32_16x16x32_bf16 v[144:147], a[160:163], v[88:91], v[144:147]
 s_waitcnt vmcnt(19)
 ds_read_b64_tr_b16 v[84:85], v20 offset:28672
 ds_read_b64_tr_b16 v[86:87], v20 offset:30720
 v_mfma_f32_16x16x32_bf16 v[148:151], a[164:167], v[88:91], v[148:151]
 v_mfma_f32_16x16x32_bf16 v[152:155], a[160:163], v[92:95], v[152:155]
 s_waitcnt lgkmcnt(6)
 ds_read_b64_tr_b16 v[88:89], v21 offset:28672
 ds_read_b64_tr_b16 v[90:91], v21 offset:30720
 v_mfma_f32_16x16x32_bf16 v[156:159], a[164:167], v[92:95], v[156:159]
 buffer_load_dwordx4 a[204:207], v14, s[4:7], s64 offen offset:2048 sc1
 v_mfma_f32_16x16x32_bf16 v[96:99], a[168:171], v[64:67], v[96:99]
 s_add_u32 m0, s60, 0x10000
 ds_read_b64_tr_b16 v[92:93], v22 offset:28672
 ds_read_b64_tr_b16 v[94:95], v22 offset:30720
 v_mfma_f32_16x16x32_bf16 v[100:103], a[172:175], v[64:67], v[100:103]
 s_bfe_u32 s65, s85, 0x40014
 s_mul_i32 s65, s65, 0x60000
 s_add_u32 s65, s65, s61
 v_mfma_f32_16x16x32_bf16 v[104:107], a[168:171], v[68:71], v[104:107]
 s_waitcnt vmcnt(16)
 s_barrier
 ds_read_b64_tr_b16 v[64:65], v19 offset:32768
 ds_read_b64_tr_b16 v[66:67], v19 offset:34816
 v_mfma_f32_16x16x32_bf16 v[108:111], a[172:175], v[68:71], v[108:111]
 buffer_load_dwordx4 v3, s[8:11], s65 offen offset:0  lds
 v_mfma_f32_16x16x32_bf16 v[112:115], a[168:171], v[72:75], v[112:115]
 s_waitcnt lgkmcnt(6)
 ds_read_b64_tr_b16 v[68:69], v20 offset:32768
 ds_read_b64_tr_b16 v[70:71], v20 offset:34816
 v_mfma_f32_16x16x32_bf16 v[116:119], a[172:175], v[72:75], v[116:119]
 s_cmp_lg_u32 s41, 0
 s_cbranch_scc1 mk_c9
 s_waitcnt vmcnt(15)
 s_mov_b32 s67, 0
mk_w10:
 v_cmp_ne_u32 vcc, s96, v217
 s_add_u32 s67, s67, 1
 s_cbranch_vccz mk_d11
 buffer_load_dword v217, v216, s[4:7], s92 offen sc1
 s_waitcnt vmcnt(0)
 s_cmp_lt_u32 s67, 0x8000
 s_cbranch_scc1 mk_w10
mk_d11:
 s_lshl_b32 s66, s37, 15
 s_add_u32 s66, s66, s60
 s_add_u32 s66, s66, 0xc000000
 buffer_load_dwordx4 v[160:163], v1, s[4:7], s66 offen offset:0 sc1
 buffer_load_dwordx4 v[164:167], v1, s[4:7], s66 offen offset:1024 sc1
 buffer_load_dwordx4 v[168:171], v1, s[4:7], s66 offen offset:2048 sc1
 buffer_load_dwordx4 v[172:175], v1, s[4:7], s66 offen offset:3072 sc1
 s_add_u32 s66, s66, 16384
 buffer_load_dwordx4 v[176:179], v1, s[4:7], s66 offen offset:0 sc1
 buffer_load_dwordx4 v[180:183], v1, s[4:7], s66 offen offset:1024 sc1
 buffer_load_dwordx4 v[184:187], v1, s[4:7], s66 offen offset:2048 sc1
 buffer_load_dwordx4 v[188:191], v1, s[4:7], s66 offen offset:3072 sc1
 s_nop 1
mk_c9:
 v_mfma_f32_16x16x32_bf16 v[120:123], a[168:171], v[76:79], v[120:123]
 ds_read_b64_tr_b16 v[72:73], v21 offset:32768
 ds_read_b64_tr_b16 v[74:75], v21 offset:34816
 v_mfma_f32_16x16x32_bf16 v[124:127], a[172:175], v[76:79], v[124:127]
 buffer_load_dwordx4 v4, s[8:11], s65 offen offset:1024  lds
 v_mfma_f32_16x16x32_bf16 v[128:131], a[168:171], v[80:83], v[128:131]
 ds_read_b64_tr_b16 v[76:77], v22 offset:32768
 ds_read_b64_tr_b16 v[78:79], v22 offset:34816
 v_mfma_f32_16x16x32_bf16 v[132:135], a[172:175], v[80:83], v[132:135]
 v_mfma_f32_16x16x32_bf16 v[136:139], a[168:171], v[84:87], v[136:139]
 s_waitcnt lgkmcnt(6)
 ds_read_b64_tr_b16 v[80:81], v19 offset:40960
 ds_read_b64_tr_b16 v[82:83], v19 offset:43008
 v_mfma_f32_16x16x32_bf16 v[140:143], a[172:175], v[84:87], v[140:143]
 buffer_load_dwordx4 v5, s[8:11], s65 offen offset:2048  lds
 v_mfma_f32_16x16x32_bf16 v[144:147], a[168:171], v[88:91], v[144:147]
 s_waitcnt vmcnt(13)
 ds_read_b64_tr_b16 v[84:85], v20 offset:40960
 ds_read_b64_tr_b16 v[86:87], v20 offset:43008
 v_mfma_f32_16x16x32_bf16 v[148:151], a[172:175], v[88:91], v[148:151]
 v_mfma_f32_16x16x32_bf16 v[152:155], a[168:171], v[92:95], v[152:155]
 ds_read_b64_tr_b16 v[88:89], v21 offset:40960
 ds_read_b64_tr_b16 v[90:91], v21 offset:43008
 v_mfma_f32_16x16x32_bf16 v[156:159], a[172:175], v[92:95], v[156:159]
 buffer_load_dwordx4 v6, s[8:11], s65 offen offset:3072  lds
 v_mfma_f32_16x16x32_bf16 v[96:99], a[176:179], v[64:67], v[96:99]
 s_waitcnt lgkmcnt(6)
 ds_read_b64_tr_b16 v[92:93], v22 offset:40960
 ds_read_b64_tr_b16 v[94:95], v22 offset:43008
 v_mfma_f32_16x16x32_bf16 v[100:103], a[180:183], v[64:67], v[100:103]
 s_bfe_u32 s64, s85, 0x40014
 s_mul_i32 s64, s64, 0x80000
 s_add_u32 s64, s64, s16
 v_mfma_f32_16x16x32_bf16 v[104:107], a[176:179], v[68:71], v[104:107]
 ds_read_b64_tr_b16 v[64:65], v19 offset:36864
 ds_read_b64_tr_b16 v[66:67], v19 offset:38912
 v_mfma_f32_16x16x32_bf16 v[108:111], a[180:183], v[68:71], v[108:111]
 buffer_load_dwordx4 a[208:211], v11, s[4:7], s64 offen offset:0 sc1
 v_mfma_f32_16x16x32_bf16 v[112:115], a[176:179], v[72:75], v[112:115]
 ds_read_b64_tr_b16 v[68:69], v20 offset:36864
 ds_read_b64_tr_b16 v[70:71], v20 offset:38912
 v_mfma_f32_16x16x32_bf16 v[116:119], a[180:183], v[72:75], v[116:119]
 v_mfma_f32_16x16x32_bf16 v[120:123], a[176:179], v[76:79], v[120:123]
 s_waitcnt lgkmcnt(6)
 ds_read_b64_tr_b16 v[72:73], v21 offset:36864
 ds_read_b64_tr_b16 v[74:75], v21 offset:38912
 v_mfma_f32_16x16x32_bf16 v[124:127], a[180:183], v[76:79], v[124:127]
 buffer_load_dwordx4 a[212:215], v11, s[4:7], s64 offen offset:2048 sc1
 v_mfma_f32_16x16x32_bf16 v[128:131], a[176:179], v[80:83], v[128:131]
 ds_read_b64_tr_b16 v[76:77], v22 offset:36864
 ds_read_b64_tr_b16 v[78:79], v22 offset:38912
 v_mfma_f32_16x16x32_bf16 v[132:135], a[180:183], v[80:83], v[132:135]
 v_mfma_f32_16x16x32_bf16 v[136:139], a[176:179], v[84:87], v[136:139]
 ds_read_b64_tr_b16 v[80:81], v19 offset:45056
 ds_read_b64_tr_b16 v[82:83], v19 offset:47104
 v_mfma_f32_16x16x32_bf16 v[140:143], a[180:183], v[84:87], v[140:143]
 buffer_load_dwordx4 a[216:219], v14, s[4:7], s64 offen offset:0 sc1
 v_mfma_f32_16x16x32_bf16 v[144:147], a[176:179], v[88:91], v[144:147]
 s_waitcnt lgkmcnt(6)
 ds_read_b64_tr_b16 v[84:85], v20 offset:45056
 ds_read_b64_tr_b16 v[86:87], v20 offset:47104
 v_mfma_f32_16x16x32_bf16 v[148:151], a[180:183], v[88:91], v[148:151]
 v_mfma_f32_16x16x32_bf16 v[152:155], a[176:179], v[92:95], v[152:155]
 s_waitcnt vmcnt(15)
 ds_read_b64_tr_b16 v[88:89], v21 offset:45056
 ds_read_b64_tr_b16 v[90:91], v21 offset:47104
 v_mfma_f32_16x16x32_bf16 v[156:159], a[180:183], v[92:95], v[156:159]
 buffer_load_dwordx4 a[220:223], v14, s[4:7], s64 offen offset:2048 sc1
 v_mfma_f32_16x16x32_bf16 v[96:99], a[184:187], v[64:67], v[96:99]
 s_add_u32 m0, s60, 0x14000
 ds_read_b64_tr_b16 v[92:93], v22 offset:45056
 ds_read_b64_tr_b16 v[94:95], v22 offset:47104
 v_mfma_f32_16x16x32_bf16 v[100:103], a[188:191], v[64:67], v[100:103]
 s_bfe_u32 s65, s85, 0x40018
 s_mul_i32 s65, s65, 0x60000
 s_add_u32 s65, s65, s61
 v_mfma_f32_16x16x32_bf16 v[104:107], a[184:187], v[68:71], v[104:107]
 s_waitcnt lgkmcnt(6)
 s_waitcnt vmcnt(12)
 s_barrier
 ds_read_b64_tr_b16 v[64:65], v19 offset:49152
 ds_read_b64_tr_b16 v[66:67], v19 offset:51200
 v_mfma_f32_16x16x32_bf16 v[108:111], a[188:191], v[68:71], v[108:111]
 buffer_load_dwordx4 v3, s[8:11], s65 offen offset:0  lds
 v_mfma_f32_16x16x32_bf16 v[112:115], a[184:187], v[72:75], v[112:115]
 ds_read_b64_tr_b16 v[68:69], v20 offset:49152
 ds_read_b64_tr_b16 v[70:71], v20 offset:51200
 v_mfma_f32_16x16x32_bf16 v[116:119], a[188:191], v[72:75], v[116:119]
 v_mfma_f32_16x16x32_bf16 v[120:123], a[184:187], v[76:79], v[120:123]
 ds_read_b64_tr_b16 v[72:73], v21 offset:49152
 ds_read_b64_tr_b16 v[74:75], v21 offset:51200
 v_mfma_f32_16x16x32_bf16 v[124:127], a[188:191], v[76:79], v[124:127]
 buffer_load_dwordx4 v4, s[8:11], s65 offen offset:1024  lds
 v_mfma_f32_16x16x32_bf16 v[128:131], a[184:187], v[80:83], v[128:131]
 s_waitcnt lgkmcnt(6)
 ds_read_b64_tr_b16 v[76:77], v22 offset:49152
 ds_read_b64_tr_b16 v[78:79], v22 offset:51200
 v_mfma_f32_16x16x32_bf16 v[132:135], a[188:191], v[80:83], v[132:135]
 v_mfma_f32_16x16x32_bf16 v[136:139], a[184:187], v[84:87], v[136:139]
 ds_read_b64_tr_b16 v[80:81], v19 offset:57344
 ds_read_b64_tr_b16 v[82:83], v19 offset:59392
 v_mfma_f32_16x16x32_bf16 v[140:143], a[188:191], v[84:87], v[140:143]
 buffer_load_dwordx4 v5, s[8:11], s65 offen offset:2048  lds
 v_mfma_f32_16x16x32_bf16 v[144:147], a[184:187], v[88:91], v[144:147]
 s_waitcnt vmcnt(13)
 ds_read_b64_tr_b16 v[84:85], v20 offset:57344
 ds_read_b64_tr_b16 v[86:87], v20 offset:59392
 v_mfma_f32_16x16x32_bf16 v[148:151], a[188:191], v[88:91], v[148:151]
 v_mfma_f32_16x16x32_bf16 v[152:155], a[184:187], v[92:95], v[152:155]
 s_waitcnt lgkmcnt(6)
 ds_read_b64_tr_b16 v[88:89], v21 offset:57344
 ds_read_b64_tr_b16 v[90:91], v21 offset:59392
 v_mfma_f32_16x16x32_bf16 v[156:159], a[188:191], v[92:95], v[156:159]
 buffer_load_dwordx4 v6, s[8:11], s65 offen offset:3072  lds
 v_mfma_f32_16x16x32_bf16 v[96:99], a[192:195], v[64:67], v[96:99]
 s_bfe_u32 s64, s85, 0x40018
 ds_read_b64_tr_b16 v[92:93], v22 offset:57344
 ds_read_b64_tr_b16 v[94:95], v22 offset:59392
 v_mfma_f32_16x16x32_bf16 v[100:103], a[196:199], v[64:67], v[100:103]
 s_mul_i32 s64, s64, 0x80000
 s_add_u32 s64, s64, s16
 v_mfma_f32_16x16x32_bf16 v[104:107], a[192:195], v[68:71], v[104:107]
 ds_read_b64_tr_b16 v[64:65], v19 offset:53248
 ds_read_b64_tr_b16 v[66:67], v19 offset:55296
 v_mfma_f32_16x16x32_bf16 v[108:111], a[196:199], v[68:71], v[108:111]
 buffer_load_dwordx4 a[224:227], v11, s[4:7], s64 offen offset:0 sc1
 v_mfma_f32_16x16x32_bf16 v[112:115], a[192:195], v[72:75], v[112:115]
 s_waitcnt lgkmcnt(6)
 ds_read_b64_tr_b16 v[68:69], v20 offset:53248
 ds_read_b64_tr_b16 v[70:71], v20 offset:55296
 v_mfma_f32_16x16x32_bf16 v[116:119], a[196:199], v[72:75], v[116:119]
 v_mfma_f32_16x16x32_bf16 v[120:123], a[192:195], v[76:79], v[120:123]
 ds_read_b64_tr_b16 v[72:73], v21 offset:53248
 ds_read_b64_tr_b16 v[74:75], v21 offset:55296
 v_mfma_f32_16x16x32_bf16 v[124:127], a[196:199], v[76:79], v[124:127]
 buffer_load_dwordx4 a[228:231], v11, s[4:7], s64 offen offset:2048 sc1
 v_mfma_f32_16x16x32_bf16 v[128:131], a[192:195], v[80:83], v[128:131]
 ds_read_b64_tr_b16 v[76:77], v22 offset:53248
 ds_read_b64_tr_b16 v[78:79], v22 offset:55296
 v_mfma_f32_16x16x32_bf16 v[132:135], a[196:199], v[80:83], v[132:135]
 v_mfma_f32_16x16x32_bf16 v[136:139], a[192:195], v[84:87], v[136:139]
 s_waitcnt lgkmcnt(6)
 ds_read_b64_tr_b16 v[80:81], v19 offset:61440
 ds_read_b64_tr_b16 v[82:83], v19 offset:63488
 v_mfma_f32_16x16x32_bf16 v[140:143], a[196:199], v[84:87], v[140:143]
 buffer_load_dwordx4 a[232:235], v14, s[4:7], s64 offen offset:0 sc1
 v_mfma_f32_16x16x32_bf16 v[144:147], a[192:195], v[88:91], v[144:147]
 s_waitcnt vmcnt(15)
 ds_read_b64_tr_b16 v[84:85], v20 offset:61440
 ds_read_b64_tr_b16 v[86:87], v20 offset:63488
 v_mfma_f32_16x16x32_bf16 v[148:151], a[196:199], v[88:91], v[148:151]
 v_mfma_f32_16x16x32_bf16 v[152:155], a[192:195], v[92:95], v[152:155]
 ds_read_b64_tr_b16 v[88:89], v21 offset:61440
 ds_read_b64_tr_b16 v[90:91], v21 offset:63488
 v_mfma_f32_16x16x32_bf16 v[156:159], a[196:199], v[92:95], v[156:159]
 buffer_load_dwordx4 a[236:239], v14, s[4:7], s64 offen offset:2048 sc1
 v_mfma_f32_16x16x32_bf16 v[96:99], a[200:203], v[64:67], v[96:99]
 s_waitcnt lgkmcnt(6)
 ds_read_b64_tr_b16 v[92:93], v22 offset:61440
 ds_read_b64_tr_b16 v[94:95], v22 offset:63488
 v_mfma_f32_16x16x32_bf16 v[100:103], a[204:207], v[64:67], v[100:103]
 s_add_u32 m0, s60, 0x18000
 s_bfe_u32 s65, s85, 0x4001c
 s_mul_i32 s65, s65, 0x60000
 v_mfma_f32_16x16x32_bf16 v[104:107], a[200:203], v[68:71], v[104:107]
 s_add_u32 s65, s65, s61
 s_waitcnt vmcnt(12)
 s_barrier
 ds_read_b64_tr_b16 v[64:65], v23 offset:0
 ds_read_b64_tr_b16 v[66:67], v23 offset:2048
 v_mfma_f32_16x16x32_bf16 v[108:111], a[204:207], v[68:71], v[108:111]
 buffer_load_dwordx4 v3, s[8:11], s65 offen offset:0  lds
 v_mfma_f32_16x16x32_bf16 v[112:115], a[200:203], v[72:75], v[112:115]
 ds_read_b64_tr_b16 v[68:69], v24 offset:0
 ds_read_b64_tr_b16 v[70:71], v24 offset:2048
 v_mfma_f32_16x16x32_bf16 v[116:119], a[204:207], v[72:75], v[116:119]
 v_mfma_f32_16x16x32_bf16 v[120:123], a[200:203], v[76:79], v[120:123]
 s_waitcnt lgkmcnt(6)
 ds_read_b64_tr_b16 v[72:73], v25 offset:0
 ds_read_b64_tr_b16 v[74:75], v25 offset:2048
 v_mfma_f32_16x16x32_bf16 v[124:127], a[204:207], v[76:79], v[124:127]
 buffer_load_dwordx4 v4, s[8:11], s65 offen offset:1024  lds
 v_mfma_f32_16x16x32_bf16 v[128:131], a[200:203], v[80:83], v[128:131]
 ds_read_b64_tr_b16 v[76:77], v26 offset:0
 ds_read_b64_tr_b16 v[78:79], v26 offset:2048
 v_mfma_f32_16x16x32_bf16 v[132:135], a[204:207], v[80:83], v[132:135]
 v_mfma_f32_16x16x32_bf16 v[136:139], a[200:203], v[84:87], v[136:139]
 ds_read_b64_tr_b16 v[80:81], v23 offset:8192
 ds_read_b64_tr_b16 v[82:83], v23 offset:10240
 v_mfma_f32_16x16x32_bf16 v[140:143], a[204:207], v[84:87], v[140:143]
 buffer_load_dwordx4 v5, s[8:11], s65 offen offset:2048  lds
 v_mfma_f32_16x16x32_bf16 v[144:147], a[200:203], v[88:91], v[144:147]
 s_waitcnt lgkmcnt(6)
 ds_read_b64_tr_b16 v[84:85], v24 offset:8192
 ds_read_b64_tr_b16 v[86:87], v24 offset:10240
 v_mfma_f32_16x16x32_bf16 v[148:151], a[204:207], v[88:91], v[148:151]
 s_cmp_lg_u32 s41, 0
 s_cbranch_scc1 mk_c12
 s_waitcnt vmcnt(18)
 v_and_b32 v216, 15, v0
 v_lshlrev_b32 v216, 4, v216
 v_lshrrev_b32 v217, 4, v0
 v_lshl_add_u32 v216, v217, 2, v216
 s_lshl_b32 s66, s38, 8
 s_add_u32 s66, s66, 0x24000
 v_add_u32 v216, s66, v216
 v_add_f32 v160, v160, v164
 v_add_f32 v168, v168, v172
 v_add_f32 v161, v161, v165
 v_add_f32 v169, v169, v173
 v_add_f32 v162, v162, v166
 v_add_f32 v170, v170, v174
 v_add_f32 v163, v163, v167
 v_add_f32 v171, v171, v175
 v_add_f32 v160, v160, v168
 v_add_f32 v161, v161, v169
 v_add_f32 v162, v162, v170
 v_add_f32 v163, v163, v171
 v_permlane16_swap_b32 v160, v161
 s_nop 0
 v_permlane16_swap_b32 v162, v163
 v_add_f32 v160, v160, v161
 v_add_f32 v162, v162, v163
 s_nop 1
 v_permlane32_swap_b32 v160, v162
 v_add_f32 v160, v160, v162
 v_cvt_pk_bf16_f32 v161, v160, v160
 v_lshlrev_b32 v161, 16, v161
 v_sub_f32 v161, v160, v161
 v_cvt_pk_bf16_f32 v160, v160, v161
 ds_write_b32 v216, v160 offset:0
 v_add_f32 v176, v176, v180
 v_add_f32 v184, v184, v188
 v_add_f32 v177, v177, v181
 v_add_f32 v185, v185, v189
 v_add_f32 v178, v178, v182
 v_add_f32 v186, v186, v190
 v_add_f32 v179, v179, v183
 v_add_f32 v187, v187, v191
 v_add_f32 v176, v176, v184
 v_add_f32 v177, v177, v185
 v_add_f32 v178, v178, v186
 v_add_f32 v179, v179, v187
 v_permlane16_swap_b32 v176, v177
 s_nop 0
 v_permlane16_swap_b32 v178, v179
 v_add_f32 v176, v176, v177
 v_add_f32 v178, v178, v179
 s_nop 1
 v_permlane32_swap_b32 v176, v178
 v_add_f32 v176, v176, v178
 v_cvt_pk_bf16_f32 v177, v176, v176
 v_lshlrev_b32 v177, 16, v177
 v_sub_f32 v177, v176, v177
 v_cvt_pk_bf16_f32 v176, v176, v177
 ds_write_b32 v216, v176 offset:1024
 s_waitcnt lgkmcnt(0)
 s_nop 1
mk_c12:
 v_mfma_f32_16x16x32_bf16 v[152:155], a[200:203], v[92:95], v[152:155]
 s_waitcnt vmcnt(13)
 ds_read_b64_tr_b16 v[88:89], v25 offset:8192
 ds_read_b64_tr_b16 v[90:91], v25 offset:10240
 v_mfma_f32_16x16x32_bf16 v[156:159], a[204:207], v[92:95], v[156:159]
 buffer_load_dwordx4 v6, s[8:11], s65 offen offset:3072  lds
 v_mfma_f32_16x16x32_bf16 v[96:99], a[208:211], v[64:67], v[96:99]
 s_bfe_u32 s64, s85, 0x4001c
 ds_read_b64_tr_b16 v[92:93], v26 offset:8192
 ds_read_b64_tr_b16 v[94:95], v26 offset:10240
 v_mfma_f32_16x16x32_bf16 v[100:103], a[212:215], v[64:67], v[100:103]
 s_mul_i32 s64, s64, 0x80000
 s_add_u32 s64, s64, s16
 v_mfma_f32_16x16x32_bf16 v[104:107], a[208:211], v[68:71], v[104:107]
 s_waitcnt lgkmcnt(6)
 ds_read_b64_tr_b16 v[64:65], v23 offset:4096
 ds_read_b64_tr_b16 v[66:67], v23 offset:6144
 v_mfma_f32_16x16x32_bf16 v[108:111], a[212:215], v[68:71], v[108:111]
 buffer_load_dwordx4 a[240:243], v11, s[4:7], s64 offen offset:0 sc1
 v_mfma_f32_16x16x32_bf16 v[112:115], a[208:211], v[72:75], v[112:115]
 ds_read_b64_tr_b16 v[68:69], v24 offset:4096
 ds_read_b64_tr_b16 v[70:71], v24 offset:6144
 v_mfma_f32_16x16x32_bf16 v[116:119], a[212:215], v[72:75], v[116:119]
 v_mfma_f32_16x16x32_bf16 v[120:123], a[208:211], v[76:79], v[120:123]
 ds_read_b64_tr_b16 v[72:73], v25 offset:4096
 ds_read_b64_tr_b16 v[74:75], v25 offset:6144
 v_mfma_f32_16x16x32_bf16 v[124:127], a[212:215], v[76:79], v[124:127]
 buffer_load_dwordx4 a[244:247], v11, s[4:7], s64 offen offset:2048 sc1
 v_mfma_f32_16x16x32_bf16 v[128:131], a[208:211], v[80:83], v[128:131]
 s_waitcnt lgkmcnt(6)
 ds_read_b64_tr_b16 v[76:77], v26 offset:4096
 ds_read_b64_tr_b16 v[78:79], v26 offset:6144
 v_mfma_f32_16x16x32_bf16 v[132:135], a[212:215], v[80:83], v[132:135]
 v_mfma_f32_16x16x32_bf16 v[136:139], a[208:211], v[84:87], v[136:139]
 ds_read_b64_tr_b16 v[80:81], v23 offset:12288
 ds_read_b64_tr_b16 v[82:83], v23 offset:14336
 v_mfma_f32_16x16x32_bf16 v[140:143], a[212:215], v[84:87], v[140:143]
 buffer_load_dwordx4 a[248:251], v14, s[4:7], s64 offen offset:0 sc1
 v_mfma_f32_16x16x32_bf16 v[144:147], a[208:211], v[88:91], v[144:147]
 s_waitcnt vmcnt(15)
 ds_read_b64_tr_b16 v[84:85], v24 offset:12288
 ds_read_b64_tr_b16 v[86:87], v24 offset:14336
 v_mfma_f32_16x16x32_bf16 v[148:151], a[212:215], v[88:91], v[148:151]
 v_mfma_f32_16x16x32_bf16 v[152:155], a[208:211], v[92:95], v[152:155]
 s_waitcnt lgkmcnt(6)
 ds_read_b64_tr_b16 v[88:89], v25 offset:12288
 ds_read_b64_tr_b16 v[90:91], v25 offset:14336
 v_mfma_f32_16x16x32_bf16 v[156:159], a[212:215], v[92:95], v[156:159]
 buffer_load_dwordx4 a[252:255], v14, s[4:7], s64 offen offset:2048 sc1
 v_mfma_f32_16x16x32_bf16 v[96:99], a[216:219], v[64:67], v[96:99]
 s_add_u32 m0, s60, 0x1c000
 ds_read_b64_tr_b16 v[92:93], v26 offset:12288
 ds_read_b64_tr_b16 v[94:95], v26 offset:14336
 v_mfma_f32_16x16x32_bf16 v[100:103], a[220:223], v[64:67], v[100:103]
 s_bfe_u32 s65, s86, 0x40000
 s_mul_i32 s65, s65, 0x60000
 v_mfma_f32_16x16x32_bf16 v[104:107], a[216:219], v[68:71], v[104:107]
 s_waitcnt vmcnt(12)
 s_barrier
 ds_read_b64_tr_b16 v[64:65], v23 offset:16384
 ds_read_b64_tr_b16 v[66:67], v23 offset:18432
 v_mfma_f32_16x16x32_bf16 v[108:111], a[220:223], v[68:71], v[108:111]
 buffer_load_dwordx4 v3, s[8:11], s65 offen offset:0  lds
 v_mfma_f32_16x16x32_bf16 v[112:115], a[216:219], v[72:75], v[112:115]
 s_waitcnt lgkmcnt(6)
 ds_read_b64_tr_b16 v[68:69], v24 offset:16384
 ds_read_b64_tr_b16 v[70:71], v24 offset:18432
 v_mfma_f32_16x16x32_bf16 v[116:119], a[220:223], v[72:75], v[116:119]
 v_pk_add_f32 v[224:225], v[224:225], v[228:229]
 v_pk_add_f32 v[232:233], v[232:233], v[236:237]
 v_pk_add_f32 v[226:227], v[226:227], v[230:231]
 v_pk_add_f32 v[234:235], v[234:235], v[238:239]
 v_pk_add_f32 v[224:225], v[224:225], v[232:233]
 v_pk_add_f32 v[226:227], v[226:227], v[234:235]
 s_nop 0
 v_permlane16_swap_b32 v224, v225
 v_permlane16_swap_b32 v226, v227
 v_add_f32 v224, v224, v225
 v_add_f32 v226, v226, v227
 s_nop 1
 v_permlane32_swap_b32 v224, v226
 v_add_f32 v224, v224, v226
 v_mov_b32 v225, v224
 v_mov_b32 v226, 0xba800000
 s_nop 0
 v_permlane32_swap_b32 v224, v225
 v_mul_f32 v224, v226, v224
 v_mul_f32 v225, 0x3a800000, v225
 v_fma_f32 v225, -v224, v224, v225
 v_max_f32 v225, 0, v225
 v_add_f32 v225, 0x3727c5ac, v225
 v_rsq_f32 v225, v225
 v_mov_b32 v226, v224
 v_mov_b32 v40, v225
 v_mov_b32 v42, v225
 v_permlane16_swap_b32 v224, v226
 s_nop 0
 v_permlane16_swap_b32 v40, v42
 v_cndmask_b32 v224, 0, v224, s[76:77]
 v_cvt_pk_bf16_f32 v48, v224, v224
 v_and_b32 v49, s78, v48
 v_sub_f32 v49, v224, v49
 v_cvt_pk_bf16_f32 v49, v49, v49
 v_cndmask_b32 v226, 0, v226, s[76:77]
 v_cvt_pk_bf16_f32 v52, v226, v226
 v_and_b32 v53, s78, v52
 v_sub_f32 v53, v226, v53
 v_cvt_pk_bf16_f32 v53, v53, v53
 ds_write_b32 v59, v225
 v_mfma_f32_16x16x32_bf16 v[120:123], a[216:219], v[76:79], v[120:123]
 ds_read_b64_tr_b16 v[72:73], v25 offset:16384
 ds_read_b64_tr_b16 v[74:75], v25 offset:18432
 v_mfma_f32_16x16x32_bf16 v[124:127], a[220:223], v[76:79], v[124:127]
 buffer_load_dwordx4 v4, s[8:11], s65 offen offset:1024  lds
 v_mfma_f32_16x16x32_bf16 v[128:131], a[216:219], v[80:83], v[128:131]
 ds_read_b64_tr_b16 v[76:77], v26 offset:16384
 ds_read_b64_tr_b16 v[78:79], v26 offset:18432
 v_mfma_f32_16x16x32_bf16 v[132:135], a[220:223], v[80:83], v[132:135]
 v_mfma_f32_16x16x32_bf16 v[136:139], a[216:219], v[84:87], v[136:139]
 s_waitcnt lgkmcnt(7)
 ds_read_b64_tr_b16 v[80:81], v23 offset:24576
 ds_read_b64_tr_b16 v[82:83], v23 offset:26624
 v_mfma_f32_16x16x32_bf16 v[140:143], a[220:223], v[84:87], v[140:143]
 buffer_load_dwordx4 v5, s[8:11], s65 offen offset:2048  lds
 v_mfma_f32_16x16x32_bf16 v[144:147], a[216:219], v[88:91], v[144:147]
 s_waitcnt vmcnt(13)
 ds_read_b64_tr_b16 v[84:85], v24 offset:24576
 ds_read_b64_tr_b16 v[86:87], v24 offset:26624
 v_mfma_f32_16x16x32_bf16 v[148:151], a[220:223], v[88:91], v[148:151]
 v_mfma_f32_16x16x32_bf16 v[152:155], a[216:219], v[92:95], v[152:155]
 ds_read_b64_tr_b16 v[88:89], v25 offset:24576
 ds_read_b64_tr_b16 v[90:91], v25 offset:26624
 v_mfma_f32_16x16x32_bf16 v[156:159], a[220:223], v[92:95], v[156:159]
 buffer_load_dwordx4 v6, s[8:11], s65 offen offset:3072  lds
 v_mfma_f32_16x16x32_bf16 v[96:99], a[224:227], v[64:67], v[96:99]
 s_waitcnt lgkmcnt(6)
 ds_read_b64_tr_b16 v[92:93], v26 offset:24576
 ds_read_b64_tr_b16 v[94:95], v26 offset:26624
 v_mfma_f32_16x16x32_bf16 v[100:103], a[228:231], v[64:67], v[100:103]
 s_add_u32 m0, s60, 0x20000
 s_bfe_u32 s65, s86, 0x40008
 s_mul_i32 s65, s65, 0x60000
 v_mfma_f32_16x16x32_bf16 v[104:107], a[224:227], v[68:71], v[104:107]
 ds_read_b64_tr_b16 v[64:65], v23 offset:20480
 ds_read_b64_tr_b16 v[66:67], v23 offset:22528
 v_mfma_f32_16x16x32_bf16 v[108:111], a[228:231], v[68:71], v[108:111]
 buffer_load_dwordx4 v3, s[8:11], s65 offen offset:0  lds
 v_mfma_f32_16x16x32_bf16 v[112:115], a[224:227], v[72:75], v[112:115]
 ds_read_b64_tr_b16 v[68:69], v24 offset:20480
 ds_read_b64_tr_b16 v[70:71], v24 offset:22528
 v_mfma_f32_16x16x32_bf16 v[116:119], a[228:231], v[72:75], v[116:119]
 ds_read_b128 v[192:195], v60 offset:0
 ds_read_b128 v[196:199], v60 offset:64
 v_mfma_f32_16x16x32_bf16 v[120:123], a[224:227], v[76:79], v[120:123]
 s_waitcnt lgkmcnt(8)
 ds_read_b64_tr_b16 v[72:73], v25 offset:20480
 ds_read_b64_tr_b16 v[74:75], v25 offset:22528
 v_mfma_f32_16x16x32_bf16 v[124:127], a[228:231], v[76:79], v[124:127]
 buffer_load_dwordx4 v4, s[8:11], s65 offen offset:1024  lds
 v_mfma_f32_16x16x32_bf16 v[128:131], a[224:227], v[80:83], v[128:131]
 ds_read_b64_tr_b16 v[76:77], v26 offset:20480
 ds_read_b64_tr_b16 v[78:79], v26 offset:22528
 v_mfma_f32_16x16x32_bf16 v[132:135], a[228:231], v[80:83], v[132:135]
 v_mfma_f32_16x16x32_bf16 v[136:139], a[224:227], v[84:87], v[136:139]
 ds_read_b64_tr_b16 v[80:81], v23 offset:28672
 ds_read_b64_tr_b16 v[82:83], v23 offset:30720
 v_mfma_f32_16x16x32_bf16 v[140:143], a[228:231], v[84:87], v[140:143]
 buffer_load_dwordx4 v5, s[8:11], s65 offen offset:2048  lds
 v_mfma_f32_16x16x32_bf16 v[144:147], a[224:227], v[88:91], v[144:147]
 s_waitcnt lgkmcnt(8)
 ds_read_b64_tr_b16 v[84:85], v24 offset:28672
 ds_read_b64_tr_b16 v[86:87], v24 offset:30720
 v_mfma_f32_16x16x32_bf16 v[148:151], a[228:231], v[88:91], v[148:151]
 v_mfma_f32_16x16x32_bf16 v[152:155], a[224:227], v[92:95], v[152:155]
 s_waitcnt vmcnt(15)
 ds_read_b64_tr_b16 v[88:89], v25 offset:28672
 ds_read_b64_tr_b16 v[90:91], v25 offset:30720
 v_mfma_f32_16x16x32_bf16 v[156:159], a[228:231], v[92:95], v[156:159]
 buffer_load_dwordx4 v6, s[8:11], s65 offen offset:3072  lds
 v_mfma_f32_16x16x32_bf16 v[96:99], a[232:235], v[64:67], v[96:99]
 s_add_u32 m0, s60, 0x0
 ds_read_b64_tr_b16 v[92:93], v26 offset:28672
 ds_read_b64_tr_b16 v[94:95], v26 offset:30720
 v_mfma_f32_16x16x32_bf16 v[100:103], a[236:239], v[64:67], v[100:103]
 s_bfe_u32 s65, s86, 0x40010
 s_mul_i32 s65, s65, 0x60000
 v_mfma_f32_16x16x32_bf16 v[104:107], a[232:235], v[68:71], v[104:107]
 s_waitcnt lgkmcnt(6)
 s_waitcnt vmcnt(12)
 s_barrier
 ds_read_b64_tr_b16 v[64:65], v23 offset:32768
 ds_read_b64_tr_b16 v[66:67], v23 offset:34816
 v_mfma_f32_16x16x32_bf16 v[108:111], a[236:239], v[68:71], v[108:111]
 buffer_load_dwordx4 v3, s[8:11], s65 offen offset:0  lds
 v_mfma_f32_16x16x32_bf16 v[112:115], a[232:235], v[72:75], v[112:115]
 ds_read_b64_tr_b16 v[68:69], v24 offset:32768
 ds_read_b64_tr_b16 v[70:71], v24 offset:34816
 v_mfma_f32_16x16x32_bf16 v[116:119], a[236:239], v[72:75], v[116:119]
 v_mfma_f32_16x16x32_bf16 v[120:123], a[232:235], v[76:79], v[120:123]
 ds_read_b64_tr_b16 v[72:73], v25 offset:32768
 ds_read_b64_tr_b16 v[74:75], v25 offset:34816
 v_mfma_f32_16x16x32_bf16 v[124:127], a[236:239], v[76:79], v[124:127]
 buffer_load_dwordx4 v4, s[8:11], s65 offen offset:1024  lds
 v_mfma_f32_16x16x32_bf16 v[128:131], a[232:235], v[80:83], v[128:131]
 s_waitcnt lgkmcnt(6)
 ds_read_b64_tr_b16 v[76:77], v26 offset:32768
 ds_read_b64_tr_b16 v[78:79], v26 offset:34816
 v_mfma_f32_16x16x32_bf16 v[132:135], a[236:239], v[80:83], v[132:135]
 v_mfma_f32_16x16x32_bf16 v[136:139], a[232:235], v[84:87], v[136:139]
 ds_read_b64_tr_b16 v[80:81], v23 offset:40960
 ds_read_b64_tr_b16 v[82:83], v23 offset:43008
 v_mfma_f32_16x16x32_bf16 v[140:143], a[236:239], v[84:87], v[140:143]
 buffer_load_dwordx4 v5, s[8:11], s65 offen offset:2048  lds
 v_mfma_f32_16x16x32_bf16 v[144:147], a[232:235], v[88:91], v[144:147]
 s_waitcnt vmcnt(13)
 ds_read_b64_tr_b16 v[84:85], v24 offset:40960
 ds_read_b64_tr_b16 v[86:87], v24 offset:43008
 v_mfma_f32_16x16x32_bf16 v[148:151], a[236:239], v[88:91], v[148:151]
 v_mfma_f32_16x16x32_bf16 v[152:155], a[232:235], v[92:95], v[152:155]
 s_waitcnt lgkmcnt(6)
 ds_read_b64_tr_b16 v[88:89], v25 offset:40960
 ds_read_b64_tr_b16 v[90:91], v25 offset:43008
 v_mfma_f32_16x16x32_bf16 v[156:159], a[236:239], v[92:95], v[156:159]
 buffer_load_dwordx4 v6, s[8:11], s65 offen offset:3072  lds
 v_mfma_f32_16x16x32_bf16 v[96:99], a[240:243], v[64:67], v[96:99]
 s_add_u32 m0, s60, 0x4000
 ds_read_b64_tr_b16 v[92:93], v26 offset:40960
 ds_read_b64_tr_b16 v[94:95], v26 offset:43008
 v_mfma_f32_16x16x32_bf16 v[100:103], a[244:247], v[64:67], v[100:103]
 s_bfe_u32 s65, s86, 0x40018
 s_mul_i32 s65, s65, 0x60000
 v_mfma_f32_16x16x32_bf16 v[104:107], a[240:243], v[68:71], v[104:107]
 ds_read_b64_tr_b16 v[64:65], v23 offset:36864
 ds_read_b64_tr_b16 v[66:67], v23 offset:38912
 v_mfma_f32_16x16x32_bf16 v[108:111], a[244:247], v[68:71], v[108:111]
 buffer_load_dwordx4 v3, s[8:11], s65 offen offset:0  lds
 v_mfma_f32_16x16x32_bf16 v[112:115], a[240:243], v[72:75], v[112:115]
 s_waitcnt lgkmcnt(6)
 ds_read_b64_tr_b16 v[68:69], v24 offset:36864
 ds_read_b64_tr_b16 v[70:71], v24 offset:38912
 v_mfma_f32_16x16x32_bf16 v[116:119], a[244:247], v[72:75], v[116:119]
 v_mfma_f32_16x16x32_bf16 v[120:123], a[240:243], v[76:79], v[120:123]
 ds_read_b64_tr_b16 v[72:73], v25 offset:36864
 ds_read_b64_tr_b16 v[74:75], v25 offset:38912
 v_mfma_f32_16x16x32_bf16 v[124:127], a[244:247], v[76:79], v[124:127]
 buffer_load_dwordx4 v4, s[8:11], s65 offen offset:1024  lds
 v_mfma_f32_16x16x32_bf16 v[128:131], a[240:243], v[80:83], v[128:131]
 ds_read_b64_tr_b16 v[76:77], v26 offset:36864
 ds_read_b64_tr_b16 v[78:79], v26 offset:38912
 v_mfma_f32_16x16x32_bf16 v[132:135], a[244:247], v[80:83], v[132:135]
 v_mfma_f32_16x16x32_bf16 v[136:139], a[240:243], v[84:87], v[136:139]
 s_waitcnt lgkmcnt(6)
 ds_read_b64_tr_b16 v[80:81], v23 offset:45056
 ds_read_b64_tr_b16 v[82:83], v23 offset:47104
 v_mfma_f32_16x16x32_bf16 v[140:143], a[244:247], v[84:87], v[140:143]
 buffer_load_dwordx4 v5, s[8:11], s65 offen offset:2048  lds
 v_mfma_f32_16x16x32_bf16 v[144:147], a[240:243], v[88:91], v[144:147]
 s_waitcnt vmcnt(15)
 ds_read_b64_tr_b16 v[84:85], v24 offset:45056
 ds_read_b64_tr_b16 v[86:87], v24 offset:47104
 v_mfma_f32_16x16x32_bf16 v[148:151], a[244:247], v[88:91], v[148:151]
 v_mfma_f32_16x16x32_bf16 v[152:155], a[240:243], v[92:95], v[152:155]
 ds_read_b64_tr_b16 v[88:89], v25 offset:45056
 ds_read_b64_tr_b16 v[90:91], v25 offset:47104
 v_mfma_f32_16x16x32_bf16 v[156:159], a[244:247], v[92:95], v[156:159]
 buffer_load_dwordx4 v6, s[8:11], s65 offen offset:3072  lds
 v_mfma_f32_16x16x32_bf16 v[96:99], a[248:251], v[64:67], v[96:99]
 s_waitcnt lgkmcnt(6)
 ds_read_b64_tr_b16 v[92:93], v26 offset:45056
 ds_read_b64_tr_b16 v[94:95], v26 offset:47104
 v_mfma_f32_16x16x32_bf16 v[100:103], a[252:255], v[64:67], v[100:103]
 s_add_u32 m0, s60, 0x8000
 s_bfe_u32 s65, s87, 0x40000
 s_mul_i32 s65, s65, 0x60000
 v_mfma_f32_16x16x32_bf16 v[104:107], a[248:251], v[68:71], v[104:107]
 ds_read_b32 v64, v58 offset:0
 ds_read_b32 v65, v58 offset:0
 v_mfma_f32_16x16x32_bf16 v[108:111], a[252:255], v[68:71], v[108:111]
 buffer_load_dwordx4 v3, s[8:11], s65 offen offset:0  lds
 v_mfma_f32_16x16x32_bf16 v[112:115], a[248:251], v[72:75], v[112:115]
 ds_read_b32 v68, v58 offset:64
 ds_read_b32 v69, v58 offset:64
 v_mfma_f32_16x16x32_bf16 v[116:119], a[252:255], v[72:75], v[116:119]
 v_mfma_f32_16x16x32_bf16 v[120:123], a[248:251], v[76:79], v[120:123]
 s_waitcnt lgkmcnt(6)
 ds_read_b32 v72, v58 offset:128
 ds_read_b32 v73, v58 offset:128
 v_mfma_f32_16x16x32_bf16 v[124:127], a[252:255], v[76:79], v[124:127]
 buffer_load_dwordx4 v4, s[8:11], s65 offen offset:1024  lds
 v_mfma_f32_16x16x32_bf16 v[128:131], a[248:251], v[80:83], v[128:131]
 ds_read_b32 v76, v58 offset:192
 ds_read_b32 v77, v58 offset:192
 v_mfma_f32_16x16x32_bf16 v[132:135], a[252:255], v[80:83], v[132:135]
 v_mfma_f32_16x16x32_bf16 v[136:139], a[248:251], v[84:87], v[136:139]
 ds_read_b32 v80, v58 offset:256
 ds_read_b32 v81, v58 offset:256
 v_mfma_f32_16x16x32_bf16 v[140:143], a[252:255], v[84:87], v[140:143]
 buffer_load_dwordx4 v5, s[8:11], s65 offen offset:2048  lds
 v_mfma_f32_16x16x32_bf16 v[144:147], a[248:251], v[88:91], v[144:147]
 s_waitcnt lgkmcnt(6)
 ds_read_b32 v84, v58 offset:320
 ds_read_b32 v85, v58 offset:320
 v_mfma_f32_16x16x32_bf16 v[148:151], a[252:255], v[88:91], v[148:151]
 v_mfma_f32_16x16x32_bf16 v[152:155], a[248:251], v[92:95], v[152:155]
 ds_read_b32 v88, v58 offset:384
 ds_read_b32 v89, v58 offset:384
 v_mfma_f32_16x16x32_bf16 v[156:159], a[252:255], v[92:95], v[156:159]
 buffer_load_dwordx4 v6, s[8:11], s65 offen offset:3072  lds
 v_mfma_f32_16x16x32_bf16 v[96:99], v[48:51], v[64:67], v[96:99]
 s_add_u32 m0, s60, 0xc000
 ds_read_b32 v92, v58 offset:448
 ds_read_b32 v93, v58 offset:448
 v_mfma_f32_16x16x32_bf16 v[100:103], v[52:55], v[64:67], v[100:103]
 s_bfe_u32 s65, s87, 0x40008
 s_mul_i32 s65, s65, 0x60000
 v_mfma_f32_16x16x32_bf16 v[104:107], v[48:51], v[68:71], v[104:107]
 s_waitcnt lgkmcnt(6)
 v_mfma_f32_16x16x32_bf16 v[108:111], v[52:55], v[68:71], v[108:111]
 buffer_load_dwordx4 v3, s[8:11], s65 offen offset:0  lds
 v_mfma_f32_16x16x32_bf16 v[112:115], v[48:51], v[72:75], v[112:115]
 v_mfma_f32_16x16x32_bf16 v[116:119], v[52:55], v[72:75], v[116:119]
 v_mfma_f32_16x16x32_bf16 v[120:123], v[48:51], v[76:79], v[120:123]
 v_mfma_f32_16x16x32_bf16 v[124:127], v[52:55], v[76:79], v[124:127]
 buffer_load_dwordx4 v4, s[8:11], s65 offen offset:1024  lds
 v_mfma_f32_16x16x32_bf16 v[128:131], v[48:51], v[80:83], v[128:131]
 s_waitcnt lgkmcnt(0)
 v_mfma_f32_16x16x32_bf16 v[132:135], v[52:55], v[80:83], v[132:135]
 v_mfma_f32_16x16x32_bf16 v[136:139], v[48:51], v[84:87], v[136:139]
 v_mfma_f32_16x16x32_bf16 v[140:143], v[52:55], v[84:87], v[140:143]
 buffer_load_dwordx4 v5, s[8:11], s65 offen offset:2048  lds
 v_mfma_f32_16x16x32_bf16 v[144:147], v[48:51], v[88:91], v[144:147]
 v_mfma_f32_16x16x32_bf16 v[148:151], v[52:55], v[88:91], v[148:151]
 v_mfma_f32_16x16x32_bf16 v[152:155], v[48:51], v[92:95], v[152:155]
 v_mfma_f32_16x16x32_bf16 v[156:159], v[52:55], v[92:95], v[156:159]
 buffer_load_dwordx4 v6, s[8:11], s65 offen offset:3072  lds
 s_barrier
mk_k1:
 s_lshl_b32 s66, s38, 13
 s_add_u32 s66, s66, 0x14000
 v_add_u32 v60, s66, v1
 v_pk_fma_f32 v[96:97], v[96:97], v[192:193], s[70:71]
 v_pk_mul_f32 v[224:225], v[96:97], s[72:73]
 v_max_f32 v96, s70, v96
 v_exp_f32_e64 v224, v224 clamp
 v_max_f32 v97, s70, v97
 v_exp_f32_e64 v225, v225 clamp
 v_pk_mul_f32 v[128:129], v[128:129], v[192:193]
 v_pk_add_f32 v[96:97], v[96:97], v[224:225]
 v_cvt_pk_bf16_f32 v160, v128, v129
 v_pk_mul_f32 v[232:233], v[96:97], s[74:75]
 v_cvt_pk_bf16_f32 v208, v96, v97
 v_pk_fma_f32 v[98:99], v[98:99], v[194:195], s[70:71]
 v_pk_mul_f32 v[226:227], v[98:99], s[72:73]
 v_max_f32 v98, s70, v98
 v_exp_f32_e64 v226, v226 clamp
 v_max_f32 v99, s70, v99
 v_exp_f32_e64 v227, v227 clamp
 v_pk_mul_f32 v[130:131], v[130:131], v[194:195]
 v_pk_add_f32 v[98:99], v[98:99], v[226:227]
 v_cvt_pk_bf16_f32 v161, v130, v131
 v_pk_add_f32 v[232:233], v[232:233], v[98:99]
 v_cvt_pk_bf16_f32 v209, v98, v99
 v_pk_fma_f32 v[100:101], v[100:101], v[196:197], s[70:71]
 v_pk_mul_f32 v[228:229], v[100:101], s[72:73]
 v_max_f32 v100, s70, v100
 v_exp_f32_e64 v228, v228 clamp
 v_max_f32 v101, s70, v101
 s_add_u32 m0, s60, 0x10000
 s_bfe_u32 s65, s87, 0x40010
 s_mul_i32 s65, s65, 0x60000
 buffer_load_dwordx4 v3, s[8:11], s65 offen offset:0  lds
 v_exp_f32_e64 v229, v229 clamp
 v_pk_mul_f32 v[132:133], v[132:133], v[196:197]
 v_pk_add_f32 v[100:101], v[100:101], v[228:229]
 v_cvt_pk_bf16_f32 v162, v132, v133
 v_pk_add_f32 v[232:233], v[232:233], v[100:101]
 v_cvt_pk_bf16_f32 v210, v100, v101
 v_pk_fma_f32 v[102:103], v[102:103], v[198:199], s[70:71]
 v_pk_mul_f32 v[230:231], v[102:103], s[72:73]
 v_max_f32 v102, s70, v102
 v_exp_f32_e64 v230, v230 clamp
 v_max_f32 v103, s70, v103
 v_exp_f32_e64 v231, v231 clamp
 v_pk_mul_f32 v[134:135], v[134:135], v[198:199]
 v_pk_add_f32 v[102:103], v[102:103], v[230:231]
 v_cvt_pk_bf16_f32 v163, v134, v135
 v_pk_add_f32 v[232:233], v[232:233], v[102:103]
 v_cvt_pk_bf16_f32 v211, v102, v103
 v_pk_fma_f32 v[104:105], v[104:105], v[192:193], s[70:71]
 v_pk_mul_f32 v[224:225], v[104:105], s[72:73]
 v_max_f32 v104, s70, v104
 v_exp_f32_e64 v224, v224 clamp
 v_max_f32 v105, s70, v105
 v_exp_f32_e64 v225, v225 clamp
 v_pk_mul_f32 v[136:137], v[136:137], v[192:193]
 v_pk_add_f32 v[104:105], v[104:105], v[224:225]
 v_cvt_pk_bf16_f32 v164, v136, v137
 v_pk_mul_f32 v[234:235], v[104:105], s[74:75]
 v_cvt_pk_bf16_f32 v212, v104, v105
 v_pk_fma_f32 v[106:107], v[106:107], v[194:195], s[70:71]
 v_pk_mul_f32 v[226:227], v[106:107], s[72:73]
 buffer_load_dwordx4 v4, s[8:11], s65 offen offset:1024  lds
 v_max_f32 v106, s70, v106
 v_exp_f32_e64 v226, v226 clamp
 v_max_f32 v107, s70, v107
 v_exp_f32_e64 v227, v227 clamp
 v_pk_mul_f32 v[138:139], v[138:139], v[194:195]
 v_pk_add_f32 v[106:107], v[106:107], v[226:227]
 v_cvt_pk_bf16_f32 v165, v138, v139
 v_pk_add_f32 v[234:235], v[234:235], v[106:107]
 v_cvt_pk_bf16_f32 v213, v106, v107
 v_pk_fma_f32 v[108:109], v[108:109], v[196:197], s[70:71]
 v_pk_mul_f32 v[228:229], v[108:109], s[72:73]
 v_max_f32 v108, s70, v108
 v_exp_f32_e64 v228, v228 clamp
 v_max_f32 v109, s70, v109
 v_exp_f32_e64 v229, v229 clamp
 v_pk_mul_f32 v[140:141], v[140:141], v[196:197]
 v_pk_add_f32 v[108:109], v[108:109], v[228:229]
 v_cvt_pk_bf16_f32 v166, v140, v141
 v_pk_add_f32 v[234:235], v[234:235], v[108:109]
 v_cvt_pk_bf16_f32 v214, v108, v109
 v_pk_fma_f32 v[110:111], v[110:111], v[198:199], s[70:71]
 v_pk_mul_f32 v[230:231], v[110:111], s[72:73]
 v_max_f32 v110, s70, v110
 v_exp_f32_e64 v230, v230 clamp
 v_max_f32 v111, s70, v111
 v_exp_f32_e64 v231, v231 clamp
 v_pk_mul_f32 v[142:143], v[142:143], v[198:199]
 v_pk_add_f32 v[110:111], v[110:111], v[230:231]
 v_cvt_pk_bf16_f32 v167, v142, v143
 v_pk_add_f32 v[234:235], v[234:235], v[110:111]
 buffer_load_dwordx4 v5, s[8:11], s65 offen offset:2048  lds
 v_cvt_pk_bf16_f32 v215, v110, v111
 v_mfma_f32_16x16x32_bf16 v[96:99], v[208:211], v[160:163], 0
 s_nop 0
 v_mfma_f32_16x16x32_bf16 v[100:103], v[212:215], v[160:163], 0
 v_mfma_f32_16x16x32_bf16 v[104:107], v[208:211], v[164:167], 0
 v_mfma_f32_16x16x32_bf16 v[108:111], v[212:215], v[164:167], 0
 v_pk_fma_f32 v[112:113], v[112:113], v[192:193], s[70:71]
 v_pk_mul_f32 v[224:225], v[112:113], s[72:73]
 v_max_f32 v112, s70, v112
 v_exp_f32_e64 v224, v224 clamp
 v_max_f32 v113, s70, v113
 v_exp_f32_e64 v225, v225 clamp
 v_pk_mul_f32 v[144:145], v[144:145], v[192:193]
 v_pk_add_f32 v[112:113], v[112:113], v[224:225]
 v_cvt_pk_bf16_f32 v168, v144, v145
 v_pk_mul_f32 v[236:237], v[112:113], s[74:75]
 v_cvt_pk_bf16_f32 v216, v112, v113
 v_pk_fma_f32 v[114:115], v[114:115], v[194:195], s[70:71]
 v_pk_mul_f32 v[226:227], v[114:115], s[72:73]
 v_max_f32 v114, s70, v114
 v_exp_f32_e64 v226, v226 clamp
 v_max_f32 v115, s70, v115
 v_exp_f32_e64 v227, v227 clamp
 v_pk_mul_f32 v[146:147], v[146:147], v[194:195]
 v_pk_add_f32 v[114:115], v[114:115], v[226:227]
 v_cvt_pk_bf16_f32 v169, v146, v147
 v_pk_add_f32 v[236:237], v[236:237], v[114:115]
 v_cvt_pk_bf16_f32 v217, v114, v115
 v_pk_fma_f32 v[116:117], v[116:117], v[196:197], s[70:71]
 v_pk_mul_f32 v[228:229], v[116:117], s[72:73]
 v_max_f32 v116, s70, v116
 buffer_load_dwordx4 v6, s[8:11], s65 offen offset:3072  lds
 v_exp_f32_e64 v228, v228 clamp
 v_max_f32 v117, s70, v117
 v_exp_f32_e64 v229, v229 clamp
 v_pk_mul_f32 v[148:149], v[148:149], v[196:197]
 v_pk_add_f32 v[116:117], v[116:117], v[228:229]
 v_cvt_pk_bf16_f32 v170, v148, v149
 v_pk_add_f32 v[236:237], v[236:237], v[116:117]
 v_cvt_pk_bf16_f32 v218, v116, v117
 v_pk_fma_f32 v[118:119], v[118:119], v[198:199], s[70:71]
 v_pk_mul_f32 v[230:231], v[118:119], s[72:73]
 v_max_f32 v118, s70, v118
 v_exp_f32_e64 v230, v230 clamp
 v_max_f32 v119, s70, v119
 v_exp_f32_e64 v231, v231 clamp
 v_pk_mul_f32 v[150:151], v[150:151], v[198:199]
 v_pk_add_f32 v[118:119], v[118:119], v[230:231]
 v_cvt_pk_bf16_f32 v171, v150, v151
 v_pk_add_f32 v[236:237], v[236:237], v[118:119]
 v_cvt_pk_bf16_f32 v219, v118, v119
 v_pk_fma_f32 v[120:121], v[120:121], v[192:193], s[70:71]
 v_pk_mul_f32 v[224:225], v[120:121], s[72:73]
 v_max_f32 v120, s70, v120
 v_exp_f32_e64 v224, v224 clamp
 v_max_f32 v121, s70, v121
 v_exp_f32_e64 v225, v225 clamp
 v_pk_mul_f32 v[152:153], v[152:153], v[192:193]
 v_pk_add_f32 v[120:121], v[120:121], v[224:225]
 v_cvt_pk_bf16_f32 v172, v152, v153
 v_pk_mul_f32 v[238:239], v[120:121], s[74:75]
 v_cvt_pk_bf16_f32 v220, v120, v121
 v_pk_fma_f32 v[122:123], v[122:123], v[194:195], s[70:71]
 v_pk_mul_f32 v[226:227], v[122:123], s[72:73]
 v_max_f32 v122, s70, v122
 v_exp_f32_e64 v226, v226 clamp
 v_max_f32 v123, s70, v123
 v_exp_f32_e64 v227, v227 clamp
 v_pk_mul_f32 v[154:155], v[154:155], v[194:195]
 v_pk_add_f32 v[122:123], v[122:123], v[226:227]
 v_cvt_pk_bf16_f32 v173, v154, v155
 v_pk_add_f32 v[238:239], v[238:239], v[122:123]
 v_cvt_pk_bf16_f32 v221, v122, v123
 v_pk_fma_f32 v[124:125], v[124:125], v[196:197], s[70:71]
 v_pk_mul_f32 v[228:229], v[124:125], s[72:73]
 v_max_f32 v124, s70, v124
 v_exp_f32_e64 v228, v228 clamp
 v_max_f32 v125, s70, v125
 v_exp_f32_e64 v229, v229 clamp
 v_pk_mul_f32 v[156:157], v[156:157], v[196:197]
 v_pk_add_f32 v[124:125], v[124:125], v[228:229]
 v_cvt_pk_bf16_f32 v174, v156, v157
 v_pk_add_f32 v[238:239], v[238:239], v[124:125]
 v_cvt_pk_bf16_f32 v222, v124, v125
 v_pk_fma_f32 v[126:127], v[126:127], v[198:199], s[70:71]
 v_pk_mul_f32 v[230:231], v[126:127], s[72:73]
 v_max_f32 v126, s70, v126
 v_exp_f32_e64 v230, v230 clamp
 v_max_f32 v127, s70, v127
 v_exp_f32_e64 v231, v231 clamp
 v_pk_mul_f32 v[158:159], v[158:159], v[198:199]
 v_pk_add_f32 v[126:127], v[126:127], v[230:231]
 v_cvt_pk_bf16_f32 v175, v158, v159
 v_pk_add_f32 v[238:239], v[238:239], v[126:127]
 v_cvt_pk_bf16_f32 v223, v126, v127
 v_mfma_f32_16x16x32_bf16 v[112:115], v[216:219], v[168:171], 0
 s_nop 0
 v_mfma_f32_16x16x32_bf16 v[116:119], v[220:223], v[168:171], 0
 v_mfma_f32_16x16x32_bf16 v[120:123], v[216:219], v[172:175], 0
 v_mfma_f32_16x16x32_bf16 v[124:127], v[220:223], v[172:175], 0
 v_add_f32 v232, v232, v233
 v_add_f32 v234, v234, v235
 v_add_f32 v236, v236, v237
 v_add_f32 v238, v238, v239
 ds_write_b128 v60, v[96:99] offset:0
 ds_write_b128 v60, v[100:103] offset:1024
 ds_write_b128 v60, v[104:107] offset:2048
 ds_write_b128 v60, v[108:111] offset:3072
 ds_write_b128 v60, v[112:115] offset:4096
 ds_write_b128 v60, v[116:119] offset:5120
 ds_write_b128 v60, v[120:123] offset:6144
 ds_write_b128 v60, v[124:127] offset:7168
 v_permlane16_swap_b32 v232, v234
 v_permlane16_swap_b32 v236, v238
 v_add_f32 v232, v232, v234
 v_add_f32 v236, v236, v238
 s_nop 1
 v_permlane32_swap_b32 v232, v236
 v_add_f32 v232, v232, v236
 s_lshl_b32 s66, s38, 8
 s_add_u32 s66, s66, 0x24a00
 v_add_u32 v59, s66, v2
 ds_write_b32 v59, v232
 s_lshl_b32 s66, s38, 11
 s_add_u32 s66, s66, 0x14000
 v_add_u32 v60, s66, v1
 v_add_u32 v61, 0x24a00, v2
 s_waitcnt lgkmcnt(0)
 s_barrier
 ds_read_b128 v[96:99], v60 offset:0
 ds_read_b128 v[100:103], v60 offset:1024
 ds_read_b128 v[104:107], v60 offset:8192
 ds_read_b128 v[108:111], v60 offset:9216
 ds_read_b128 v[112:115], v60 offset:16384
 ds_read_b128 v[116:119], v60 offset:17408
 ds_read_b128 v[120:123], v60 offset:24576
 ds_read_b128 v[124:127], v60 offset:25600
 ds_read_b32 v224, v61 offset:0
 ds_read_b32 v225, v61 offset:256
 ds_read_b32 v226, v61 offset:512
 ds_read_b32 v227, v61 offset:768
 s_waitcnt lgkmcnt(4)
 s_waitcnt vmcnt(24)
 s_barrier
 ds_read_b64_tr_b16 v[64:65], v23 offset:49152
 ds_read_b64_tr_b16 v[66:67], v23 offset:51200
 ds_read_b64_tr_b16 v[68:69], v24 offset:49152
 ds_read_b64_tr_b16 v[70:71], v24 offset:51200
 ds_read_b64_tr_b16 v[72:73], v25 offset:49152
 ds_read_b64_tr_b16 v[74:75], v25 offset:51200
 ds_read_b64_tr_b16 v[76:77], v26 offset:49152
 ds_read_b64_tr_b16 v[78:79], v26 offset:51200
 ds_read_b64_tr_b16 v[80:81], v23 offset:53248
 ds_read_b64_tr_b16 v[82:83], v23 offset:55296
 ds_read_b64_tr_b16 v[84:85], v24 offset:53248
 ds_read_b64_tr_b16 v[86:87], v24 offset:55296
 ds_read_b64_tr_b16 v[88:89], v25 offset:53248
 ds_read_b64_tr_b16 v[90:91], v25 offset:55296
 v_pk_add_f32 v[96:97], v[96:97], v[104:105]
 v_pk_add_f32 v[112:113], v[112:113], v[120:121]
 v_pk_add_f32 v[98:99], v[98:99], v[106:107]
 v_pk_add_f32 v[114:115], v[114:115], v[122:123]
 v_pk_add_f32 v[100:101], v[100:101], v[108:109]
 v_pk_add_f32 v[116:117], v[116:117], v[124:125]
 v_pk_add_f32 v[102:103], v[102:103], v[110:111]
 v_pk_add_f32 v[118:119], v[118:119], v[126:127]
 v_pk_add_f32 v[96:97], v[96:97], v[112:113]
 v_pk_add_f32 v[98:99], v[98:99], v[114:115]
 v_pk_add_f32 v[100:101], v[100:101], v[116:117]
 v_pk_add_f32 v[102:103], v[102:103], v[118:119]
 v_cvt_pk_bf16_f32 v128, v96, v97
 v_cvt_pk_bf16_f32 v129, v98, v99
 v_cvt_pk_bf16_f32 v130, v100, v101
 v_cvt_pk_bf16_f32 v131, v102, v103
 s_add_u32 s69, s46, 0x3a00000
 buffer_store_dwordx4 v[128:131], v11, s[4:7], s69 offen sc1
 s_waitcnt lgkmcnt(14)
 v_add_f32 v224, v224, v225
 v_add_f32 v226, v226, v227
 v_add_f32 v224, v224, v226
 s_add_u32 s69, s48, 0x3c00000
 buffer_store_dword v224, v2, s[4:7], s69 offen sc1
 s_waitcnt lgkmcnt(8)
 v_mfma_f32_16x16x32_bf16 v[160:163], v[64:67], a[0:3], 0
 ds_read_b64_tr_b16 v[92:93], v26 offset:53248
 ds_read_b64_tr_b16 v[94:95], v26 offset:55296
 v_mfma_f32_16x16x32_bf16 v[164:167], v[64:67], a[4:7], 0
 v_mfma_f32_16x16x32_bf16 v[168:171], v[68:71], a[0:3], 0
 ds_read_b64_tr_b16 v[64:65], v23 offset:57344
 ds_read_b64_tr_b16 v[66:67], v23 offset:59392
 v_mfma_f32_16x16x32_bf16 v[172:175], v[68:71], a[4:7], 0
 v_mfma_f32_16x16x32_bf16 v[176:179], v[72:75], a[0:3], 0
 s_waitcnt lgkmcnt(6)
 ds_read_b64_tr_b16 v[68:69], v24 offset:57344
 ds_read_b64_tr_b16 v[70:71], v24 offset:59392
 v_mfma_f32_16x16x32_bf16 v[180:183], v[72:75], a[4:7], 0
 v_mfma_f32_16x16x32_bf16 v[184:187], v[76:79], a[0:3], 0
 ds_read_b64_tr_b16 v[72:73], v25 offset:57344
 ds_read_b64_tr_b16 v[74:75], v25 offset:59392
 v_mfma_f32_16x16x32_bf16 v[188:191], v[76:79], a[4:7], 0
 v_mfma_f32_16x16x32_bf16 v[160:163], v[80:83], a[8:11], v[160:163]
 ds_read_b64_tr_b16 v[76:77], v26 offset:57344
 ds_read_b64_tr_b16 v[78:79], v26 offset:59392
 v_mfma_f32_16x16x32_bf16 v[164:167], v[80:83], a[12:15], v[164:167]
 v_mfma_f32_16x16x32_bf16 v[168:171], v[84:87], a[8:11], v[168:171]
 s_waitcnt lgkmcnt(6)
 ds_read_b64_tr_b16 v[80:81], v23 offset:61440
 ds_read_b64_tr_b16 v[82:83], v23 offset:63488
 v_mfma_f32_16x16x32_bf16 v[172:175], v[84:87], a[12:15], v[172:175]
 v_mfma_f32_16x16x32_bf16 v[176:179], v[88:91], a[8:11], v[176:179]
 ds_read_b64_tr_b16 v[84:85], v24 offset:61440
 ds_read_b64_tr_b16 v[86:87], v24 offset:63488
 v_mfma_f32_16x16x32_bf16 v[180:183], v[88:91], a[12:15], v[180:183]
 v_mfma_f32_16x16x32_bf16 v[184:187], v[92:95], a[8:11], v[184:187]
 ds_read_b64_tr_b16 v[88:89], v25 offset:61440
 ds_read_b64_tr_b16 v[90:91], v25 offset:63488
 v_mfma_f32_16x16x32_bf16 v[188:191], v[92:95], a[12:15], v[188:191]
 v_mfma_f32_16x16x32_bf16 v[160:163], v[64:67], a[16:19], v[160:163]
 s_waitcnt lgkmcnt(6)
 ds_read_b64_tr_b16 v[92:93], v26 offset:61440
 ds_read_b64_tr_b16 v[94:95], v26 offset:63488
 v_mfma_f32_16x16x32_bf16 v[164:167], v[64:67], a[20:23], v[164:167]
 v_add_u32 v61, mk_k3-mk_top+0, v249
 v_min_u32 v61, mk_end-mk_top, v61
 global_load_dword v255, v61, s[18:19]
 v_mfma_f32_16x16x32_bf16 v[168:171], v[68:71], a[16:19], v[168:171]
 s_waitcnt vmcnt(23)
 s_barrier
 ds_read_b64_tr_b16 v[64:65], v27 offset:0
 ds_read_b64_tr_b16 v[66:67], v27 offset:2048
 v_mfma_f32_16x16x32_bf16 v[172:175], v[68:71], a[20:23], v[172:175]
 s_add_u32 m0, s60, 0x14000
 s_bfe_u32 s65, s87, 0x40010
 s_mul_i32 s65, s65, 0x20000
 v_mfma_f32_16x16x32_bf16 v[176:179], v[72:75], a[16:19], v[176:179]
 ds_read_b64_tr_b16 v[68:69], v28 offset:0
 ds_read_b64_tr_b16 v[70:71], v28 offset:2048
 v_mfma_f32_16x16x32_bf16 v[180:183], v[72:75], a[20:23], v[180:183]
 buffer_load_dwordx4 v7, s[12:15], s65 offen offset:0  lds
 v_mfma_f32_16x16x32_bf16 v[184:187], v[76:79], a[16:19], v[184:187]
 s_waitcnt lgkmcnt(6)
 ds_read_b64_tr_b16 v[72:73], v29 offset:0
 ds_read_b64_tr_b16 v[74:75], v29 offset:2048
 v_mfma_f32_16x16x32_bf16 v[188:191], v[76:79], a[20:23], v[188:191]
 buffer_load_dwordx4 v8, s[12:15], s65 offen offset:1024  lds
 v_mfma_f32_16x16x32_bf16 v[160:163], v[80:83], a[24:27], v[160:163]
 ds_read_b64_tr_b16 v[76:77], v30 offset:0
 ds_read_b64_tr_b16 v[78:79], v30 offset:2048
 v_mfma_f32_16x16x32_bf16 v[164:167], v[80:83], a[28:31], v[164:167]
 buffer_load_dwordx4 v9, s[12:15], s65 offen offset:2048  lds
 v_mfma_f32_16x16x32_bf16 v[168:171], v[84:87], a[24:27], v[168:171]
 ds_read_b64_tr_b16 v[80:81], v27 offset:4096
 ds_read_b64_tr_b16 v[82:83], v27 offset:6144
 v_mfma_f32_16x16x32_bf16 v[172:175], v[84:87], a[28:31], v[172:175]
 v_mfma_f32_16x16x32_bf16 v[176:179], v[88:91], a[24:27], v[176:179]
 s_waitcnt lgkmcnt(6)
 ds_read_b64_tr_b16 v[84:85], v28 offset:4096
 ds_read_b64_tr_b16 v[86:87], v28 offset:6144
 v_mfma_f32_16x16x32_bf16 v[180:183], v[88:91], a[28:31], v[180:183]
 buffer_load_dwordx4 v10, s[12:15], s65 offen offset:3072  lds
 v_mfma_f32_16x16x32_bf16 v[184:187], v[92:95], a[24:27], v[184:187]
 s_add_u32 m0, s60, 0x18000
 ds_read_b64_tr_b16 v[88:89], v29 offset:4096
 ds_read_b64_tr_b16 v[90:91], v29 offset:6144
 v_mfma_f32_16x16x32_bf16 v[188:191], v[92:95], a[28:31], v[188:191]
 s_bfe_u32 s65, s87, 0x40018
 s_mul_i32 s65, s65, 0x20000
 v_mfma_f32_16x16x32_bf16 v[160:163], v[64:67], a[32:35], v[160:163]
 ds_read_b64_tr_b16 v[92:93], v30 offset:4096
 ds_read_b64_tr_b16 v[94:95], v30 offset:6144
 v_mfma_f32_16x16x32_bf16 v[164:167], v[64:67], a[36:39], v[164:167]
 buffer_load_dwordx4 v7, s[12:15], s65 offen offset:0  lds
 v_mfma_f32_16x16x32_bf16 v[168:171], v[68:71], a[32:35], v[168:171]
 s_waitcnt lgkmcnt(6)
 ds_read_b64_tr_b16 v[64:65], v27 offset:8192
 ds_read_b64_tr_b16 v[66:67], v27 offset:10240
 v_mfma_f32_16x16x32_bf16 v[172:175], v[68:71], a[36:39], v[172:175]
 v_mfma_f32_16x16x32_bf16 v[176:179], v[72:75], a[32:35], v[176:179]
 ds_read_b64_tr_b16 v[68:69], v28 offset:8192
 ds_read_b64_tr_b16 v[70:71], v28 offset:10240
 v_mfma_f32_16x16x32_bf16 v[180:183], v[72:75], a[36:39], v[180:183]
 buffer_load_dwordx4 v8, s[12:15], s65 offen offset:1024  lds
 v_mfma_f32_16x16x32_bf16 v[184:187], v[76:79], a[32:35], v[184:187]
 ds_read_b64_tr_b16 v[72:73], v29 offset:8192
 ds_read_b64_tr_b16 v[74:75], v29 offset:10240
 v_mfma_f32_16x16x32_bf16 v[188:191], v[76:79], a[36:39], v[188:191]
 v_mfma_f32_16x16x32_bf16 v[160:163], v[80:83], a[40:43], v[160:163]
 s_waitcnt lgkmcnt(6)
 ds_read_b64_tr_b16 v[76:77], v30 offset:8192
 ds_read_b64_tr_b16 v[78:79], v30 offset:10240
 v_mfma_f32_16x16x32_bf16 v[164:167], v[80:83], a[44:47], v[164:167]
 buffer_load_dwordx4 v9, s[12:15], s65 offen offset:2048  lds
 v_mfma_f32_16x16x32_bf16 v[168:171], v[84:87], a[40:43], v[168:171]
 ds_read_b64_tr_b16 v[80:81], v27 offset:12288
 ds_read_b64_tr_b16 v[82:83], v27 offset:14336
 v_mfma_f32_16x16x32_bf16 v[172:175], v[84:87], a[44:47], v[172:175]
 v_mfma_f32_16x16x32_bf16 v[176:179], v[88:91], a[40:43], v[176:179]
 ds_read_b64_tr_b16 v[84:85], v28 offset:12288
 ds_read_b64_tr_b16 v[86:87], v28 offset:14336
 v_mfma_f32_16x16x32_bf16 v[180:183], v[88:91], a[44:47], v[180:183]
 buffer_load_dwordx4 v10, s[12:15], s65 offen offset:3072  lds
 v_mfma_f32_16x16x32_bf16 v[184:187], v[92:95], a[40:43], v[184:187]
 s_waitcnt lgkmcnt(6)
 ds_read_b64_tr_b16 v[88:89], v29 offset:12288
 ds_read_b64_tr_b16 v[90:91], v29 offset:14336
 v_mfma_f32_16x16x32_bf16 v[188:191], v[92:95], a[44:47], v[188:191]
 v_mfma_f32_16x16x32_bf16 v[160:163], v[64:67], a[48:51], v[160:163]
 ds_read_b64_tr_b16 v[92:93], v30 offset:12288
 ds_read_b64_tr_b16 v[94:95], v30 offset:14336
 v_mfma_f32_16x16x32_bf16 v[164:167], v[64:67], a[52:55], v[164:167]
 v_mfma_f32_16x16x32_bf16 v[168:171], v[68:71], a[48:51], v[168:171]
 s_waitcnt vmcnt(27)
 s_barrier
 ds_read_b64_tr_b16 v[64:65], v19 offset:0
 ds_read_b64_tr_b16 v[66:67], v19 offset:2048
 v_mfma_f32_16x16x32_bf16 v[172:175], v[68:71], a[52:55], v[172:175]
 s_add_u32 m0, s60, 0x1c000
 s_bfe_u32 s65, s87, 0x40018
 s_mul_i32 s65, s65, 0x60000
 v_mfma_f32_16x16x32_bf16 v[176:179], v[72:75], a[48:51], v[176:179]
 s_waitcnt lgkmcnt(6)
 ds_read_b64_tr_b16 v[68:69], v20 offset:0
 ds_read_b64_tr_b16 v[70:71], v20 offset:2048
 v_mfma_f32_16x16x32_bf16 v[180:183], v[72:75], a[52:55], v[180:183]
 buffer_load_dwordx4 v3, s[8:11], s65 offen offset:0  lds
 v_mfma_f32_16x16x32_bf16 v[184:187], v[76:79], a[48:51], v[184:187]
 ds_read_b64_tr_b16 v[72:73], v21 offset:0
 ds_read_b64_tr_b16 v[74:75], v21 offset:2048
 v_mfma_f32_16x16x32_bf16 v[188:191], v[76:79], a[52:55], v[188:191]
 buffer_load_dwordx4 v4, s[8:11], s65 offen offset:1024  lds
 v_mfma_f32_16x16x32_bf16 v[160:163], v[80:83], a[56:59], v[160:163]
 ds_read_b64_tr_b16 v[76:77], v22 offset:0
 ds_read_b64_tr_b16 v[78:79], v22 offset:2048
 v_mfma_f32_16x16x32_bf16 v[164:167], v[80:83], a[60:63], v[164:167]
 buffer_load_dwordx4 v5, s[8:11], s65 offen offset:2048  lds
 v_mfma_f32_16x16x32_bf16 v[168:171], v[84:87], a[56:59], v[168:171]
 s_waitcnt lgkmcnt(6)
 ds_read_b64_tr_b16 v[80:81], v19 offset:4096
 ds_read_b64_tr_b16 v[82:83], v19 offset:6144
 v_mfma_f32_16x16x32_bf16 v[172:175], v[84:87], a[60:63], v[172:175]
 v_mfma_f32_16x16x32_bf16 v[176:179], v[88:91], a[56:59], v[176:179]
 ds_read_b64_tr_b16 v[84:85], v20 offset:4096
 ds_read_b64_tr_b16 v[86:87], v20 offset:6144
 v_mfma_f32_16x16x32_bf16 v[180:183], v[88:91], a[60:63], v[180:183]
 buffer_load_dwordx4 v6, s[8:11], s65 offen offset:3072  lds
 v_mfma_f32_16x16x32_bf16 v[184:187], v[92:95], a[56:59], v[184:187]
 ds_read_b64_tr_b16 v[88:89], v21 offset:4096
 ds_read_b64_tr_b16 v[90:91], v21 offset:6144
 v_mfma_f32_16x16x32_bf16 v[188:191], v[92:95], a[60:63], v[188:191]
 s_waitcnt vmcnt(13)
 v_mfma_f32_16x16x32_bf16 v[160:163], v[64:67], a[64:67], v[160:163]
 s_waitcnt lgkmcnt(6)
 ds_read_b64_tr_b16 v[92:93], v22 offset:4096
 ds_read_b64_tr_b16 v[94:95], v22 offset:6144
 v_mfma_f32_16x16x32_bf16 v[164:167], v[64:67], a[68:71], v[164:167]
 s_atomic_add s93, s[56:57], 0
 v_mfma_f32_16x16x32_bf16 v[168:171], v[68:71], a[64:67], v[168:171]
 ds_read_b64_tr_b16 v[64:65], v19 offset:8192
 ds_read_b64_tr_b16 v[66:67], v19 offset:10240
 v_mfma_f32_16x16x32_bf16 v[172:175], v[68:71], a[68:71], v[172:175]
 v_mfma_f32_16x16x32_bf16 v[176:179], v[72:75], a[64:67], v[176:179]
 ds_read_b64_tr_b16 v[68:69], v20 offset:8192
 ds_read_b64_tr_b16 v[70:71], v20 offset:10240
 v_mfma_f32_16x16x32_bf16 v[180:183], v[72:75], a[68:71], v[180:183]
 v_mfma_f32_16x16x32_bf16 v[184:187], v[76:79], a[64:67], v[184:187]
 s_waitcnt lgkmcnt(6)
 ds_read_b64_tr_b16 v[72:73], v21 offset:8192
 ds_read_b64_tr_b16 v[74:75], v21 offset:10240
 v_mfma_f32_16x16x32_bf16 v[188:191], v[76:79], a[68:71], v[188:191]
 v_mfma_f32_16x16x32_bf16 v[160:163], v[80:83], a[72:75], v[160:163]
 ds_read_b64_tr_b16 v[76:77], v22 offset:8192
 ds_read_b64_tr_b16 v[78:79], v22 offset:10240
 v_mfma_f32_16x16x32_bf16 v[164:167], v[80:83], a[76:79], v[164:167]
 v_mfma_f32_16x16x32_bf16 v[168:171], v[84:87], a[72:75], v[168:171]
 ds_read_b64_tr_b16 v[80:81], v19 offset:12288
 ds_read_b64_tr_b16 v[82:83], v19 offset:14336
 v_mfma_f32_16x16x32_bf16 v[172:175], v[84:87], a[76:79], v[172:175]
 v_mfma_f32_16x16x32_bf16 v[176:179], v[88:91], a[72:75], v[176:179]
 s_waitcnt lgkmcnt(6)
 ds_read_b64_tr_b16 v[84:85], v20 offset:12288
 ds_read_b64_tr_b16 v[86:87], v20 offset:14336
 v_mfma_f32_16x16x32_bf16 v[180:183], v[88:91], a[76:79], v[180:183]
 v_mfma_f32_16x16x32_bf16 v[184:187], v[92:95], a[72:75], v[184:187]
 ds_read_b64_tr_b16 v[88:89], v21 offset:12288
 ds_read_b64_tr_b16 v[90:91], v21 offset:14336
 v_mfma_f32_16x16x32_bf16 v[188:191], v[92:95], a[76:79], v[188:191]
 v_mfma_f32_16x16x32_bf16 v[160:163], v[64:67], a[80:83], v[160:163]
 ds_read_b64_tr_b16 v[92:93], v22 offset:12288
 ds_read_b64_tr_b16 v[94:95], v22 offset:14336
 v_mfma_f32_16x16x32_bf16 v[164:167], v[64:67], a[84:87], v[164:167]
 v_mfma_f32_16x16x32_bf16 v[168:171], v[68:71], a[80:83], v[168:171]
 s_waitcnt lgkmcnt(6)
 s_barrier
 ds_read_b64_tr_b16 v[64:65], v19 offset:16384
 ds_read_b64_tr_b16 v[66:67], v19 offset:18432
 v_mfma_f32_16x16x32_bf16 v[172:175], v[68:71], a[84:87], v[172:175]
 s_add_u32 m0, s60, 0x20000
 s_bfe_u32 s65, s86, 0x40000
 s_mul_i32 s65, s65, 0x20000
 v_mfma_f32_16x16x32_bf16 v[176:179], v[72:75], a[80:83], v[176:179]
 ds_read_b64_tr_b16 v[68:69], v20 offset:16384
 ds_read_b64_tr_b16 v[70:71], v20 offset:18432
 v_mfma_f32_16x16x32_bf16 v[180:183], v[72:75], a[84:87], v[180:183]
 buffer_load_dwordx4 v7, s[12:15], s65 offen offset:0  lds
 v_mfma_f32_16x16x32_bf16 v[184:187], v[76:79], a[80:83], v[184:187]
 ds_read_b64_tr_b16 v[72:73], v21 offset:16384
 ds_read_b64_tr_b16 v[74:75], v21 offset:18432
 v_mfma_f32_16x16x32_bf16 v[188:191], v[76:79], a[84:87], v[188:191]
 buffer_load_dwordx4 v8, s[12:15], s65 offen offset:1024  lds
 v_mfma_f32_16x16x32_bf16 v[160:163], v[80:83], a[88:91], v[160:163]
 s_waitcnt lgkmcnt(6)
 ds_read_b64_tr_b16 v[76:77], v22 offset:16384
 ds_read_b64_tr_b16 v[78:79], v22 offset:18432
 v_mfma_f32_16x16x32_bf16 v[164:167], v[80:83], a[92:95], v[164:167]
 buffer_load_dwordx4 v9, s[12:15], s65 offen offset:2048  lds
 v_mfma_f32_16x16x32_bf16 v[168:171], v[84:87], a[88:91], v[168:171]
 ds_read_b64_tr_b16 v[80:81], v19 offset:20480
 ds_read_b64_tr_b16 v[82:83], v19 offset:22528
 v_mfma_f32_16x16x32_bf16 v[172:175], v[84:87], a[92:95], v[172:175]
 v_mfma_f32_16x16x32_bf16 v[176:179], v[88:91], a[88:91], v[176:179]
 ds_read_b64_tr_b16 v[84:85], v20 offset:20480
 ds_read_b64_tr_b16 v[86:87], v20 offset:22528
 v_mfma_f32_16x16x32_bf16 v[180:183], v[88:91], a[92:95], v[180:183]
 buffer_load_dwordx4 v10, s[12:15], s65 offen offset:3072  lds
 v_mfma_f32_16x16x32_bf16 v[184:187], v[92:95], a[88:91], v[184:187]
 s_waitcnt lgkmcnt(6)
 ds_read_b64_tr_b16 v[88:89], v21 offset:20480
 ds_read_b64_tr_b16 v[90:91], v21 offset:22528
 v_mfma_f32_16x16x32_bf16 v[188:191], v[92:95], a[92:95], v[188:191]
 v_mfma_f32_16x16x32_bf16 v[160:163], v[64:67], a[96:99], v[160:163]
 ds_read_b64_tr_b16 v[92:93], v22 offset:20480
 ds_read_b64_tr_b16 v[94:95], v22 offset:22528
 v_mfma_f32_16x16x32_bf16 v[164:167], v[64:67], a[100:103], v[164:167]
 v_mfma_f32_16x16x32_bf16 v[168:171], v[68:71], a[96:99], v[168:171]
 ds_read_b64_tr_b16 v[64:65], v19 offset:24576
 ds_read_b64_tr_b16 v[66:67], v19 offset:26624
 v_mfma_f32_16x16x32_bf16 v[172:175], v[68:71], a[100:103], v[172:175]
 v_mfma_f32_16x16x32_bf16 v[176:179], v[72:75], a[96:99], v[176:179]
 s_waitcnt lgkmcnt(6)
 ds_read_b64_tr_b16 v[68:69], v20 offset:24576
 ds_read_b64_tr_b16 v[70:71], v20 offset:26624
 v_mfma_f32_16x16x32_bf16 v[180:183], v[72:75], a[100:103], v[180:183]
 v_mfma_f32_16x16x32_bf16 v[184:187], v[76:79], a[96:99], v[184:187]
 ds_read_b64_tr_b16 v[72:73], v21 offset:24576
 ds_read_b64_tr_b16 v[74:75], v21 offset:26624
 v_mfma_f32_16x16x32_bf16 v[188:191], v[76:79], a[100:103], v[188:191]
 v_mfma_f32_16x16x32_bf16 v[160:163], v[80:83], a[104:107], v[160:163]
 ds_read_b64_tr_b16 v[76:77], v22 offset:24576
 ds_read_b64_tr_b16 v[78:79], v22 offset:26624
 v_mfma_f32_16x16x32_bf16 v[164:167], v[80:83], a[108:111], v[164:167]
 v_mfma_f32_16x16x32_bf16 v[168:171], v[84:87], a[104:107], v[168:171]
 s_waitcnt lgkmcnt(6)
 ds_read_b64_tr_b16 v[80:81], v19 offset:28672
 ds_read_b64_tr_b16 v[82:83], v19 offset:30720
 v_mfma_f32_16x16x32_bf16 v[172:175], v[84:87], a[108:111], v[172:175]
 v_mfma_f32_16x16x32_bf16 v[176:179], v[88:91], a[104:107], v[176:179]
 ds_read_b64_tr_b16 v[84:85], v20 offset:28672
 ds_read_b64_tr_b16 v[86:87], v20 offset:30720
 v_mfma_f32_16x16x32_bf16 v[180:183], v[88:91], a[108:111], v[180:183]
 v_mfma_f32_16x16x32_bf16 v[184:187], v[92:95], a[104:107], v[184:187]
 ds_read_b64_tr_b16 v[88:89], v21 offset:28672
 ds_read_b64_tr_b16 v[90:91], v21 offset:30720
 v_mfma_f32_16x16x32_bf16 v[188:191], v[92:95], a[108:111], v[188:191]
 v_mfma_f32_16x16x32_bf16 v[160:163], v[64:67], a[112:115], v[160:163]
 s_waitcnt lgkmcnt(6)
 ds_read_b64_tr_b16 v[92:93], v22 offset:28672
 ds_read_b64_tr_b16 v[94:95], v22 offset:30720
 v_mfma_f32_16x16x32_bf16 v[164:167], v[64:67], a[116:119], v[164:167]
 v_mfma_f32_16x16x32_bf16 v[168:171], v[68:71], a[112:115], v[168:171]
 s_barrier
 ds_read_b64_tr_b16 v[64:65], v19 offset:32768
 ds_read_b64_tr_b16 v[66:67], v19 offset:34816
 v_mfma_f32_16x16x32_bf16 v[172:175], v[68:71], a[116:119], v[172:175]
 s_add_u32 m0, s60, 0x0
 s_bfe_u32 s65, s86, 0x40008
 s_mul_i32 s65, s65, 0x20000
 v_mfma_f32_16x16x32_bf16 v[176:179], v[72:75], a[112:115], v[176:179]
 ds_read_b64_tr_b16 v[68:69], v20 offset:32768
 ds_read_b64_tr_b16 v[70:71], v20 offset:34816
 v_mfma_f32_16x16x32_bf16 v[180:183], v[72:75], a[116:119], v[180:183]
 buffer_load_dwordx4 v7, s[12:15], s65 offen offset:0  lds
 v_mfma_f32_16x16x32_bf16 v[184:187], v[76:79], a[112:115], v[184:187]
 s_waitcnt lgkmcnt(6)
 ds_read_b64_tr_b16 v[72:73], v21 offset:32768
 ds_read_b64_tr_b16 v[74:75], v21 offset:34816
 v_mfma_f32_16x16x32_bf16 v[188:191], v[76:79], a[116:119], v[188:191]
 buffer_load_dwordx4 v8, s[12:15], s65 offen offset:1024  lds
 v_mfma_f32_16x16x32_bf16 v[160:163], v[80:83], a[120:123], v[160:163]
 ds_read_b64_tr_b16 v[76:77], v22 offset:32768
 ds_read_b64_tr_b16 v[78:79], v22 offset:34816
 v_mfma_f32_16x16x32_bf16 v[164:167], v[80:83], a[124:127], v[164:167]
 buffer_load_dwordx4 v9, s[12:15], s65 offen offset:2048  lds
 v_mfma_f32_16x16x32_bf16 v[168:171], v[84:87], a[120:123], v[168:171]
 ds_read_b64_tr_b16 v[80:81], v19 offset:36864
 ds_read_b64_tr_b16 v[82:83], v19 offset:38912
 v_mfma_f32_16x16x32_bf16 v[172:175], v[84:87], a[124:127], v[172:175]
 v_mfma_f32_16x16x32_bf16 v[176:179], v[88:91], a[120:123], v[176:179]
 s_waitcnt lgkmcnt(6)
 ds_read_b64_tr_b16 v[84:85], v20 offset:36864
 ds_read_b64_tr_b16 v[86:87], v20 offset:38912
 v_mfma_f32_16x16x32_bf16 v[180:183], v[88:91], a[124:127], v[180:183]
 buffer_load_dwordx4 v10, s[12:15], s65 offen offset:3072  lds
 v_mfma_f32_16x16x32_bf16 v[184:187], v[92:95], a[120:123], v[184:187]
 ds_read_b64_tr_b16 v[88:89], v21 offset:36864
 ds_read_b64_tr_b16 v[90:91], v21 offset:38912
 v_mfma_f32_16x16x32_bf16 v[188:191], v[92:95], a[124:127], v[188:191]
 s_mov_b32 s79, 0
 s_atomic_add s79, s[56:57], 0 glc
 v_mfma_f32_16x16x32_bf16 v[160:163], v[64:67], a[128:131], v[160:163]
 ds_read_b64_tr_b16 v[92:93], v22 offset:36864
 ds_read_b64_tr_b16 v[94:95], v22 offset:38912
 v_mfma_f32_16x16x32_bf16 v[164:167], v[64:67], a[132:135], v[164:167]
 v_mfma_f32_16x16x32_bf16 v[168:171], v[68:71], a[128:131], v[168:171]
 s_waitcnt lgkmcnt(6)
 ds_read_b64_tr_b16 v[64:65], v19 offset:40960
 ds_read_b64_tr_b16 v[66:67], v19 offset:43008
 v_mfma_f32_16x16x32_bf16 v[172:175], v[68:71], a[132:135], v[172:175]
 v_mfma_f32_16x16x32_bf16 v[176:179], v[72:75], a[128:131], v[176:179]
 ds_read_b64_tr_b16 v[68:69], v20 offset:40960
 ds_read_b64_tr_b16 v[70:71], v20 offset:43008
 v_mfma_f32_16x16x32_bf16 v[180:183], v[72:75], a[132:135], v[180:183]
 v_mfma_f32_16x16x32_bf16 v[184:187], v[76:79], a[128:131], v[184:187]
 ds_read_b64_tr_b16 v[72:73], v21 offset:40960
 ds_read_b64_tr_b16 v[74:75], v21 offset:43008
 v_mfma_f32_16x16x32_bf16 v[188:191], v[76:79], a[132:135], v[188:191]
 v_mfma_f32_16x16x32_bf16 v[160:163], v[80:83], a[136:139], v[160:163]
 s_waitcnt lgkmcnt(6)
 ds_read_b64_tr_b16 v[76:77], v22 offset:40960
 ds_read_b64_tr_b16 v[78:79], v22 offset:43008
 v_mfma_f32_16x16x32_bf16 v[164:167], v[80:83], a[140:143], v[164:167]
 v_mfma_f32_16x16x32_bf16 v[168:171], v[84:87], a[136:139], v[168:171]
 ds_read_b64_tr_b16 v[80:81], v19 offset:45056
 ds_read_b64_tr_b16 v[82:83], v19 offset:47104
 v_mfma_f32_16x16x32_bf16 v[172:175], v[84:87], a[140:143], v[172:175]
 v_mfma_f32_16x16x32_bf16 v[176:179], v[88:91], a[136:139], v[176:179]
 ds_read_b64_tr_b16 v[84:85], v20 offset:45056
 ds_read_b64_tr_b16 v[86:87], v20 offset:47104
 v_mfma_f32_16x16x32_bf16 v[180:183], v[88:91], a[140:143], v[180:183]
 v_mfma_f32_16x16x32_bf16 v[184:187], v[92:95], a[136:139], v[184:187]
 s_waitcnt lgkmcnt(6)
 ds_read_b64_tr_b16 v[88:89], v21 offset:45056
 ds_read_b64_tr_b16 v[90:91], v21 offset:47104
 v_mfma_f32_16x16x32_bf16 v[188:191], v[92:95], a[140:143], v[188:191]
 v_mfma_f32_16x16x32_bf16 v[160:163], v[64:67], a[144:147], v[160:163]
 ds_read_b64_tr_b16 v[92:93], v22 offset:45056
 ds_read_b64_tr_b16 v[94:95], v22 offset:47104
 v_mfma_f32_16x16x32_bf16 v[164:167], v[64:67], a[148:151], v[164:167]
 v_mfma_f32_16x16x32_bf16 v[168:171], v[68:71], a[144:147], v[168:171]
 s_barrier
 ds_read_b64_tr_b16 v[64:65], v19 offset:49152
 ds_read_b64_tr_b16 v[66:67], v19 offset:51200
 v_mfma_f32_16x16x32_bf16 v[172:175], v[68:71], a[148:151], v[172:175]
 s_add_u32 m0, s60, 0x4000
 s_bfe_u32 s65, s86, 0x40010
 s_mul_i32 s65, s65, 0x20000
 v_mfma_f32_16x16x32_bf16 v[176:179], v[72:75], a[144:147], v[176:179]
 s_waitcnt lgkmcnt(6)
 ds_read_b64_tr_b16 v[68:69], v20 offset:49152
 ds_read_b64_tr_b16 v[70:71], v20 offset:51200
 v_mfma_f32_16x16x32_bf16 v[180:183], v[72:75], a[148:151], v[180:183]
 buffer_load_dwordx4 v7, s[12:15], s65 offen offset:0  lds
 v_mfma_f32_16x16x32_bf16 v[184:187], v[76:79], a[144:147], v[184:187]
 ds_read_b64_tr_b16 v[72:73], v21 offset:49152
 ds_read_b64_tr_b16 v[74:75], v21 offset:51200
 v_mfma_f32_16x16x32_bf16 v[188:191], v[76:79], a[148:151], v[188:191]
 buffer_load_dwordx4 v8, s[12:15], s65 offen offset:1024  lds
 v_mfma_f32_16x16x32_bf16 v[160:163], v[80:83], a[152:155], v[160:163]
 ds_read_b64_tr_b16 v[76:77], v22 offset:49152
 ds_read_b64_tr_b16 v[78:79], v22 offset:51200
 v_mfma_f32_16x16x32_bf16 v[164:167], v[80:83], a[156:159], v[164:167]
 buffer_load_dwordx4 v9, s[12:15], s65 offen offset:2048  lds
 v_mfma_f32_16x16x32_bf16 v[168:171], v[84:87], a[152:155], v[168:171]
 s_waitcnt lgkmcnt(6)
 ds_read_b64_tr_b16 v[80:81], v19 offset:53248
 ds_read_b64_tr_b16 v[82:83], v19 offset:55296
 v_mfma_f32_16x16x32_bf16 v[172:175], v[84:87], a[156:159], v[172:175]
 v_mfma_f32_16x16x32_bf16 v[176:179], v[88:91], a[152:155], v[176:179]
 ds_read_b64_tr_b16 v[84:85], v20 offset:53248
 ds_read_b64_tr_b16 v[86:87], v20 offset:55296
 v_mfma_f32_16x16x32_bf16 v[180:183], v[88:91], a[156:159], v[180:183]
 buffer_load_dwordx4 v10, s[12:15], s65 offen offset:3072  lds
 v_mfma_f32_16x16x32_bf16 v[184:187], v[92:95], a[152:155], v[184:187]
 ds_read_b64_tr_b16 v[88:89], v21 offset:53248
 ds_read_b64_tr_b16 v[90:91], v21 offset:55296
 v_mfma_f32_16x16x32_bf16 v[188:191], v[92:95], a[156:159], v[188:191]
 v_mfma_f32_16x16x32_bf16 v[160:163], v[64:67], a[160:163], v[160:163]
 s_waitcnt lgkmcnt(6)
 ds_read_b64_tr_b16 v[92:93], v22 offset:53248
 ds_read_b64_tr_b16 v[94:95], v22 offset:55296
 v_mfma_f32_16x16x32_bf16 v[164:167], v[64:67], a[164:167], v[164:167]
 v_mfma_f32_16x16x32_bf16 v[168:171], v[68:71], a[160:163], v[168:171]
 ds_read_b64_tr_b16 v[64:65], v19 offset:57344
 ds_read_b64_tr_b16 v[66:67], v19 offset:59392
 v_mfma_f32_16x16x32_bf16 v[172:175], v[68:71], a[164:167], v[172:175]
 v_mfma_f32_16x16x32_bf16 v[176:179], v[72:75], a[160:163], v[176:179]
 ds_read_b64_tr_b16 v[68:69], v20 offset:57344
 ds_read_b64_tr_b16 v[70:71], v20 offset:59392
 v_mfma_f32_16x16x32_bf16 v[180:183], v[72:75], a[164:167], v[180:183]
 v_mfma_f32_16x16x32_bf16 v[184:187], v[76:79], a[160:163], v[184:187]
 s_waitcnt lgkmcnt(6)
 ds_read_b64_tr_b16 v[72:73], v21 offset:57344
 ds_read_b64_tr_b16 v[74:75], v21 offset:59392
 v_mfma_f32_16x16x32_bf16 v[188:191], v[76:79], a[164:167], v[188:191]
 v_mfma_f32_16x16x32_bf16 v[160:163], v[80:83], a[168:171], v[160:163]
 ds_read_b64_tr_b16 v[76:77], v22 offset:57344
 ds_read_b64_tr_b16 v[78:79], v22 offset:59392
 v_mfma_f32_16x16x32_bf16 v[164:167], v[80:83], a[172:175], v[164:167]
 v_mfma_f32_16x16x32_bf16 v[168:171], v[84:87], a[168:171], v[168:171]
 ds_read_b64_tr_b16 v[80:81], v19 offset:61440
 ds_read_b64_tr_b16 v[82:83], v19 offset:63488
 v_mfma_f32_16x16x32_bf16 v[172:175], v[84:87], a[172:175], v[172:175]
 v_mfma_f32_16x16x32_bf16 v[176:179], v[88:91], a[168:171], v[176:179]
 s_waitcnt lgkmcnt(6)
 ds_read_b64_tr_b16 v[84:85], v20 offset:61440
 ds_read_b64_tr_b16 v[86:87], v20 offset:63488
 v_mfma_f32_16x16x32_bf16 v[180:183], v[88:91], a[172:175], v[180:183]
 v_mfma_f32_16x16x32_bf16 v[184:187], v[92:95], a[168:171], v[184:187]
 ds_read_b64_tr_b16 v[88:89], v21 offset:61440
 ds_read_b64_tr_b16 v[90:91], v21 offset:63488
 v_mfma_f32_16x16x32_bf16 v[188:191], v[92:95], a[172:175], v[188:191]
 v_mfma_f32_16x16x32_bf16 v[160:163], v[64:67], a[176:179], v[160:163]
 ds_read_b64_tr_b16 v[92:93], v22 offset:61440
 ds_read_b64_tr_b16 v[94:95], v22 offset:63488
 v_mfma_f32_16x16x32_bf16 v[164:167], v[64:67], a[180:183], v[164:167]
 v_mfma_f32_16x16x32_bf16 v[168:171], v[68:71], a[176:179], v[168:171]
 s_waitcnt lgkmcnt(6)
 s_barrier
 ds_read_b64_tr_b16 v[64:65], v23 offset:0
 ds_read_b64_tr_b16 v[66:67], v23 offset:2048
 v_mfma_f32_16x16x32_bf16 v[172:175], v[68:71], a[180:183], v[172:175]
 s_add_u32 m0, s60, 0x8000
 s_bfe_u32 s65, s86, 0x40018
 s_mul_i32 s65, s65, 0x20000
 v_mfma_f32_16x16x32_bf16 v[176:179], v[72:75], a[176:179], v[176:179]
 ds_read_b64_tr_b16 v[68:69], v24 offset:0
 ds_read_b64_tr_b16 v[70:71], v24 offset:2048
 v_mfma_f32_16x16x32_bf16 v[180:183], v[72:75], a[180:183], v[180:183]
 buffer_load_dwordx4 v7, s[12:15], s65 offen offset:0  lds
 v_mfma_f32_16x16x32_bf16 v[184:187], v[76:79], a[176:179], v[184:187]
 ds_read_b64_tr_b16 v[72:73], v25 offset:0
 ds_read_b64_tr_b16 v[74:75], v25 offset:2048
 v_mfma_f32_16x16x32_bf16 v[188:191], v[76:79], a[180:183], v[188:191]
 buffer_load_dwordx4 v8, s[12:15], s65 offen offset:1024  lds
 v_mfma_f32_16x16x32_bf16 v[160:163], v[80:83], a[184:187], v[160:163]
 s_waitcnt lgkmcnt(6)
 ds_read_b64_tr_b16 v[76:77], v26 offset:0
 ds_read_b64_tr_b16 v[78:79], v26 offset:2048
 v_mfma_f32_16x16x32_bf16 v[164:167], v[80:83], a[188:191], v[164:167]
 buffer_load_dwordx4 v9, s[12:15], s65 offen offset:2048  lds
 v_mfma_f32_16x16x32_bf16 v[168:171], v[84:87], a[184:187], v[168:171]
 ds_read_b64_tr_b16 v[80:81], v23 offset:4096
 ds_read_b64_tr_b16 v[82:83], v23 offset:6144
 v_mfma_f32_16x16x32_bf16 v[172:175], v[84:87], a[188:191], v[172:175]
 s_mov_b32 s67, 0
mk_w13:
 s_waitcnt lgkmcnt(0)
 s_cmp_ge_u32 s79, 16
 s_cbranch_scc1 mk_d14
 s_mov_b32 s79, 0
 s_atomic_add s79, s[56:57], 0 glc
 s_add_u32 s67, s67, 1
 s_cmp_lt_u32 s67, 0x8000
 s_cbranch_scc1 mk_w13
mk_d14:
 v_mfma_f32_16x16x32_bf16 v[176:179], v[88:91], a[184:187], v[176:179]
 ds_read_b64_tr_b16 v[84:85], v24 offset:4096
 ds_read_b64_tr_b16 v[86:87], v24 offset:6144
 v_mfma_f32_16x16x32_bf16 v[180:183], v[88:91], a[188:191], v[180:183]
 buffer_load_dwordx4 v10, s[12:15], s65 offen offset:3072  lds
 v_mfma_f32_16x16x32_bf16 v[184:187], v[92:95], a[184:187], v[184:187]
 ds_read_b64_tr_b16 v[88:89], v25 offset:4096
 ds_read_b64_tr_b16 v[90:91], v25 offset:6144
 v_mfma_f32_16x16x32_bf16 v[188:191], v[92:95], a[188:191], v[188:191]
 v_mfma_f32_16x16x32_bf16 v[160:163], v[64:67], a[192:195], v[160:163]
 s_add_u32 s69, s49, 0x3c00000
 ds_read_b64_tr_b16 v[92:93], v26 offset:4096
 ds_read_b64_tr_b16 v[94:95], v26 offset:6144
 v_mfma_f32_16x16x32_bf16 v[164:167], v[64:67], a[196:199], v[164:167]
 buffer_load_dwordx4 v[224:227], v1, s[4:7], s69 offen offset:0 sc1
 v_mfma_f32_16x16x32_bf16 v[168:171], v[68:71], a[192:195], v[168:171]
 ds_read_b64_tr_b16 v[64:65], v23 offset:8192
 ds_read_b64_tr_b16 v[66:67], v23 offset:10240
 v_mfma_f32_16x16x32_bf16 v[172:175], v[68:71], a[196:199], v[172:175]
 v_mfma_f32_16x16x32_bf16 v[176:179], v[72:75], a[192:195], v[176:179]
 s_waitcnt lgkmcnt(6)
 ds_read_b64_tr_b16 v[68:69], v24 offset:8192
 ds_read_b64_tr_b16 v[70:71], v24 offset:10240
 v_mfma_f32_16x16x32_bf16 v[180:183], v[72:75], a[196:199], v[180:183]
 buffer_load_dwordx4 v[228:231], v1, s[4:7], s69 offen offset:1024 sc1
 v_mfma_f32_16x16x32_bf16 v[184:187], v[76:79], a[192:195], v[184:187]
 ds_read_b64_tr_b16 v[72:73], v25 offset:8192
 ds_read_b64_tr_b16 v[74:75], v25 offset:10240
 v_mfma_f32_16x16x32_bf16 v[188:191], v[76:79], a[196:199], v[188:191]
 v_mfma_f32_16x16x32_bf16 v[160:163], v[80:83], a[200:203], v[160:163]
 ds_read_b64_tr_b16 v[76:77], v26 offset:8192
 ds_read_b64_tr_b16 v[78:79], v26 offset:10240
 v_mfma_f32_16x16x32_bf16 v[164:167], v[80:83], a[204:207], v[164:167]
 buffer_load_dwordx4 v[232:235], v1, s[4:7], s69 offen offset:2048 sc1
 v_mfma_f32_16x16x32_bf16 v[168:171], v[84:87], a[200:203], v[168:171]
 s_waitcnt lgkmcnt(6)
 ds_read_b64_tr_b16 v[80:81], v23 offset:12288
 ds_read_b64_tr_b16 v[82:83], v23 offset:14336
 v_mfma_f32_16x16x32_bf16 v[172:175], v[84:87], a[204:207], v[172:175]
 v_mfma_f32_16x16x32_bf16 v[176:179], v[88:91], a[200:203], v[176:179]
 ds_read_b64_tr_b16 v[84:85], v24 offset:12288
 ds_read_b64_tr_b16 v[86:87], v24 offset:14336
 v_mfma_f32_16x16x32_bf16 v[180:183], v[88:91], a[204:207], v[180:183]
 buffer_load_dwordx4 v[236:239], v1, s[4:7], s69 offen offset:3072 sc1
 v_mfma_f32_16x16x32_bf16 v[184:187], v[92:95], a[200:203], v[184:187]
 s_add_u32 s69, s47, 0x3a00000
 ds_read_b64_tr_b16 v[88:89], v25 offset:12288
 ds_read_b64_tr_b16 v[90:91], v25 offset:14336
 v_mfma_f32_16x16x32_bf16 v[188:191], v[92:95], a[204:207], v[188:191]
 v_mfma_f32_16x16x32_bf16 v[160:163], v[64:67], a[208:211], v[160:163]
 s_waitcnt lgkmcnt(6)
 ds_read_b64_tr_b16 v[92:93], v26 offset:12288
 ds_read_b64_tr_b16 v[94:95], v26 offset:14336
 v_mfma_f32_16x16x32_bf16 v[164:167], v[64:67], a[212:215], v[164:167]
 buffer_load_dwordx4 a[16:19], v11, s[4:7], s69 offen offset:0 sc1
 v_mfma_f32_16x16x32_bf16 v[168:171], v[68:71], a[208:211], v[168:171]
 s_waitcnt vmcnt(21)
 s_barrier
 ds_read_b64_tr_b16 v[64:65], v23 offset:49152
 ds_read_b64_tr_b16 v[66:67], v23 offset:51200
 v_mfma_f32_16x16x32_bf16 v[172:175], v[68:71], a[212:215], v[172:175]
 v_mfma_f32_16x16x32_bf16 v[176:179], v[72:75], a[208:211], v[176:179]
 ds_read_b64_tr_b16 v[68:69], v24 offset:49152
 ds_read_b64_tr_b16 v[70:71], v24 offset:51200
 v_mfma_f32_16x16x32_bf16 v[180:183], v[72:75], a[212:215], v[180:183]
 buffer_load_dwordx4 a[20:23], v11, s[4:7], s69 offen offset:2048 sc1
 v_mfma_f32_16x16x32_bf16 v[184:187], v[76:79], a[208:211], v[184:187]
 s_waitcnt lgkmcnt(6)
 ds_read_b64_tr_b16 v[72:73], v25 offset:49152
 ds_read_b64_tr_b16 v[74:75], v25 offset:51200
 v_mfma_f32_16x16x32_bf16 v[188:191], v[76:79], a[212:215], v[188:191]
 v_mfma_f32_16x16x32_bf16 v[160:163], v[80:83], a[216:219], v[160:163]
 ds_read_b64_tr_b16 v[76:77], v26 offset:49152
 ds_read_b64_tr_b16 v[78:79], v26 offset:51200
 v_mfma_f32_16x16x32_bf16 v[164:167], v[80:83], a[220:223], v[164:167]
 buffer_load_dwordx4 a[24:27], v14, s[4:7], s69 offen offset:0 sc1
 v_mfma_f32_16x16x32_bf16 v[168:171], v[84:87], a[216:219], v[168:171]
 ds_read_b64_tr_b16 v[80:81], v23 offset:53248
 ds_read_b64_tr_b16 v[82:83], v23 offset:55296
 v_mfma_f32_16x16x32_bf16 v[172:175], v[84:87], a[220:223], v[172:175]
 v_mfma_f32_16x16x32_bf16 v[176:179], v[88:91], a[216:219], v[176:179]
 s_waitcnt lgkmcnt(6)
 ds_read_b64_tr_b16 v[84:85], v24 offset:53248
 ds_read_b64_tr_b16 v[86:87], v24 offset:55296
 v_mfma_f32_16x16x32_bf16 v[180:183], v[88:91], a[220:223], v[180:183]
 buffer_load_dwordx4 a[28:31], v14, s[4:7], s69 offen offset:2048 sc1
 v_mfma_f32_16x16x32_bf16 v[184:187], v[92:95], a[216:219], v[184:187]
 s_add_u32 s69, s47, 0x3a02000
 ds_read_b64_tr_b16 v[88:89], v25 offset:53248
 ds_read_b64_tr_b16 v[90:91], v25 offset:55296
 v_mfma_f32_16x16x32_bf16 v[188:191], v[92:95], a[220:223], v[188:191]
 v_mfma_f32_16x16x32_bf16 v[160:163], v[64:67], a[224:227], v[160:163]
 ds_read_b64_tr_b16 v[92:93], v26 offset:53248
 ds_read_b64_tr_b16 v[94:95], v26 offset:55296
 v_mfma_f32_16x16x32_bf16 v[164:167], v[64:67], a[228:231], v[164:167]
 buffer_load_dwordx4 a[32:35], v11, s[4:7], s69 offen offset:0 sc1
 v_mfma_f32_16x16x32_bf16 v[168:171], v[68:71], a[224:227], v[168:171]
 s_waitcnt lgkmcnt(6)
 ds_read_b64_tr_b16 v[64:65], v23 offset:57344
 ds_read_b64_tr_b16 v[66:67], v23 offset:59392
 v_mfma_f32_16x16x32_bf16 v[172:175], v[68:71], a[228:231], v[172:175]
 v_mfma_f32_16x16x32_bf16 v[176:179], v[72:75], a[224:227], v[176:179]
 ds_read_b64_tr_b16 v[68:69], v24 offset:57344
 ds_read_b64_tr_b16 v[70:71], v24 offset:59392
 v_mfma_f32_16x16x32_bf16 v[180:183], v[72:75], a[228:231], v[180:183]
 buffer_load_dwordx4 a[36:39], v11, s[4:7], s69 offen offset:2048 sc1
 v_mfma_f32_16x16x32_bf16 v[184:187], v[76:79], a[224:227], v[184:187]
 ds_read_b64_tr_b16 v[72:73], v25 offset:57344
 ds_read_b64_tr_b16 v[74:75], v25 offset:59392
 v_mfma_f32_16x16x32_bf16 v[188:191], v[76:79], a[228:231], v[188:191]
 v_mfma_f32_16x16x32_bf16 v[160:163], v[80:83], a[232:235], v[160:163]
 s_waitcnt lgkmcnt(6)
 ds_read_b64_tr_b16 v[76:77], v26 offset:57344
 ds_read_b64_tr_b16 v[78:79], v26 offset:59392
 v_mfma_f32_16x16x32_bf16 v[164:167], v[80:83], a[236:239], v[164:167]
 buffer_load_dwordx4 a[40:43], v14, s[4:7], s69 offen offset:0 sc1
 v_mfma_f32_16x16x32_bf16 v[168:171], v[84:87], a[232:235], v[168:171]
 ds_read_b64_tr_b16 v[80:81], v23 offset:61440
 ds_read_b64_tr_b16 v[82:83], v23 offset:63488
 v_mfma_f32_16x16x32_bf16 v[172:175], v[84:87], a[236:239], v[172:175]
 v_mfma_f32_16x16x32_bf16 v[176:179], v[88:91], a[232:235], v[176:179]
 ds_read_b64_tr_b16 v[84:85], v24 offset:61440
 ds_read_b64_tr_b16 v[86:87], v24 offset:63488
 v_mfma_f32_16x16x32_bf16 v[180:183], v[88:91], a[236:239], v[180:183]
 buffer_load_dwordx4 a[44:47], v14, s[4:7], s69 offen offset:2048 sc1
 v_mfma_f32_16x16x32_bf16 v[184:187], v[92:95], a[232:235], v[184:187]
 s_waitcnt lgkmcnt(6)
 ds_read_b64_tr_b16 v[88:89], v25 offset:61440
 ds_read_b64_tr_b16 v[90:91], v25 offset:63488
 v_mfma_f32_16x16x32_bf16 v[188:191], v[92:95], a[236:239], v[188:191]
 s_add_u32 s69, s47, 0x3a04000
 v_mfma_f32_16x16x32_bf16 v[160:163], v[64:67], a[240:243], v[160:163]
 ds_read_b64_tr_b16 v[92:93], v26 offset:61440
 ds_read_b64_tr_b16 v[94:95], v26 offset:63488
 v_mfma_f32_16x16x32_bf16 v[164:167], v[64:67], a[244:247], v[164:167]
 buffer_load_dwordx4 a[48:51], v11, s[4:7], s69 offen offset:0 sc1
 v_mfma_f32_16x16x32_bf16 v[168:171], v[68:71], a[240:243], v[168:171]
 ds_read_b32 v64, v58 offset:512
 ds_read_b32 v65, v58 offset:512
 v_mfma_f32_16x16x32_bf16 v[172:175], v[68:71], a[244:247], v[172:175]
 v_mfma_f32_16x16x32_bf16 v[176:179], v[72:75], a[240:243], v[176:179]
 s_waitcnt lgkmcnt(6)
 ds_read_b32 v68, v58 offset:576
 ds_read_b32 v69, v58 offset:576
 v_mfma_f32_16x16x32_bf16 v[180:183], v[72:75], a[244:247], v[180:183]
 buffer_load_dwordx4 a[52:55], v11, s[4:7], s69 offen offset:2048 sc1
 v_mfma_f32_16x16x32_bf16 v[184:187], v[76:79], a[240:243], v[184:187]
 ds_read_b32 v72, v58 offset:640
 ds_read_b32 v73, v58 offset:640
 v_mfma_f32_16x16x32_bf16 v[188:191], v[76:79], a[244:247], v[188:191]
 v_mfma_f32_16x16x32_bf16 v[160:163], v[80:83], a[248:251], v[160:163]
 ds_read_b32 v76, v58 offset:704
 ds_read_b32 v77, v58 offset:704
 v_mfma_f32_16x16x32_bf16 v[164:167], v[80:83], a[252:255], v[164:167]
 buffer_load_dwordx4 a[56:59], v14, s[4:7], s69 offen offset:0 sc1
 v_mfma_f32_16x16x32_bf16 v[168:171], v[84:87], a[248:251], v[168:171]
 s_waitcnt lgkmcnt(6)
 v_mfma_f32_16x16x32_bf16 v[172:175], v[84:87], a[252:255], v[172:175]
 v_mfma_f32_16x16x32_bf16 v[176:179], v[88:91], a[248:251], v[176:179]
 v_mfma_f32_16x16x32_bf16 v[180:183], v[88:91], a[252:255], v[180:183]
 buffer_load_dwordx4 a[60:63], v14, s[4:7], s69 offen offset:2048 sc1
 v_mfma_f32_16x16x32_bf16 v[184:187], v[92:95], a[248:251], v[184:187]
 s_add_u32 s69, s47, 0x3a06000
 v_mfma_f32_16x16x32_bf16 v[188:191], v[92:95], a[252:255], v[188:191]
 v_mfma_f32_16x16x32_bf16 v[160:163], v[64:67], v[48:51], v[160:163]
 s_waitcnt lgkmcnt(0)
 v_mfma_f32_16x16x32_bf16 v[164:167], v[64:67], v[52:55], v[164:167]
 buffer_load_dwordx4 a[64:67], v11, s[4:7], s69 offen offset:0 sc1
 v_mfma_f32_16x16x32_bf16 v[168:171], v[68:71], v[48:51], v[168:171]
 v_mfma_f32_16x16x32_bf16 v[172:175], v[68:71], v[52:55], v[172:175]
 v_mfma_f32_16x16x32_bf16 v[176:179], v[72:75], v[48:51], v[176:179]
 v_mfma_f32_16x16x32_bf16 v[180:183], v[72:75], v[52:55], v[180:183]
 buffer_load_dwordx4 a[68:71], v11, s[4:7], s69 offen offset:2048 sc1
 v_mfma_f32_16x16x32_bf16 v[184:187], v[76:79], v[48:51], v[184:187]
 v_mfma_f32_16x16x32_bf16 v[188:191], v[76:79], v[52:55], v[188:191]
 s_barrier
 v_pk_fma_f32 v[160:161], v[160:161], v[40:41], s[70:71] op_sel_hi:[1,0,1]
 v_pk_mul_f32 v[64:65], v[160:161], s[72:73]
 v_max_f32 v160, s70, v160
 v_exp_f32_e64 v64, v64 clamp
 v_max_f32 v161, s70, v161
 v_exp_f32_e64 v65, v65 clamp
 buffer_load_dwordx4 a[72:75], v14, s[4:7], s69 offen offset:0 sc1
 v_pk_fma_f32 v[162:163], v[162:163], v[40:41], s[70:71] op_sel_hi:[1,0,1]
 v_pk_mul_f32 v[66:67], v[162:163], s[72:73]
 v_max_f32 v162, s70, v162
 v_exp_f32_e64 v66, v66 clamp
 v_max_f32 v163, s70, v163
 v_exp_f32_e64 v67, v67 clamp
 buffer_load_dwordx4 a[76:79], v14, s[4:7], s69 offen offset:2048 sc1
 v_pk_fma_f32 v[168:169], v[168:169], v[40:41], s[70:71] op_sel_hi:[1,0,1]
 v_pk_mul_f32 v[68:69], v[168:169], s[72:73]
 v_max_f32 v168, s70, v168
 v_exp_f32_e64 v68, v68 clamp
 v_max_f32 v169, s70, v169
 v_exp_f32_e64 v69, v69 clamp
 v_pk_fma_f32 v[170:171], v[170:171], v[40:41], s[70:71] op_sel_hi:[1,0,1]
 v_pk_mul_f32 v[70:71], v[170:171], s[72:73]
 v_max_f32 v170, s70, v170
 v_exp_f32_e64 v70, v70 clamp
 v_max_f32 v171, s70, v171
 v_exp_f32_e64 v71, v71 clamp
 v_pk_add_f32 v[160:161], v[160:161], v[64:65]
 v_cvt_pk_bf16_f32 v208, v160, v161
 v_pk_add_f32 v[162:163], v[162:163], v[66:67]
 v_cvt_pk_bf16_f32 v209, v162, v163
 v_pk_add_f32 v[168:169], v[168:169], v[68:69]
 v_cvt_pk_bf16_f32 v210, v168, v169
 v_pk_add_f32 v[170:171], v[170:171], v[70:71]
 v_cvt_pk_bf16_f32 v211, v170, v171
 v_pk_fma_f32 v[164:165], v[164:165], v[42:43], s[70:71] op_sel_hi:[1,0,1]
 v_pk_mul_f32 v[64:65], v[164:165], s[72:73]
 v_max_f32 v164, s70, v164
 v_exp_f32_e64 v64, v64 clamp
 v_max_f32 v165, s70, v165
 v_exp_f32_e64 v65, v65 clamp
 v_pk_fma_f32 v[166:167], v[166:167], v[42:43], s[70:71] op_sel_hi:[1,0,1]
 v_pk_mul_f32 v[66:67], v[166:167], s[72:73]
 v_max_f32 v166, s70, v166
 v_exp_f32_e64 v66, v66 clamp
 v_max_f32 v167, s70, v167
 v_exp_f32_e64 v67, v67 clamp
 v_pk_fma_f32 v[172:173], v[172:173], v[42:43], s[70:71] op_sel_hi:[1,0,1]
 v_pk_mul_f32 v[68:69], v[172:173], s[72:73]
 v_max_f32 v172, s70, v172
 v_exp_f32_e64 v68, v68 clamp
 v_max_f32 v173, s70, v173
 v_exp_f32_e64 v69, v69 clamp
 v_pk_fma_f32 v[174:175], v[174:175], v[42:43], s[70:71] op_sel_hi:[1,0,1]
 v_pk_mul_f32 v[70:71], v[174:175], s[72:73]
 v_max_f32 v174, s70, v174
 v_exp_f32_e64 v70, v70 clamp
 v_max_f32 v175, s70, v175
 v_exp_f32_e64 v71, v71 clamp
 v_pk_add_f32 v[164:165], v[164:165], v[64:65]
 v_cvt_pk_bf16_f32 v212, v164, v165
 v_pk_add_f32 v[166:167], v[166:167], v[66:67]
 v_cvt_pk_bf16_f32 v213, v166, v167
 v_pk_add_f32 v[172:173], v[172:173], v[68:69]
 v_cvt_pk_bf16_f32 v214, v172, v173
 v_pk_add_f32 v[174:175], v[174:175], v[70:71]
 v_cvt_pk_bf16_f32 v215, v174, v175
 v_pk_fma_f32 v[176:177], v[176:177], v[40:41], s[70:71] op_sel_hi:[1,0,1]
 v_pk_mul_f32 v[64:65], v[176:177], s[72:73]
 v_max_f32 v176, s70, v176
 v_exp_f32_e64 v64, v64 clamp
 v_max_f32 v177, s70, v177
 v_exp_f32_e64 v65, v65 clamp
 v_pk_fma_f32 v[178:179], v[178:179], v[40:41], s[70:71] op_sel_hi:[1,0,1]
 v_pk_mul_f32 v[66:67], v[178:179], s[72:73]
 v_max_f32 v178, s70, v178
 v_exp_f32_e64 v66, v66 clamp
 v_max_f32 v179, s70, v179
 v_exp_f32_e64 v67, v67 clamp
 v_pk_fma_f32 v[184:185], v[184:185], v[40:41], s[70:71] op_sel_hi:[1,0,1]
 v_pk_mul_f32 v[68:69], v[184:185], s[72:73]
 v_max_f32 v184, s70, v184
 v_exp_f32_e64 v68, v68 clamp
 v_max_f32 v185, s70, v185
 v_exp_f32_e64 v69, v69 clamp
 v_pk_fma_f32 v[186:187], v[186:187], v[40:41], s[70:71] op_sel_hi:[1,0,1]
 v_pk_mul_f32 v[70:71], v[186:187], s[72:73]
 v_max_f32 v186, s70, v186
 v_exp_f32_e64 v70, v70 clamp
 v_max_f32 v187, s70, v187
 v_exp_f32_e64 v71, v71 clamp
 v_pk_add_f32 v[176:177], v[176:177], v[64:65]
 v_cvt_pk_bf16_f32 v216, v176, v177
 v_pk_add_f32 v[178:179], v[178:179], v[66:67]
 v_cvt_pk_bf16_f32 v217, v178, v179
 v_pk_add_f32 v[184:185], v[184:185], v[68:69]
 v_cvt_pk_bf16_f32 v218, v184, v185
 v_pk_add_f32 v[186:187], v[186:187], v[70:71]
 v_cvt_pk_bf16_f32 v219, v186, v187
 v_pk_fma_f32 v[180:181], v[180:181], v[42:43], s[70:71] op_sel_hi:[1,0,1]
 v_pk_mul_f32 v[64:65], v[180:181], s[72:73]
 v_max_f32 v180, s70, v180
 v_exp_f32_e64 v64, v64 clamp
 v_max_f32 v181, s70, v181
 v_exp_f32_e64 v65, v65 clamp
 v_pk_fma_f32 v[182:183], v[182:183], v[42:43], s[70:71] op_sel_hi:[1,0,1]
 v_pk_mul_f32 v[66:67], v[182:183], s[72:73]
 v_max_f32 v182, s70, v182
 v_exp_f32_e64 v66, v66 clamp
 v_max_f32 v183, s70, v183
 v_exp_f32_e64 v67, v67 clamp
 v_pk_fma_f32 v[188:189], v[188:189], v[42:43], s[70:71] op_sel_hi:[1,0,1]
 v_pk_mul_f32 v[68:69], v[188:189], s[72:73]
 v_max_f32 v188, s70, v188
 v_exp_f32_e64 v68, v68 clamp
 v_max_f32 v189, s70, v189
 v_exp_f32_e64 v69, v69 clamp
 v_pk_fma_f32 v[190:191], v[190:191], v[42:43], s[70:71] op_sel_hi:[1,0,1]
 v_pk_mul_f32 v[70:71], v[190:191], s[72:73]
 v_max_f32 v190, s70, v190
 v_exp_f32_e64 v70, v70 clamp
 v_max_f32 v191, s70, v191
 v_exp_f32_e64 v71, v71 clamp
 v_pk_add_f32 v[180:181], v[180:181], v[64:65]
 v_cvt_pk_bf16_f32 v220, v180, v181
 v_pk_add_f32 v[182:183], v[182:183], v[66:67]
 v_cvt_pk_bf16_f32 v221, v182, v183
 v_pk_add_f32 v[188:189], v[188:189], v[68:69]
 v_cvt_pk_bf16_f32 v222, v188, v189
 v_pk_add_f32 v[190:191], v[190:191], v[70:71]
 v_cvt_pk_bf16_f32 v223, v190, v191
 s_waitcnt vmcnt(16)
 v_pk_add_f32 v[224:225], v[224:225], v[228:229]
 v_pk_add_f32 v[232:233], v[232:233], v[236:237]
 v_pk_add_f32 v[226:227], v[226:227], v[230:231]
 v_pk_add_f32 v[234:235], v[234:235], v[238:239]
 v_pk_add_f32 v[224:225], v[224:225], v[232:233]
 v_pk_add_f32 v[226:227], v[226:227], v[234:235]
 s_nop 0
 v_permlane16_swap_b32 v224, v225
 v_permlane16_swap_b32 v226, v227
 v_add_f32 v224, v224, v225
 v_add_f32 v226, v226, v227
 s_nop 1
 v_permlane32_swap_b32 v224, v226
 v_add_f32 v224, v224, v226
 v_and_b32 v59, 3, v0
 v_lshlrev_b32 v59, 4, v59
 v_bfe_u32 v60, v0, 2, 1
 v_lshl_add_u32 v59, v60, 3, v59
 v_bfe_u32 v60, v0, 3, 1
 v_lshl_add_u32 v59, v60, 6, v59
 v_lshrrev_b32 v60, 4, v0
 v_lshl_add_u32 v59, v60, 1, v59
 s_lshl_b32 s66, s38, 7
 s_add_u32 s66, s66, 0x25200
 v_add_u32 v59, s66, v59
 v_cvt_pk_bf16_f32 v224, v224, v224
 v_lshl_add_u32 v60, v60, 4, s66
 ds_write_b16 v59, v224
 s_waitcnt vmcnt(12)
 v_mfma_f32_16x16x32_bf16 v[192:195], v[200:203], a[16:19], 0
 v_mfma_f32_16x16x32_bf16 v[196:199], v[202:205], a[16:19], 0
 v_mfma_f32_16x16x32_bf16 v[192:195], v[200:203], a[20:23], v[192:195]
 v_mfma_f32_16x16x32_bf16 v[196:199], v[202:205], a[20:23], v[196:199]
 v_mfma_f32_16x16x32_bf16 v[192:195], v[200:203], a[24:27], v[192:195]
 v_mfma_f32_16x16x32_bf16 v[196:199], v[202:205], a[24:27], v[196:199]
 v_mfma_f32_16x16x32_bf16 v[192:195], v[200:203], a[28:31], v[192:195]
 v_mfma_f32_16x16x32_bf16 v[196:199], v[202:205], a[28:31], v[196:199]
 s_waitcnt vmcnt(8)
 v_mfma_f32_16x16x32_bf16 v[192:195], v[200:203], a[32:35], v[192:195]
 v_mfma_f32_16x16x32_bf16 v[196:199], v[202:205], a[32:35], v[196:199]
 v_mfma_f32_16x16x32_bf16 v[192:195], v[200:203], a[36:39], v[192:195]
 v_mfma_f32_16x16x32_bf16 v[196:199], v[202:205], a[36:39], v[196:199]
 v_mfma_f32_16x16x32_bf16 v[192:195], v[200:203], a[40:43], v[192:195]
 v_mfma_f32_16x16x32_bf16 v[196:199], v[202:205], a[40:43], v[196:199]
 v_mfma_f32_16x16x32_bf16 v[192:195], v[200:203], a[44:47], v[192:195]
 v_mfma_f32_16x16x32_bf16 v[196:199], v[202:205], a[44:47], v[196:199]
 s_waitcnt vmcnt(4)
 v_mfma_f32_16x16x32_bf16 v[192:195], v[200:203], a[48:51], v[192:195]
 v_mfma_f32_16x16x32_bf16 v[196:199], v[202:205], a[48:51], v[196:199]
 v_mfma_f32_16x16x32_bf16 v[192:195], v[200:203], a[52:55], v[192:195]
 v_mfma_f32_16x16x32_bf16 v[196:199], v[202:205], a[52:55], v[196:199]
 v_mfma_f32_16x16x32_bf16 v[192:195], v[200:203], a[56:59], v[192:195]
 v_mfma_f32_16x16x32_bf16 v[196:199], v[202:205], a[56:59], v[196:199]
 v_mfma_f32_16x16x32_bf16 v[192:195], v[200:203], a[60:63], v[192:195]
 v_mfma_f32_16x16x32_bf16 v[196:199], v[202:205], a[60:63], v[196:199]
 s_waitcnt vmcnt(0)
 v_mfma_f32_16x16x32_bf16 v[192:195], v[200:203], a[64:67], v[192:195]
 v_mfma_f32_16x16x32_bf16 v[196:199], v[202:205], a[64:67], v[196:199]
 v_mfma_f32_16x16x32_bf16 v[192:195], v[200:203], a[68:71], v[192:195]
 v_mfma_f32_16x16x32_bf16 v[196:199], v[202:205], a[68:71], v[196:199]
 v_mfma_f32_16x16x32_bf16 v[192:195], v[200:203], a[72:75], v[192:195]
 v_mfma_f32_16x16x32_bf16 v[196:199], v[202:205], a[72:75], v[196:199]
 v_mfma_f32_16x16x32_bf16 v[192:195], v[200:203], a[76:79], v[192:195]
 v_mfma_f32_16x16x32_bf16 v[196:199], v[202:205], a[76:79], v[196:199]
 s_lshl_b32 s66, s38, 10
 s_add_u32 s66, s66, 0x25400
 v_add_u32 v59, s66, v1
 v_add_u32 v61, 0x25400, v1
 s_nop 2
 v_cvt_pk_bf16_f32 v192, v192, v193
 v_cvt_pk_bf16_f32 v193, v194, v195
 v_cvt_pk_bf16_f32 v194, v196, v197
 v_cvt_pk_bf16_f32 v195, v198, v199
 ds_write_b128 v59, v[192:195]
 s_waitcnt lgkmcnt(0)
 s_barrier
 ds_read_b128 v[80:83], v60 offset:0
 ds_read_b128 v[84:87], v60 offset:64
 ds_read_b128 v[64:67], v61 offset:0
 ds_read_b128 v[68:71], v61 offset:1024
 ds_read_b128 v[72:75], v61 offset:2048
 ds_read_b128 v[76:79], v61 offset:3072
 s_waitcnt lgkmcnt(4)
 v_mfma_f32_16x16x32_bf16 v[128:131], v[80:83], v[208:211], 0
 v_mfma_f32_16x16x32_bf16 v[132:135], v[80:83], v[212:215], 0
 v_mfma_f32_16x16x32_bf16 v[136:139], v[84:87], v[216:219], 0
 v_mfma_f32_16x16x32_bf16 v[140:143], v[84:87], v[220:223], 0
 s_waitcnt lgkmcnt(0)
 v_mfma_f32_16x16x32_bf16 v[96:99], v[64:67], v[208:211], 0
 v_mfma_f32_16x16x32_bf16 v[100:103], v[68:71], v[208:211], 0
 v_mfma_f32_16x16x32_bf16 v[104:107], v[64:67], v[212:215], 0
 v_mfma_f32_16x16x32_bf16 v[108:111], v[68:71], v[212:215], 0
 v_mfma_f32_16x16x32_bf16 v[112:115], v[72:75], v[216:219], 0
 v_mfma_f32_16x16x32_bf16 v[116:119], v[76:79], v[216:219], 0
 v_mfma_f32_16x16x32_bf16 v[120:123], v[72:75], v[220:223], 0
 v_mfma_f32_16x16x32_bf16 v[124:127], v[76:79], v[220:223], 0
 s_add_u32 s69, s43, 0x1000000
 v_add_f32 v128, s70, v128
 v_add_f32 v132, s70, v132
 v_add_f32 v136, s70, v136
 v_add_f32 v140, s70, v140
 v_rcp_f32 v128, v128
 v_rcp_f32 v132, v132
 v_rcp_f32 v136, v136
 v_rcp_f32 v140, v140
 v_pk_mul_f32 v[96:97], v[96:97], v[128:129] op_sel_hi:[1,0]
 v_pk_mul_f32 v[98:99], v[98:99], v[128:129] op_sel_hi:[1,0]
 v_pk_mul_f32 v[100:101], v[100:101], v[128:129] op_sel_hi:[1,0]
 v_pk_mul_f32 v[102:103], v[102:103], v[128:129] op_sel_hi:[1,0]
 v_cvt_pk_bf16_f32 v160, v96, v97
 v_cvt_pk_bf16_f32 v161, v98, v99
 v_cvt_pk_bf16_f32 v162, v100, v101
 v_cvt_pk_bf16_f32 v163, v102, v103
 buffer_store_dwordx4 v[160:163], v11, s[4:7], s69 offen offset:0 sc1
 v_pk_mul_f32 v[104:105], v[104:105], v[132:133] op_sel_hi:[1,0]
 v_pk_mul_f32 v[106:107], v[106:107], v[132:133] op_sel_hi:[1,0]
 v_pk_mul_f32 v[108:109], v[108:109], v[132:133] op_sel_hi:[1,0]
 v_pk_mul_f32 v[110:111], v[110:111], v[132:133] op_sel_hi:[1,0]
 v_cvt_pk_bf16_f32 v164, v104, v105
 v_cvt_pk_bf16_f32 v165, v106, v107
 v_cvt_pk_bf16_f32 v166, v108, v109
 v_cvt_pk_bf16_f32 v167, v110, v111
 buffer_store_dwordx4 v[164:167], v11, s[4:7], s69 offen offset:2048 sc1
 v_pk_mul_f32 v[112:113], v[112:113], v[136:137] op_sel_hi:[1,0]
 v_pk_mul_f32 v[114:115], v[114:115], v[136:137] op_sel_hi:[1,0]
 v_pk_mul_f32 v[116:117], v[116:117], v[136:137] op_sel_hi:[1,0]
 v_pk_mul_f32 v[118:119], v[118:119], v[136:137] op_sel_hi:[1,0]
 v_cvt_pk_bf16_f32 v168, v112, v113
 v_cvt_pk_bf16_f32 v169, v114, v115
 v_cvt_pk_bf16_f32 v170, v116, v117
 v_cvt_pk_bf16_f32 v171, v118, v119
 buffer_store_dwordx4 v[168:171], v14, s[4:7], s69 offen offset:0 sc1
 v_pk_mul_f32 v[120:121], v[120:121], v[140:141] op_sel_hi:[1,0]
 v_pk_mul_f32 v[122:123], v[122:123], v[140:141] op_sel_hi:[1,0]
 v_pk_mul_f32 v[124:125], v[124:125], v[140:141] op_sel_hi:[1,0]
 v_pk_mul_f32 v[126:127], v[126:127], v[140:141] op_sel_hi:[1,0]
 v_cvt_pk_bf16_f32 v172, v120, v121
 v_cvt_pk_bf16_f32 v173, v122, v123
 v_cvt_pk_bf16_f32 v174, v124, v125
 v_cvt_pk_bf16_f32 v175, v126, v127
 buffer_store_dwordx4 v[172:175], v14, s[4:7], s69 offen offset:2048 sc1
 s_add_u32 m0, s60, 0xc000
 s_bfe_u32 s65, s87, 0x40000
 s_mul_i32 s65, s65, 0x20000
 buffer_load_dwordx4 v7, s[12:15], s65 offen offset:0  lds
 buffer_load_dwordx4 v8, s[12:15], s65 offen offset:1024  lds
 s_waitcnt vmcnt(2)
 s_atomic_add s93, s[54:55], 0
 buffer_load_dwordx4 v9, s[12:15], s65 offen offset:2048  lds
 buffer_load_dwordx4 v10, s[12:15], s65 offen offset:3072  lds
 s_add_u32 m0, s60, 0x10000
 s_bfe_u32 s65, s87, 0x40008
 s_mul_i32 s65, s65, 0x20000
 buffer_load_dwordx4 v7, s[12:15], s65 offen offset:0  lds
 buffer_load_dwordx4 v8, s[12:15], s65 offen offset:1024  lds
 buffer_load_dwordx4 v9, s[12:15], s65 offen offset:2048  lds
 buffer_load_dwordx4 v10, s[12:15], s65 offen offset:3072  lds
 s_mov_b32 s79, 0
 s_atomic_add s79, s[54:55], 0 glc
 v_accvgpr_read_b32 v144, a0
 v_accvgpr_read_b32 v145, a1
 v_accvgpr_read_b32 v146, a2
 v_accvgpr_read_b32 v147, a3
 v_accvgpr_read_b32 v148, a4
 v_accvgpr_read_b32 v149, a5
 v_accvgpr_read_b32 v150, a6
 v_accvgpr_read_b32 v151, a7
 s_add_u32 m0, s60, 0x1c000
 s_bfe_u32 s65, s84, 0x40000
 s_mul_i32 s65, s65, 0x7000
 s_add_u32 s65, s65, s40
 buffer_load_dwordx4 v11, s[4:7], s65 offen offset:0 sc1 lds
 v_accvgpr_read_b32 v152, a8
 v_accvgpr_read_b32 v153, a9
 v_accvgpr_read_b32 v154, a10
 v_accvgpr_read_b32 v155, a11
 v_accvgpr_read_b32 v156, a12
 v_accvgpr_read_b32 v157, a13
 v_accvgpr_read_b32 v158, a14
 v_accvgpr_read_b32 v159, a15
 buffer_load_dwordx4 v252, s[4:7], s65 offen offset:1024 sc1 lds
 v_accvgpr_write_b32 a0, v160
 v_accvgpr_write_b32 a1, v161
 v_accvgpr_write_b32 a2, v162
 v_accvgpr_write_b32 a3, v163
 v_accvgpr_write_b32 a4, v164
 v_accvgpr_write_b32 a5, v165
 v_accvgpr_write_b32 a6, v166
 v_accvgpr_write_b32 a7, v167
 buffer_load_dwordx4 v253, s[4:7], s65 offen offset:2048 sc1 lds
 v_accvgpr_write_b32 a8, v168
 v_accvgpr_write_b32 a9, v169
 v_accvgpr_write_b32 a10, v170
 v_accvgpr_write_b32 a11, v171
 v_accvgpr_write_b32 a12, v172
 v_accvgpr_write_b32 a13, v173
 v_accvgpr_write_b32 a14, v174
 v_accvgpr_write_b32 a15, v175
 buffer_load_dwordx4 v254, s[4:7], s65 offen offset:3072 sc1 lds
 v_lshlrev_b32 v96, 16, v144
 v_and_b32 v97, s78, v144
 v_lshlrev_b32 v98, 16, v145
 v_and_b32 v99, s78, v145
 v_lshlrev_b32 v104, 16, v146
 v_and_b32 v105, s78, v146
 v_lshlrev_b32 v106, 16, v147
 v_and_b32 v107, s78, v147
 v_lshlrev_b32 v100, 16, v148
 v_and_b32 v101, s78, v148
 v_lshlrev_b32 v102, 16, v149
 v_and_b32 v103, s78, v149
 v_lshlrev_b32 v108, 16, v150
 v_and_b32 v109, s78, v150
 v_lshlrev_b32 v110, 16, v151
 v_and_b32 v111, s78, v151
 v_lshlrev_b32 v112, 16, v152
 v_and_b32 v113, s78, v152
 v_lshlrev_b32 v114, 16, v153
 v_and_b32 v115, s78, v153
 v_lshlrev_b32 v120, 16, v154
 v_and_b32 v121, s78, v154
 v_lshlrev_b32 v122, 16, v155
 v_and_b32 v123, s78, v155
 v_lshlrev_b32 v116, 16, v156
 v_and_b32 v117, s78, v156
 v_lshlrev_b32 v118, 16, v157
 v_and_b32 v119, s78, v157
 v_lshlrev_b32 v124, 16, v158
 v_and_b32 v125, s78, v158
 v_lshlrev_b32 v126, 16, v159
 v_and_b32 v127, s78, v159
 s_barrier
 ds_read_b64_tr_b16 v[80:81], v27 offset:0
 ds_read_b64_tr_b16 v[82:83], v27 offset:2048
 ds_read_b64_tr_b16 v[84:85], v28 offset:0
 ds_read_b64_tr_b16 v[86:87], v28 offset:2048
 ds_read_b64_tr_b16 v[88:89], v29 offset:0
 ds_read_b64_tr_b16 v[90:91], v29 offset:2048
 ds_read_b64_tr_b16 v[92:93], v30 offset:0
 ds_read_b64_tr_b16 v[94:95], v30 offset:2048
 ds_read_b64_tr_b16 v[64:65], v27 offset:4096
 ds_read_b64_tr_b16 v[66:67], v27 offset:6144
 ds_read_b64_tr_b16 v[68:69], v28 offset:4096
 ds_read_b64_tr_b16 v[70:71], v28 offset:6144
 ds_read_b64_tr_b16 v[72:73], v29 offset:4096
 ds_read_b64_tr_b16 v[74:75], v29 offset:6144
 s_mov_b32 s67, 0
mk_w15:
 s_waitcnt lgkmcnt(0)
 s_cmp_ge_u32 s79, 16
 s_cbranch_scc1 mk_d16
 s_mov_b32 s79, 0
 s_atomic_add s79, s[54:55], 0 glc
 s_add_u32 s67, s67, 1
 s_cmp_lt_u32 s67, 0x8000
 s_cbranch_scc1 mk_w15
mk_d16:
mk_k3:
 s_add_u32 s16, s3, 0x1000000
 s_bfe_u32 s64, s84, 0x40004
 s_mul_i32 s64, s64, 0x80000
 s_add_u32 s64, s64, s16
 buffer_load_dwordx4 a[16:19], v11, s[4:7], s64 offen offset:0 sc1
 buffer_load_dwordx4 a[20:23], v11, s[4:7], s64 offen offset:2048 sc1
 buffer_load_dwordx4 a[24:27], v14, s[4:7], s64 offen offset:0 sc1
 buffer_load_dwordx4 a[28:31], v14, s[4:7], s64 offen offset:2048 sc1
 s_bfe_u32 s64, s84, 0x40008
 s_mul_i32 s64, s64, 0x80000
 s_add_u32 s64, s64, s16
 buffer_load_dwordx4 a[32:35], v11, s[4:7], s64 offen offset:0 sc1
 buffer_load_dwordx4 a[36:39], v11, s[4:7], s64 offen offset:2048 sc1
 buffer_load_dwordx4 a[40:43], v14, s[4:7], s64 offen offset:0 sc1
 buffer_load_dwordx4 a[44:47], v14, s[4:7], s64 offen offset:2048 sc1
 s_bfe_u32 s64, s84, 0x4000c
 s_mul_i32 s64, s64, 0x80000
 s_add_u32 s64, s64, s16
 buffer_load_dwordx4 a[48:51], v11, s[4:7], s64 offen offset:0 sc1
 buffer_load_dwordx4 a[52:55], v11, s[4:7], s64 offen offset:2048 sc1
 buffer_load_dwordx4 a[56:59], v14, s[4:7], s64 offen offset:0 sc1
 buffer_load_dwordx4 a[60:63], v14, s[4:7], s64 offen offset:2048 sc1
 v_mfma_f32_16x16x32_bf16 v[96:99], v[80:83], a[0:3], v[96:99]
 s_bfe_u32 s64, s84, 0x40010
 ds_read_b64_tr_b16 v[76:77], v30 offset:4096
 ds_read_b64_tr_b16 v[78:79], v30 offset:6144
 v_mfma_f32_16x16x32_bf16 v[100:103], v[80:83], a[4:7], v[100:103]
 s_mul_i32 s64, s64, 0x80000
 s_add_u32 s64, s64, s16
 v_mfma_f32_16x16x32_bf16 v[104:107], v[84:87], a[0:3], v[104:107]
 ds_read_b64_tr_b16 v[80:81], v27 offset:8192
 ds_read_b64_tr_b16 v[82:83], v27 offset:10240
 v_mfma_f32_16x16x32_bf16 v[108:111], v[84:87], a[4:7], v[108:111]
 buffer_load_dwordx4 a[64:67], v11, s[4:7], s64 offen offset:0 sc1
 v_mfma_f32_16x16x32_bf16 v[112:115], v[88:91], a[0:3], v[112:115]
 ds_read_b64_tr_b16 v[84:85], v28 offset:8192
 ds_read_b64_tr_b16 v[86:87], v28 offset:10240
 v_mfma_f32_16x16x32_bf16 v[116:119], v[88:91], a[4:7], v[116:119]
 v_mfma_f32_16x16x32_bf16 v[120:123], v[92:95], a[0:3], v[120:123]
 ds_read_b64_tr_b16 v[88:89], v29 offset:8192
 ds_read_b64_tr_b16 v[90:91], v29 offset:10240
 v_mfma_f32_16x16x32_bf16 v[124:127], v[92:95], a[4:7], v[124:127]
 buffer_load_dwordx4 a[68:71], v11, s[4:7], s64 offen offset:2048 sc1
 v_mfma_f32_16x16x32_bf16 v[96:99], v[64:67], a[8:11], v[96:99]
 ds_read_b64_tr_b16 v[92:93], v30 offset:8192
 ds_read_b64_tr_b16 v[94:95], v30 offset:10240
 v_mfma_f32_16x16x32_bf16 v[100:103], v[64:67], a[12:15], v[100:103]
 v_mfma_f32_16x16x32_bf16 v[104:107], v[68:71], a[8:11], v[104:107]
 s_waitcnt lgkmcnt(6)
 ds_read_b64_tr_b16 v[64:65], v27 offset:12288
 ds_read_b64_tr_b16 v[66:67], v27 offset:14336
 v_mfma_f32_16x16x32_bf16 v[108:111], v[68:71], a[12:15], v[108:111]
 buffer_load_dwordx4 a[72:75], v14, s[4:7], s64 offen offset:0 sc1
 v_mfma_f32_16x16x32_bf16 v[112:115], v[72:75], a[8:11], v[112:115]
 s_waitcnt vmcnt(13)
 ds_read_b64_tr_b16 v[68:69], v28 offset:12288
 ds_read_b64_tr_b16 v[70:71], v28 offset:14336
 v_mfma_f32_16x16x32_bf16 v[116:119], v[72:75], a[12:15], v[116:119]
 v_mfma_f32_16x16x32_bf16 v[120:123], v[76:79], a[8:11], v[120:123]
 ds_read_b64_tr_b16 v[72:73], v29 offset:12288
 ds_read_b64_tr_b16 v[74:75], v29 offset:14336
 v_mfma_f32_16x16x32_bf16 v[124:127], v[76:79], a[12:15], v[124:127]
 buffer_load_dwordx4 a[76:79], v14, s[4:7], s64 offen offset:2048 sc1
 v_mfma_f32_16x16x32_bf16 v[96:99], v[80:83], a[16:19], v[96:99]
 s_waitcnt lgkmcnt(6)
 ds_read_b64_tr_b16 v[76:77], v30 offset:12288
 ds_read_b64_tr_b16 v[78:79], v30 offset:14336
 v_mfma_f32_16x16x32_bf16 v[100:103], v[80:83], a[20:23], v[100:103]
 s_bfe_u32 s64, s84, 0x40014
 s_mul_i32 s64, s64, 0x80000
 s_add_u32 s64, s64, s16
 v_mfma_f32_16x16x32_bf16 v[104:107], v[84:87], a[16:19], v[104:107]
 s_barrier
 ds_read_b64_tr_b16 v[80:81], v19 offset:0
 ds_read_b64_tr_b16 v[82:83], v19 offset:2048
 v_mfma_f32_16x16x32_bf16 v[108:111], v[84:87], a[20:23], v[108:111]
 buffer_load_dwordx4 a[80:83], v11, s[4:7], s64 offen offset:0 sc1
 v_mfma_f32_16x16x32_bf16 v[112:115], v[88:91], a[16:19], v[112:115]
 s_waitcnt vmcnt(13)
 ds_read_b64_tr_b16 v[84:85], v20 offset:0
 ds_read_b64_tr_b16 v[86:87], v20 offset:2048
 v_mfma_f32_16x16x32_bf16 v[116:119], v[88:91], a[20:23], v[116:119]
 v_mfma_f32_16x16x32_bf16 v[120:123], v[92:95], a[16:19], v[120:123]
 s_waitcnt lgkmcnt(6)
 ds_read_b64_tr_b16 v[88:89], v21 offset:0
 ds_read_b64_tr_b16 v[90:91], v21 offset:2048
 v_mfma_f32_16x16x32_bf16 v[124:127], v[92:95], a[20:23], v[124:127]
 buffer_load_dwordx4 a[84:87], v11, s[4:7], s64 offen offset:2048 sc1
 v_mfma_f32_16x16x32_bf16 v[96:99], v[64:67], a[24:27], v[96:99]
 ds_read_b64_tr_b16 v[92:93], v22 offset:0
 ds_read_b64_tr_b16 v[94:95], v22 offset:2048
 v_mfma_f32_16x16x32_bf16 v[100:103], v[64:67], a[28:31], v[100:103]
 v_mfma_f32_16x16x32_bf16 v[104:107], v[68:71], a[24:27], v[104:107]
 ds_read_b64_tr_b16 v[64:65], v19 offset:4096
 ds_read_b64_tr_b16 v[66:67], v19 offset:6144
 v_mfma_f32_16x16x32_bf16 v[108:111], v[68:71], a[28:31], v[108:111]
 buffer_load_dwordx4 a[88:91], v14, s[4:7], s64 offen offset:0 sc1
 v_mfma_f32_16x16x32_bf16 v[112:115], v[72:75], a[24:27], v[112:115]
 s_waitcnt lgkmcnt(6)
 ds_read_b64_tr_b16 v[68:69], v20 offset:4096
 ds_read_b64_tr_b16 v[70:71], v20 offset:6144
 v_mfma_f32_16x16x32_bf16 v[116:119], v[72:75], a[28:31], v[116:119]
 v_mfma_f32_16x16x32_bf16 v[120:123], v[76:79], a[24:27], v[120:123]
 s_waitcnt vmcnt(13)
 ds_read_b64_tr_b16 v[72:73], v21 offset:4096
 ds_read_b64_tr_b16 v[74:75], v21 offset:6144
 v_mfma_f32_16x16x32_bf16 v[124:127], v[76:79], a[28:31], v[124:127]
 buffer_load_dwordx4 a[92:95], v14, s[4:7], s64 offen offset:2048 sc1
 v_mfma_f32_16x16x32_bf16 v[96:99], v[80:83], a[32:35], v[96:99]
 s_bfe_u32 s64, s84, 0x40018
 ds_read_b64_tr_b16 v[76:77], v22 offset:4096
 ds_read_b64_tr_b16 v[78:79], v22 offset:6144
 v_mfma_f32_16x16x32_bf16 v[100:103], v[80:83], a[36:39], v[100:103]
 s_mul_i32 s64, s64, 0x80000
 s_add_u32 s64, s64, s16
 v_mfma_f32_16x16x32_bf16 v[104:107], v[84:87], a[32:35], v[104:107]
 s_waitcnt lgkmcnt(6)
 ds_read_b64_tr_b16 v[80:81], v19 offset:8192
 ds_read_b64_tr_b16 v[82:83], v19 offset:10240
 v_mfma_f32_16x16x32_bf16 v[108:111], v[84:87], a[36:39], v[108:111]
 buffer_load_dwordx4 a[96:99], v11, s[4:7], s64 offen offset:0 sc1
 v_mfma_f32_16x16x32_bf16 v[112:115], v[88:91], a[32:35], v[112:115]
 s_waitcnt vmcnt(13)
 ds_read_b64_tr_b16 v[84:85], v20 offset:8192
 ds_read_b64_tr_b16 v[86:87], v20 offset:10240
 v_mfma_f32_16x16x32_bf16 v[116:119], v[88:91], a[36:39], v[116:119]
 v_mfma_f32_16x16x32_bf16 v[120:123], v[92:95], a[32:35], v[120:123]
 ds_read_b64_tr_b16 v[88:89], v21 offset:8192
 ds_read_b64_tr_b16 v[90:91], v21 offset:10240
 v_mfma_f32_16x16x32_bf16 v[124:127], v[92:95], a[36:39], v[124:127]
 buffer_load_dwordx4 a[100:103], v11, s[4:7], s64 offen offset:2048 sc1
 v_mfma_f32_16x16x32_bf16 v[96:99], v[64:67], a[40:43], v[96:99]
 s_waitcnt lgkmcnt(6)
 ds_read_b64_tr_b16 v[92:93], v22 offset:8192
 ds_read_b64_tr_b16 v[94:95], v22 offset:10240
 v_mfma_f32_16x16x32_bf16 v[100:103], v[64:67], a[44:47], v[100:103]
 v_mfma_f32_16x16x32_bf16 v[104:107], v[68:71], a[40:43], v[104:107]
 ds_read_b64_tr_b16 v[64:65], v19 offset:12288
 ds_read_b64_tr_b16 v[66:67], v19 offset:14336
 v_mfma_f32_16x16x32_bf16 v[108:111], v[68:71], a[44:47], v[108:111]
 buffer_load_dwordx4 a[104:107], v14, s[4:7], s64 offen offset:0 sc1
 v_mfma_f32_16x16x32_bf16 v[112:115], v[72:75], a[40:43], v[112:115]
 s_waitcnt vmcnt(13)
 ds_read_b64_tr_b16 v[68:69], v20 offset:12288
 ds_read_b64_tr_b16 v[70:71], v20 offset:14336
 v_mfma_f32_16x16x32_bf16 v[116:119], v[72:75], a[44:47], v[116:119]
 v_mfma_f32_16x16x32_bf16 v[120:123], v[76:79], a[40:43], v[120:123]
 s_waitcnt lgkmcnt(6)
 ds_read_b64_tr_b16 v[72:73], v21 offset:12288
 ds_read_b64_tr_b16 v[74:75], v21 offset:14336
 v_mfma_f32_16x16x32_bf16 v[124:127], v[76:79], a[44:47], v[124:127]
 buffer_load_dwordx4 a[108:111], v14, s[4:7], s64 offen offset:2048 sc1
 v_mfma_f32_16x16x32_bf16 v[96:99], v[80:83], a[48:51], v[96:99]
 s_bfe_u32 s64, s84, 0x4001c
 ds_read_b64_tr_b16 v[76:77], v22 offset:12288
 ds_read_b64_tr_b16 v[78:79], v22 offset:14336
 v_mfma_f32_16x16x32_bf16 v[100:103], v[80:83], a[52:55], v[100:103]
 s_mul_i32 s64, s64, 0x80000
 s_add_u32 s64, s64, s16
 v_mfma_f32_16x16x32_bf16 v[104:107], v[84:87], a[48:51], v[104:107]
 s_barrier
 ds_read_b64_tr_b16 v[80:81], v19 offset:16384
 ds_read_b64_tr_b16 v[82:83], v19 offset:18432
 v_mfma_f32_16x16x32_bf16 v[108:111], v[84:87], a[52:55], v[108:111]
 buffer_load_dwordx4 a[112:115], v11, s[4:7], s64 offen offset:0 sc1
 v_mfma_f32_16x16x32_bf16 v[112:115], v[88:91], a[48:51], v[112:115]
 s_waitcnt lgkmcnt(6)
 ds_read_b64_tr_b16 v[84:85], v20 offset:16384
 ds_read_b64_tr_b16 v[86:87], v20 offset:18432
 v_mfma_f32_16x16x32_bf16 v[116:119], v[88:91], a[52:55], v[116:119]
 v_mfma_f32_16x16x32_bf16 v[120:123], v[92:95], a[48:51], v[120:123]
 s_waitcnt vmcnt(13)
 ds_read_b64_tr_b16 v[88:89], v21 offset:16384
 ds_read_b64_tr_b16 v[90:91], v21 offset:18432
 v_mfma_f32_16x16x32_bf16 v[124:127], v[92:95], a[52:55], v[124:127]
 buffer_load_dwordx4 a[116:119], v11, s[4:7], s64 offen offset:2048 sc1
 v_mfma_f32_16x16x32_bf16 v[96:99], v[64:67], a[56:59], v[96:99]
 ds_read_b64_tr_b16 v[92:93], v22 offset:16384
 ds_read_b64_tr_b16 v[94:95], v22 offset:18432
 v_mfma_f32_16x16x32_bf16 v[100:103], v[64:67], a[60:63], v[100:103]
 v_mfma_f32_16x16x32_bf16 v[104:107], v[68:71], a[56:59], v[104:107]
 s_waitcnt lgkmcnt(6)
 ds_read_b64_tr_b16 v[64:65], v19 offset:20480
 ds_read_b64_tr_b16 v[66:67], v19 offset:22528
 v_mfma_f32_16x16x32_bf16 v[108:111], v[68:71], a[60:63], v[108:111]
 buffer_load_dwordx4 a[120:123], v14, s[4:7], s64 offen offset:0 sc1
 v_mfma_f32_16x16x32_bf16 v[112:115], v[72:75], a[56:59], v[112:115]
 s_waitcnt vmcnt(13)
 ds_read_b64_tr_b16 v[68:69], v20 offset:20480
 ds_read_b64_tr_b16 v[70:71], v20 offset:22528
 v_mfma_f32_16x16x32_bf16 v[116:119], v[72:75], a[60:63], v[116:119]
 v_mfma_f32_16x16x32_bf16 v[120:123], v[76:79], a[56:59], v[120:123]
 ds_read_b64_tr_b16 v[72:73], v21 offset:20480
 ds_read_b64_tr_b16 v[74:75], v21 offset:22528
 v_mfma_f32_16x16x32_bf16 v[124:127], v[76:79], a[60:63], v[124:127]
 buffer_load_dwordx4 a[124:127], v14, s[4:7], s64 offen offset:2048 sc1
 v_mfma_f32_16x16x32_bf16 v[96:99], v[80:83], a[64:67], v[96:99]
 s_waitcnt lgkmcnt(6)
 ds_read_b64_tr_b16 v[76:77], v22 offset:20480
 ds_read_b64_tr_b16 v[78:79], v22 offset:22528
 v_mfma_f32_16x16x32_bf16 v[100:103], v[80:83], a[68:71], v[100:103]
 s_bfe_u32 s64, s85, 0x40000
 s_mul_i32 s64, s64, 0x80000
 s_add_u32 s64, s64, s16
 v_mfma_f32_16x16x32_bf16 v[104:107], v[84:87], a[64:67], v[104:107]
 ds_read_b64_tr_b16 v[80:81], v19 offset:24576
 ds_read_b64_tr_b16 v[82:83], v19 offset:26624
 v_mfma_f32_16x16x32_bf16 v[108:111], v[84:87], a[68:71], v[108:111]
 buffer_load_dwordx4 a[128:131], v11, s[4:7], s64 offen offset:0 sc1
 v_mfma_f32_16x16x32_bf16 v[112:115], v[88:91], a[64:67], v[112:115]
 s_waitcnt vmcnt(13)
 ds_read_b64_tr_b16 v[84:85], v20 offset:24576
 ds_read_b64_tr_b16 v[86:87], v20 offset:26624
 v_mfma_f32_16x16x32_bf16 v[116:119], v[88:91], a[68:71], v[116:119]
 v_mfma_f32_16x16x32_bf16 v[120:123], v[92:95], a[64:67], v[120:123]
 s_waitcnt lgkmcnt(6)
 ds_read_b64_tr_b16 v[88:89], v21 offset:24576
 ds_read_b64_tr_b16 v[90:91], v21 offset:26624
 v_mfma_f32_16x16x32_bf16 v[124:127], v[92:95], a[68:71], v[124:127]
 buffer_load_dwordx4 a[132:135], v11, s[4:7], s64 offen offset:2048 sc1
 v_mfma_f32_16x16x32_bf16 v[96:99], v[64:67], a[72:75], v[96:99]
 ds_read_b64_tr_b16 v[92:93], v22 offset:24576
 ds_read_b64_tr_b16 v[94:95], v22 offset:26624
 v_mfma_f32_16x16x32_bf16 v[100:103], v[64:67], a[76:79], v[100:103]
 v_mfma_f32_16x16x32_bf16 v[104:107], v[68:71], a[72:75], v[104:107]
 ds_read_b64_tr_b16 v[64:65], v19 offset:28672
 ds_read_b64_tr_b16 v[66:67], v19 offset:30720
 v_mfma_f32_16x16x32_bf16 v[108:111], v[68:71], a[76:79], v[108:111]
 buffer_load_dwordx4 a[136:139], v14, s[4:7], s64 offen offset:0 sc1
 v_mfma_f32_16x16x32_bf16 v[112:115], v[72:75], a[72:75], v[112:115]
 s_waitcnt lgkmcnt(6)
 ds_read_b64_tr_b16 v[68:69], v20 offset:28672
 ds_read_b64_tr_b16 v[70:71], v20 offset:30720
 v_mfma_f32_16x16x32_bf16 v[116:119], v[72:75], a[76:79], v[116:119]
 v_mfma_f32_16x16x32_bf16 v[120:123], v[76:79], a[72:75], v[120:123]
 s_waitcnt vmcnt(13)
 ds_read_b64_tr_b16 v[72:73], v21 offset:28672
 ds_read_b64_tr_b16 v[74:75], v21 offset:30720
 v_mfma_f32_16x16x32_bf16 v[124:127], v[76:79], a[76:79], v[124:127]
 buffer_load_dwordx4 a[140:143], v14, s[4:7], s64 offen offset:2048 sc1
 v_mfma_f32_16x16x32_bf16 v[96:99], v[80:83], a[80:83], v[96:99]
 s_bfe_u32 s64, s85, 0x40004
 ds_read_b64_tr_b16 v[76:77], v22 offset:28672
 ds_read_b64_tr_b16 v[78:79], v22 offset:30720
 v_mfma_f32_16x16x32_bf16 v[100:103], v[80:83], a[84:87], v[100:103]
 s_mul_i32 s64, s64, 0x80000
 s_add_u32 s64, s64, s16
 v_mfma_f32_16x16x32_bf16 v[104:107], v[84:87], a[80:83], v[104:107]
 s_waitcnt lgkmcnt(6)
 s_barrier
 ds_read_b64_tr_b16 v[80:81], v19 offset:32768
 ds_read_b64_tr_b16 v[82:83], v19 offset:34816
 v_mfma_f32_16x16x32_bf16 v[108:111], v[84:87], a[84:87], v[108:111]
 buffer_load_dwordx4 a[144:147], v11, s[4:7], s64 offen offset:0 sc1
 v_mfma_f32_16x16x32_bf16 v[112:115], v[88:91], a[80:83], v[112:115]
 s_waitcnt vmcnt(13)
 ds_read_b64_tr_b16 v[84:85], v20 offset:32768
 ds_read_b64_tr_b16 v[86:87], v20 offset:34816
 v_mfma_f32_16x16x32_bf16 v[116:119], v[88:91], a[84:87], v[116:119]
 v_mfma_f32_16x16x32_bf16 v[120:123], v[92:95], a[80:83], v[120:123]
 ds_read_b64_tr_b16 v[88:89], v21 offset:32768
 ds_read_b64_tr_b16 v[90:91], v21 offset:34816
 v_mfma_f32_16x16x32_bf16 v[124:127], v[92:95], a[84:87], v[124:127]
 buffer_load_dwordx4 a[148:151], v11, s[4:7], s64 offen offset:2048 sc1
 v_mfma_f32_16x16x32_bf16 v[96:99], v[64:67], a[88:91], v[96:99]
 s_waitcnt lgkmcnt(6)
 ds_read_b64_tr_b16 v[92:93], v22 offset:32768
 ds_read_b64_tr_b16 v[94:95], v22 offset:34816
 v_mfma_f32_16x16x32_bf16 v[100:103], v[64:67], a[92:95], v[100:103]
 v_mfma_f32_16x16x32_bf16 v[104:107], v[68:71], a[88:91], v[104:107]
 ds_read_b64_tr_b16 v[64:65], v19 offset:36864
 ds_read_b64_tr_b16 v[66:67], v19 offset:38912
 v_mfma_f32_16x16x32_bf16 v[108:111], v[68:71], a[92:95], v[108:111]
 buffer_load_dwordx4 a[152:155], v14, s[4:7], s64 offen offset:0 sc1
 v_mfma_f32_16x16x32_bf16 v[112:115], v[72:75], a[88:91], v[112:115]
 s_waitcnt vmcnt(13)
 ds_read_b64_tr_b16 v[68:69], v20 offset:36864
 ds_read_b64_tr_b16 v[70:71], v20 offset:38912
 v_mfma_f32_16x16x32_bf16 v[116:119], v[72:75], a[92:95], v[116:119]
 v_mfma_f32_16x16x32_bf16 v[120:123], v[76:79], a[88:91], v[120:123]
 s_waitcnt lgkmcnt(6)
 ds_read_b64_tr_b16 v[72:73], v21 offset:36864
 ds_read_b64_tr_b16 v[74:75], v21 offset:38912
 v_mfma_f32_16x16x32_bf16 v[124:127], v[76:79], a[92:95], v[124:127]
 buffer_load_dwordx4 a[156:159], v14, s[4:7], s64 offen offset:2048 sc1
 v_mfma_f32_16x16x32_bf16 v[96:99], v[80:83], a[96:99], v[96:99]
 s_bfe_u32 s64, s85, 0x40008
 ds_read_b64_tr_b16 v[76:77], v22 offset:36864
 ds_read_b64_tr_b16 v[78:79], v22 offset:38912
 v_mfma_f32_16x16x32_bf16 v[100:103], v[80:83], a[100:103], v[100:103]
 s_mul_i32 s64, s64, 0x80000
 s_add_u32 s64, s64, s16
 v_mfma_f32_16x16x32_bf16 v[104:107], v[84:87], a[96:99], v[104:107]
 ds_read_b64_tr_b16 v[80:81], v19 offset:40960
 ds_read_b64_tr_b16 v[82:83], v19 offset:43008
 v_mfma_f32_16x16x32_bf16 v[108:111], v[84:87], a[100:103], v[108:111]
 buffer_load_dwordx4 a[160:163], v11, s[4:7], s64 offen offset:0 sc1
 v_mfma_f32_16x16x32_bf16 v[112:115], v[88:91], a[96:99], v[112:115]
 s_waitcnt lgkmcnt(6)
 ds_read_b64_tr_b16 v[84:85], v20 offset:40960
 ds_read_b64_tr_b16 v[86:87], v20 offset:43008
 v_mfma_f32_16x16x32_bf16 v[116:119], v[88:91], a[100:103], v[116:119]
 v_mfma_f32_16x16x32_bf16 v[120:123], v[92:95], a[96:99], v[120:123]
 s_waitcnt vmcnt(13)
 ds_read_b64_tr_b16 v[88:89], v21 offset:40960
 ds_read_b64_tr_b16 v[90:91], v21 offset:43008
 v_mfma_f32_16x16x32_bf16 v[124:127], v[92:95], a[100:103], v[124:127]
 buffer_load_dwordx4 a[164:167], v11, s[4:7], s64 offen offset:2048 sc1
 v_mfma_f32_16x16x32_bf16 v[96:99], v[64:67], a[104:107], v[96:99]
 ds_read_b64_tr_b16 v[92:93], v22 offset:40960
 ds_read_b64_tr_b16 v[94:95], v22 offset:43008
 v_mfma_f32_16x16x32_bf16 v[100:103], v[64:67], a[108:111], v[100:103]
 v_mfma_f32_16x16x32_bf16 v[104:107], v[68:71], a[104:107], v[104:107]
 s_waitcnt lgkmcnt(6)
 ds_read_b64_tr_b16 v[64:65], v19 offset:45056
 ds_read_b64_tr_b16 v[66:67], v19 offset:47104
 v_mfma_f32_16x16x32_bf16 v[108:111], v[68:71], a[108:111], v[108:111]
 buffer_load_dwordx4 a[168:171], v14, s[4:7], s64 offen offset:0 sc1
 v_mfma_f32_16x16x32_bf16 v[112:115], v[72:75], a[104:107], v[112:115]
 s_waitcnt vmcnt(13)
 ds_read_b64_tr_b16 v[68:69], v20 offset:45056
 ds_read_b64_tr_b16 v[70:71], v20 offset:47104
 v_mfma_f32_16x16x32_bf16 v[116:119], v[72:75], a[108:111], v[116:119]
 v_mfma_f32_16x16x32_bf16 v[120:123], v[76:79], a[104:107], v[120:123]
 ds_read_b64_tr_b16 v[72:73], v21 offset:45056
 ds_read_b64_tr_b16 v[74:75], v21 offset:47104
 v_mfma_f32_16x16x32_bf16 v[124:127], v[76:79], a[108:111], v[124:127]
 buffer_load_dwordx4 a[172:175], v14, s[4:7], s64 offen offset:2048 sc1
 v_mfma_f32_16x16x32_bf16 v[96:99], v[80:83], a[112:115], v[96:99]
 s_waitcnt lgkmcnt(6)
 ds_read_b64_tr_b16 v[76:77], v22 offset:45056
 ds_read_b64_tr_b16 v[78:79], v22 offset:47104
 v_mfma_f32_16x16x32_bf16 v[100:103], v[80:83], a[116:119], v[100:103]
 s_bfe_u32 s64, s85, 0x4000c
 s_mul_i32 s64, s64, 0x80000
 s_add_u32 s64, s64, s16
 v_mfma_f32_16x16x32_bf16 v[104:107], v[84:87], a[112:115], v[104:107]
 s_barrier
 ds_read_b64_tr_b16 v[80:81], v19 offset:49152
 ds_read_b64_tr_b16 v[82:83], v19 offset:51200
 v_mfma_f32_16x16x32_bf16 v[108:111], v[84:87], a[116:119], v[108:111]
 buffer_load_dwordx4 a[176:179], v11, s[4:7], s64 offen offset:0 sc1
 v_mfma_f32_16x16x32_bf16 v[112:115], v[88:91], a[112:115], v[112:115]
 s_waitcnt vmcnt(13)
 ds_read_b64_tr_b16 v[84:85], v20 offset:49152
 ds_read_b64_tr_b16 v[86:87], v20 offset:51200
 v_mfma_f32_16x16x32_bf16 v[116:119], v[88:91], a[116:119], v[116:119]
 v_mfma_f32_16x16x32_bf16 v[120:123], v[92:95], a[112:115], v[120:123]
 s_waitcnt lgkmcnt(6)
 ds_read_b64_tr_b16 v[88:89], v21 offset:49152
 ds_read_b64_tr_b16 v[90:91], v21 offset:51200
 v_mfma_f32_16x16x32_bf16 v[124:127], v[92:95], a[116:119], v[124:127]
 buffer_load_dwordx4 a[180:183], v11, s[4:7], s64 offen offset:2048 sc1
 v_mfma_f32_16x16x32_bf16 v[96:99], v[64:67], a[120:123], v[96:99]
 ds_read_b64_tr_b16 v[92:93], v22 offset:49152
 ds_read_b64_tr_b16 v[94:95], v22 offset:51200
 v_mfma_f32_16x16x32_bf16 v[100:103], v[64:67], a[124:127], v[100:103]
 v_mfma_f32_16x16x32_bf16 v[104:107], v[68:71], a[120:123], v[104:107]
 ds_read_b64_tr_b16 v[64:65], v19 offset:53248
 ds_read_b64_tr_b16 v[66:67], v19 offset:55296
 v_mfma_f32_16x16x32_bf16 v[108:111], v[68:71], a[124:127], v[108:111]
 buffer_load_dwordx4 a[184:187], v14, s[4:7], s64 offen offset:0 sc1
 v_mfma_f32_16x16x32_bf16 v[112:115], v[72:75], a[120:123], v[112:115]
 s_waitcnt lgkmcnt(6)
 ds_read_b64_tr_b16 v[68:69], v20 offset:53248
 ds_read_b64_tr_b16 v[70:71], v20 offset:55296
 v_mfma_f32_16x16x32_bf16 v[116:119], v[72:75], a[124:127], v[116:119]
 v_mfma_f32_16x16x32_bf16 v[120:123], v[76:79], a[120:123], v[120:123]
 s_waitcnt vmcnt(13)
 ds_read_b64_tr_b16 v[72:73], v21 offset:53248
 ds_read_b64_tr_b16 v[74:75], v21 offset:55296
 v_mfma_f32_16x16x32_bf16 v[124:127], v[76:79], a[124:127], v[124:127]
 buffer_load_dwordx4 a[188:191], v14, s[4:7], s64 offen offset:2048 sc1
 v_mfma_f32_16x16x32_bf16 v[96:99], v[80:83], a[128:131], v[96:99]
 s_bfe_u32 s64, s85, 0x40010
 ds_read_b64_tr_b16 v[76:77], v22 offset:53248
 ds_read_b64_tr_b16 v[78:79], v22 offset:55296
 v_mfma_f32_16x16x32_bf16 v[100:103], v[80:83], a[132:135], v[100:103]
 s_mul_i32 s64, s64, 0x80000
 s_add_u32 s64, s64, s16
 v_mfma_f32_16x16x32_bf16 v[104:107], v[84:87], a[128:131], v[104:107]
 s_waitcnt lgkmcnt(6)
 ds_read_b64_tr_b16 v[80:81], v19 offset:57344
 ds_read_b64_tr_b16 v[82:83], v19 offset:59392
 v_mfma_f32_16x16x32_bf16 v[108:111], v[84:87], a[132:135], v[108:111]
 buffer_load_dwordx4 a[192:195], v11, s[4:7], s64 offen offset:0 sc1
 v_mfma_f32_16x16x32_bf16 v[112:115], v[88:91], a[128:131], v[112:115]
 s_waitcnt vmcnt(13)
 ds_read_b64_tr_b16 v[84:85], v20 offset:57344
 ds_read_b64_tr_b16 v[86:87], v20 offset:59392
 v_mfma_f32_16x16x32_bf16 v[116:119], v[88:91], a[132:135], v[116:119]
 v_mfma_f32_16x16x32_bf16 v[120:123], v[92:95], a[128:131], v[120:123]
 ds_read_b64_tr_b16 v[88:89], v21 offset:57344
 ds_read_b64_tr_b16 v[90:91], v21 offset:59392
 v_mfma_f32_16x16x32_bf16 v[124:127], v[92:95], a[132:135], v[124:127]
 buffer_load_dwordx4 a[196:199], v11, s[4:7], s64 offen offset:2048 sc1
 v_mfma_f32_16x16x32_bf16 v[96:99], v[64:67], a[136:139], v[96:99]
 s_waitcnt lgkmcnt(6)
 ds_read_b64_tr_b16 v[92:93], v22 offset:57344
 ds_read_b64_tr_b16 v[94:95], v22 offset:59392
 v_mfma_f32_16x16x32_bf16 v[100:103], v[64:67], a[140:143], v[100:103]
 v_mfma_f32_16x16x32_bf16 v[104:107], v[68:71], a[136:139], v[104:107]
 ds_read_b64_tr_b16 v[64:65], v19 offset:61440
 ds_read_b64_tr_b16 v[66:67], v19 offset:63488
 v_mfma_f32_16x16x32_bf16 v[108:111], v[68:71], a[140:143], v[108:111]
 buffer_load_dwordx4 a[200:203], v14, s[4:7], s64 offen offset:0 sc1
 v_mfma_f32_16x16x32_bf16 v[112:115], v[72:75], a[136:139], v[112:115]
 s_waitcnt vmcnt(13)
 ds_read_b64_tr_b16 v[68:69], v20 offset:61440
 ds_read_b64_tr_b16 v[70:71], v20 offset:63488
 v_mfma_f32_16x16x32_bf16 v[116:119], v[72:75], a[140:143], v[116:119]
 v_mfma_f32_16x16x32_bf16 v[120:123], v[76:79], a[136:139], v[120:123]
 s_waitcnt lgkmcnt(6)
 ds_read_b64_tr_b16 v[72:73], v21 offset:61440
 ds_read_b64_tr_b16 v[74:75], v21 offset:63488
 v_mfma_f32_16x16x32_bf16 v[124:127], v[76:79], a[140:143], v[124:127]
 buffer_load_dwordx4 a[204:207], v14, s[4:7], s64 offen offset:2048 sc1
 v_mfma_f32_16x16x32_bf16 v[96:99], v[80:83], a[144:147], v[96:99]
 s_bfe_u32 s64, s85, 0x40014
 ds_read_b64_tr_b16 v[76:77], v22 offset:61440
 ds_read_b64_tr_b16 v[78:79], v22 offset:63488
 v_mfma_f32_16x16x32_bf16 v[100:103], v[80:83], a[148:151], v[100:103]
 s_mul_i32 s64, s64, 0x80000
 s_add_u32 s64, s64, s16
 v_mfma_f32_16x16x32_bf16 v[104:107], v[84:87], a[144:147], v[104:107]
 s_barrier
 ds_read_b64_tr_b16 v[80:81], v23 offset:0
 ds_read_b64_tr_b16 v[82:83], v23 offset:2048
 v_mfma_f32_16x16x32_bf16 v[108:111], v[84:87], a[148:151], v[108:111]
 buffer_load_dwordx4 a[208:211], v11, s[4:7], s64 offen offset:0 sc1
 v_mfma_f32_16x16x32_bf16 v[112:115], v[88:91], a[144:147], v[112:115]
 s_waitcnt lgkmcnt(6)
 ds_read_b64_tr_b16 v[84:85], v24 offset:0
 ds_read_b64_tr_b16 v[86:87], v24 offset:2048
 v_mfma_f32_16x16x32_bf16 v[116:119], v[88:91], a[148:151], v[116:119]
 v_mfma_f32_16x16x32_bf16 v[120:123], v[92:95], a[144:147], v[120:123]
 s_waitcnt vmcnt(13)
 ds_read_b64_tr_b16 v[88:89], v25 offset:0
 ds_read_b64_tr_b16 v[90:91], v25 offset:2048
 v_mfma_f32_16x16x32_bf16 v[124:127], v[92:95], a[148:151], v[124:127]
 buffer_load_dwordx4 a[212:215], v11, s[4:7], s64 offen offset:2048 sc1
 v_mfma_f32_16x16x32_bf16 v[96:99], v[64:67], a[152:155], v[96:99]
 ds_read_b64_tr_b16 v[92:93], v26 offset:0
 ds_read_b64_tr_b16 v[94:95], v26 offset:2048
 v_mfma_f32_16x16x32_bf16 v[100:103], v[64:67], a[156:159], v[100:103]
 v_mfma_f32_16x16x32_bf16 v[104:107], v[68:71], a[152:155], v[104:107]
 s_waitcnt lgkmcnt(6)
 ds_read_b64_tr_b16 v[64:65], v23 offset:4096
 ds_read_b64_tr_b16 v[66:67], v23 offset:6144
 v_mfma_f32_16x16x32_bf16 v[108:111], v[68:71], a[156:159], v[108:111]
 buffer_load_dwordx4 a[216:219], v14, s[4:7], s64 offen offset:0 sc1
 v_mfma_f32_16x16x32_bf16 v[112:115], v[72:75], a[152:155], v[112:115]
 s_waitcnt vmcnt(13)
 ds_read_b64_tr_b16 v[68:69], v24 offset:4096
 ds_read_b64_tr_b16 v[70:71], v24 offset:6144
 v_mfma_f32_16x16x32_bf16 v[116:119], v[72:75], a[156:159], v[116:119]
 v_mfma_f32_16x16x32_bf16 v[120:123], v[76:79], a[152:155], v[120:123]
 ds_read_b64_tr_b16 v[72:73], v25 offset:4096
 ds_read_b64_tr_b16 v[74:75], v25 offset:6144
 v_mfma_f32_16x16x32_bf16 v[124:127], v[76:79], a[156:159], v[124:127]
 buffer_load_dwordx4 a[220:223], v14, s[4:7], s64 offen offset:2048 sc1
 v_mfma_f32_16x16x32_bf16 v[96:99], v[80:83], a[160:163], v[96:99]
 s_waitcnt lgkmcnt(6)
 ds_read_b64_tr_b16 v[76:77], v26 offset:4096
 ds_read_b64_tr_b16 v[78:79], v26 offset:6144
 v_mfma_f32_16x16x32_bf16 v[100:103], v[80:83], a[164:167], v[100:103]
 s_bfe_u32 s64, s85, 0x40018
 s_mul_i32 s64, s64, 0x80000
 s_add_u32 s64, s64, s16
 v_mfma_f32_16x16x32_bf16 v[104:107], v[84:87], a[160:163], v[104:107]
 ds_read_b64_tr_b16 v[80:81], v23 offset:8192
 ds_read_b64_tr_b16 v[82:83], v23 offset:10240
 v_mfma_f32_16x16x32_bf16 v[108:111], v[84:87], a[164:167], v[108:111]
 buffer_load_dwordx4 a[224:227], v11, s[4:7], s64 offen offset:0 sc1
 v_mfma_f32_16x16x32_bf16 v[112:115], v[88:91], a[160:163], v[112:115]
 s_waitcnt vmcnt(13)
 ds_read_b64_tr_b16 v[84:85], v24 offset:8192
 ds_read_b64_tr_b16 v[86:87], v24 offset:10240
 v_mfma_f32_16x16x32_bf16 v[116:119], v[88:91], a[164:167], v[116:119]
 v_mfma_f32_16x16x32_bf16 v[120:123], v[92:95], a[160:163], v[120:123]
 s_waitcnt lgkmcnt(6)
 ds_read_b64_tr_b16 v[88:89], v25 offset:8192
 ds_read_b64_tr_b16 v[90:91], v25 offset:10240
 v_mfma_f32_16x16x32_bf16 v[124:127], v[92:95], a[164:167], v[124:127]
 buffer_load_dwordx4 a[228:231], v11, s[4:7], s64 offen offset:2048 sc1
 v_mfma_f32_16x16x32_bf16 v[96:99], v[64:67], a[168:171], v[96:99]
 ds_read_b64_tr_b16 v[92:93], v26 offset:8192
 ds_read_b64_tr_b16 v[94:95], v26 offset:10240
 v_mfma_f32_16x16x32_bf16 v[100:103], v[64:67], a[172:175], v[100:103]
 v_mfma_f32_16x16x32_bf16 v[104:107], v[68:71], a[168:171], v[104:107]
 ds_read_b64_tr_b16 v[64:65], v23 offset:12288
 ds_read_b64_tr_b16 v[66:67], v23 offset:14336
 v_mfma_f32_16x16x32_bf16 v[108:111], v[68:71], a[172:175], v[108:111]
 buffer_load_dwordx4 a[232:235], v14, s[4:7], s64 offen offset:0 sc1
 v_mfma_f32_16x16x32_bf16 v[112:115], v[72:75], a[168:171], v[112:115]
 s_waitcnt lgkmcnt(6)
 ds_read_b64_tr_b16 v[68:69], v24 offset:12288
 ds_read_b64_tr_b16 v[70:71], v24 offset:14336
 v_mfma_f32_16x16x32_bf16 v[116:119], v[72:75], a[172:175], v[116:119]
 v_mfma_f32_16x16x32_bf16 v[120:123], v[76:79], a[168:171], v[120:123]
 s_waitcnt vmcnt(13)
 ds_read_b64_tr_b16 v[72:73], v25 offset:12288
 ds_read_b64_tr_b16 v[74:75], v25 offset:14336
 v_mfma_f32_16x16x32_bf16 v[124:127], v[76:79], a[172:175], v[124:127]
 buffer_load_dwordx4 a[236:239], v14, s[4:7], s64 offen offset:2048 sc1
 v_mfma_f32_16x16x32_bf16 v[96:99], v[80:83], a[176:179], v[96:99]
 s_bfe_u32 s64, s85, 0x4001c
 ds_read_b64_tr_b16 v[76:77], v26 offset:12288
 ds_read_b64_tr_b16 v[78:79], v26 offset:14336
 v_mfma_f32_16x16x32_bf16 v[100:103], v[80:83], a[180:183], v[100:103]
 s_mul_i32 s64, s64, 0x80000
 s_add_u32 s64, s64, s16
 v_mfma_f32_16x16x32_bf16 v[104:107], v[84:87], a[176:179], v[104:107]
 s_waitcnt lgkmcnt(6)
 s_barrier
 ds_read_b64_tr_b16 v[80:81], v23 offset:16384
 ds_read_b64_tr_b16 v[82:83], v23 offset:18432
 v_mfma_f32_16x16x32_bf16 v[108:111], v[84:87], a[180:183], v[108:111]
 buffer_load_dwordx4 a[240:243], v11, s[4:7], s64 offen offset:0 sc1
 v_mfma_f32_16x16x32_bf16 v[112:115], v[88:91], a[176:179], v[112:115]
 s_waitcnt vmcnt(13)
 ds_read_b64_tr_b16 v[84:85], v24 offset:16384
 ds_read_b64_tr_b16 v[86:87], v24 offset:18432
 v_mfma_f32_16x16x32_bf16 v[116:119], v[88:91], a[180:183], v[116:119]
 v_mfma_f32_16x16x32_bf16 v[120:123], v[92:95], a[176:179], v[120:123]
 ds_read_b64_tr_b16 v[88:89], v25 offset:16384
 ds_read_b64_tr_b16 v[90:91], v25 offset:18432
 v_mfma_f32_16x16x32_bf16 v[124:127], v[92:95], a[180:183], v[124:127]
 buffer_load_dwordx4 a[244:247], v11, s[4:7], s64 offen offset:2048 sc1
 v_mfma_f32_16x16x32_bf16 v[96:99], v[64:67], a[184:187], v[96:99]
 s_waitcnt lgkmcnt(6)
 ds_read_b64_tr_b16 v[92:93], v26 offset:16384
 ds_read_b64_tr_b16 v[94:95], v26 offset:18432
 v_mfma_f32_16x16x32_bf16 v[100:103], v[64:67], a[188:191], v[100:103]
 v_mfma_f32_16x16x32_bf16 v[104:107], v[68:71], a[184:187], v[104:107]
 ds_read_b64_tr_b16 v[64:65], v23 offset:20480
 ds_read_b64_tr_b16 v[66:67], v23 offset:22528
 v_mfma_f32_16x16x32_bf16 v[108:111], v[68:71], a[188:191], v[108:111]
 buffer_load_dwordx4 a[248:251], v14, s[4:7], s64 offen offset:0 sc1
 v_mfma_f32_16x16x32_bf16 v[112:115], v[72:75], a[184:187], v[112:115]
 s_waitcnt vmcnt(13)
 ds_read_b64_tr_b16 v[68:69], v24 offset:20480
 ds_read_b64_tr_b16 v[70:71], v24 offset:22528
 v_mfma_f32_16x16x32_bf16 v[116:119], v[72:75], a[188:191], v[116:119]
 v_mfma_f32_16x16x32_bf16 v[120:123], v[76:79], a[184:187], v[120:123]
 s_waitcnt lgkmcnt(6)
 ds_read_b64_tr_b16 v[72:73], v25 offset:20480
 ds_read_b64_tr_b16 v[74:75], v25 offset:22528
 v_mfma_f32_16x16x32_bf16 v[124:127], v[76:79], a[188:191], v[124:127]
 buffer_load_dwordx4 a[252:255], v14, s[4:7], s64 offen offset:2048 sc1
 v_mfma_f32_16x16x32_bf16 v[96:99], v[80:83], a[192:195], v[96:99]
 s_add_u32 m0, s60, 0x20000
 ds_read_b64_tr_b16 v[76:77], v26 offset:20480
 ds_read_b64_tr_b16 v[78:79], v26 offset:22528
 v_mfma_f32_16x16x32_bf16 v[100:103], v[80:83], a[196:199], v[100:103]
 s_bfe_u32 s65, s84, 0x40004
 s_mul_i32 s65, s65, 0x7000
 s_add_u32 s65, s65, s40
 v_mfma_f32_16x16x32_bf16 v[104:107], v[84:87], a[192:195], v[104:107]
 ds_read_b64_tr_b16 v[80:81], v23 offset:24576
 ds_read_b64_tr_b16 v[82:83], v23 offset:26624
 v_mfma_f32_16x16x32_bf16 v[108:111], v[84:87], a[196:199], v[108:111]
 buffer_load_dwordx4 v11, s[4:7], s65 offen offset:0 sc1 lds
 v_mfma_f32_16x16x32_bf16 v[112:115], v[88:91], a[192:195], v[112:115]
 s_waitcnt lgkmcnt(6)
 ds_read_b64_tr_b16 v[84:85], v24 offset:24576
 ds_read_b64_tr_b16 v[86:87], v24 offset:26624
 v_mfma_f32_16x16x32_bf16 v[116:119], v[88:91], a[196:199], v[116:119]
 v_mfma_f32_16x16x32_bf16 v[120:123], v[92:95], a[192:195], v[120:123]
 s_waitcnt vmcnt(13)
 ds_read_b64_tr_b16 v[88:89], v25 offset:24576
 ds_read_b64_tr_b16 v[90:91], v25 offset:26624
 v_mfma_f32_16x16x32_bf16 v[124:127], v[92:95], a[196:199], v[124:127]
 buffer_load_dwordx4 v252, s[4:7], s65 offen offset:1024 sc1 lds
 v_mfma_f32_16x16x32_bf16 v[96:99], v[64:67], a[200:203], v[96:99]
 ds_read_b64_tr_b16 v[92:93], v26 offset:24576
 ds_read_b64_tr_b16 v[94:95], v26 offset:26624
 v_mfma_f32_16x16x32_bf16 v[100:103], v[64:67], a[204:207], v[100:103]
 v_mfma_f32_16x16x32_bf16 v[104:107], v[68:71], a[200:203], v[104:107]
 s_waitcnt lgkmcnt(6)
 ds_read_b64_tr_b16 v[64:65], v23 offset:28672
 ds_read_b64_tr_b16 v[66:67], v23 offset:30720
 v_mfma_f32_16x16x32_bf16 v[108:111], v[68:71], a[204:207], v[108:111]
 buffer_load_dwordx4 v253, s[4:7], s65 offen offset:2048 sc1 lds
 v_mfma_f32_16x16x32_bf16 v[112:115], v[72:75], a[200:203], v[112:115]
 s_waitcnt vmcnt(13)
 ds_read_b64_tr_b16 v[68:69], v24 offset:28672
 ds_read_b64_tr_b16 v[70:71], v24 offset:30720
 v_mfma_f32_16x16x32_bf16 v[116:119], v[72:75], a[204:207], v[116:119]
 v_mfma_f32_16x16x32_bf16 v[120:123], v[76:79], a[200:203], v[120:123]
 ds_read_b64_tr_b16 v[72:73], v25 offset:28672
 ds_read_b64_tr_b16 v[74:75], v25 offset:30720
 v_mfma_f32_16x16x32_bf16 v[124:127], v[76:79], a[204:207], v[124:127]
 buffer_load_dwordx4 v254, s[4:7], s65 offen offset:3072 sc1 lds
 v_mfma_f32_16x16x32_bf16 v[96:99], v[80:83], a[208:211], v[96:99]
 s_waitcnt lgkmcnt(6)
 ds_read_b64_tr_b16 v[76:77], v26 offset:28672
 ds_read_b64_tr_b16 v[78:79], v26 offset:30720
 v_mfma_f32_16x16x32_bf16 v[100:103], v[80:83], a[212:215], v[100:103]
 s_add_u32 m0, s60, 0x0
 s_bfe_u32 s65, s84, 0x40008
 s_mul_i32 s65, s65, 0x7000
 v_mfma_f32_16x16x32_bf16 v[104:107], v[84:87], a[208:211], v[104:107]
 s_add_u32 s65, s65, s40
 s_barrier
 ds_read_b64_tr_b16 v[80:81], v23 offset:32768
 ds_read_b64_tr_b16 v[82:83], v23 offset:34816
 v_mfma_f32_16x16x32_bf16 v[108:111], v[84:87], a[212:215], v[108:111]
 buffer_load_dwordx4 v11, s[4:7], s65 offen offset:0 sc1 lds
 v_mfma_f32_16x16x32_bf16 v[112:115], v[88:91], a[208:211], v[112:115]
 s_waitcnt vmcnt(13)
 ds_read_b64_tr_b16 v[84:85], v24 offset:32768
 ds_read_b64_tr_b16 v[86:87], v24 offset:34816
 v_mfma_f32_16x16x32_bf16 v[116:119], v[88:91], a[212:215], v[116:119]
 v_mfma_f32_16x16x32_bf16 v[120:123], v[92:95], a[208:211], v[120:123]
 s_waitcnt lgkmcnt(6)
 ds_read_b64_tr_b16 v[88:89], v25 offset:32768
 ds_read_b64_tr_b16 v[90:91], v25 offset:34816
 v_mfma_f32_16x16x32_bf16 v[124:127], v[92:95], a[212:215], v[124:127]
 buffer_load_dwordx4 v252, s[4:7], s65 offen offset:1024 sc1 lds
 v_mfma_f32_16x16x32_bf16 v[96:99], v[64:67], a[216:219], v[96:99]
 ds_read_b64_tr_b16 v[92:93], v26 offset:32768
 ds_read_b64_tr_b16 v[94:95], v26 offset:34816
 v_mfma_f32_16x16x32_bf16 v[100:103], v[64:67], a[220:223], v[100:103]
 v_mfma_f32_16x16x32_bf16 v[104:107], v[68:71], a[216:219], v[104:107]
 ds_read_b64_tr_b16 v[64:65], v23 offset:36864
 ds_read_b64_tr_b16 v[66:67], v23 offset:38912
 v_mfma_f32_16x16x32_bf16 v[108:111], v[68:71], a[220:223], v[108:111]
 buffer_load_dwordx4 v253, s[4:7], s65 offen offset:2048 sc1 lds
 v_mfma_f32_16x16x32_bf16 v[112:115], v[72:75], a[216:219], v[112:115]
 s_waitcnt lgkmcnt(6)
 ds_read_b64_tr_b16 v[68:69], v24 offset:36864
 ds_read_b64_tr_b16 v[70:71], v24 offset:38912
 v_mfma_f32_16x16x32_bf16 v[116:119], v[72:75], a[220:223], v[116:119]
 v_mfma_f32_16x16x32_bf16 v[120:123], v[76:79], a[216:219], v[120:123]
 s_waitcnt vmcnt(13)
 ds_read_b64_tr_b16 v[72:73], v25 offset:36864
 ds_read_b64_tr_b16 v[74:75], v25 offset:38912
 v_mfma_f32_16x16x32_bf16 v[124:127], v[76:79], a[220:223], v[124:127]
 buffer_load_dwordx4 v254, s[4:7], s65 offen offset:3072 sc1 lds
 v_mfma_f32_16x16x32_bf16 v[96:99], v[80:83], a[224:227], v[96:99]
 ds_read_b64_tr_b16 v[76:77], v26 offset:36864
 ds_read_b64_tr_b16 v[78:79], v26 offset:38912
 v_mfma_f32_16x16x32_bf16 v[100:103], v[80:83], a[228:231], v[100:103]
 v_mfma_f32_16x16x32_bf16 v[104:107], v[84:87], a[224:227], v[104:107]
 s_waitcnt lgkmcnt(6)
 ds_read_b64_tr_b16 v[80:81], v23 offset:40960
 ds_read_b64_tr_b16 v[82:83], v23 offset:43008
 v_mfma_f32_16x16x32_bf16 v[108:111], v[84:87], a[228:231], v[108:111]
 v_mfma_f32_16x16x32_bf16 v[112:115], v[88:91], a[224:227], v[112:115]
 s_waitcnt vmcnt(12)
 ds_read_b64_tr_b16 v[84:85], v24 offset:40960
 ds_read_b64_tr_b16 v[86:87], v24 offset:43008
 v_mfma_f32_16x16x32_bf16 v[116:119], v[88:91], a[228:231], v[116:119]
 v_mfma_f32_16x16x32_bf16 v[120:123], v[92:95], a[224:227], v[120:123]
 ds_read_b64_tr_b16 v[88:89], v25 offset:40960
 ds_read_b64_tr_b16 v[90:91], v25 offset:43008
 v_mfma_f32_16x16x32_bf16 v[124:127], v[92:95], a[228:231], v[124:127]
 v_mfma_f32_16x16x32_bf16 v[96:99], v[64:67], a[232:235], v[96:99]
 s_waitcnt lgkmcnt(6)
 ds_read_b64_tr_b16 v[92:93], v26 offset:40960
 ds_read_b64_tr_b16 v[94:95], v26 offset:43008
 v_mfma_f32_16x16x32_bf16 v[100:103], v[64:67], a[236:239], v[100:103]
 v_mfma_f32_16x16x32_bf16 v[104:107], v[68:71], a[232:235], v[104:107]
 ds_read_b64_tr_b16 v[64:65], v23 offset:45056
 ds_read_b64_tr_b16 v[66:67], v23 offset:47104
 v_mfma_f32_16x16x32_bf16 v[108:111], v[68:71], a[236:239], v[108:111]
 v_mfma_f32_16x16x32_bf16 v[112:115], v[72:75], a[232:235], v[112:115]
 s_waitcnt vmcnt(10)
 ds_read_b64_tr_b16 v[68:69], v24 offset:45056
 ds_read_b64_tr_b16 v[70:71], v24 offset:47104
 v_mfma_f32_16x16x32_bf16 v[116:119], v[72:75], a[236:239], v[116:119]
 v_mfma_f32_16x16x32_bf16 v[120:123], v[76:79], a[232:235], v[120:123]
 s_waitcnt lgkmcnt(6)
 ds_read_b64_tr_b16 v[72:73], v25 offset:45056
 ds_read_b64_tr_b16 v[74:75], v25 offset:47104
 v_mfma_f32_16x16x32_bf16 v[124:127], v[76:79], a[236:239], v[124:127]
 v_mfma_f32_16x16x32_bf16 v[96:99], v[80:83], a[240:243], v[96:99]
 ds_read_b64_tr_b16 v[76:77], v26 offset:45056
 ds_read_b64_tr_b16 v[78:79], v26 offset:47104
 v_mfma_f32_16x16x32_bf16 v[100:103], v[80:83], a[244:247], v[100:103]
 v_mfma_f32_16x16x32_bf16 v[104:107], v[84:87], a[240:243], v[104:107]
 v_mfma_f32_16x16x32_bf16 v[108:111], v[84:87], a[244:247], v[108:111]
 v_mfma_f32_16x16x32_bf16 v[112:115], v[88:91], a[240:243], v[112:115]
 s_waitcnt lgkmcnt(4)
 v_mfma_f32_16x16x32_bf16 v[116:119], v[88:91], a[244:247], v[116:119]
 v_mfma_f32_16x16x32_bf16 v[120:123], v[92:95], a[240:243], v[120:123]
 s_waitcnt vmcnt(8)
 v_mfma_f32_16x16x32_bf16 v[124:127], v[92:95], a[244:247], v[124:127]
 v_mfma_f32_16x16x32_bf16 v[96:99], v[64:67], a[248:251], v[96:99]
 v_mfma_f32_16x16x32_bf16 v[100:103], v[64:67], a[252:255], v[100:103]
 v_mfma_f32_16x16x32_bf16 v[104:107], v[68:71], a[248:251], v[104:107]
 s_waitcnt lgkmcnt(0)
 v_mfma_f32_16x16x32_bf16 v[108:111], v[68:71], a[252:255], v[108:111]
 v_mfma_f32_16x16x32_bf16 v[112:115], v[72:75], a[248:251], v[112:115]
 v_mfma_f32_16x16x32_bf16 v[116:119], v[72:75], a[252:255], v[116:119]
 v_mfma_f32_16x16x32_bf16 v[120:123], v[76:79], a[248:251], v[120:123]
 v_mfma_f32_16x16x32_bf16 v[124:127], v[76:79], a[252:255], v[124:127]
 s_barrier
 v_cvt_pk_bf16_f32 v224, v96, v97
 v_cvt_pk_bf16_f32 v225, v98, v99
 v_cvt_pk_bf16_f32 v226, v104, v105
 v_cvt_pk_bf16_f32 v227, v106, v107
 v_cvt_pk_bf16_f32 v228, v100, v101
 v_cvt_pk_bf16_f32 v229, v102, v103
 v_cvt_pk_bf16_f32 v230, v108, v109
 v_cvt_pk_bf16_f32 v231, v110, v111
 s_add_u32 s69, s43, 0x800000
 buffer_store_dwordx4 v[224:227], v11, s[4:7], s69 offen offset:0 sc1
 v_pk_mul_f32 v[244:245], v[96:97], v[96:97]
 v_pk_add_f32 v[240:241], v[96:97], v[98:99]
 v_pk_fma_f32 v[244:245], v[98:99], v[98:99], v[244:245]
 v_pk_mul_f32 v[246:247], v[100:101], v[100:101]
 v_pk_add_f32 v[242:243], v[100:101], v[102:103]
 v_pk_fma_f32 v[246:247], v[102:103], v[102:103], v[246:247]
 buffer_store_dwordx4 v[228:231], v11, s[4:7], s69 offen offset:2048 sc1
 v_pk_fma_f32 v[244:245], v[104:105], v[104:105], v[244:245]
 v_pk_add_f32 v[240:241], v[240:241], v[104:105]
 v_pk_fma_f32 v[244:245], v[106:107], v[106:107], v[244:245]
 v_pk_add_f32 v[240:241], v[240:241], v[106:107]
 v_pk_fma_f32 v[246:247], v[108:109], v[108:109], v[246:247]
 v_pk_add_f32 v[242:243], v[242:243], v[108:109]
 v_pk_fma_f32 v[246:247], v[110:111], v[110:111], v[246:247]
 v_pk_add_f32 v[242:243], v[242:243], v[110:111]
 v_cvt_pk_bf16_f32 v232, v112, v113
 v_cvt_pk_bf16_f32 v233, v114, v115
 v_cvt_pk_bf16_f32 v234, v120, v121
 v_cvt_pk_bf16_f32 v235, v122, v123
 v_cvt_pk_bf16_f32 v236, v116, v117
 v_cvt_pk_bf16_f32 v237, v118, v119
 v_cvt_pk_bf16_f32 v238, v124, v125
 v_cvt_pk_bf16_f32 v239, v126, v127
 s_add_u32 s69, s43, 0x800000
 buffer_store_dwordx4 v[232:235], v14, s[4:7], s69 offen offset:0 sc1
 v_pk_fma_f32 v[244:245], v[112:113], v[112:113], v[244:245]
 v_pk_add_f32 v[240:241], v[240:241], v[112:113]
 v_pk_fma_f32 v[244:245], v[114:115], v[114:115], v[244:245]
 v_pk_add_f32 v[240:241], v[240:241], v[114:115]
 v_pk_fma_f32 v[246:247], v[116:117], v[116:117], v[246:247]
 v_pk_add_f32 v[242:243], v[242:243], v[116:117]
 v_pk_fma_f32 v[246:247], v[118:119], v[118:119], v[246:247]
 v_pk_add_f32 v[242:243], v[242:243], v[118:119]
 buffer_store_dwordx4 v[236:239], v14, s[4:7], s69 offen offset:2048 sc1
 v_pk_fma_f32 v[244:245], v[120:121], v[120:121], v[244:245]
 v_pk_add_f32 v[240:241], v[240:241], v[120:121]
 v_pk_fma_f32 v[244:245], v[122:123], v[122:123], v[244:245]
 v_pk_add_f32 v[240:241], v[240:241], v[122:123]
 v_pk_fma_f32 v[246:247], v[124:125], v[124:125], v[246:247]
 v_pk_add_f32 v[242:243], v[242:243], v[124:125]
 v_pk_fma_f32 v[246:247], v[126:127], v[126:127], v[246:247]
 v_pk_add_f32 v[242:243], v[242:243], v[126:127]
 v_and_b32 v60, 15, v0
 v_lshlrev_b32 v60, 4, v60
 v_lshrrev_b32 v61, 4, v0
 v_lshl_add_u32 v60, v61, 2, v60
 v_add_f32 v240, v240, v241
 v_add_f32 v242, v242, v243
 v_add_f32 v244, v244, v245
 v_add_f32 v246, v246, v247
 v_permlane16_swap_b32 v240, v242
 s_nop 0
 v_permlane16_swap_b32 v244, v246
 v_add_f32 v240, v240, v242
 v_add_f32 v244, v244, v246
 s_nop 1
 v_permlane32_swap_b32 v240, v244
 v_add_f32 v240, v240, v244
 s_add_u32 s69, s51, 0x3840000
 buffer_store_dword v240, v60, s[4:7], s69 offen sc1
 s_add_u32 m0, s60, 0x4000
 s_bfe_u32 s65, s84, 0x4000c
 s_mul_i32 s65, s65, 0x7000
 s_add_u32 s65, s65, s40
 buffer_load_dwordx4 v11, s[4:7], s65 offen offset:0 sc1 lds
 buffer_load_dwordx4 v252, s[4:7], s65 offen offset:1024 sc1 lds
 s_waitcnt vmcnt(2)
 s_atomic_add s93, s[54:55], 256
 buffer_load_dwordx4 v253, s[4:7], s65 offen offset:2048 sc1 lds
 buffer_load_dwordx4 v254, s[4:7], s65 offen offset:3072 sc1 lds
 s_add_u32 m0, s60, 0x8000
 s_bfe_u32 s65, s84, 0x40010
 s_mul_i32 s65, s65, 0x7000
 s_add_u32 s65, s65, s40
 buffer_load_dwordx4 v11, s[4:7], s65 offen offset:0 sc1 lds
 buffer_load_dwordx4 v252, s[4:7], s65 offen offset:1024 sc1 lds
 buffer_load_dwordx4 v253, s[4:7], s65 offen offset:2048 sc1 lds
 buffer_load_dwordx4 v254, s[4:7], s65 offen offset:3072 sc1 lds
 s_mov_b32 s79, 0
 s_atomic_add s79, s[54:55], 256 glc
 v_accvgpr_write_b32 a0, v224
 v_accvgpr_write_b32 a1, v225
 v_accvgpr_write_b32 a2, v226
 v_accvgpr_write_b32 a3, v227
 v_accvgpr_write_b32 a4, v228
 v_accvgpr_write_b32 a5, v229
 v_accvgpr_write_b32 a6, v230
 v_accvgpr_write_b32 a7, v231
 v_accvgpr_write_b32 a8, v232
 v_accvgpr_write_b32 a9, v233
 v_accvgpr_write_b32 a10, v234
 v_accvgpr_write_b32 a11, v235
 v_accvgpr_write_b32 a12, v236
 v_accvgpr_write_b32 a13, v237
 v_accvgpr_write_b32 a14, v238
 v_accvgpr_write_b32 a15, v239
 s_add_u32 m0, s60, 0xc000
 s_bfe_u32 s65, s84, 0x40014
 s_mul_i32 s65, s65, 0x7000
 s_add_u32 s65, s65, s40
 buffer_load_dwordx4 v11, s[4:7], s65 offen offset:0 sc1 lds
 buffer_load_dwordx4 v252, s[4:7], s65 offen offset:1024 sc1 lds
 buffer_load_dwordx4 v253, s[4:7], s65 offen offset:2048 sc1 lds
 buffer_load_dwordx4 v254, s[4:7], s65 offen offset:3072 sc1 lds
 s_add_u32 m0, s60, 0x10000
 s_bfe_u32 s65, s84, 0x40018
 s_mul_i32 s65, s65, 0x7000
 s_add_u32 s65, s65, s40
 buffer_load_dwordx4 v11, s[4:7], s65 offen offset:0 sc1 lds
 buffer_load_dwordx4 v252, s[4:7], s65 offen offset:1024 sc1 lds
 buffer_load_dwordx4 v253, s[4:7], s65 offen offset:2048 sc1 lds
 buffer_load_dwordx4 v254, s[4:7], s65 offen offset:3072 sc1 lds
 s_barrier
 ds_read_b128 v[80:83], v12 offset:49152
 ds_read_b128 v[84:87], v12 offset:50176
 ds_read_b128 v[88:91], v12 offset:51200
 ds_read_b128 v[92:95], v12 offset:52224
 ds_read_b128 v[64:67], v12 offset:53248
 ds_read_b128 v[68:71], v12 offset:54272
 ds_read_b128 v[72:75], v12 offset:55296
 s_mov_b32 s67, 0
mk_w17:
 s_waitcnt lgkmcnt(0)
 s_cmp_ge_u32 s79, 16
 s_cbranch_scc1 mk_d18
 s_mov_b32 s79, 0
 s_atomic_add s79, s[54:55], 256 glc
 s_add_u32 s67, s67, 1
 s_cmp_lt_u32 s67, 0x8000
 s_cbranch_scc1 mk_w17
mk_d18:
 s_add_u32 s16, s3, 0x800000
 s_bfe_u32 s64, s84, 0x40004
 s_mul_i32 s64, s64, 0x80000
 s_add_u32 s64, s64, s16
 buffer_load_dwordx4 a[16:19], v11, s[4:7], s64 offen offset:0 sc1
 buffer_load_dwordx4 a[20:23], v11, s[4:7], s64 offen offset:2048 sc1
 buffer_load_dwordx4 a[24:27], v14, s[4:7], s64 offen offset:0 sc1
 buffer_load_dwordx4 a[28:31], v14, s[4:7], s64 offen offset:2048 sc1
 s_bfe_u32 s64, s84, 0x40008
 s_mul_i32 s64, s64, 0x80000
 s_add_u32 s64, s64, s16
 buffer_load_dwordx4 a[32:35], v11, s[4:7], s64 offen offset:0 sc1
 buffer_load_dwordx4 a[36:39], v11, s[4:7], s64 offen offset:2048 sc1
 buffer_load_dwordx4 a[40:43], v14, s[4:7], s64 offen offset:0 sc1
 buffer_load_dwordx4 a[44:47], v14, s[4:7], s64 offen offset:2048 sc1
 v_mfma_f32_16x16x32_bf16 v[96:99], v[80:83], a[0:3], 0
 s_bfe_u32 s64, s84, 0x4000c
 ds_read_b128 v[76:79], v12 offset:56320
 v_mfma_f32_16x16x32_bf16 v[100:103], v[80:83], a[4:7], 0
 s_mul_i32 s64, s64, 0x80000
 s_add_u32 s64, s64, s16
 v_mfma_f32_16x16x32_bf16 v[104:107], v[84:87], a[0:3], 0
 ds_read_b128 v[80:83], v12 offset:57344
 v_mfma_f32_16x16x32_bf16 v[108:111], v[84:87], a[4:7], 0
 buffer_load_dwordx4 a[48:51], v11, s[4:7], s64 offen offset:0 sc1
 v_mfma_f32_16x16x32_bf16 v[112:115], v[88:91], a[0:3], 0
 ds_read_b128 v[84:87], v12 offset:58368
 v_mfma_f32_16x16x32_bf16 v[116:119], v[88:91], a[4:7], 0
 v_mfma_f32_16x16x32_bf16 v[120:123], v[92:95], a[0:3], 0
 ds_read_b128 v[88:91], v12 offset:59392
 v_mfma_f32_16x16x32_bf16 v[124:127], v[92:95], a[4:7], 0
 buffer_load_dwordx4 a[52:55], v11, s[4:7], s64 offen offset:2048 sc1
 v_mfma_f32_16x16x32_bf16 v[128:131], v[64:67], a[0:3], 0
 ds_read_b128 v[92:95], v12 offset:60416
 v_mfma_f32_16x16x32_bf16 v[132:135], v[64:67], a[4:7], 0
 v_mfma_f32_16x16x32_bf16 v[136:139], v[68:71], a[0:3], 0
 s_waitcnt lgkmcnt(3)
 ds_read_b128 v[64:67], v12 offset:61440
 v_mfma_f32_16x16x32_bf16 v[140:143], v[68:71], a[4:7], 0
 buffer_load_dwordx4 a[56:59], v14, s[4:7], s64 offen offset:0 sc1
 v_mfma_f32_16x16x32_bf16 v[144:147], v[72:75], a[0:3], 0
 ds_read_b128 v[68:71], v12 offset:62464
 v_mfma_f32_16x16x32_bf16 v[148:151], v[72:75], a[4:7], 0
 v_mfma_f32_16x16x32_bf16 v[96:99], v[76:79], a[8:11], v[96:99]
 s_barrier
 ds_read_b128 v[72:75], v13 offset:0
 v_mfma_f32_16x16x32_bf16 v[100:103], v[76:79], a[12:15], v[100:103]
 buffer_load_dwordx4 a[60:63], v14, s[4:7], s64 offen offset:2048 sc1
 v_mfma_f32_16x16x32_bf16 v[104:107], v[80:83], a[8:11], v[104:107]
 s_waitcnt lgkmcnt(3)
 ds_read_b128 v[76:79], v13 offset:1024
 v_mfma_f32_16x16x32_bf16 v[108:111], v[80:83], a[12:15], v[108:111]
 s_bfe_u32 s64, s84, 0x40010
 s_mul_i32 s64, s64, 0x80000
 s_add_u32 s64, s64, s16
 v_mfma_f32_16x16x32_bf16 v[112:115], v[84:87], a[8:11], v[112:115]
 ds_read_b128 v[80:83], v13 offset:2048
 v_mfma_f32_16x16x32_bf16 v[116:119], v[84:87], a[12:15], v[116:119]
 buffer_load_dwordx4 a[64:67], v11, s[4:7], s64 offen offset:0 sc1
 v_mfma_f32_16x16x32_bf16 v[120:123], v[88:91], a[8:11], v[120:123]
 ds_read_b128 v[84:87], v13 offset:3072
 v_mfma_f32_16x16x32_bf16 v[124:127], v[88:91], a[12:15], v[124:127]
 v_mfma_f32_16x16x32_bf16 v[128:131], v[92:95], a[8:11], v[128:131]
 s_waitcnt lgkmcnt(3)
 ds_read_b128 v[88:91], v13 offset:4096
 v_mfma_f32_16x16x32_bf16 v[132:135], v[92:95], a[12:15], v[132:135]
 buffer_load_dwordx4 a[68:71], v11, s[4:7], s64 offen offset:2048 sc1
 v_mfma_f32_16x16x32_bf16 v[136:139], v[64:67], a[8:11], v[136:139]
 s_waitcnt vmcnt(12)
 ds_read_b128 v[92:95], v13 offset:5120
 v_mfma_f32_16x16x32_bf16 v[140:143], v[64:67], a[12:15], v[140:143]
 v_mfma_f32_16x16x32_bf16 v[144:147], v[68:71], a[8:11], v[144:147]
 ds_read_b128 v[64:67], v13 offset:6144
 v_mfma_f32_16x16x32_bf16 v[148:151], v[68:71], a[12:15], v[148:151]
 buffer_load_dwordx4 a[72:75], v14, s[4:7], s64 offen offset:0 sc1
 v_mfma_f32_16x16x32_bf16 v[96:99], v[72:75], a[16:19], v[96:99]
 s_waitcnt lgkmcnt(3)
 ds_read_b128 v[68:71], v13 offset:7168
 v_mfma_f32_16x16x32_bf16 v[100:103], v[72:75], a[20:23], v[100:103]
 v_mfma_f32_16x16x32_bf16 v[104:107], v[76:79], a[16:19], v[104:107]
 ds_read_b128 v[72:75], v13 offset:8192
 v_mfma_f32_16x16x32_bf16 v[108:111], v[76:79], a[20:23], v[108:111]
 buffer_load_dwordx4 a[76:79], v14, s[4:7], s64 offen offset:2048 sc1
 v_mfma_f32_16x16x32_bf16 v[112:115], v[80:83], a[16:19], v[112:115]
 s_bfe_u32 s64, s84, 0x40014
 ds_read_b128 v[76:79], v13 offset:9216
 v_mfma_f32_16x16x32_bf16 v[116:119], v[80:83], a[20:23], v[116:119]
 s_mul_i32 s64, s64, 0x80000
 s_add_u32 s64, s64, s16
 v_mfma_f32_16x16x32_bf16 v[120:123], v[84:87], a[16:19], v[120:123]
 s_waitcnt lgkmcnt(3)
 ds_read_b128 v[80:83], v13 offset:10240
 v_mfma_f32_16x16x32_bf16 v[124:127], v[84:87], a[20:23], v[124:127]
 buffer_load_dwordx4 a[80:83], v11, s[4:7], s64 offen offset:0 sc1
 v_mfma_f32_16x16x32_bf16 v[128:131], v[88:91], a[16:19], v[128:131]
 ds_read_b128 v[84:87], v13 offset:11264
 v_mfma_f32_16x16x32_bf16 v[132:135], v[88:91], a[20:23], v[132:135]
 v_mfma_f32_16x16x32_bf16 v[136:139], v[92:95], a[16:19], v[136:139]
 s_waitcnt vmcnt(13)
 ds_read_b128 v[88:91], v13 offset:12288
 v_mfma_f32_16x16x32_bf16 v[140:143], v[92:95], a[20:23], v[140:143]
 buffer_load_dwordx4 a[84:87], v11, s[4:7], s64 offen offset:2048 sc1
 v_mfma_f32_16x16x32_bf16 v[144:147], v[64:67], a[16:19], v[144:147]
 s_waitcnt lgkmcnt(3)
 ds_read_b128 v[92:95], v13 offset:13312
 v_mfma_f32_16x16x32_bf16 v[148:151], v[64:67], a[20:23], v[148:151]
 v_mfma_f32_16x16x32_bf16 v[96:99], v[68:71], a[24:27], v[96:99]
 s_barrier
 ds_read_b128 v[64:67], v1 offset:0
 v_mfma_f32_16x16x32_bf16 v[100:103], v[68:71], a[28:31], v[100:103]
 buffer_load_dwordx4 a[88:91], v14, s[4:7], s64 offen offset:0 sc1
 v_mfma_f32_16x16x32_bf16 v[104:107], v[72:75], a[24:27], v[104:107]
 ds_read_b128 v[68:71], v1 offset:1024
 v_mfma_f32_16x16x32_bf16 v[108:111], v[72:75], a[28:31], v[108:111]
 v_mfma_f32_16x16x32_bf16 v[112:115], v[76:79], a[24:27], v[112:115]
 s_waitcnt lgkmcnt(3)
 ds_read_b128 v[72:75], v1 offset:2048
 v_mfma_f32_16x16x32_bf16 v[116:119], v[76:79], a[28:31], v[116:119]
 buffer_load_dwordx4 a[92:95], v14, s[4:7], s64 offen offset:2048 sc1
 v_mfma_f32_16x16x32_bf16 v[120:123], v[80:83], a[24:27], v[120:123]
 s_bfe_u32 s64, s84, 0x40018
 ds_read_b128 v[76:79], v1 offset:3072
 v_mfma_f32_16x16x32_bf16 v[124:127], v[80:83], a[28:31], v[124:127]
 s_mul_i32 s64, s64, 0x80000
 s_add_u32 s64, s64, s16
 v_mfma_f32_16x16x32_bf16 v[128:131], v[84:87], a[24:27], v[128:131]
 ds_read_b128 v[80:83], v1 offset:4096
 v_mfma_f32_16x16x32_bf16 v[132:135], v[84:87], a[28:31], v[132:135]
 buffer_load_dwordx4 a[96:99], v11, s[4:7], s64 offen offset:0 sc1
 v_mfma_f32_16x16x32_bf16 v[136:139], v[88:91], a[24:27], v[136:139]
 s_waitcnt lgkmcnt(3)
 ds_read_b128 v[84:87], v1 offset:5120
 v_mfma_f32_16x16x32_bf16 v[140:143], v[88:91], a[28:31], v[140:143]
 v_mfma_f32_16x16x32_bf16 v[144:147], v[92:95], a[24:27], v[144:147]
 s_waitcnt vmcnt(15)
 ds_read_b128 v[88:91], v1 offset:6144
 v_mfma_f32_16x16x32_bf16 v[148:151], v[92:95], a[28:31], v[148:151]
 buffer_load_dwordx4 a[100:103], v11, s[4:7], s64 offen offset:2048 sc1
 v_mfma_f32_16x16x32_bf16 v[96:99], v[64:67], a[32:35], v[96:99]
 s_add_u32 m0, s60, 0x14000
 ds_read_b128 v[92:95], v1 offset:7168
 v_mfma_f32_16x16x32_bf16 v[100:103], v[64:67], a[36:39], v[100:103]
 s_bfe_u32 s65, s84, 0x4001c
 s_mul_i32 s65, s65, 0x7000
 s_add_u32 s65, s65, s40
 v_mfma_f32_16x16x32_bf16 v[104:107], v[68:71], a[32:35], v[104:107]
 s_waitcnt lgkmcnt(3)
 ds_read_b128 v[64:67], v1 offset:8192
 v_mfma_f32_16x16x32_bf16 v[108:111], v[68:71], a[36:39], v[108:111]
 buffer_load_dwordx4 v11, s[4:7], s65 offen offset:0 sc1 lds
 v_mfma_f32_16x16x32_bf16 v[112:115], v[72:75], a[32:35], v[112:115]
 ds_read_b128 v[68:71], v1 offset:9216
 v_mfma_f32_16x16x32_bf16 v[116:119], v[72:75], a[36:39], v[116:119]
 v_mfma_f32_16x16x32_bf16 v[120:123], v[76:79], a[32:35], v[120:123]
 ds_read_b128 v[72:75], v1 offset:10240
 v_mfma_f32_16x16x32_bf16 v[124:127], v[76:79], a[36:39], v[124:127]
 buffer_load_dwordx4 a[104:107], v14, s[4:7], s64 offen offset:0 sc1
 v_mfma_f32_16x16x32_bf16 v[128:131], v[80:83], a[32:35], v[128:131]
 s_waitcnt lgkmcnt(3)
 ds_read_b128 v[76:79], v1 offset:11264
 v_mfma_f32_16x16x32_bf16 v[132:135], v[80:83], a[36:39], v[132:135]
 v_mfma_f32_16x16x32_bf16 v[136:139], v[84:87], a[32:35], v[136:139]
 s_waitcnt vmcnt(16)
 ds_read_b128 v[80:83], v1 offset:12288
 v_mfma_f32_16x16x32_bf16 v[140:143], v[84:87], a[36:39], v[140:143]
 buffer_load_dwordx4 a[108:111], v14, s[4:7], s64 offen offset:2048 sc1
 v_mfma_f32_16x16x32_bf16 v[144:147], v[88:91], a[32:35], v[144:147]
 ds_read_b128 v[84:87], v1 offset:13312
 v_mfma_f32_16x16x32_bf16 v[148:151], v[88:91], a[36:39], v[148:151]
 v_mfma_f32_16x16x32_bf16 v[96:99], v[92:95], a[40:43], v[96:99]
 s_waitcnt lgkmcnt(3)
 s_barrier
 ds_read_b128 v[88:91], v1 offset:16384
 v_mfma_f32_16x16x32_bf16 v[100:103], v[92:95], a[44:47], v[100:103]
 buffer_load_dwordx4 v252, s[4:7], s65 offen offset:1024 sc1 lds
 v_mfma_f32_16x16x32_bf16 v[104:107], v[64:67], a[40:43], v[104:107]
 ds_read_b128 v[92:95], v1 offset:17408
 v_mfma_f32_16x16x32_bf16 v[108:111], v[64:67], a[44:47], v[108:111]
 v_mfma_f32_16x16x32_bf16 v[112:115], v[68:71], a[40:43], v[112:115]
 ds_read_b128 v[64:67], v1 offset:18432
 v_mfma_f32_16x16x32_bf16 v[116:119], v[68:71], a[44:47], v[116:119]
 buffer_load_dwordx4 v253, s[4:7], s65 offen offset:2048 sc1 lds
 v_mfma_f32_16x16x32_bf16 v[120:123], v[72:75], a[40:43], v[120:123]
 s_waitcnt lgkmcnt(3)
 ds_read_b128 v[68:71], v1 offset:19456
 v_mfma_f32_16x16x32_bf16 v[124:127], v[72:75], a[44:47], v[124:127]
 v_mfma_f32_16x16x32_bf16 v[128:131], v[76:79], a[40:43], v[128:131]
 ds_read_b128 v[72:75], v1 offset:20480
 v_mfma_f32_16x16x32_bf16 v[132:135], v[76:79], a[44:47], v[132:135]
 buffer_load_dwordx4 v254, s[4:7], s65 offen offset:3072 sc1 lds
 v_mfma_f32_16x16x32_bf16 v[136:139], v[80:83], a[40:43], v[136:139]
 s_waitcnt vmcnt(18)
 ds_read_b128 v[76:79], v1 offset:21504
 v_mfma_f32_16x16x32_bf16 v[140:143], v[80:83], a[44:47], v[140:143]
 s_bfe_u32 s64, s84, 0x4001c
 s_mul_i32 s64, s64, 0x80000
 s_add_u32 s64, s64, s16
 v_mfma_f32_16x16x32_bf16 v[144:147], v[84:87], a[40:43], v[144:147]
 s_waitcnt lgkmcnt(3)
 ds_read_b128 v[80:83], v1 offset:22528
 v_mfma_f32_16x16x32_bf16 v[148:151], v[84:87], a[44:47], v[148:151]
 buffer_load_dwordx4 a[112:115], v11, s[4:7], s64 offen offset:0 sc1
 v_mfma_f32_16x16x32_bf16 v[96:99], v[88:91], a[48:51], v[96:99]
 ds_read_b128 v[84:87], v1 offset:23552
 v_mfma_f32_16x16x32_bf16 v[100:103], v[88:91], a[52:55], v[100:103]
 v_mfma_f32_16x16x32_bf16 v[104:107], v[92:95], a[48:51], v[104:107]
 ds_read_b128 v[88:91], v1 offset:24576
 v_mfma_f32_16x16x32_bf16 v[108:111], v[92:95], a[52:55], v[108:111]
 buffer_load_dwordx4 a[116:119], v11, s[4:7], s64 offen offset:2048 sc1
 v_mfma_f32_16x16x32_bf16 v[112:115], v[64:67], a[48:51], v[112:115]
 s_waitcnt lgkmcnt(3)
 ds_read_b128 v[92:95], v1 offset:25600
 v_mfma_f32_16x16x32_bf16 v[116:119], v[64:67], a[52:55], v[116:119]
 s_add_u32 m0, s60, 0x18000
 s_bfe_u32 s65, s85, 0x40000
 s_mul_i32 s65, s65, 0x7000
 v_mfma_f32_16x16x32_bf16 v[120:123], v[68:71], a[48:51], v[120:123]
 s_add_u32 s65, s65, s40
 ds_read_b128 v[64:67], v1 offset:26624
 v_mfma_f32_16x16x32_bf16 v[124:127], v[68:71], a[52:55], v[124:127]
 buffer_load_dwordx4 v11, s[4:7], s65 offen offset:0 sc1 lds
 v_mfma_f32_16x16x32_bf16 v[128:131], v[72:75], a[48:51], v[128:131]
 ds_read_b128 v[68:71], v1 offset:27648
 v_mfma_f32_16x16x32_bf16 v[132:135], v[72:75], a[52:55], v[132:135]
 v_mfma_f32_16x16x32_bf16 v[136:139], v[76:79], a[48:51], v[136:139]
 s_waitcnt lgkmcnt(3)
 ds_read_b128 v[72:75], v1 offset:28672
 v_mfma_f32_16x16x32_bf16 v[140:143], v[76:79], a[52:55], v[140:143]
 buffer_load_dwordx4 a[120:123], v14, s[4:7], s64 offen offset:0 sc1
 v_mfma_f32_16x16x32_bf16 v[144:147], v[80:83], a[48:51], v[144:147]
 s_waitcnt vmcnt(20)
 ds_read_b128 v[76:79], v1 offset:29696
 v_mfma_f32_16x16x32_bf16 v[148:151], v[80:83], a[52:55], v[148:151]
 v_mfma_f32_16x16x32_bf16 v[96:99], v[84:87], a[56:59], v[96:99]
 s_barrier
 ds_read_b128 v[80:83], v1 offset:32768
 v_mfma_f32_16x16x32_bf16 v[100:103], v[84:87], a[60:63], v[100:103]
 buffer_load_dwordx4 a[124:127], v14, s[4:7], s64 offen offset:2048 sc1
 v_mfma_f32_16x16x32_bf16 v[104:107], v[88:91], a[56:59], v[104:107]
 s_waitcnt lgkmcnt(3)
 ds_read_b128 v[84:87], v1 offset:33792
 v_mfma_f32_16x16x32_bf16 v[108:111], v[88:91], a[60:63], v[108:111]
 v_mfma_f32_16x16x32_bf16 v[112:115], v[92:95], a[56:59], v[112:115]
 ds_read_b128 v[88:91], v1 offset:34816
 v_mfma_f32_16x16x32_bf16 v[116:119], v[92:95], a[60:63], v[116:119]
 buffer_load_dwordx4 v252, s[4:7], s65 offen offset:1024 sc1 lds
 v_mfma_f32_16x16x32_bf16 v[120:123], v[64:67], a[56:59], v[120:123]
 ds_read_b128 v[92:95], v1 offset:35840
 v_mfma_f32_16x16x32_bf16 v[124:127], v[64:67], a[60:63], v[124:127]
 v_mfma_f32_16x16x32_bf16 v[128:131], v[68:71], a[56:59], v[128:131]
 s_waitcnt lgkmcnt(3)
 ds_read_b128 v[64:67], v1 offset:36864
 v_mfma_f32_16x16x32_bf16 v[132:135], v[68:71], a[60:63], v[132:135]
 buffer_load_dwordx4 v253, s[4:7], s65 offen offset:2048 sc1 lds
 v_mfma_f32_16x16x32_bf16 v[136:139], v[72:75], a[56:59], v[136:139]
 s_waitcnt vmcnt(21)
 ds_read_b128 v[68:71], v1 offset:37888
 v_mfma_f32_16x16x32_bf16 v[140:143], v[72:75], a[60:63], v[140:143]
 v_mfma_f32_16x16x32_bf16 v[144:147], v[76:79], a[56:59], v[144:147]
 ds_read_b128 v[72:75], v1 offset:38912
 v_mfma_f32_16x16x32_bf16 v[148:151], v[76:79], a[60:63], v[148:151]
 buffer_load_dwordx4 v254, s[4:7], s65 offen offset:3072 sc1 lds
 v_mfma_f32_16x16x32_bf16 v[96:99], v[80:83], a[64:67], v[96:99]
 s_waitcnt lgkmcnt(3)
 ds_read_b128 v[76:79], v1 offset:39936
 v_mfma_f32_16x16x32_bf16 v[100:103], v[80:83], a[68:71], v[100:103]
 s_bfe_u32 s64, s85, 0x40000
 s_mul_i32 s64, s64, 0x80000
 s_add_u32 s64, s64, s16
 v_mfma_f32_16x16x32_bf16 v[104:107], v[84:87], a[64:67], v[104:107]
 ds_read_b128 v[80:83], v1 offset:40960
 v_mfma_f32_16x16x32_bf16 v[108:111], v[84:87], a[68:71], v[108:111]
 buffer_load_dwordx4 a[128:131], v11, s[4:7], s64 offen offset:0 sc1
 v_mfma_f32_16x16x32_bf16 v[112:115], v[88:91], a[64:67], v[112:115]
 ds_read_b128 v[84:87], v1 offset:41984
 v_mfma_f32_16x16x32_bf16 v[116:119], v[88:91], a[68:71], v[116:119]
 v_mfma_f32_16x16x32_bf16 v[120:123], v[92:95], a[64:67], v[120:123]
 s_waitcnt lgkmcnt(3)
 ds_read_b128 v[88:91], v1 offset:43008
 v_mfma_f32_16x16x32_bf16 v[124:127], v[92:95], a[68:71], v[124:127]
 buffer_load_dwordx4 a[132:135], v11, s[4:7], s64 offen offset:2048 sc1
 v_mfma_f32_16x16x32_bf16 v[128:131], v[64:67], a[64:67], v[128:131]
 s_add_u32 m0, s60, 0x1c000
 ds_read_b128 v[92:95], v1 offset:44032
 v_mfma_f32_16x16x32_bf16 v[132:135], v[64:67], a[68:71], v[132:135]
 s_bfe_u32 s65, s85, 0x40004
 s_mul_i32 s65, s65, 0x7000
 s_add_u32 s65, s65, s40
 v_mfma_f32_16x16x32_bf16 v[136:139], v[68:71], a[64:67], v[136:139]
 s_waitcnt vmcnt(22)
 ds_read_b128 v[64:67], v1 offset:45056
 v_mfma_f32_16x16x32_bf16 v[140:143], v[68:71], a[68:71], v[140:143]
 buffer_load_dwordx4 v11, s[4:7], s65 offen offset:0 sc1 lds
 v_mfma_f32_16x16x32_bf16 v[144:147], v[72:75], a[64:67], v[144:147]
 s_waitcnt lgkmcnt(3)
 ds_read_b128 v[68:71], v1 offset:46080
 v_mfma_f32_16x16x32_bf16 v[148:151], v[72:75], a[68:71], v[148:151]
 v_add_u32 v61, mk_k4-mk_top+0, v249
 v_min_u32 v61, mk_end-mk_top, v61
 global_load_dword v255, v61, s[18:19]
 v_mfma_f32_16x16x32_bf16 v[96:99], v[76:79], a[72:75], v[96:99]
 s_barrier
 ds_read_b128 v[72:75], v1 offset:49152
 v_mfma_f32_16x16x32_bf16 v[100:103], v[76:79], a[76:79], v[100:103]
 buffer_load_dwordx4 a[136:139], v14, s[4:7], s64 offen offset:0 sc1
 v_mfma_f32_16x16x32_bf16 v[104:107], v[80:83], a[72:75], v[104:107]
 ds_read_b128 v[76:79], v1 offset:50176
 v_mfma_f32_16x16x32_bf16 v[108:111], v[80:83], a[76:79], v[108:111]
 v_mfma_f32_16x16x32_bf16 v[112:115], v[84:87], a[72:75], v[112:115]
 s_waitcnt lgkmcnt(3)
 ds_read_b128 v[80:83], v1 offset:51200
 v_mfma_f32_16x16x32_bf16 v[116:119], v[84:87], a[76:79], v[116:119]
 buffer_load_dwordx4 a[140:143], v14, s[4:7], s64 offen offset:2048 sc1
 v_mfma_f32_16x16x32_bf16 v[120:123], v[88:91], a[72:75], v[120:123]
 ds_read_b128 v[84:87], v1 offset:52224
 v_mfma_f32_16x16x32_bf16 v[124:127], v[88:91], a[76:79], v[124:127]
 v_mfma_f32_16x16x32_bf16 v[128:131], v[92:95], a[72:75], v[128:131]
 ds_read_b128 v[88:91], v1 offset:53248
 v_mfma_f32_16x16x32_bf16 v[132:135], v[92:95], a[76:79], v[132:135]
 buffer_load_dwordx4 v252, s[4:7], s65 offen offset:1024 sc1 lds
 v_mfma_f32_16x16x32_bf16 v[136:139], v[64:67], a[72:75], v[136:139]
 s_waitcnt lgkmcnt(3)
 ds_read_b128 v[92:95], v1 offset:54272
 v_mfma_f32_16x16x32_bf16 v[140:143], v[64:67], a[76:79], v[140:143]
 v_mfma_f32_16x16x32_bf16 v[144:147], v[68:71], a[72:75], v[144:147]
 s_waitcnt vmcnt(25)
 ds_read_b128 v[64:67], v1 offset:55296
 v_mfma_f32_16x16x32_bf16 v[148:151], v[68:71], a[76:79], v[148:151]
 buffer_load_dwordx4 v253, s[4:7], s65 offen offset:2048 sc1 lds
 v_mfma_f32_16x16x32_bf16 v[96:99], v[72:75], a[80:83], v[96:99]
 ds_read_b128 v[68:71], v1 offset:56320
 v_mfma_f32_16x16x32_bf16 v[100:103], v[72:75], a[84:87], v[100:103]
 v_mfma_f32_16x16x32_bf16 v[104:107], v[76:79], a[80:83], v[104:107]
 s_waitcnt lgkmcnt(3)
 ds_read_b128 v[72:75], v1 offset:57344
 v_mfma_f32_16x16x32_bf16 v[108:111], v[76:79], a[84:87], v[108:111]
 buffer_load_dwordx4 v254, s[4:7], s65 offen offset:3072 sc1 lds
 v_mfma_f32_16x16x32_bf16 v[112:115], v[80:83], a[80:83], v[112:115]
 s_bfe_u32 s64, s85, 0x40004
 ds_read_b128 v[76:79], v1 offset:58368
 v_mfma_f32_16x16x32_bf16 v[116:119], v[80:83], a[84:87], v[116:119]
 s_mul_i32 s64, s64, 0x80000
 s_add_u32 s64, s64, s16
 v_mfma_f32_16x16x32_bf16 v[120:123], v[84:87], a[80:83], v[120:123]
 ds_read_b128 v[80:83], v1 offset:59392
 v_mfma_f32_16x16x32_bf16 v[124:127], v[84:87], a[84:87], v[124:127]
 buffer_load_dwordx4 a[144:147], v11, s[4:7], s64 offen offset:0 sc1
 v_mfma_f32_16x16x32_bf16 v[128:131], v[88:91], a[80:83], v[128:131]
 s_waitcnt lgkmcnt(3)
 ds_read_b128 v[84:87], v1 offset:60416
 v_mfma_f32_16x16x32_bf16 v[132:135], v[88:91], a[84:87], v[132:135]
 v_mfma_f32_16x16x32_bf16 v[136:139], v[92:95], a[80:83], v[136:139]
 s_waitcnt vmcnt(26)
 ds_read_b128 v[88:91], v1 offset:61440
 v_mfma_f32_16x16x32_bf16 v[140:143], v[92:95], a[84:87], v[140:143]
 buffer_load_dwordx4 a[148:151], v11, s[4:7], s64 offen offset:2048 sc1
 v_mfma_f32_16x16x32_bf16 v[144:147], v[64:67], a[80:83], v[144:147]
 s_add_u32 m0, s60, 0x20000
 ds_read_b128 v[92:95], v1 offset:62464
 v_mfma_f32_16x16x32_bf16 v[148:151], v[64:67], a[84:87], v[148:151]
 s_bfe_u32 s65, s85, 0x40008
 s_mul_i32 s65, s65, 0x7000
 s_add_u32 s65, s65, s40
 v_mfma_f32_16x16x32_bf16 v[96:99], v[68:71], a[88:91], v[96:99]
 s_waitcnt lgkmcnt(3)
 s_barrier
 ds_read_b128 v[64:67], v12 offset:0
 v_mfma_f32_16x16x32_bf16 v[100:103], v[68:71], a[92:95], v[100:103]
 buffer_load_dwordx4 v11, s[4:7], s65 offen offset:0 sc1 lds
 v_mfma_f32_16x16x32_bf16 v[104:107], v[72:75], a[88:91], v[104:107]
 ds_read_b128 v[68:71], v12 offset:1024
 v_mfma_f32_16x16x32_bf16 v[108:111], v[72:75], a[92:95], v[108:111]
 v_mfma_f32_16x16x32_bf16 v[112:115], v[76:79], a[88:91], v[112:115]
 ds_read_b128 v[72:75], v12 offset:2048
 v_mfma_f32_16x16x32_bf16 v[116:119], v[76:79], a[92:95], v[116:119]
 buffer_load_dwordx4 a[152:155], v14, s[4:7], s64 offen offset:0 sc1
 v_mfma_f32_16x16x32_bf16 v[120:123], v[80:83], a[88:91], v[120:123]
 s_waitcnt lgkmcnt(3)
 ds_read_b128 v[76:79], v12 offset:3072
 v_mfma_f32_16x16x32_bf16 v[124:127], v[80:83], a[92:95], v[124:127]
 v_mfma_f32_16x16x32_bf16 v[128:131], v[84:87], a[88:91], v[128:131]
 ds_read_b128 v[80:83], v12 offset:4096
 v_mfma_f32_16x16x32_bf16 v[132:135], v[84:87], a[92:95], v[132:135]
 buffer_load_dwordx4 a[156:159], v14, s[4:7], s64 offen offset:2048 sc1
 v_mfma_f32_16x16x32_bf16 v[136:139], v[88:91], a[88:91], v[136:139]
 s_waitcnt vmcnt(28)
 ds_read_b128 v[84:87], v12 offset:5120
 v_mfma_f32_16x16x32_bf16 v[140:143], v[88:91], a[92:95], v[140:143]
 v_mfma_f32_16x16x32_bf16 v[144:147], v[92:95], a[88:91], v[144:147]
 s_waitcnt lgkmcnt(3)
 ds_read_b128 v[88:91], v12 offset:6144
 v_mfma_f32_16x16x32_bf16 v[148:151], v[92:95], a[92:95], v[148:151]
 buffer_load_dwordx4 v252, s[4:7], s65 offen offset:1024 sc1 lds
 v_mfma_f32_16x16x32_bf16 v[96:99], v[64:67], a[96:99], v[96:99]
 ds_read_b128 v[92:95], v12 offset:7168
 v_mfma_f32_16x16x32_bf16 v[100:103], v[64:67], a[100:103], v[100:103]
 v_mfma_f32_16x16x32_bf16 v[104:107], v[68:71], a[96:99], v[104:107]
 ds_read_b128 v[64:67], v12 offset:8192
 v_mfma_f32_16x16x32_bf16 v[108:111], v[68:71], a[100:103], v[108:111]
 buffer_load_dwordx4 v253, s[4:7], s65 offen offset:2048 sc1 lds
 v_mfma_f32_16x16x32_bf16 v[112:115], v[72:75], a[96:99], v[112:115]
 s_waitcnt lgkmcnt(3)
 ds_read_b128 v[68:71], v12 offset:9216
 v_mfma_f32_16x16x32_bf16 v[116:119], v[72:75], a[100:103], v[116:119]
 v_mfma_f32_16x16x32_bf16 v[120:123], v[76:79], a[96:99], v[120:123]
 ds_read_b128 v[72:75], v12 offset:10240
 v_mfma_f32_16x16x32_bf16 v[124:127], v[76:79], a[100:103], v[124:127]
 buffer_load_dwordx4 v254, s[4:7], s65 offen offset:3072 sc1 lds
 v_mfma_f32_16x16x32_bf16 v[128:131], v[80:83], a[96:99], v[128:131]
 s_bfe_u32 s64, s85, 0x40008
 ds_read_b128 v[76:79], v12 offset:11264
 v_mfma_f32_16x16x32_bf16 v[132:135], v[80:83], a[100:103], v[132:135]
 s_mul_i32 s64, s64, 0x80000
 s_add_u32 s64, s64, s16
 v_mfma_f32_16x16x32_bf16 v[136:139], v[84:87], a[96:99], v[136:139]
 s_waitcnt lgkmcnt(3)
 ds_read_b128 v[80:83], v12 offset:12288
 v_mfma_f32_16x16x32_bf16 v[140:143], v[84:87], a[100:103], v[140:143]
 buffer_load_dwordx4 a[160:163], v11, s[4:7], s64 offen offset:0 sc1
 v_mfma_f32_16x16x32_bf16 v[144:147], v[88:91], a[96:99], v[144:147]
 s_waitcnt vmcnt(29)
 ds_read_b128 v[84:87], v12 offset:13312
 v_mfma_f32_16x16x32_bf16 v[148:151], v[88:91], a[100:103], v[148:151]
 v_mfma_f32_16x16x32_bf16 v[96:99], v[92:95], a[104:107], v[96:99]
 s_waitcnt vmcnt(26)
 s_barrier
 ds_read_b128 v[88:91], v12 offset:16384
 v_mfma_f32_16x16x32_bf16 v[100:103], v[92:95], a[108:111], v[100:103]
 buffer_load_dwordx4 a[164:167], v11, s[4:7], s64 offen offset:2048 sc1
 v_mfma_f32_16x16x32_bf16 v[104:107], v[64:67], a[104:107], v[104:107]
 s_waitcnt lgkmcnt(3)
 ds_read_b128 v[92:95], v12 offset:17408
 v_mfma_f32_16x16x32_bf16 v[108:111], v[64:67], a[108:111], v[108:111]
 s_add_u32 m0, s60, 0x0
 s_bfe_u32 s65, s85, 0x4000c
 s_mul_i32 s65, s65, 0x7000
 v_mfma_f32_16x16x32_bf16 v[112:115], v[68:71], a[104:107], v[112:115]
 s_add_u32 s65, s65, s40
 ds_read_b128 v[64:67], v12 offset:18432
 v_mfma_f32_16x16x32_bf16 v[116:119], v[68:71], a[108:111], v[116:119]
 buffer_load_dwordx4 v11, s[4:7], s65 offen offset:0 sc1 lds
 v_mfma_f32_16x16x32_bf16 v[120:123], v[72:75], a[104:107], v[120:123]
 ds_read_b128 v[68:71], v12 offset:19456
 v_mfma_f32_16x16x32_bf16 v[124:127], v[72:75], a[108:111], v[124:127]
 v_mfma_f32_16x16x32_bf16 v[128:131], v[76:79], a[104:107], v[128:131]
 s_waitcnt lgkmcnt(3)
 ds_read_b128 v[72:75], v12 offset:20480
 v_mfma_f32_16x16x32_bf16 v[132:135], v[76:79], a[108:111], v[132:135]
 buffer_load_dwordx4 a[168:171], v14, s[4:7], s64 offen offset:0 sc1
 v_mfma_f32_16x16x32_bf16 v[136:139], v[80:83], a[104:107], v[136:139]
 s_waitcnt vmcnt(27)
 ds_read_b128 v[76:79], v12 offset:21504
 v_mfma_f32_16x16x32_bf16 v[140:143], v[80:83], a[108:111], v[140:143]
 v_mfma_f32_16x16x32_bf16 v[144:147], v[84:87], a[104:107], v[144:147]
 ds_read_b128 v[80:83], v12 offset:22528
 v_mfma_f32_16x16x32_bf16 v[148:151], v[84:87], a[108:111], v[148:151]
 buffer_load_dwordx4 a[172:175], v14, s[4:7], s64 offen offset:2048 sc1
 v_mfma_f32_16x16x32_bf16 v[96:99], v[88:91], a[112:115], v[96:99]
 s_waitcnt lgkmcnt(3)
 ds_read_b128 v[84:87], v12 offset:23552
 v_mfma_f32_16x16x32_bf16 v[100:103], v[88:91], a[116:119], v[100:103]
 v_mfma_f32_16x16x32_bf16 v[104:107], v[92:95], a[112:115], v[104:107]
 ds_read_b128 v[88:91], v12 offset:24576
 v_mfma_f32_16x16x32_bf16 v[108:111], v[92:95], a[116:119], v[108:111]
 buffer_load_dwordx4 v252, s[4:7], s65 offen offset:1024 sc1 lds
 v_mfma_f32_16x16x32_bf16 v[112:115], v[64:67], a[112:115], v[112:115]
 ds_read_b128 v[92:95], v12 offset:25600
 v_mfma_f32_16x16x32_bf16 v[116:119], v[64:67], a[116:119], v[116:119]
 v_mfma_f32_16x16x32_bf16 v[120:123], v[68:71], a[112:115], v[120:123]
 s_waitcnt lgkmcnt(3)
 ds_read_b128 v[64:67], v12 offset:26624
 v_mfma_f32_16x16x32_bf16 v[124:127], v[68:71], a[116:119], v[124:127]
 buffer_load_dwordx4 v253, s[4:7], s65 offen offset:2048 sc1 lds
 v_mfma_f32_16x16x32_bf16 v[128:131], v[72:75], a[112:115], v[128:131]
 ds_read_b128 v[68:71], v12 offset:27648
 v_mfma_f32_16x16x32_bf16 v[132:135], v[72:75], a[116:119], v[132:135]
 v_mfma_f32_16x16x32_bf16 v[136:139], v[76:79], a[112:115], v[136:139]
 s_waitcnt vmcnt(27)
 ds_read_b128 v[72:75], v12 offset:28672
 v_mfma_f32_16x16x32_bf16 v[140:143], v[76:79], a[116:119], v[140:143]
 buffer_load_dwordx4 v254, s[4:7], s65 offen offset:3072 sc1 lds
 v_mfma_f32_16x16x32_bf16 v[144:147], v[80:83], a[112:115], v[144:147]
 s_waitcnt lgkmcnt(3)
 ds_read_b128 v[76:79], v12 offset:29696
 v_mfma_f32_16x16x32_bf16 v[148:151], v[80:83], a[116:119], v[148:151]
 s_bfe_u32 s64, s85, 0x4000c
 s_mul_i32 s64, s64, 0x80000
 s_add_u32 s64, s64, s16
 v_mfma_f32_16x16x32_bf16 v[96:99], v[84:87], a[120:123], v[96:99]
 s_waitcnt vmcnt(25)
 s_barrier
 ds_read_b128 v[80:83], v12 offset:32768
 v_mfma_f32_16x16x32_bf16 v[100:103], v[84:87], a[124:127], v[100:103]
 buffer_load_dwordx4 a[176:179], v11, s[4:7], s64 offen offset:0 sc1
 v_mfma_f32_16x16x32_bf16 v[104:107], v[88:91], a[120:123], v[104:107]
 ds_read_b128 v[84:87], v12 offset:33792
 v_mfma_f32_16x16x32_bf16 v[108:111], v[88:91], a[124:127], v[108:111]
 v_mfma_f32_16x16x32_bf16 v[112:115], v[92:95], a[120:123], v[112:115]
 s_waitcnt lgkmcnt(3)
 ds_read_b128 v[88:91], v12 offset:34816
 v_mfma_f32_16x16x32_bf16 v[116:119], v[92:95], a[124:127], v[116:119]
 buffer_load_dwordx4 a[180:183], v11, s[4:7], s64 offen offset:2048 sc1
 v_mfma_f32_16x16x32_bf16 v[120:123], v[64:67], a[120:123], v[120:123]
 s_add_u32 s69, s42, 0x3840000
 ds_read_b128 v[92:95], v12 offset:35840
 v_mfma_f32_16x16x32_bf16 v[124:127], v[64:67], a[124:127], v[124:127]
 v_mfma_f32_16x16x32_bf16 v[128:131], v[68:71], a[120:123], v[128:131]
 ds_read_b128 v[64:67], v12 offset:36864
 v_mfma_f32_16x16x32_bf16 v[132:135], v[68:71], a[124:127], v[132:135]
 buffer_load_dwordx4 v[224:227], v1, s[4:7], s69 offen offset:0 sc1
 v_mfma_f32_16x16x32_bf16 v[136:139], v[72:75], a[120:123], v[136:139]
 s_waitcnt lgkmcnt(3)
 ds_read_b128 v[68:71], v12 offset:37888
 v_mfma_f32_16x16x32_bf16 v[140:143], v[72:75], a[124:127], v[140:143]
 v_mfma_f32_16x16x32_bf16 v[144:147], v[76:79], a[120:123], v[144:147]
 s_waitcnt vmcnt(26)
 ds_read_b128 v[72:75], v12 offset:38912
 v_mfma_f32_16x16x32_bf16 v[148:151], v[76:79], a[124:127], v[148:151]
 buffer_load_dwordx4 v[228:231], v1, s[4:7], s69 offen offset:1024 sc1
 v_mfma_f32_16x16x32_bf16 v[96:99], v[80:83], a[128:131], v[96:99]
 ds_read_b128 v[76:79], v12 offset:39936
 v_mfma_f32_16x16x32_bf16 v[100:103], v[80:83], a[132:135], v[100:103]
 v_mfma_f32_16x16x32_bf16 v[104:107], v[84:87], a[128:131], v[104:107]
 s_waitcnt lgkmcnt(3)
 ds_read_b128 v[80:83], v12 offset:40960
 v_mfma_f32_16x16x32_bf16 v[108:111], v[84:87], a[132:135], v[108:111]
 buffer_load_dwordx4 v[232:235], v1, s[4:7], s69 offen offset:2048 sc1
 v_mfma_f32_16x16x32_bf16 v[112:115], v[88:91], a[128:131], v[112:115]
 ds_read_b128 v[84:87], v12 offset:41984
 v_mfma_f32_16x16x32_bf16 v[116:119], v[88:91], a[132:135], v[116:119]
 v_mfma_f32_16x16x32_bf16 v[120:123], v[92:95], a[128:131], v[120:123]
 ds_read_b128 v[88:91], v12 offset:43008
 v_mfma_f32_16x16x32_bf16 v[124:127], v[92:95], a[132:135], v[124:127]
 buffer_load_dwordx4 v[236:239], v1, s[4:7], s69 offen offset:3072 sc1
 v_mfma_f32_16x16x32_bf16 v[128:131], v[64:67], a[128:131], v[128:131]
 s_waitcnt lgkmcnt(3)
 ds_read_b128 v[92:95], v12 offset:44032
 v_mfma_f32_16x16x32_bf16 v[132:135], v[64:67], a[132:135], v[132:135]
 s_add_u32 m0, s60, 0x4000
 s_bfe_u32 s65, s85, 0x40010
 s_mul_i32 s65, s65, 0x7000
 v_mfma_f32_16x16x32_bf16 v[136:139], v[68:71], a[128:131], v[136:139]
 s_waitcnt vmcnt(25)
 ds_read_b128 v[64:67], v12 offset:45056
 v_mfma_f32_16x16x32_bf16 v[140:143], v[68:71], a[132:135], v[140:143]
 s_add_u32 s65, s65, s40
 v_mfma_f32_16x16x32_bf16 v[144:147], v[72:75], a[128:131], v[144:147]
 ds_read_b128 v[68:71], v12 offset:46080
 v_mfma_f32_16x16x32_bf16 v[148:151], v[72:75], a[132:135], v[148:151]
 buffer_load_dwordx4 v11, s[4:7], s65 offen offset:0 sc1 lds
 v_mfma_f32_16x16x32_bf16 v[96:99], v[76:79], a[136:139], v[96:99]
 s_waitcnt lgkmcnt(3)
 s_waitcnt vmcnt(23)
 s_barrier
 ds_read_b128 v[72:75], v12 offset:49152
 v_mfma_f32_16x16x32_bf16 v[100:103], v[76:79], a[140:143], v[100:103]
 buffer_load_dwordx4 a[184:187], v14, s[4:7], s64 offen offset:0 sc1
 v_mfma_f32_16x16x32_bf16 v[104:107], v[80:83], a[136:139], v[104:107]
 ds_read_b128 v[76:79], v12 offset:50176
 v_mfma_f32_16x16x32_bf16 v[108:111], v[80:83], a[140:143], v[108:111]
 v_mfma_f32_16x16x32_bf16 v[112:115], v[84:87], a[136:139], v[112:115]
 ds_read_b128 v[80:83], v12 offset:51200
 v_mfma_f32_16x16x32_bf16 v[116:119], v[84:87], a[140:143], v[116:119]
 buffer_load_dwordx4 a[188:191], v14, s[4:7], s64 offen offset:2048 sc1
 v_mfma_f32_16x16x32_bf16 v[120:123], v[88:91], a[136:139], v[120:123]
 s_waitcnt lgkmcnt(3)
 ds_read_b128 v[84:87], v12 offset:52224
 v_mfma_f32_16x16x32_bf16 v[124:127], v[88:91], a[140:143], v[124:127]
 v_mfma_f32_16x16x32_bf16 v[128:131], v[92:95], a[136:139], v[128:131]
 ds_read_b128 v[88:91], v12 offset:53248
 v_mfma_f32_16x16x32_bf16 v[132:135], v[92:95], a[140:143], v[132:135]
 buffer_load_dwordx4 v252, s[4:7], s65 offen offset:1024 sc1 lds
 v_mfma_f32_16x16x32_bf16 v[136:139], v[64:67], a[136:139], v[136:139]
 s_waitcnt vmcnt(24)
 ds_read_b128 v[92:95], v12 offset:54272
 v_mfma_f32_16x16x32_bf16 v[140:143], v[64:67], a[140:143], v[140:143]
 v_mfma_f32_16x16x32_bf16 v[144:147], v[68:71], a[136:139], v[144:147]
 s_waitcnt lgkmcnt(3)
 ds_read_b128 v[64:67], v12 offset:55296
 v_mfma_f32_16x16x32_bf16 v[148:151], v[68:71], a[140:143], v[148:151]
 buffer_load_dwordx4 v253, s[4:7], s65 offen offset:2048 sc1 lds
 v_mfma_f32_16x16x32_bf16 v[96:99], v[72:75], a[144:147], v[96:99]
 ds_read_b128 v[68:71], v12 offset:56320
 v_mfma_f32_16x16x32_bf16 v[100:103], v[72:75], a[148:151], v[100:103]
 v_mfma_f32_16x16x32_bf16 v[104:107], v[76:79], a[144:147], v[104:107]
 ds_read_b128 v[72:75], v12 offset:57344
 v_mfma_f32_16x16x32_bf16 v[108:111], v[76:79], a[148:151], v[108:111]
 buffer_load_dwordx4 v254, s[4:7], s65 offen offset:3072 sc1 lds
 v_mfma_f32_16x16x32_bf16 v[112:115], v[80:83], a[144:147], v[112:115]
 s_waitcnt lgkmcnt(3)
 ds_read_b128 v[76:79], v12 offset:58368
 v_mfma_f32_16x16x32_bf16 v[116:119], v[80:83], a[148:151], v[116:119]
 s_bfe_u32 s64, s85, 0x40010
 s_mul_i32 s64, s64, 0x80000
 s_add_u32 s64, s64, s16
 v_mfma_f32_16x16x32_bf16 v[120:123], v[84:87], a[144:147], v[120:123]
 ds_read_b128 v[80:83], v12 offset:59392
 v_mfma_f32_16x16x32_bf16 v[124:127], v[84:87], a[148:151], v[124:127]
 buffer_load_dwordx4 a[192:195], v11, s[4:7], s64 offen offset:0 sc1
 v_mfma_f32_16x16x32_bf16 v[128:131], v[88:91], a[144:147], v[128:131]
 ds_read_b128 v[84:87], v12 offset:60416
 v_mfma_f32_16x16x32_bf16 v[132:135], v[88:91], a[148:151], v[132:135]
 v_and_b32 v58, 0x3c, v2
 v_mfma_f32_16x16x32_bf16 v[136:139], v[92:95], a[144:147], v[136:139]
 s_waitcnt lgkmcnt(3)
 ds_read_b128 v[88:91], v12 offset:61440
 v_mfma_f32_16x16x32_bf16 v[140:143], v[92:95], a[148:151], v[140:143]
 buffer_load_dwordx4 a[196:199], v11, s[4:7], s64 offen offset:2048 sc1
 v_mfma_f32_16x16x32_bf16 v[144:147], v[64:67], a[144:147], v[144:147]
 s_waitcnt vmcnt(25)
 ds_read_b128 v[92:95], v12 offset:62464
 v_mfma_f32_16x16x32_bf16 v[148:151], v[64:67], a[148:151], v[148:151]
 s_add_u32 m0, s60, 0x8000
 s_bfe_u32 s65, s85, 0x40014
 s_mul_i32 s65, s65, 0x7000
 v_mfma_f32_16x16x32_bf16 v[96:99], v[68:71], a[152:155], v[96:99]
 s_add_u32 s65, s65, s40
 s_waitcnt vmcnt(22)
 s_barrier
 ds_read_b128 v[64:67], v13 offset:0
 v_mfma_f32_16x16x32_bf16 v[100:103], v[68:71], a[156:159], v[100:103]
 buffer_load_dwordx4 v11, s[4:7], s65 offen offset:0 sc1 lds
 v_mfma_f32_16x16x32_bf16 v[104:107], v[72:75], a[152:155], v[104:107]
 s_waitcnt lgkmcnt(3)
 ds_read_b128 v[68:71], v13 offset:1024
 v_mfma_f32_16x16x32_bf16 v[108:111], v[72:75], a[156:159], v[108:111]
 v_add_u32 v58, 0x24000, v58
 v_mfma_f32_16x16x32_bf16 v[112:115], v[76:79], a[152:155], v[112:115]
 ds_read_b128 v[72:75], v13 offset:2048
 v_mfma_f32_16x16x32_bf16 v[116:119], v[76:79], a[156:159], v[116:119]
 buffer_load_dwordx4 a[200:203], v14, s[4:7], s64 offen offset:0 sc1
 v_mfma_f32_16x16x32_bf16 v[120:123], v[80:83], a[152:155], v[120:123]
 ds_read_b128 v[76:79], v13 offset:3072
 v_mfma_f32_16x16x32_bf16 v[124:127], v[80:83], a[156:159], v[124:127]
 v_mfma_f32_16x16x32_bf16 v[128:131], v[84:87], a[152:155], v[128:131]
 s_waitcnt lgkmcnt(3)
 ds_read_b128 v[80:83], v13 offset:4096
 v_mfma_f32_16x16x32_bf16 v[132:135], v[84:87], a[156:159], v[132:135]
 buffer_load_dwordx4 a[204:207], v14, s[4:7], s64 offen offset:2048 sc1
 v_mfma_f32_16x16x32_bf16 v[136:139], v[88:91], a[152:155], v[136:139]
 s_waitcnt vmcnt(23)
 ds_read_b128 v[84:87], v13 offset:5120
 v_mfma_f32_16x16x32_bf16 v[140:143], v[88:91], a[156:159], v[140:143]
 v_mfma_f32_16x16x32_bf16 v[144:147], v[92:95], a[152:155], v[144:147]
 ds_read_b128 v[88:91], v13 offset:6144
 v_mfma_f32_16x16x32_bf16 v[148:151], v[92:95], a[156:159], v[148:151]
 buffer_load_dwordx4 v252, s[4:7], s65 offen offset:1024 sc1 lds
 v_mfma_f32_16x16x32_bf16 v[96:99], v[64:67], a[160:163], v[96:99]
 s_waitcnt lgkmcnt(3)
 ds_read_b128 v[92:95], v13 offset:7168
 v_mfma_f32_16x16x32_bf16 v[100:103], v[64:67], a[164:167], v[100:103]
 v_mfma_f32_16x16x32_bf16 v[104:107], v[68:71], a[160:163], v[104:107]
 ds_read_b128 v[64:67], v13 offset:8192
 v_mfma_f32_16x16x32_bf16 v[108:111], v[68:71], a[164:167], v[108:111]
 buffer_load_dwordx4 v253, s[4:7], s65 offen offset:2048 sc1 lds
 v_mfma_f32_16x16x32_bf16 v[112:115], v[72:75], a[160:163], v[112:115]
 ds_read_b128 v[68:71], v13 offset:9216
 v_mfma_f32_16x16x32_bf16 v[116:119], v[72:75], a[164:167], v[116:119]
 v_mfma_f32_16x16x32_bf16 v[120:123], v[76:79], a[160:163], v[120:123]
 s_waitcnt lgkmcnt(3)
 ds_read_b128 v[72:75], v13 offset:10240
 v_mfma_f32_16x16x32_bf16 v[124:127], v[76:79], a[164:167], v[124:127]
 buffer_load_dwordx4 v254, s[4:7], s65 offen offset:3072 sc1 lds
 v_mfma_f32_16x16x32_bf16 v[128:131], v[80:83], a[160:163], v[128:131]
 s_bfe_u32 s64, s85, 0x40014
 ds_read_b128 v[76:79], v13 offset:11264
 v_mfma_f32_16x16x32_bf16 v[132:135], v[80:83], a[164:167], v[132:135]
 s_mul_i32 s64, s64, 0x80000
 s_add_u32 s64, s64, s16
 v_mfma_f32_16x16x32_bf16 v[136:139], v[84:87], a[160:163], v[136:139]
 s_waitcnt vmcnt(23)
 ds_read_b128 v[80:83], v13 offset:12288
 v_mfma_f32_16x16x32_bf16 v[140:143], v[84:87], a[164:167], v[140:143]
 buffer_load_dwordx4 a[208:211], v11, s[4:7], s64 offen offset:0 sc1
 v_mfma_f32_16x16x32_bf16 v[144:147], v[88:91], a[160:163], v[144:147]
 s_waitcnt lgkmcnt(3)
 ds_read_b128 v[84:87], v13 offset:13312
 v_mfma_f32_16x16x32_bf16 v[148:151], v[88:91], a[164:167], v[148:151]
 v_mfma_f32_16x16x32_bf16 v[96:99], v[92:95], a[168:171], v[96:99]
 s_waitcnt vmcnt(21)
 s_barrier
 ds_read_b128 v[88:91], v1 offset:0
 v_mfma_f32_16x16x32_bf16 v[100:103], v[92:95], a[172:175], v[100:103]
 buffer_load_dwordx4 a[212:215], v11, s[4:7], s64 offen offset:2048 sc1
 v_mfma_f32_16x16x32_bf16 v[104:107], v[64:67], a[168:171], v[104:107]
 s_add_u32 m0, s60, 0xc000
 ds_read_b128 v[92:95], v1 offset:1024
 v_mfma_f32_16x16x32_bf16 v[108:111], v[64:67], a[172:175], v[108:111]
 s_bfe_u32 s65, s85, 0x40018
 s_mul_i32 s65, s65, 0x7000
 s_add_u32 s65, s65, s40
 v_mfma_f32_16x16x32_bf16 v[112:115], v[68:71], a[168:171], v[112:115]
 s_waitcnt lgkmcnt(3)
 ds_read_b128 v[64:67], v1 offset:2048
 v_mfma_f32_16x16x32_bf16 v[116:119], v[68:71], a[172:175], v[116:119]
 buffer_load_dwordx4 v11, s[4:7], s65 offen offset:0 sc1 lds
 v_mfma_f32_16x16x32_bf16 v[120:123], v[72:75], a[168:171], v[120:123]
 ds_read_b128 v[68:71], v1 offset:3072
 v_mfma_f32_16x16x32_bf16 v[124:127], v[72:75], a[172:175], v[124:127]
 v_mfma_f32_16x16x32_bf16 v[128:131], v[76:79], a[168:171], v[128:131]
 ds_read_b128 v[72:75], v1 offset:4096
 v_mfma_f32_16x16x32_bf16 v[132:135], v[76:79], a[172:175], v[132:135]
 buffer_load_dwordx4 a[216:219], v14, s[4:7], s64 offen offset:0 sc1
 v_mfma_f32_16x16x32_bf16 v[136:139], v[80:83], a[168:171], v[136:139]
 s_waitcnt lgkmcnt(3)
 ds_read_b128 v[76:79], v1 offset:5120
 v_mfma_f32_16x16x32_bf16 v[140:143], v[80:83], a[172:175], v[140:143]
 v_mfma_f32_16x16x32_bf16 v[144:147], v[84:87], a[168:171], v[144:147]
 s_waitcnt vmcnt(22)
 ds_read_b128 v[80:83], v1 offset:6144
 v_mfma_f32_16x16x32_bf16 v[148:151], v[84:87], a[172:175], v[148:151]
 buffer_load_dwordx4 a[220:223], v14, s[4:7], s64 offen offset:2048 sc1
 v_mfma_f32_16x16x32_bf16 v[96:99], v[88:91], a[176:179], v[96:99]
 ds_read_b128 v[84:87], v1 offset:7168
 v_mfma_f32_16x16x32_bf16 v[100:103], v[88:91], a[180:183], v[100:103]
 v_mfma_f32_16x16x32_bf16 v[104:107], v[92:95], a[176:179], v[104:107]
 s_waitcnt lgkmcnt(3)
 ds_read_b128 v[88:91], v1 offset:8192
 v_mfma_f32_16x16x32_bf16 v[108:111], v[92:95], a[180:183], v[108:111]
 buffer_load_dwordx4 v252, s[4:7], s65 offen offset:1024 sc1 lds
 v_mfma_f32_16x16x32_bf16 v[112:115], v[64:67], a[176:179], v[112:115]
 ds_read_b128 v[92:95], v1 offset:9216
 v_mfma_f32_16x16x32_bf16 v[116:119], v[64:67], a[180:183], v[116:119]
 v_mfma_f32_16x16x32_bf16 v[120:123], v[68:71], a[176:179], v[120:123]
 ds_read_b128 v[64:67], v1 offset:10240
 v_mfma_f32_16x16x32_bf16 v[124:127], v[68:71], a[180:183], v[124:127]
 buffer_load_dwordx4 v253, s[4:7], s65 offen offset:2048 sc1 lds
 v_mfma_f32_16x16x32_bf16 v[128:131], v[72:75], a[176:179], v[128:131]
 s_waitcnt lgkmcnt(3)
 ds_read_b128 v[68:71], v1 offset:11264
 v_mfma_f32_16x16x32_bf16 v[132:135], v[72:75], a[180:183], v[132:135]
 v_mfma_f32_16x16x32_bf16 v[136:139], v[76:79], a[176:179], v[136:139]
 s_waitcnt vmcnt(18)
 ds_read_b128 v[72:75], v1 offset:12288
 v_mfma_f32_16x16x32_bf16 v[140:143], v[76:79], a[180:183], v[140:143]
 buffer_load_dwordx4 v254, s[4:7], s65 offen offset:3072 sc1 lds
 v_mfma_f32_16x16x32_bf16 v[144:147], v[80:83], a[176:179], v[144:147]
 s_bfe_u32 s64, s85, 0x40018
 ds_read_b128 v[76:79], v1 offset:13312
 v_mfma_f32_16x16x32_bf16 v[148:151], v[80:83], a[180:183], v[148:151]
 s_mul_i32 s64, s64, 0x80000
 s_add_u32 s64, s64, s16
 v_mfma_f32_16x16x32_bf16 v[96:99], v[84:87], a[184:187], v[96:99]
 s_waitcnt lgkmcnt(3)
 s_waitcnt vmcnt(16)
 s_barrier
 ds_read_b128 v[80:83], v1 offset:16384
 v_mfma_f32_16x16x32_bf16 v[100:103], v[84:87], a[188:191], v[100:103]
 buffer_load_dwordx4 a[224:227], v11, s[4:7], s64 offen offset:0 sc1
 v_mfma_f32_16x16x32_bf16 v[104:107], v[88:91], a[184:187], v[104:107]
 ds_read_b128 v[84:87], v1 offset:17408
 v_mfma_f32_16x16x32_bf16 v[108:111], v[88:91], a[188:191], v[108:111]
 v_mfma_f32_16x16x32_bf16 v[112:115], v[92:95], a[184:187], v[112:115]
 ds_read_b128 v[88:91], v1 offset:18432
 v_mfma_f32_16x16x32_bf16 v[116:119], v[92:95], a[188:191], v[116:119]
 buffer_load_dwordx4 a[228:231], v11, s[4:7], s64 offen offset:2048 sc1
 v_mfma_f32_16x16x32_bf16 v[120:123], v[64:67], a[184:187], v[120:123]
 s_waitcnt lgkmcnt(3)
 ds_read_b128 v[92:95], v1 offset:19456
 v_mfma_f32_16x16x32_bf16 v[124:127], v[64:67], a[188:191], v[124:127]
 s_add_u32 m0, s60, 0x10000
 s_bfe_u32 s65, s85, 0x4001c
 s_mul_i32 s65, s65, 0x7000
 v_mfma_f32_16x16x32_bf16 v[128:131], v[68:71], a[184:187], v[128:131]
 s_add_u32 s65, s65, s40
 ds_read_b128 v[64:67], v1 offset:20480
 v_mfma_f32_16x16x32_bf16 v[132:135], v[68:71], a[188:191], v[132:135]
 buffer_load_dwordx4 v11, s[4:7], s65 offen offset:0 sc1 lds
 v_mfma_f32_16x16x32_bf16 v[136:139], v[72:75], a[184:187], v[136:139]
 s_waitcnt vmcnt(17)
 ds_read_b128 v[68:71], v1 offset:21504
 v_mfma_f32_16x16x32_bf16 v[140:143], v[72:75], a[188:191], v[140:143]
 v_mfma_f32_16x16x32_bf16 v[144:147], v[76:79], a[184:187], v[144:147]
 s_waitcnt lgkmcnt(3)
 ds_read_b128 v[72:75], v1 offset:22528
 v_mfma_f32_16x16x32_bf16 v[148:151], v[76:79], a[188:191], v[148:151]
 buffer_load_dwordx4 a[232:235], v14, s[4:7], s64 offen offset:0 sc1
 v_mfma_f32_16x16x32_bf16 v[96:99], v[80:83], a[192:195], v[96:99]
 ds_read_b128 v[76:79], v1 offset:23552
 v_mfma_f32_16x16x32_bf16 v[100:103], v[80:83], a[196:199], v[100:103]
 v_mfma_f32_16x16x32_bf16 v[104:107], v[84:87], a[192:195], v[104:107]
 ds_read_b128 v[80:83], v1 offset:24576
 v_mfma_f32_16x16x32_bf16 v[108:111], v[84:87], a[196:199], v[108:111]
 buffer_load_dwordx4 a[236:239], v14, s[4:7], s64 offen offset:2048 sc1
 v_mfma_f32_16x16x32_bf16 v[112:115], v[88:91], a[192:195], v[112:115]
 s_waitcnt lgkmcnt(3)
 ds_read_b128 v[84:87], v1 offset:25600
 v_mfma_f32_16x16x32_bf16 v[116:119], v[88:91], a[196:199], v[116:119]
 v_mfma_f32_16x16x32_bf16 v[120:123], v[92:95], a[192:195], v[120:123]
 ds_read_b128 v[88:91], v1 offset:26624
 v_mfma_f32_16x16x32_bf16 v[124:127], v[92:95], a[196:199], v[124:127]
 buffer_load_dwordx4 v252, s[4:7], s65 offen offset:1024 sc1 lds
 v_mfma_f32_16x16x32_bf16 v[128:131], v[64:67], a[192:195], v[128:131]
 ds_read_b128 v[92:95], v1 offset:27648
 v_mfma_f32_16x16x32_bf16 v[132:135], v[64:67], a[196:199], v[132:135]
 v_mfma_f32_16x16x32_bf16 v[136:139], v[68:71], a[192:195], v[136:139]
 s_waitcnt lgkmcnt(3)
 ds_read_b128 v[64:67], v1 offset:28672
 v_mfma_f32_16x16x32_bf16 v[140:143], v[68:71], a[196:199], v[140:143]
 buffer_load_dwordx4 v253, s[4:7], s65 offen offset:2048 sc1 lds
 v_mfma_f32_16x16x32_bf16 v[144:147], v[72:75], a[192:195], v[144:147]
 s_waitcnt vmcnt(18)
 ds_read_b128 v[68:71], v1 offset:29696
 v_mfma_f32_16x16x32_bf16 v[148:151], v[72:75], a[196:199], v[148:151]
 v_mfma_f32_16x16x32_bf16 v[96:99], v[76:79], a[200:203], v[96:99]
 s_waitcnt vmcnt(15)
 s_barrier
 ds_read_b128 v[72:75], v1 offset:32768
 v_mfma_f32_16x16x32_bf16 v[100:103], v[76:79], a[204:207], v[100:103]
 buffer_load_dwordx4 v254, s[4:7], s65 offen offset:3072 sc1 lds
 v_mfma_f32_16x16x32_bf16 v[104:107], v[80:83], a[200:203], v[104:107]
 s_waitcnt lgkmcnt(3)
 ds_read_b128 v[76:79], v1 offset:33792
 v_mfma_f32_16x16x32_bf16 v[108:111], v[80:83], a[204:207], v[108:111]
 s_bfe_u32 s64, s85, 0x4001c
 s_mul_i32 s64, s64, 0x80000
 s_add_u32 s64, s64, s16
 v_mfma_f32_16x16x32_bf16 v[112:115], v[84:87], a[200:203], v[112:115]
 ds_read_b128 v[80:83], v1 offset:34816
 v_mfma_f32_16x16x32_bf16 v[116:119], v[84:87], a[204:207], v[116:119]
 buffer_load_dwordx4 a[240:243], v11, s[4:7], s64 offen offset:0 sc1
 v_mfma_f32_16x16x32_bf16 v[120:123], v[88:91], a[200:203], v[120:123]
 ds_read_b128 v[84:87], v1 offset:35840
 v_mfma_f32_16x16x32_bf16 v[124:127], v[88:91], a[204:207], v[124:127]
 v_mfma_f32_16x16x32_bf16 v[128:131], v[92:95], a[200:203], v[128:131]
 s_waitcnt lgkmcnt(3)
 ds_read_b128 v[88:91], v1 offset:36864
 v_mfma_f32_16x16x32_bf16 v[132:135], v[92:95], a[204:207], v[132:135]
 buffer_load_dwordx4 a[244:247], v11, s[4:7], s64 offen offset:2048 sc1
 v_mfma_f32_16x16x32_bf16 v[136:139], v[64:67], a[200:203], v[136:139]
 s_waitcnt vmcnt(16)
 ds_read_b128 v[92:95], v1 offset:37888
 v_mfma_f32_16x16x32_bf16 v[140:143], v[64:67], a[204:207], v[140:143]
 s_add_u32 m0, s60, 0x14000
 s_bfe_u32 s65, s84, 0x40000
 s_mul_i32 s65, s65, 0x7000
 v_mfma_f32_16x16x32_bf16 v[144:147], v[68:71], a[200:203], v[144:147]
 s_add_u32 s65, s65, s17
 ds_read_b128 v[64:67], v1 offset:38912
 v_mfma_f32_16x16x32_bf16 v[148:151], v[68:71], a[204:207], v[148:151]
 buffer_load_dwordx4 v11, s[4:7], s65 offen offset:0 sc1 lds
 v_mfma_f32_16x16x32_bf16 v[96:99], v[72:75], a[208:211], v[96:99]
 s_waitcnt lgkmcnt(3)
 ds_read_b128 v[68:71], v1 offset:39936
 v_mfma_f32_16x16x32_bf16 v[100:103], v[72:75], a[212:215], v[100:103]
 v_pk_add_f32 v[224:225], v[224:225], v[228:229]
 v_pk_add_f32 v[232:233], v[232:233], v[236:237]
 v_pk_add_f32 v[226:227], v[226:227], v[230:231]
 v_pk_add_f32 v[234:235], v[234:235], v[238:239]
 v_pk_add_f32 v[224:225], v[224:225], v[232:233]
 v_pk_add_f32 v[226:227], v[226:227], v[234:235]
 s_nop 0
 v_permlane16_swap_b32 v224, v225
 v_permlane16_swap_b32 v226, v227
 v_add_f32 v224, v224, v225
 v_add_f32 v226, v226, v227
 s_nop 1
 v_permlane32_swap_b32 v224, v226
 v_add_f32 v224, v224, v226
 v_mov_b32 v225, v224
 v_mov_b32 v226, 0xba800000
 s_nop 0
 v_permlane32_swap_b32 v224, v225
 v_mul_f32 v224, v226, v224
 v_mul_f32 v225, 0x3a800000, v225
 v_fma_f32 v225, -v224, v224, v225
 v_max_f32 v225, 0, v225
 v_add_f32 v225, 0x3727c5ac, v225
 v_rsq_f32 v225, v225
 v_mov_b32 v226, v224
 v_mov_b32 v40, v225
 v_mov_b32 v42, v225
 v_permlane16_swap_b32 v224, v226
 s_nop 0
 v_permlane16_swap_b32 v40, v42
 v_cndmask_b32 v224, 0, v224, s[76:77]
 v_cvt_pk_bf16_f32 v48, v224, v224
 v_and_b32 v49, s78, v48
 v_sub_f32 v49, v224, v49
 v_cvt_pk_bf16_f32 v49, v49, v49
 v_cndmask_b32 v226, 0, v226, s[76:77]
 v_cvt_pk_bf16_f32 v52, v226, v226
 v_and_b32 v53, s78, v52
 v_sub_f32 v53, v226, v53
 v_cvt_pk_bf16_f32 v53, v53, v53
 v_mul_f32 v44, 0xc0135761, v40
 v_mul_f32 v45, v40, v40
 v_mul_f32 v45, v45, v40
 v_mul_f32 v45, 0xbdd2d3e8, v45
 v_mul_f32 v41, v56, v40
 v_mul_f32 v46, 0xc0135761, v42
 v_mul_f32 v47, v42, v42
 v_mul_f32 v47, v47, v42
 v_mul_f32 v47, 0xbdd2d3e8, v47
 v_mul_f32 v43, v57, v42
 v_mfma_f32_16x16x32_bf16 v[104:107], v[76:79], a[208:211], v[104:107]
 ds_read_b128 v[72:75], v1 offset:40960
 v_mfma_f32_16x16x32_bf16 v[108:111], v[76:79], a[212:215], v[108:111]
 buffer_load_dwordx4 a[248:251], v14, s[4:7], s64 offen offset:0 sc1
 v_mfma_f32_16x16x32_bf16 v[112:115], v[80:83], a[208:211], v[112:115]
 ds_read_b128 v[76:79], v1 offset:41984
 v_mfma_f32_16x16x32_bf16 v[116:119], v[80:83], a[212:215], v[116:119]
 v_mfma_f32_16x16x32_bf16 v[120:123], v[84:87], a[208:211], v[120:123]
 s_waitcnt lgkmcnt(3)
 ds_read_b128 v[80:83], v1 offset:43008
 v_mfma_f32_16x16x32_bf16 v[124:127], v[84:87], a[212:215], v[124:127]
 buffer_load_dwordx4 a[252:255], v14, s[4:7], s64 offen offset:2048 sc1
 v_mfma_f32_16x16x32_bf16 v[128:131], v[88:91], a[208:211], v[128:131]
 ds_read_b128 v[84:87], v1 offset:44032
 v_mfma_f32_16x16x32_bf16 v[132:135], v[88:91], a[212:215], v[132:135]
 v_mfma_f32_16x16x32_bf16 v[136:139], v[92:95], a[208:211], v[136:139]
 s_waitcnt vmcnt(16)
 ds_read_b128 v[88:91], v1 offset:45056
 v_mfma_f32_16x16x32_bf16 v[140:143], v[92:95], a[212:215], v[140:143]
 buffer_load_dwordx4 v252, s[4:7], s65 offen offset:1024 sc1 lds
 v_mfma_f32_16x16x32_bf16 v[144:147], v[64:67], a[208:211], v[144:147]
 s_waitcnt lgkmcnt(3)
 ds_read_b128 v[92:95], v1 offset:46080
 v_mfma_f32_16x16x32_bf16 v[148:151], v[64:67], a[212:215], v[148:151]
 v_mfma_f32_16x16x32_bf16 v[96:99], v[68:71], a[216:219], v[96:99]
 s_waitcnt vmcnt(14)
 s_barrier
 ds_read_b128 v[64:67], v1 offset:49152
 v_mfma_f32_16x16x32_bf16 v[100:103], v[68:71], a[220:223], v[100:103]
 buffer_load_dwordx4 v253, s[4:7], s65 offen offset:2048 sc1 lds
 v_mfma_f32_16x16x32_bf16 v[104:107], v[72:75], a[216:219], v[104:107]
 ds_read_b128 v[68:71], v1 offset:50176
 v_mfma_f32_16x16x32_bf16 v[108:111], v[72:75], a[220:223], v[108:111]
 v_mfma_f32_16x16x32_bf16 v[112:115], v[76:79], a[216:219], v[112:115]
 s_waitcnt lgkmcnt(3)
 ds_read_b128 v[72:75], v1 offset:51200
 v_mfma_f32_16x16x32_bf16 v[116:119], v[76:79], a[220:223], v[116:119]
 buffer_load_dwordx4 v254, s[4:7], s65 offen offset:3072 sc1 lds
 v_mfma_f32_16x16x32_bf16 v[120:123], v[80:83], a[216:219], v[120:123]
 s_add_u32 m0, s60, 0x18000
 ds_read_b128 v[76:79], v1 offset:52224
 v_mfma_f32_16x16x32_bf16 v[124:127], v[80:83], a[220:223], v[124:127]
 s_bfe_u32 s65, s84, 0x40004
 s_mul_i32 s65, s65, 0x7000
 s_add_u32 s65, s65, s17
 v_mfma_f32_16x16x32_bf16 v[128:131], v[84:87], a[216:219], v[128:131]
 ds_read_b128 v[80:83], v1 offset:53248
 v_mfma_f32_16x16x32_bf16 v[132:135], v[84:87], a[220:223], v[132:135]
 buffer_load_dwordx4 v11, s[4:7], s65 offen offset:0 sc1 lds
 v_mfma_f32_16x16x32_bf16 v[136:139], v[88:91], a[216:219], v[136:139]
 s_waitcnt lgkmcnt(3)
 ds_read_b128 v[84:87], v1 offset:54272
 v_mfma_f32_16x16x32_bf16 v[140:143], v[88:91], a[220:223], v[140:143]
 v_mfma_f32_16x16x32_bf16 v[144:147], v[92:95], a[216:219], v[144:147]
 s_waitcnt vmcnt(15)
 ds_read_b128 v[88:91], v1 offset:55296
 v_mfma_f32_16x16x32_bf16 v[148:151], v[92:95], a[220:223], v[148:151]
 buffer_load_dwordx4 v252, s[4:7], s65 offen offset:1024 sc1 lds
 v_mfma_f32_16x16x32_bf16 v[96:99], v[64:67], a[224:227], v[96:99]
 ds_read_b128 v[92:95], v1 offset:56320
 v_mfma_f32_16x16x32_bf16 v[100:103], v[64:67], a[228:231], v[100:103]
 v_mfma_f32_16x16x32_bf16 v[104:107], v[68:71], a[224:227], v[104:107]
 s_waitcnt lgkmcnt(3)
 ds_read_b128 v[64:67], v1 offset:57344
 v_mfma_f32_16x16x32_bf16 v[108:111], v[68:71], a[228:231], v[108:111]
 buffer_load_dwordx4 v253, s[4:7], s65 offen offset:2048 sc1 lds
 v_mfma_f32_16x16x32_bf16 v[112:115], v[72:75], a[224:227], v[112:115]
 ds_read_b128 v[68:71], v1 offset:58368
 v_mfma_f32_16x16x32_bf16 v[116:119], v[72:75], a[228:231], v[116:119]
 v_mfma_f32_16x16x32_bf16 v[120:123], v[76:79], a[224:227], v[120:123]
 ds_read_b128 v[72:75], v1 offset:59392
 v_mfma_f32_16x16x32_bf16 v[124:127], v[76:79], a[228:231], v[124:127]
 buffer_load_dwordx4 v254, s[4:7], s65 offen offset:3072 sc1 lds
 v_mfma_f32_16x16x32_bf16 v[128:131], v[80:83], a[224:227], v[128:131]
 s_waitcnt lgkmcnt(3)
 ds_read_b128 v[76:79], v1 offset:60416
 v_mfma_f32_16x16x32_bf16 v[132:135], v[80:83], a[228:231], v[132:135]
 s_add_u32 m0, s60, 0x1c000
 s_bfe_u32 s65, s84, 0x40008
 s_mul_i32 s65, s65, 0x7000
 v_mfma_f32_16x16x32_bf16 v[136:139], v[84:87], a[224:227], v[136:139]
 s_waitcnt vmcnt(15)
 ds_read_b128 v[80:83], v1 offset:61440
 v_mfma_f32_16x16x32_bf16 v[140:143], v[84:87], a[228:231], v[140:143]
 s_add_u32 s65, s65, s17
 v_mfma_f32_16x16x32_bf16 v[144:147], v[88:91], a[224:227], v[144:147]
 ds_read_b128 v[84:87], v1 offset:62464
 v_mfma_f32_16x16x32_bf16 v[148:151], v[88:91], a[228:231], v[148:151]
 buffer_load_dwordx4 v11, s[4:7], s65 offen offset:0 sc1 lds
 v_mfma_f32_16x16x32_bf16 v[96:99], v[92:95], a[232:235], v[96:99]
 s_waitcnt lgkmcnt(3)
 s_waitcnt vmcnt(13)
 s_barrier
 ds_read_b128 v[88:91], v12 offset:0
 v_mfma_f32_16x16x32_bf16 v[100:103], v[92:95], a[236:239], v[100:103]
 buffer_load_dwordx4 v252, s[4:7], s65 offen offset:1024 sc1 lds
 v_mfma_f32_16x16x32_bf16 v[104:107], v[64:67], a[232:235], v[104:107]
 ds_read_b128 v[92:95], v12 offset:1024
 v_mfma_f32_16x16x32_bf16 v[108:111], v[64:67], a[236:239], v[108:111]
 v_mfma_f32_16x16x32_bf16 v[112:115], v[68:71], a[232:235], v[112:115]
 ds_read_b128 v[64:67], v12 offset:2048
 v_mfma_f32_16x16x32_bf16 v[116:119], v[68:71], a[236:239], v[116:119]
 buffer_load_dwordx4 v253, s[4:7], s65 offen offset:2048 sc1 lds
 v_mfma_f32_16x16x32_bf16 v[120:123], v[72:75], a[232:235], v[120:123]
 s_waitcnt lgkmcnt(3)
 ds_read_b128 v[68:71], v12 offset:3072
 v_mfma_f32_16x16x32_bf16 v[124:127], v[72:75], a[236:239], v[124:127]
 v_mfma_f32_16x16x32_bf16 v[128:131], v[76:79], a[232:235], v[128:131]
 ds_read_b128 v[72:75], v12 offset:4096
 v_mfma_f32_16x16x32_bf16 v[132:135], v[76:79], a[236:239], v[132:135]
 buffer_load_dwordx4 v254, s[4:7], s65 offen offset:3072 sc1 lds
 v_mfma_f32_16x16x32_bf16 v[136:139], v[80:83], a[232:235], v[136:139]
 s_waitcnt vmcnt(14)
 ds_read_b128 v[76:79], v12 offset:5120
 v_mfma_f32_16x16x32_bf16 v[140:143], v[80:83], a[236:239], v[140:143]
 s_add_u32 m0, s60, 0x20000
 s_bfe_u32 s65, s84, 0x4000c
 s_mul_i32 s65, s65, 0x7000
 v_mfma_f32_16x16x32_bf16 v[144:147], v[84:87], a[232:235], v[144:147]
 s_waitcnt lgkmcnt(3)
 ds_read_b128 v[80:83], v12 offset:6144
 v_mfma_f32_16x16x32_bf16 v[148:151], v[84:87], a[236:239], v[148:151]
 s_add_u32 s65, s65, s17
 v_mfma_f32_16x16x32_bf16 v[96:99], v[88:91], a[240:243], v[96:99]
 ds_read_b128 v[84:87], v12 offset:7168
 v_mfma_f32_16x16x32_bf16 v[100:103], v[88:91], a[244:247], v[100:103]
 buffer_load_dwordx4 v11, s[4:7], s65 offen offset:0 sc1 lds
 v_mfma_f32_16x16x32_bf16 v[104:107], v[92:95], a[240:243], v[104:107]
 ds_read_b128 v[88:91], v12 offset:8192
 v_mfma_f32_16x16x32_bf16 v[108:111], v[92:95], a[244:247], v[108:111]
 buffer_load_dwordx4 v252, s[4:7], s65 offen offset:1024 sc1 lds
 v_mfma_f32_16x16x32_bf16 v[112:115], v[64:67], a[240:243], v[112:115]
 s_waitcnt lgkmcnt(3)
 ds_read_b128 v[92:95], v12 offset:9216
 v_mfma_f32_16x16x32_bf16 v[116:119], v[64:67], a[244:247], v[116:119]
 v_mfma_f32_16x16x32_bf16 v[120:123], v[68:71], a[240:243], v[120:123]
 ds_read_b128 v[64:67], v12 offset:10240
 v_mfma_f32_16x16x32_bf16 v[124:127], v[68:71], a[244:247], v[124:127]
 buffer_load_dwordx4 v253, s[4:7], s65 offen offset:2048 sc1 lds
 v_mfma_f32_16x16x32_bf16 v[128:131], v[72:75], a[240:243], v[128:131]
 ds_read_b128 v[68:71], v12 offset:11264
 v_mfma_f32_16x16x32_bf16 v[132:135], v[72:75], a[244:247], v[132:135]
 v_mfma_f32_16x16x32_bf16 v[136:139], v[76:79], a[240:243], v[136:139]
 s_waitcnt lgkmcnt(3)
 ds_read_b128 v[72:75], v12 offset:12288
 v_mfma_f32_16x16x32_bf16 v[140:143], v[76:79], a[244:247], v[140:143]
 buffer_load_dwordx4 v254, s[4:7], s65 offen offset:3072 sc1 lds
 v_mfma_f32_16x16x32_bf16 v[144:147], v[80:83], a[240:243], v[144:147]
 s_waitcnt vmcnt(15)
 ds_read_b128 v[76:79], v12 offset:13312
 v_mfma_f32_16x16x32_bf16 v[148:151], v[80:83], a[244:247], v[148:151]
 s_add_u32 m0, s60, 0x0
 s_bfe_u32 s65, s84, 0x40010
 s_mul_i32 s65, s65, 0x7000
 v_mfma_f32_16x16x32_bf16 v[96:99], v[84:87], a[248:251], v[96:99]
 s_add_u32 s65, s65, s17
 ds_read_b32 v80, v58 offset:768
 ds_read_b32 v81, v58 offset:768
 v_mfma_f32_16x16x32_bf16 v[100:103], v[84:87], a[252:255], v[100:103]
 buffer_load_dwordx4 v11, s[4:7], s65 offen offset:0 sc1 lds
 v_mfma_f32_16x16x32_bf16 v[104:107], v[88:91], a[248:251], v[104:107]
 s_waitcnt lgkmcnt(4)
 ds_read_b32 v84, v58 offset:832
 ds_read_b32 v85, v58 offset:832
 v_mfma_f32_16x16x32_bf16 v[108:111], v[88:91], a[252:255], v[108:111]
 v_mfma_f32_16x16x32_bf16 v[112:115], v[92:95], a[248:251], v[112:115]
 ds_read_b32 v88, v58 offset:896
 ds_read_b32 v89, v58 offset:896
 v_mfma_f32_16x16x32_bf16 v[116:119], v[92:95], a[252:255], v[116:119]
 buffer_load_dwordx4 v252, s[4:7], s65 offen offset:1024 sc1 lds
 v_mfma_f32_16x16x32_bf16 v[120:123], v[64:67], a[248:251], v[120:123]
 ds_read_b32 v92, v58 offset:960
 ds_read_b32 v93, v58 offset:960
 v_mfma_f32_16x16x32_bf16 v[124:127], v[64:67], a[252:255], v[124:127]
 v_mfma_f32_16x16x32_bf16 v[128:131], v[68:71], a[248:251], v[128:131]
 s_waitcnt lgkmcnt(6)
 ds_read_b32 v64, v58 offset:1024
 ds_read_b32 v65, v58 offset:1024
 v_mfma_f32_16x16x32_bf16 v[132:135], v[68:71], a[252:255], v[132:135]
 buffer_load_dwordx4 v253, s[4:7], s65 offen offset:2048 sc1 lds
 v_mfma_f32_16x16x32_bf16 v[136:139], v[72:75], a[248:251], v[136:139]
 ds_read_b32 v68, v58 offset:1088
 ds_read_b32 v69, v58 offset:1088
 v_mfma_f32_16x16x32_bf16 v[140:143], v[72:75], a[252:255], v[140:143]
 v_mfma_f32_16x16x32_bf16 v[144:147], v[76:79], a[248:251], v[144:147]
 ds_read_b32 v72, v58 offset:1152
 ds_read_b32 v73, v58 offset:1152
 v_mfma_f32_16x16x32_bf16 v[148:151], v[76:79], a[252:255], v[148:151]
 buffer_load_dwordx4 v254, s[4:7], s65 offen offset:3072 sc1 lds
 v_mfma_f32_16x16x32_bf16 v[96:99], v[80:83], v[48:51], v[96:99]
 s_waitcnt lgkmcnt(6)
 v_mfma_f32_16x16x32_bf16 v[100:103], v[80:83], v[52:55], v[100:103]
 s_add_u32 m0, s60, 0x4000
 s_bfe_u32 s65, s84, 0x40014
 s_mul_i32 s65, s65, 0x7000
 v_mfma_f32_16x16x32_bf16 v[104:107], v[84:87], v[48:51], v[104:107]
 s_add_u32 s65, s65, s17
 v_mfma_f32_16x16x32_bf16 v[108:111], v[84:87], v[52:55], v[108:111]
 buffer_load_dwordx4 v11, s[4:7], s65 offen offset:0 sc1 lds
 v_mfma_f32_16x16x32_bf16 v[112:115], v[88:91], v[48:51], v[112:115]
 v_mfma_f32_16x16x32_bf16 v[116:119], v[88:91], v[52:55], v[116:119]
 v_mfma_f32_16x16x32_bf16 v[120:123], v[92:95], v[48:51], v[120:123]
 s_waitcnt lgkmcnt(0)
 v_mfma_f32_16x16x32_bf16 v[124:127], v[92:95], v[52:55], v[124:127]
 buffer_load_dwordx4 v252, s[4:7], s65 offen offset:1024 sc1 lds
 v_mfma_f32_16x16x32_bf16 v[128:131], v[64:67], v[48:51], v[128:131]
 v_mfma_f32_16x16x32_bf16 v[132:135], v[64:67], v[52:55], v[132:135]
 v_mfma_f32_16x16x32_bf16 v[136:139], v[68:71], v[48:51], v[136:139]
 v_mfma_f32_16x16x32_bf16 v[140:143], v[68:71], v[52:55], v[140:143]
 buffer_load_dwordx4 v253, s[4:7], s65 offen offset:2048 sc1 lds
 v_mfma_f32_16x16x32_bf16 v[144:147], v[72:75], v[48:51], v[144:147]
 v_mfma_f32_16x16x32_bf16 v[148:151], v[72:75], v[52:55], v[148:151]
 s_barrier
mk_k4:
 v_and_b32 v60, 15, v0
 v_lshlrev_b32 v60, 4, v60
 v_lshrrev_b32 v61, 4, v0
 v_lshl_add_u32 v60, v61, 2, v60
 v_pk_mul_f32 v[224:225], v[96:97], v[96:97]
 v_pk_fma_f32 v[224:225], v[224:225], v[44:45], v[44:45] op_sel:[0,1,0] op_sel_hi:[1,1,0]
 v_pk_mul_f32 v[224:225], v[224:225], v[96:97]
 v_exp_f32 v224, v224
 v_exp_f32 v225, v225
 v_pk_mul_f32 v[226:227], v[98:99], v[98:99]
 v_pk_fma_f32 v[226:227], v[226:227], v[44:45], v[44:45] op_sel:[0,1,0] op_sel_hi:[1,1,0]
 v_pk_mul_f32 v[226:227], v[226:227], v[98:99]
 v_exp_f32 v226, v226
 v_exp_f32 v227, v227
 v_pk_add_f32 v[224:225], v[224:225], s[74:75]
 v_rcp_f32 v224, v224
 v_rcp_f32 v225, v225
 v_pk_mul_f32 v[228:229], v[100:101], v[100:101]
 v_pk_fma_f32 v[228:229], v[228:229], v[46:47], v[46:47] op_sel:[0,1,0] op_sel_hi:[1,1,0]
 v_pk_mul_f32 v[228:229], v[228:229], v[100:101]
 v_exp_f32 v228, v228
 v_exp_f32 v229, v229
 v_pk_add_f32 v[226:227], v[226:227], s[74:75]
 v_rcp_f32 v226, v226
 v_rcp_f32 v227, v227
 v_pk_mul_f32 v[96:97], v[96:97], v[224:225]
 v_pk_mul_f32 v[240:241], v[96:97], s[74:75]
 v_pk_mul_f32 v[244:245], v[96:97], v[96:97]
 v_pk_mul_f32 v[230:231], v[102:103], v[102:103]
 v_pk_fma_f32 v[230:231], v[230:231], v[46:47], v[46:47] op_sel:[0,1,0] op_sel_hi:[1,1,0]
 v_pk_mul_f32 v[230:231], v[230:231], v[102:103]
 v_exp_f32 v230, v230
 v_exp_f32 v231, v231
 v_pk_add_f32 v[228:229], v[228:229], s[74:75]
 v_rcp_f32 v228, v228
 v_rcp_f32 v229, v229
 v_pk_mul_f32 v[98:99], v[98:99], v[226:227]
 v_pk_add_f32 v[240:241], v[240:241], v[98:99]
 v_pk_fma_f32 v[244:245], v[98:99], v[98:99], v[244:245]
 v_pk_mul_f32 v[232:233], v[104:105], v[104:105]
 v_pk_fma_f32 v[232:233], v[232:233], v[44:45], v[44:45] op_sel:[0,1,0] op_sel_hi:[1,1,0]
 v_pk_mul_f32 v[232:233], v[232:233], v[104:105]
 v_exp_f32 v232, v232
 v_exp_f32 v233, v233
 buffer_load_dwordx4 v254, s[4:7], s65 offen offset:3072 sc1 lds
 v_pk_add_f32 v[230:231], v[230:231], s[74:75]
 v_rcp_f32 v230, v230
 v_rcp_f32 v231, v231
 v_pk_mul_f32 v[100:101], v[100:101], v[228:229]
 v_pk_mul_f32 v[242:243], v[100:101], s[74:75]
 v_pk_mul_f32 v[246:247], v[100:101], v[100:101]
 v_pk_mul_f32 v[234:235], v[106:107], v[106:107]
 v_pk_fma_f32 v[234:235], v[234:235], v[44:45], v[44:45] op_sel:[0,1,0] op_sel_hi:[1,1,0]
 v_pk_mul_f32 v[234:235], v[234:235], v[106:107]
 v_exp_f32 v234, v234
 v_exp_f32 v235, v235
 v_pk_add_f32 v[232:233], v[232:233], s[74:75]
 v_rcp_f32 v232, v232
 v_rcp_f32 v233, v233
 v_pk_mul_f32 v[102:103], v[102:103], v[230:231]
 v_pk_add_f32 v[242:243], v[242:243], v[102:103]
 v_pk_fma_f32 v[246:247], v[102:103], v[102:103], v[246:247]
 v_pk_mul_f32 v[236:237], v[108:109], v[108:109]
 v_pk_fma_f32 v[236:237], v[236:237], v[46:47], v[46:47] op_sel:[0,1,0] op_sel_hi:[1,1,0]
 v_pk_mul_f32 v[236:237], v[236:237], v[108:109]
 v_exp_f32 v236, v236
 v_exp_f32 v237, v237
 v_pk_add_f32 v[234:235], v[234:235], s[74:75]
 v_rcp_f32 v234, v234
 v_rcp_f32 v235, v235
 v_pk_mul_f32 v[104:105], v[104:105], v[232:233]
 v_pk_add_f32 v[240:241], v[240:241], v[104:105]
 v_pk_fma_f32 v[244:245], v[104:105], v[104:105], v[244:245]
 v_pk_mul_f32 v[238:239], v[110:111], v[110:111]
 v_pk_fma_f32 v[238:239], v[238:239], v[46:47], v[46:47] op_sel:[0,1,0] op_sel_hi:[1,1,0]
 v_pk_mul_f32 v[238:239], v[238:239], v[110:111]
 v_exp_f32 v238, v238
 v_exp_f32 v239, v239
 v_pk_add_f32 v[236:237], v[236:237], s[74:75]
 v_rcp_f32 v236, v236
 v_rcp_f32 v237, v237
 v_pk_mul_f32 v[106:107], v[106:107], v[234:235]
 v_pk_add_f32 v[240:241], v[240:241], v[106:107]
 v_pk_fma_f32 v[244:245], v[106:107], v[106:107], v[244:245]
 v_pk_mul_f32 v[224:225], v[112:113], v[112:113]
 s_add_u32 m0, s60, 0x8000
 s_bfe_u32 s65, s84, 0x40018
 s_mul_i32 s65, s65, 0x7000
 s_add_u32 s65, s65, s17
 buffer_load_dwordx4 v11, s[4:7], s65 offen offset:0 sc1 lds
 v_pk_fma_f32 v[224:225], v[224:225], v[44:45], v[44:45] op_sel:[0,1,0] op_sel_hi:[1,1,0]
 v_pk_mul_f32 v[224:225], v[224:225], v[112:113]
 v_exp_f32 v224, v224
 v_exp_f32 v225, v225
 v_pk_add_f32 v[238:239], v[238:239], s[74:75]
 v_rcp_f32 v238, v238
 v_rcp_f32 v239, v239
 v_pk_mul_f32 v[108:109], v[108:109], v[236:237]
 v_pk_add_f32 v[242:243], v[242:243], v[108:109]
 v_pk_fma_f32 v[246:247], v[108:109], v[108:109], v[246:247]
 v_pk_mul_f32 v[226:227], v[114:115], v[114:115]
 v_pk_fma_f32 v[226:227], v[226:227], v[44:45], v[44:45] op_sel:[0,1,0] op_sel_hi:[1,1,0]
 v_pk_mul_f32 v[226:227], v[226:227], v[114:115]
 v_exp_f32 v226, v226
 v_exp_f32 v227, v227
 v_pk_add_f32 v[224:225], v[224:225], s[74:75]
 v_rcp_f32 v224, v224
 v_rcp_f32 v225, v225
 v_pk_mul_f32 v[110:111], v[110:111], v[238:239]
 v_pk_add_f32 v[242:243], v[242:243], v[110:111]
 v_pk_fma_f32 v[246:247], v[110:111], v[110:111], v[246:247]
 v_pk_mul_f32 v[228:229], v[116:117], v[116:117]
 v_pk_fma_f32 v[228:229], v[228:229], v[46:47], v[46:47] op_sel:[0,1,0] op_sel_hi:[1,1,0]
 v_pk_mul_f32 v[228:229], v[228:229], v[116:117]
 v_exp_f32 v228, v228
 v_exp_f32 v229, v229
 v_pk_add_f32 v[226:227], v[226:227], s[74:75]
 v_rcp_f32 v226, v226
 v_rcp_f32 v227, v227
 v_pk_mul_f32 v[112:113], v[112:113], v[224:225]
 v_pk_add_f32 v[240:241], v[240:241], v[112:113]
 v_pk_fma_f32 v[244:245], v[112:113], v[112:113], v[244:245]
 v_pk_mul_f32 v[230:231], v[118:119], v[118:119]
 v_pk_fma_f32 v[230:231], v[230:231], v[46:47], v[46:47] op_sel:[0,1,0] op_sel_hi:[1,1,0]
 v_pk_mul_f32 v[230:231], v[230:231], v[118:119]
 v_exp_f32 v230, v230
 v_exp_f32 v231, v231
 v_pk_add_f32 v[228:229], v[228:229], s[74:75]
 v_rcp_f32 v228, v228
 v_rcp_f32 v229, v229
 buffer_load_dwordx4 v252, s[4:7], s65 offen offset:1024 sc1 lds
 v_pk_mul_f32 v[114:115], v[114:115], v[226:227]
 v_pk_add_f32 v[240:241], v[240:241], v[114:115]
 v_pk_fma_f32 v[244:245], v[114:115], v[114:115], v[244:245]
 v_pk_mul_f32 v[232:233], v[120:121], v[120:121]
 v_pk_fma_f32 v[232:233], v[232:233], v[44:45], v[44:45] op_sel:[0,1,0] op_sel_hi:[1,1,0]
 v_pk_mul_f32 v[232:233], v[232:233], v[120:121]
 v_exp_f32 v232, v232
 v_exp_f32 v233, v233
 v_pk_add_f32 v[230:231], v[230:231], s[74:75]
 v_rcp_f32 v230, v230
 v_rcp_f32 v231, v231
 v_pk_mul_f32 v[116:117], v[116:117], v[228:229]
 v_pk_add_f32 v[242:243], v[242:243], v[116:117]
 v_pk_fma_f32 v[246:247], v[116:117], v[116:117], v[246:247]
 v_pk_mul_f32 v[234:235], v[122:123], v[122:123]
 v_pk_fma_f32 v[234:235], v[234:235], v[44:45], v[44:45] op_sel:[0,1,0] op_sel_hi:[1,1,0]
 v_pk_mul_f32 v[234:235], v[234:235], v[122:123]
 v_exp_f32 v234, v234
 v_exp_f32 v235, v235
 v_pk_add_f32 v[232:233], v[232:233], s[74:75]
 v_rcp_f32 v232, v232
 v_rcp_f32 v233, v233
 v_pk_mul_f32 v[118:119], v[118:119], v[230:231]
 v_pk_add_f32 v[242:243], v[242:243], v[118:119]
 v_pk_fma_f32 v[246:247], v[118:119], v[118:119], v[246:247]
 v_pk_mul_f32 v[236:237], v[124:125], v[124:125]
 v_pk_fma_f32 v[236:237], v[236:237], v[46:47], v[46:47] op_sel:[0,1,0] op_sel_hi:[1,1,0]
 v_pk_mul_f32 v[236:237], v[236:237], v[124:125]
 v_exp_f32 v236, v236
 v_exp_f32 v237, v237
 v_pk_add_f32 v[234:235], v[234:235], s[74:75]
 v_rcp_f32 v234, v234
 v_rcp_f32 v235, v235
 v_pk_mul_f32 v[120:121], v[120:121], v[232:233]
 v_pk_add_f32 v[240:241], v[240:241], v[120:121]
 v_pk_fma_f32 v[244:245], v[120:121], v[120:121], v[244:245]
 v_pk_mul_f32 v[238:239], v[126:127], v[126:127]
 v_pk_fma_f32 v[238:239], v[238:239], v[46:47], v[46:47] op_sel:[0,1,0] op_sel_hi:[1,1,0]
 v_pk_mul_f32 v[238:239], v[238:239], v[126:127]
 v_exp_f32 v238, v238
 buffer_load_dwordx4 v253, s[4:7], s65 offen offset:2048 sc1 lds
 v_exp_f32 v239, v239
 v_pk_add_f32 v[236:237], v[236:237], s[74:75]
 v_rcp_f32 v236, v236
 v_rcp_f32 v237, v237
 v_pk_mul_f32 v[122:123], v[122:123], v[234:235]
 v_pk_add_f32 v[240:241], v[240:241], v[122:123]
 v_pk_fma_f32 v[244:245], v[122:123], v[122:123], v[244:245]
 v_pk_mul_f32 v[224:225], v[128:129], v[128:129]
 v_pk_fma_f32 v[224:225], v[224:225], v[44:45], v[44:45] op_sel:[0,1,0] op_sel_hi:[1,1,0]
 v_pk_mul_f32 v[224:225], v[224:225], v[128:129]
 v_exp_f32 v224, v224
 v_exp_f32 v225, v225
 v_pk_add_f32 v[238:239], v[238:239], s[74:75]
 v_rcp_f32 v238, v238
 v_rcp_f32 v239, v239
 v_pk_mul_f32 v[124:125], v[124:125], v[236:237]
 v_pk_add_f32 v[242:243], v[242:243], v[124:125]
 v_pk_fma_f32 v[246:247], v[124:125], v[124:125], v[246:247]
 v_pk_mul_f32 v[226:227], v[130:131], v[130:131]
 v_pk_fma_f32 v[226:227], v[226:227], v[44:45], v[44:45] op_sel:[0,1,0] op_sel_hi:[1,1,0]
 v_pk_mul_f32 v[226:227], v[226:227], v[130:131]
 v_exp_f32 v226, v226
 v_exp_f32 v227, v227
 v_pk_add_f32 v[224:225], v[224:225], s[74:75]
 v_rcp_f32 v224, v224
 v_rcp_f32 v225, v225
 v_pk_mul_f32 v[126:127], v[126:127], v[238:239]
 v_pk_add_f32 v[242:243], v[242:243], v[126:127]
 v_pk_fma_f32 v[246:247], v[126:127], v[126:127], v[246:247]
 v_pk_mul_f32 v[228:229], v[132:133], v[132:133]
 v_pk_fma_f32 v[228:229], v[228:229], v[46:47], v[46:47] op_sel:[0,1,0] op_sel_hi:[1,1,0]
 v_pk_mul_f32 v[228:229], v[228:229], v[132:133]
 v_exp_f32 v228, v228
 v_exp_f32 v229, v229
 v_pk_add_f32 v[226:227], v[226:227], s[74:75]
 v_rcp_f32 v226, v226
 v_rcp_f32 v227, v227
 v_pk_mul_f32 v[128:129], v[128:129], v[224:225]
 v_pk_add_f32 v[240:241], v[240:241], v[128:129]
 v_pk_fma_f32 v[244:245], v[128:129], v[128:129], v[244:245]
 buffer_load_dwordx4 v254, s[4:7], s65 offen offset:3072 sc1 lds
 v_pk_mul_f32 v[230:231], v[134:135], v[134:135]
 v_pk_fma_f32 v[230:231], v[230:231], v[46:47], v[46:47] op_sel:[0,1,0] op_sel_hi:[1,1,0]
 v_pk_mul_f32 v[230:231], v[230:231], v[134:135]
 v_exp_f32 v230, v230
 v_exp_f32 v231, v231
 v_pk_add_f32 v[228:229], v[228:229], s[74:75]
 v_rcp_f32 v228, v228
 v_rcp_f32 v229, v229
 v_pk_mul_f32 v[130:131], v[130:131], v[226:227]
 v_pk_add_f32 v[240:241], v[240:241], v[130:131]
 v_pk_fma_f32 v[244:245], v[130:131], v[130:131], v[244:245]
 v_pk_mul_f32 v[232:233], v[136:137], v[136:137]
 v_pk_fma_f32 v[232:233], v[232:233], v[44:45], v[44:45] op_sel:[0,1,0] op_sel_hi:[1,1,0]
 v_pk_mul_f32 v[232:233], v[232:233], v[136:137]
 v_exp_f32 v232, v232
 v_exp_f32 v233, v233
 v_pk_add_f32 v[230:231], v[230:231], s[74:75]
 v_rcp_f32 v230, v230
 v_rcp_f32 v231, v231
 v_pk_mul_f32 v[132:133], v[132:133], v[228:229]
 v_pk_add_f32 v[242:243], v[242:243], v[132:133]
 v_pk_fma_f32 v[246:247], v[132:133], v[132:133], v[246:247]
 v_pk_mul_f32 v[234:235], v[138:139], v[138:139]
 v_pk_fma_f32 v[234:235], v[234:235], v[44:45], v[44:45] op_sel:[0,1,0] op_sel_hi:[1,1,0]
 v_pk_mul_f32 v[234:235], v[234:235], v[138:139]
 v_exp_f32 v234, v234
 v_exp_f32 v235, v235
 v_pk_add_f32 v[232:233], v[232:233], s[74:75]
 v_rcp_f32 v232, v232
 v_rcp_f32 v233, v233
 v_pk_mul_f32 v[134:135], v[134:135], v[230:231]
 v_pk_add_f32 v[242:243], v[242:243], v[134:135]
 v_pk_fma_f32 v[246:247], v[134:135], v[134:135], v[246:247]
 v_pk_mul_f32 v[236:237], v[140:141], v[140:141]
 v_pk_fma_f32 v[236:237], v[236:237], v[46:47], v[46:47] op_sel:[0,1,0] op_sel_hi:[1,1,0]
 v_pk_mul_f32 v[236:237], v[236:237], v[140:141]
 v_exp_f32 v236, v236
 v_exp_f32 v237, v237
 v_pk_add_f32 v[234:235], v[234:235], s[74:75]
 v_rcp_f32 v234, v234
 s_add_u32 m0, s60, 0xc000
 s_bfe_u32 s65, s84, 0x4001c
 s_mul_i32 s65, s65, 0x7000
 s_add_u32 s65, s65, s17
 buffer_load_dwordx4 v11, s[4:7], s65 offen offset:0 sc1 lds
 v_rcp_f32 v235, v235
 v_pk_mul_f32 v[136:137], v[136:137], v[232:233]
 v_pk_add_f32 v[240:241], v[240:241], v[136:137]
 v_pk_fma_f32 v[244:245], v[136:137], v[136:137], v[244:245]
 v_pk_mul_f32 v[238:239], v[142:143], v[142:143]
 v_pk_fma_f32 v[238:239], v[238:239], v[46:47], v[46:47] op_sel:[0,1,0] op_sel_hi:[1,1,0]
 v_pk_mul_f32 v[238:239], v[238:239], v[142:143]
 v_exp_f32 v238, v238
 v_exp_f32 v239, v239
 v_pk_add_f32 v[236:237], v[236:237], s[74:75]
 v_rcp_f32 v236, v236
 v_rcp_f32 v237, v237
 v_pk_mul_f32 v[138:139], v[138:139], v[234:235]
 v_pk_add_f32 v[240:241], v[240:241], v[138:139]
 v_pk_fma_f32 v[244:245], v[138:139], v[138:139], v[244:245]
 v_pk_mul_f32 v[224:225], v[144:145], v[144:145]
 v_pk_fma_f32 v[224:225], v[224:225], v[44:45], v[44:45] op_sel:[0,1,0] op_sel_hi:[1,1,0]
 v_pk_mul_f32 v[224:225], v[224:225], v[144:145]
 v_exp_f32 v224, v224
 v_exp_f32 v225, v225
 v_pk_add_f32 v[238:239], v[238:239], s[74:75]
 v_rcp_f32 v238, v238
 v_rcp_f32 v239, v239
 v_pk_mul_f32 v[140:141], v[140:141], v[236:237]
 v_pk_add_f32 v[242:243], v[242:243], v[140:141]
 v_pk_fma_f32 v[246:247], v[140:141], v[140:141], v[246:247]
 v_pk_mul_f32 v[226:227], v[146:147], v[146:147]
 v_pk_fma_f32 v[226:227], v[226:227], v[44:45], v[44:45] op_sel:[0,1,0] op_sel_hi:[1,1,0]
 v_pk_mul_f32 v[226:227], v[226:227], v[146:147]
 v_exp_f32 v226, v226
 v_exp_f32 v227, v227
 v_pk_add_f32 v[224:225], v[224:225], s[74:75]
 v_rcp_f32 v224, v224
 v_rcp_f32 v225, v225
 v_pk_mul_f32 v[142:143], v[142:143], v[238:239]
 v_pk_add_f32 v[242:243], v[242:243], v[142:143]
 v_pk_fma_f32 v[246:247], v[142:143], v[142:143], v[246:247]
 v_pk_mul_f32 v[228:229], v[148:149], v[148:149]
 v_pk_fma_f32 v[228:229], v[228:229], v[46:47], v[46:47] op_sel:[0,1,0] op_sel_hi:[1,1,0]
 v_pk_mul_f32 v[228:229], v[228:229], v[148:149]
 buffer_load_dwordx4 v252, s[4:7], s65 offen offset:1024 sc1 lds
 v_exp_f32 v228, v228
 v_exp_f32 v229, v229
 v_pk_add_f32 v[226:227], v[226:227], s[74:75]
 v_rcp_f32 v226, v226
 v_rcp_f32 v227, v227
 v_pk_mul_f32 v[144:145], v[144:145], v[224:225]
 v_pk_add_f32 v[240:241], v[240:241], v[144:145]
 v_pk_fma_f32 v[244:245], v[144:145], v[144:145], v[244:245]
 v_pk_mul_f32 v[230:231], v[150:151], v[150:151]
 v_pk_fma_f32 v[230:231], v[230:231], v[46:47], v[46:47] op_sel:[0,1,0] op_sel_hi:[1,1,0]
 v_pk_mul_f32 v[230:231], v[230:231], v[150:151]
 v_exp_f32 v230, v230
 v_exp_f32 v231, v231
 v_pk_add_f32 v[228:229], v[228:229], s[74:75]
 v_rcp_f32 v228, v228
 v_rcp_f32 v229, v229
 v_pk_mul_f32 v[146:147], v[146:147], v[226:227]
 v_pk_add_f32 v[240:241], v[240:241], v[146:147]
 v_pk_fma_f32 v[244:245], v[146:147], v[146:147], v[244:245]
 v_pk_add_f32 v[230:231], v[230:231], s[74:75]
 v_rcp_f32 v230, v230
 v_rcp_f32 v231, v231
 v_pk_mul_f32 v[148:149], v[148:149], v[228:229]
 v_pk_add_f32 v[242:243], v[242:243], v[148:149]
 v_pk_fma_f32 v[246:247], v[148:149], v[148:149], v[246:247]
 v_pk_mul_f32 v[150:151], v[150:151], v[230:231]
 v_pk_add_f32 v[242:243], v[242:243], v[150:151]
 v_pk_fma_f32 v[246:247], v[150:151], v[150:151], v[246:247]
 s_waitcnt vmcnt(26)
 s_barrier
 ds_read_b128 v[76:79], v12 offset:16384
 ds_read_b128 v[80:83], v12 offset:17408
 ds_read_b128 v[84:87], v12 offset:18432
 ds_read_b128 v[88:91], v12 offset:19456
 ds_read_b128 v[92:95], v12 offset:20480
 ds_read_b128 v[64:67], v12 offset:21504
 ds_read_b128 v[68:71], v12 offset:22528
 v_add_f32 v240, v240, v241
 v_add_f32 v242, v242, v243
 v_add_f32 v244, v244, v245
 v_add_f32 v246, v246, v247
 v_permlane16_swap_b32 v240, v242
 s_nop 0
 v_permlane16_swap_b32 v244, v246
 v_add_f32 v240, v240, v242
 v_add_f32 v244, v244, v246
 s_nop 1
 v_permlane32_swap_b32 v240, v244
 v_add_f32 v240, v240, v244
 v_mov_b32 v59, v240
 s_add_u32 s69, s51, 0x3880000
 buffer_store_dword v59, v60, s[4:7], s69 offen sc1
 s_waitcnt lgkmcnt(4)
 v_mfma_f32_16x16x32_bf16 v[160:163], v[76:79], a[0:3], 0
 ds_read_b128 v[72:75], v12 offset:23552
 v_mfma_f32_16x16x32_bf16 v[164:167], v[76:79], a[4:7], 0
 v_mfma_f32_16x16x32_bf16 v[168:171], v[80:83], a[0:3], 0
 ds_read_b128 v[76:79], v12 offset:24576
 v_mfma_f32_16x16x32_bf16 v[172:175], v[80:83], a[4:7], 0
 buffer_load_dwordx4 v253, s[4:7], s65 offen offset:2048 sc1 lds
 v_mfma_f32_16x16x32_bf16 v[176:179], v[84:87], a[0:3], 0
 s_waitcnt lgkmcnt(3)
 ds_read_b128 v[80:83], v12 offset:25600
 v_mfma_f32_16x16x32_bf16 v[180:183], v[84:87], a[4:7], 0
 v_mfma_f32_16x16x32_bf16 v[184:187], v[88:91], a[0:3], 0
 ds_read_b128 v[84:87], v12 offset:26624
 v_mfma_f32_16x16x32_bf16 v[188:191], v[88:91], a[4:7], 0
 buffer_load_dwordx4 v254, s[4:7], s65 offen offset:3072 sc1 lds
 v_mfma_f32_16x16x32_bf16 v[192:195], v[92:95], a[0:3], 0
 s_add_u32 m0, s60, 0x10000
 ds_read_b128 v[88:91], v12 offset:27648
 v_mfma_f32_16x16x32_bf16 v[196:199], v[92:95], a[4:7], 0
 s_bfe_u32 s34, s84, 0x40000
 s_mul_i32 s34, s34, 0x100
 v_mfma_f32_16x16x32_bf16 v[200:203], v[64:67], a[0:3], 0
 s_waitcnt lgkmcnt(3)
 ds_read_b128 v[92:95], v12 offset:28672
 v_mfma_f32_16x16x32_bf16 v[204:207], v[64:67], a[4:7], 0
 buffer_load_dwordx4 v15, s[20:23], s34 offen offset:0  lds
 v_mfma_f32_16x16x32_bf16 v[208:211], v[68:71], a[0:3], 0
 ds_read_b128 v[64:67], v12 offset:29696
 v_mfma_f32_16x16x32_bf16 v[212:215], v[68:71], a[4:7], 0
 v_mfma_f32_16x16x32_bf16 v[160:163], v[72:75], a[8:11], v[160:163]
 s_waitcnt vmcnt(26)
 s_barrier
 ds_read_b128 v[68:71], v12 offset:32768
 v_mfma_f32_16x16x32_bf16 v[164:167], v[72:75], a[12:15], v[164:167]
 buffer_load_dwordx4 v16, s[20:23], s34 offen offset:1024  lds
 v_mfma_f32_16x16x32_bf16 v[168:171], v[76:79], a[8:11], v[168:171]
 s_waitcnt lgkmcnt(3)
 ds_read_b128 v[72:75], v12 offset:33792
 v_mfma_f32_16x16x32_bf16 v[172:175], v[76:79], a[12:15], v[172:175]
 v_mfma_f32_16x16x32_bf16 v[176:179], v[80:83], a[8:11], v[176:179]
 ds_read_b128 v[76:79], v12 offset:34816
 v_mfma_f32_16x16x32_bf16 v[180:183], v[80:83], a[12:15], v[180:183]
 buffer_load_dwordx4 v17, s[20:23], s34 offen offset:2048  lds
 v_mfma_f32_16x16x32_bf16 v[184:187], v[84:87], a[8:11], v[184:187]
 ds_read_b128 v[80:83], v12 offset:35840
 v_mfma_f32_16x16x32_bf16 v[188:191], v[84:87], a[12:15], v[188:191]
 buffer_load_dwordx4 v18, s[20:23], s34 offen offset:3072  lds
 v_mfma_f32_16x16x32_bf16 v[192:195], v[88:91], a[8:11], v[192:195]
 s_waitcnt lgkmcnt(3)
 ds_read_b128 v[84:87], v12 offset:36864
 v_mfma_f32_16x16x32_bf16 v[196:199], v[88:91], a[12:15], v[196:199]
 v_mfma_f32_16x16x32_bf16 v[200:203], v[92:95], a[8:11], v[200:203]
 ds_read_b128 v[88:91], v12 offset:37888
 v_mfma_f32_16x16x32_bf16 v[204:207], v[92:95], a[12:15], v[204:207]
 v_mfma_f32_16x16x32_bf16 v[208:211], v[64:67], a[8:11], v[208:211]
 ds_read_b128 v[92:95], v12 offset:38912
 v_mfma_f32_16x16x32_bf16 v[212:215], v[64:67], a[12:15], v[212:215]
 v_mfma_f32_16x16x32_bf16 v[160:163], v[68:71], a[16:19], v[160:163]
 s_waitcnt lgkmcnt(3)
 ds_read_b128 v[64:67], v12 offset:39936
 v_mfma_f32_16x16x32_bf16 v[164:167], v[68:71], a[20:23], v[164:167]
 v_mfma_f32_16x16x32_bf16 v[168:171], v[72:75], a[16:19], v[168:171]
 ds_read_b128 v[68:71], v12 offset:40960
 v_mfma_f32_16x16x32_bf16 v[172:175], v[72:75], a[20:23], v[172:175]
 v_mfma_f32_16x16x32_bf16 v[176:179], v[76:79], a[16:19], v[176:179]
 ds_read_b128 v[72:75], v12 offset:41984
 v_mfma_f32_16x16x32_bf16 v[180:183], v[76:79], a[20:23], v[180:183]
 v_mfma_f32_16x16x32_bf16 v[184:187], v[80:83], a[16:19], v[184:187]
 s_waitcnt lgkmcnt(3)
 ds_read_b128 v[76:79], v12 offset:43008
 v_mfma_f32_16x16x32_bf16 v[188:191], v[80:83], a[20:23], v[188:191]
 v_mfma_f32_16x16x32_bf16 v[192:195], v[84:87], a[16:19], v[192:195]
 ds_read_b128 v[80:83], v12 offset:44032
 v_mfma_f32_16x16x32_bf16 v[196:199], v[84:87], a[20:23], v[196:199]
 v_mfma_f32_16x16x32_bf16 v[200:203], v[88:91], a[16:19], v[200:203]
 ds_read_b128 v[84:87], v12 offset:45056
 v_mfma_f32_16x16x32_bf16 v[204:207], v[88:91], a[20:23], v[204:207]
 v_mfma_f32_16x16x32_bf16 v[208:211], v[92:95], a[16:19], v[208:211]
 s_waitcnt lgkmcnt(3)
 ds_read_b128 v[88:91], v12 offset:46080
 v_mfma_f32_16x16x32_bf16 v[212:215], v[92:95], a[20:23], v[212:215]
 v_mfma_f32_16x16x32_bf16 v[160:163], v[64:67], a[24:27], v[160:163]
 s_waitcnt vmcnt(25)
 s_barrier
 ds_read_b128 v[92:95], v12 offset:49152
 v_mfma_f32_16x16x32_bf16 v[164:167], v[64:67], a[28:31], v[164:167]
 s_add_u32 m0, s60, 0x14000
 s_bfe_u32 s65, s85, 0x40000
 s_mul_i32 s65, s65, 0x7000
 v_mfma_f32_16x16x32_bf16 v[168:171], v[68:71], a[24:27], v[168:171]
 s_add_u32 s65, s65, s17
 ds_read_b128 v[64:67], v12 offset:50176
 v_mfma_f32_16x16x32_bf16 v[172:175], v[68:71], a[28:31], v[172:175]
 buffer_load_dwordx4 v11, s[4:7], s65 offen offset:0 sc1 lds
 v_mfma_f32_16x16x32_bf16 v[176:179], v[72:75], a[24:27], v[176:179]
 s_waitcnt lgkmcnt(3)
 ds_read_b128 v[68:71], v12 offset:51200
 v_mfma_f32_16x16x32_bf16 v[180:183], v[72:75], a[28:31], v[180:183]
 buffer_load_dwordx4 v252, s[4:7], s65 offen offset:1024 sc1 lds
 v_mfma_f32_16x16x32_bf16 v[184:187], v[76:79], a[24:27], v[184:187]
 ds_read_b128 v[72:75], v12 offset:52224
 v_mfma_f32_16x16x32_bf16 v[188:191], v[76:79], a[28:31], v[188:191]
 buffer_load_dwordx4 v253, s[4:7], s65 offen offset:2048 sc1 lds
 v_mfma_f32_16x16x32_bf16 v[192:195], v[80:83], a[24:27], v[192:195]
 ds_read_b128 v[76:79], v12 offset:53248
 v_mfma_f32_16x16x32_bf16 v[196:199], v[80:83], a[28:31], v[196:199]
 v_mfma_f32_16x16x32_bf16 v[200:203], v[84:87], a[24:27], v[200:203]
 s_waitcnt lgkmcnt(3)
 ds_read_b128 v[80:83], v12 offset:54272
 v_mfma_f32_16x16x32_bf16 v[204:207], v[84:87], a[28:31], v[204:207]
 buffer_load_dwordx4 v254, s[4:7], s65 offen offset:3072 sc1 lds
 v_mfma_f32_16x16x32_bf16 v[208:211], v[88:91], a[24:27], v[208:211]
 ds_read_b128 v[84:87], v12 offset:55296
 v_mfma_f32_16x16x32_bf16 v[212:215], v[88:91], a[28:31], v[212:215]
 v_mfma_f32_16x16x32_bf16 v[160:163], v[92:95], a[32:35], v[160:163]
 ds_read_b128 v[88:91], v12 offset:56320
 v_mfma_f32_16x16x32_bf16 v[164:167], v[92:95], a[36:39], v[164:167]
 v_mfma_f32_16x16x32_bf16 v[168:171], v[64:67], a[32:35], v[168:171]
 s_waitcnt lgkmcnt(3)
 ds_read_b128 v[92:95], v12 offset:57344
 v_mfma_f32_16x16x32_bf16 v[172:175], v[64:67], a[36:39], v[172:175]
 v_mfma_f32_16x16x32_bf16 v[176:179], v[68:71], a[32:35], v[176:179]
 ds_read_b128 v[64:67], v12 offset:58368
 v_mfma_f32_16x16x32_bf16 v[180:183], v[68:71], a[36:39], v[180:183]
 v_mfma_f32_16x16x32_bf16 v[184:187], v[72:75], a[32:35], v[184:187]
 ds_read_b128 v[68:71], v12 offset:59392
 v_mfma_f32_16x16x32_bf16 v[188:191], v[72:75], a[36:39], v[188:191]
 v_mfma_f32_16x16x32_bf16 v[192:195], v[76:79], a[32:35], v[192:195]
 s_waitcnt lgkmcnt(3)
 ds_read_b128 v[72:75], v12 offset:60416
 v_mfma_f32_16x16x32_bf16 v[196:199], v[76:79], a[36:39], v[196:199]
 s_waitcnt vmcnt(10)
 v_mfma_f32_16x16x32_bf16 v[200:203], v[80:83], a[32:35], v[200:203]
 ds_read_b128 v[76:79], v12 offset:61440
 v_mfma_f32_16x16x32_bf16 v[204:207], v[80:83], a[36:39], v[204:207]
 s_atomic_add s93, s[54:55], 512
 v_mfma_f32_16x16x32_bf16 v[208:211], v[84:87], a[32:35], v[208:211]
 ds_read_b128 v[80:83], v12 offset:62464
 v_mfma_f32_16x16x32_bf16 v[212:215], v[84:87], a[36:39], v[212:215]
 v_mfma_f32_16x16x32_bf16 v[160:163], v[88:91], a[40:43], v[160:163]
 s_waitcnt lgkmcnt(3)
 s_barrier
 ds_read_b128 v[84:87], v13 offset:0
 v_mfma_f32_16x16x32_bf16 v[164:167], v[88:91], a[44:47], v[164:167]
 s_add_u32 m0, s60, 0x18000
 s_add_u32 s34, s34, 0x80
 v_mfma_f32_16x16x32_bf16 v[168:171], v[92:95], a[40:43], v[168:171]
 ds_read_b128 v[88:91], v13 offset:1024
 v_mfma_f32_16x16x32_bf16 v[172:175], v[92:95], a[44:47], v[172:175]
 buffer_load_dwordx4 v15, s[20:23], s34 offen offset:0  lds
 v_mfma_f32_16x16x32_bf16 v[176:179], v[64:67], a[40:43], v[176:179]
 ds_read_b128 v[92:95], v13 offset:2048
 v_mfma_f32_16x16x32_bf16 v[180:183], v[64:67], a[44:47], v[180:183]
 buffer_load_dwordx4 v16, s[20:23], s34 offen offset:1024  lds
 v_mfma_f32_16x16x32_bf16 v[184:187], v[68:71], a[40:43], v[184:187]
 s_waitcnt lgkmcnt(3)
 ds_read_b128 v[64:67], v13 offset:3072
 v_mfma_f32_16x16x32_bf16 v[188:191], v[68:71], a[44:47], v[188:191]
 buffer_load_dwordx4 v17, s[20:23], s34 offen offset:2048  lds
 v_mfma_f32_16x16x32_bf16 v[192:195], v[72:75], a[40:43], v[192:195]
 ds_read_b128 v[68:71], v13 offset:4096
 v_mfma_f32_16x16x32_bf16 v[196:199], v[72:75], a[44:47], v[196:199]
 v_mfma_f32_16x16x32_bf16 v[200:203], v[76:79], a[40:43], v[200:203]
 ds_read_b128 v[72:75], v13 offset:5120
 v_mfma_f32_16x16x32_bf16 v[204:207], v[76:79], a[44:47], v[204:207]
 buffer_load_dwordx4 v18, s[20:23], s34 offen offset:3072  lds
 v_mfma_f32_16x16x32_bf16 v[208:211], v[80:83], a[40:43], v[208:211]
 s_waitcnt lgkmcnt(3)
 ds_read_b128 v[76:79], v13 offset:6144
 v_mfma_f32_16x16x32_bf16 v[212:215], v[80:83], a[44:47], v[212:215]
 v_mfma_f32_16x16x32_bf16 v[160:163], v[84:87], a[48:51], v[160:163]
 ds_read_b128 v[80:83], v13 offset:7168
 v_mfma_f32_16x16x32_bf16 v[164:167], v[84:87], a[52:55], v[164:167]
 v_mfma_f32_16x16x32_bf16 v[168:171], v[88:91], a[48:51], v[168:171]
 ds_read_b128 v[84:87], v13 offset:8192
 v_mfma_f32_16x16x32_bf16 v[172:175], v[88:91], a[52:55], v[172:175]
 v_mfma_f32_16x16x32_bf16 v[176:179], v[92:95], a[48:51], v[176:179]
 s_waitcnt lgkmcnt(3)
 ds_read_b128 v[88:91], v13 offset:9216
 v_mfma_f32_16x16x32_bf16 v[180:183], v[92:95], a[52:55], v[180:183]
 v_mfma_f32_16x16x32_bf16 v[184:187], v[64:67], a[48:51], v[184:187]
 ds_read_b128 v[92:95], v13 offset:10240
 v_mfma_f32_16x16x32_bf16 v[188:191], v[64:67], a[52:55], v[188:191]
 v_mfma_f32_16x16x32_bf16 v[192:195], v[68:71], a[48:51], v[192:195]
 ds_read_b128 v[64:67], v13 offset:11264
 v_mfma_f32_16x16x32_bf16 v[196:199], v[68:71], a[52:55], v[196:199]
 v_mfma_f32_16x16x32_bf16 v[200:203], v[72:75], a[48:51], v[200:203]
 s_waitcnt lgkmcnt(3)
 ds_read_b128 v[68:71], v13 offset:12288
 v_mfma_f32_16x16x32_bf16 v[204:207], v[72:75], a[52:55], v[204:207]
 v_mfma_f32_16x16x32_bf16 v[208:211], v[76:79], a[48:51], v[208:211]
 ds_read_b128 v[72:75], v13 offset:13312
 v_mfma_f32_16x16x32_bf16 v[212:215], v[76:79], a[52:55], v[212:215]
 v_mfma_f32_16x16x32_bf16 v[160:163], v[80:83], a[56:59], v[160:163]
 s_barrier
 ds_read_b128 v[76:79], v1 offset:0
 v_mfma_f32_16x16x32_bf16 v[164:167], v[80:83], a[60:63], v[164:167]
 s_add_u32 m0, s60, 0x1c000
 s_bfe_u32 s65, s85, 0x40004
 s_mul_i32 s65, s65, 0x7000
 v_mfma_f32_16x16x32_bf16 v[168:171], v[84:87], a[56:59], v[168:171]
 s_waitcnt lgkmcnt(3)
 ds_read_b128 v[80:83], v1 offset:1024
 v_mfma_f32_16x16x32_bf16 v[172:175], v[84:87], a[60:63], v[172:175]
 s_add_u32 s65, s65, s17
 v_mfma_f32_16x16x32_bf16 v[176:179], v[88:91], a[56:59], v[176:179]
 ds_read_b128 v[84:87], v1 offset:2048
 v_mfma_f32_16x16x32_bf16 v[180:183], v[88:91], a[60:63], v[180:183]
 buffer_load_dwordx4 v11, s[4:7], s65 offen offset:0 sc1 lds
 v_mfma_f32_16x16x32_bf16 v[184:187], v[92:95], a[56:59], v[184:187]
 ds_read_b128 v[88:91], v1 offset:3072
 v_mfma_f32_16x16x32_bf16 v[188:191], v[92:95], a[60:63], v[188:191]
 buffer_load_dwordx4 v252, s[4:7], s65 offen offset:1024 sc1 lds
 v_mfma_f32_16x16x32_bf16 v[192:195], v[64:67], a[56:59], v[192:195]
 s_waitcnt lgkmcnt(3)
 ds_read_b128 v[92:95], v1 offset:4096
 v_mfma_f32_16x16x32_bf16 v[196:199], v[64:67], a[60:63], v[196:199]
 buffer_load_dwordx4 v253, s[4:7], s65 offen offset:2048 sc1 lds
 v_mfma_f32_16x16x32_bf16 v[200:203], v[68:71], a[56:59], v[200:203]
 ds_read_b128 v[64:67], v1 offset:5120
 v_mfma_f32_16x16x32_bf16 v[204:207], v[68:71], a[60:63], v[204:207]
 s_mov_b32 s79, 0
 s_atomic_add s79, s[54:55], 512 glc
 v_mfma_f32_16x16x32_bf16 v[208:211], v[72:75], a[56:59], v[208:211]
 ds_read_b128 v[68:71], v1 offset:6144
 v_mfma_f32_16x16x32_bf16 v[212:215], v[72:75], a[60:63], v[212:215]
 buffer_load_dwordx4 v254, s[4:7], s65 offen offset:3072 sc1 lds
 v_mfma_f32_16x16x32_bf16 v[160:163], v[76:79], a[64:67], v[160:163]
 s_waitcnt lgkmcnt(3)
 ds_read_b128 v[72:75], v1 offset:7168
 v_mfma_f32_16x16x32_bf16 v[164:167], v[76:79], a[68:71], v[164:167]
 v_mfma_f32_16x16x32_bf16 v[168:171], v[80:83], a[64:67], v[168:171]
 ds_read_b128 v[76:79], v1 offset:8192
 v_mfma_f32_16x16x32_bf16 v[172:175], v[80:83], a[68:71], v[172:175]
 v_mfma_f32_16x16x32_bf16 v[176:179], v[84:87], a[64:67], v[176:179]
 ds_read_b128 v[80:83], v1 offset:9216
 v_mfma_f32_16x16x32_bf16 v[180:183], v[84:87], a[68:71], v[180:183]
 v_mfma_f32_16x16x32_bf16 v[184:187], v[88:91], a[64:67], v[184:187]
 s_waitcnt lgkmcnt(3)
 ds_read_b128 v[84:87], v1 offset:10240
 v_mfma_f32_16x16x32_bf16 v[188:191], v[88:91], a[68:71], v[188:191]
 v_mfma_f32_16x16x32_bf16 v[192:195], v[92:95], a[64:67], v[192:195]
 ds_read_b128 v[88:91], v1 offset:11264
 v_mfma_f32_16x16x32_bf16 v[196:199], v[92:95], a[68:71], v[196:199]
 v_mfma_f32_16x16x32_bf16 v[200:203], v[64:67], a[64:67], v[200:203]
 ds_read_b128 v[92:95], v1 offset:12288
 v_mfma_f32_16x16x32_bf16 v[204:207], v[64:67], a[68:71], v[204:207]
 v_mfma_f32_16x16x32_bf16 v[208:211], v[68:71], a[64:67], v[208:211]
 s_waitcnt lgkmcnt(3)
 ds_read_b128 v[64:67], v1 offset:13312
 v_mfma_f32_16x16x32_bf16 v[212:215], v[68:71], a[68:71], v[212:215]
 v_mfma_f32_16x16x32_bf16 v[160:163], v[72:75], a[72:75], v[160:163]
 s_barrier
 ds_read_b128 v[68:71], v1 offset:16384
 v_mfma_f32_16x16x32_bf16 v[164:167], v[72:75], a[76:79], v[164:167]
 s_add_u32 m0, s60, 0x20000
 s_bfe_u32 s34, s84, 0x40004
 s_mul_i32 s34, s34, 0x100
 v_mfma_f32_16x16x32_bf16 v[168:171], v[76:79], a[72:75], v[168:171]
 ds_read_b128 v[72:75], v1 offset:17408
 v_mfma_f32_16x16x32_bf16 v[172:175], v[76:79], a[76:79], v[172:175]
 buffer_load_dwordx4 v15, s[20:23], s34 offen offset:0  lds
 v_mfma_f32_16x16x32_bf16 v[176:179], v[80:83], a[72:75], v[176:179]
 s_waitcnt lgkmcnt(3)
 ds_read_b128 v[76:79], v1 offset:18432
 v_mfma_f32_16x16x32_bf16 v[180:183], v[80:83], a[76:79], v[180:183]
 buffer_load_dwordx4 v16, s[20:23], s34 offen offset:1024  lds
 v_mfma_f32_16x16x32_bf16 v[184:187], v[84:87], a[72:75], v[184:187]
 ds_read_b128 v[80:83], v1 offset:19456
 v_mfma_f32_16x16x32_bf16 v[188:191], v[84:87], a[76:79], v[188:191]
 buffer_load_dwordx4 v17, s[20:23], s34 offen offset:2048  lds
 v_mfma_f32_16x16x32_bf16 v[192:195], v[88:91], a[72:75], v[192:195]
 ds_read_b128 v[84:87], v1 offset:20480
 v_mfma_f32_16x16x32_bf16 v[196:199], v[88:91], a[76:79], v[196:199]
 v_mfma_f32_16x16x32_bf16 v[200:203], v[92:95], a[72:75], v[200:203]
 s_waitcnt lgkmcnt(3)
 ds_read_b128 v[88:91], v1 offset:21504
 v_mfma_f32_16x16x32_bf16 v[204:207], v[92:95], a[76:79], v[204:207]
 buffer_load_dwordx4 v18, s[20:23], s34 offen offset:3072  lds
 v_mfma_f32_16x16x32_bf16 v[208:211], v[64:67], a[72:75], v[208:211]
 ds_read_b128 v[92:95], v1 offset:22528
 v_mfma_f32_16x16x32_bf16 v[212:215], v[64:67], a[76:79], v[212:215]
 v_mfma_f32_16x16x32_bf16 v[160:163], v[68:71], a[80:83], v[160:163]
 ds_read_b128 v[64:67], v1 offset:23552
 v_mfma_f32_16x16x32_bf16 v[164:167], v[68:71], a[84:87], v[164:167]
 v_mfma_f32_16x16x32_bf16 v[168:171], v[72:75], a[80:83], v[168:171]
 s_waitcnt lgkmcnt(3)
 ds_read_b128 v[68:71], v1 offset:24576
 v_mfma_f32_16x16x32_bf16 v[172:175], v[72:75], a[84:87], v[172:175]
 v_mfma_f32_16x16x32_bf16 v[176:179], v[76:79], a[80:83], v[176:179]
 ds_read_b128 v[72:75], v1 offset:25600
 v_mfma_f32_16x16x32_bf16 v[180:183], v[76:79], a[84:87], v[180:183]
 v_mfma_f32_16x16x32_bf16 v[184:187], v[80:83], a[80:83], v[184:187]
 ds_read_b128 v[76:79], v1 offset:26624
 v_mfma_f32_16x16x32_bf16 v[188:191], v[80:83], a[84:87], v[188:191]
 v_mfma_f32_16x16x32_bf16 v[192:195], v[84:87], a[80:83], v[192:195]
 s_waitcnt lgkmcnt(3)
 ds_read_b128 v[80:83], v1 offset:27648
 v_mfma_f32_16x16x32_bf16 v[196:199], v[84:87], a[84:87], v[196:199]
 v_mfma_f32_16x16x32_bf16 v[200:203], v[88:91], a[80:83], v[200:203]
 ds_read_b128 v[84:87], v1 offset:28672
 v_mfma_f32_16x16x32_bf16 v[204:207], v[88:91], a[84:87], v[204:207]
 v_mfma_f32_16x16x32_bf16 v[208:211], v[92:95], a[80:83], v[208:211]
 ds_read_b128 v[88:91], v1 offset:29696
 v_mfma_f32_16x16x32_bf16 v[212:215], v[92:95], a[84:87], v[212:215]
 v_mfma_f32_16x16x32_bf16 v[160:163], v[64:67], a[88:91], v[160:163]
 s_waitcnt lgkmcnt(3)
 s_barrier
 ds_read_b128 v[92:95], v1 offset:32768
 v_mfma_f32_16x16x32_bf16 v[164:167], v[64:67], a[92:95], v[164:167]
 s_add_u32 m0, s60, 0x0
 s_bfe_u32 s65, s85, 0x40008
 s_mul_i32 s65, s65, 0x7000
 v_mfma_f32_16x16x32_bf16 v[168:171], v[68:71], a[88:91], v[168:171]
 s_add_u32 s65, s65, s17
 ds_read_b128 v[64:67], v1 offset:33792
 v_mfma_f32_16x16x32_bf16 v[172:175], v[68:71], a[92:95], v[172:175]
 buffer_load_dwordx4 v11, s[4:7], s65 offen offset:0 sc1 lds
 v_mfma_f32_16x16x32_bf16 v[176:179], v[72:75], a[88:91], v[176:179]
 ds_read_b128 v[68:71], v1 offset:34816
 v_mfma_f32_16x16x32_bf16 v[180:183], v[72:75], a[92:95], v[180:183]
 buffer_load_dwordx4 v252, s[4:7], s65 offen offset:1024 sc1 lds
 v_mfma_f32_16x16x32_bf16 v[184:187], v[76:79], a[88:91], v[184:187]
 s_waitcnt lgkmcnt(3)
 ds_read_b128 v[72:75], v1 offset:35840
 v_mfma_f32_16x16x32_bf16 v[188:191], v[76:79], a[92:95], v[188:191]
 buffer_load_dwordx4 v253, s[4:7], s65 offen offset:2048 sc1 lds
 v_mfma_f32_16x16x32_bf16 v[192:195], v[80:83], a[88:91], v[192:195]
 ds_read_b128 v[76:79], v1 offset:36864
 v_mfma_f32_16x16x32_bf16 v[196:199], v[80:83], a[92:95], v[196:199]
 s_mov_b32 s67, 0
mk_w19:
 s_waitcnt lgkmcnt(0)
 s_cmp_ge_u32 s79, 16
 s_cbranch_scc1 mk_d20
 s_mov_b32 s79, 0
 s_atomic_add s79, s[54:55], 512 glc
 s_add_u32 s67, s67, 1
 s_cmp_lt_u32 s67, 0x8000
 s_cbranch_scc1 mk_w19
mk_d20:
 v_mfma_f32_16x16x32_bf16 v[200:203], v[84:87], a[88:91], v[200:203]
 ds_read_b128 v[80:83], v1 offset:37888
 v_mfma_f32_16x16x32_bf16 v[204:207], v[84:87], a[92:95], v[204:207]
 buffer_load_dwordx4 v254, s[4:7], s65 offen offset:3072 sc1 lds
 v_mfma_f32_16x16x32_bf16 v[208:211], v[88:91], a[88:91], v[208:211]
 ds_read_b128 v[84:87], v1 offset:38912
 v_mfma_f32_16x16x32_bf16 v[212:215], v[88:91], a[92:95], v[212:215]
 v_mfma_f32_16x16x32_bf16 v[160:163], v[92:95], a[96:99], v[160:163]
 s_add_u32 s69, s42, 0x3880000
 ds_read_b128 v[88:91], v1 offset:39936
 v_mfma_f32_16x16x32_bf16 v[164:167], v[92:95], a[100:103], v[164:167]
 buffer_load_dwordx4 v[224:227], v1, s[4:7], s69 offen offset:0 sc1
 v_mfma_f32_16x16x32_bf16 v[168:171], v[64:67], a[96:99], v[168:171]
 ds_read_b128 v[92:95], v1 offset:40960
 v_mfma_f32_16x16x32_bf16 v[172:175], v[64:67], a[100:103], v[172:175]
 buffer_load_dwordx4 v[228:231], v1, s[4:7], s69 offen offset:1024 sc1
 v_mfma_f32_16x16x32_bf16 v[176:179], v[68:71], a[96:99], v[176:179]
 s_waitcnt lgkmcnt(3)
 ds_read_b128 v[64:67], v1 offset:41984
 v_mfma_f32_16x16x32_bf16 v[180:183], v[68:71], a[100:103], v[180:183]
 buffer_load_dwordx4 v[232:235], v1, s[4:7], s69 offen offset:2048 sc1
 v_mfma_f32_16x16x32_bf16 v[184:187], v[72:75], a[96:99], v[184:187]
 ds_read_b128 v[68:71], v1 offset:43008
 v_mfma_f32_16x16x32_bf16 v[188:191], v[72:75], a[100:103], v[188:191]
 buffer_load_dwordx4 v[236:239], v1, s[4:7], s69 offen offset:3072 sc1
 v_mfma_f32_16x16x32_bf16 v[192:195], v[76:79], a[96:99], v[192:195]
 ds_read_b128 v[72:75], v1 offset:44032
 v_mfma_f32_16x16x32_bf16 v[196:199], v[76:79], a[100:103], v[196:199]
 v_mfma_f32_16x16x32_bf16 v[200:203], v[80:83], a[96:99], v[200:203]
 s_waitcnt lgkmcnt(3)
 ds_read_b128 v[76:79], v1 offset:45056
 v_mfma_f32_16x16x32_bf16 v[204:207], v[80:83], a[100:103], v[204:207]
 v_mfma_f32_16x16x32_bf16 v[208:211], v[84:87], a[96:99], v[208:211]
 ds_read_b128 v[80:83], v1 offset:46080
 v_mfma_f32_16x16x32_bf16 v[212:215], v[84:87], a[100:103], v[212:215]
 v_add_u32 v61, mk_k5-mk_top+0, v249
 v_min_u32 v61, mk_end-mk_top, v61
 global_load_dword v255, v61, s[18:19]
 v_mfma_f32_16x16x32_bf16 v[160:163], v[88:91], a[104:107], v[160:163]
 s_waitcnt vmcnt(29)
 s_barrier
 ds_read_b128 v[84:87], v1 offset:49152
 v_mfma_f32_16x16x32_bf16 v[164:167], v[88:91], a[108:111], v[164:167]
 s_add_u32 m0, s60, 0x4000
 s_add_u32 s34, s34, 0x80
 v_mfma_f32_16x16x32_bf16 v[168:171], v[92:95], a[104:107], v[168:171]
 s_waitcnt lgkmcnt(3)
 ds_read_b128 v[88:91], v1 offset:50176
 v_mfma_f32_16x16x32_bf16 v[172:175], v[92:95], a[108:111], v[172:175]
 buffer_load_dwordx4 v15, s[20:23], s34 offen offset:0  lds
 v_mfma_f32_16x16x32_bf16 v[176:179], v[64:67], a[104:107], v[176:179]
 ds_read_b128 v[92:95], v1 offset:51200
 v_mfma_f32_16x16x32_bf16 v[180:183], v[64:67], a[108:111], v[180:183]
 buffer_load_dwordx4 v16, s[20:23], s34 offen offset:1024  lds
 v_mfma_f32_16x16x32_bf16 v[184:187], v[68:71], a[104:107], v[184:187]
 ds_read_b128 v[64:67], v1 offset:52224
 v_mfma_f32_16x16x32_bf16 v[188:191], v[68:71], a[108:111], v[188:191]
 v_mfma_f32_16x16x32_bf16 v[192:195], v[72:75], a[104:107], v[192:195]
 s_waitcnt lgkmcnt(3)
 ds_read_b128 v[68:71], v1 offset:53248
 v_mfma_f32_16x16x32_bf16 v[196:199], v[72:75], a[108:111], v[196:199]
 buffer_load_dwordx4 v17, s[20:23], s34 offen offset:2048  lds
 v_mfma_f32_16x16x32_bf16 v[200:203], v[76:79], a[104:107], v[200:203]
 ds_read_b128 v[72:75], v1 offset:54272
 v_mfma_f32_16x16x32_bf16 v[204:207], v[76:79], a[108:111], v[204:207]
 v_mfma_f32_16x16x32_bf16 v[208:211], v[80:83], a[104:107], v[208:211]
 ds_read_b128 v[76:79], v1 offset:55296
 v_mfma_f32_16x16x32_bf16 v[212:215], v[80:83], a[108:111], v[212:215]
 buffer_load_dwordx4 v18, s[20:23], s34 offen offset:3072  lds
 v_mfma_f32_16x16x32_bf16 v[160:163], v[84:87], a[112:115], v[160:163]
 s_waitcnt lgkmcnt(3)
 ds_read_b128 v[80:83], v1 offset:56320
 v_mfma_f32_16x16x32_bf16 v[164:167], v[84:87], a[116:119], v[164:167]
 v_mfma_f32_16x16x32_bf16 v[168:171], v[88:91], a[112:115], v[168:171]
 ds_read_b128 v[84:87], v1 offset:57344
 v_mfma_f32_16x16x32_bf16 v[172:175], v[88:91], a[116:119], v[172:175]
 s_waitcnt vmcnt(29)
 ds_read_b128 a[16:19], v36 offset:0
 v_mfma_f32_16x16x32_bf16 v[176:179], v[92:95], a[112:115], v[176:179]
 ds_read_b128 v[88:91], v1 offset:58368
 v_mfma_f32_16x16x32_bf16 v[180:183], v[92:95], a[116:119], v[180:183]
 v_mfma_f32_16x16x32_bf16 v[184:187], v[64:67], a[112:115], v[184:187]
 s_waitcnt lgkmcnt(4)
 ds_read_b128 v[92:95], v1 offset:59392
 v_mfma_f32_16x16x32_bf16 v[188:191], v[64:67], a[116:119], v[188:191]
 ds_read_b128 a[20:23], v36 offset:2048
 v_mfma_f32_16x16x32_bf16 v[192:195], v[68:71], a[112:115], v[192:195]
 ds_read_b128 v[64:67], v1 offset:60416
 v_mfma_f32_16x16x32_bf16 v[196:199], v[68:71], a[116:119], v[196:199]
 v_mfma_f32_16x16x32_bf16 v[200:203], v[72:75], a[112:115], v[200:203]
 ds_read_b128 v[68:71], v1 offset:61440
 v_mfma_f32_16x16x32_bf16 v[204:207], v[72:75], a[116:119], v[204:207]
 ds_read_b128 a[24:27], v37 offset:0
 v_mfma_f32_16x16x32_bf16 v[208:211], v[76:79], a[112:115], v[208:211]
 s_waitcnt lgkmcnt(5)
 ds_read_b128 v[72:75], v1 offset:62464
 v_mfma_f32_16x16x32_bf16 v[212:215], v[76:79], a[116:119], v[212:215]
 s_waitcnt vmcnt(5)
 v_pk_add_f32 v[224:225], v[224:225], v[228:229]
 v_pk_add_f32 v[232:233], v[232:233], v[236:237]
 v_pk_add_f32 v[226:227], v[226:227], v[230:231]
 v_pk_add_f32 v[234:235], v[234:235], v[238:239]
 v_pk_add_f32 v[224:225], v[224:225], v[232:233]
 v_pk_add_f32 v[226:227], v[226:227], v[234:235]
 s_nop 0
 v_permlane16_swap_b32 v224, v225
 v_permlane16_swap_b32 v226, v227
 v_add_f32 v224, v224, v225
 v_add_f32 v226, v226, v227
 s_nop 1
 v_permlane32_swap_b32 v224, v226
 v_add_f32 v224, v224, v226
 v_mov_b32 v225, v224
 v_cndmask_b32 v226, v42, v40, s[94:95]
 s_nop 0
 v_permlane32_swap_b32 v224, v225
 v_mul_f32 v226, v226, v226
 v_mul_f32 v224, 0xba124925, v224
 v_rcp_f32 v226, v226
 v_mul_f32 v225, 0x3a124925, v225
 v_fma_f32 v225, -v224, v224, v225
 v_mul_f32 v226, 0x3727c5ac, v226
 v_max_f32 v225, 0, v225
 v_add_f32 v225, v225, v226
 v_rsq_f32 v228, v225
 v_and_b32 v240, 3, v0
 v_lshlrev_b32 v240, 4, v240
 v_mul_f32 v230, v224, v228
 v_mov_b32 v229, v228
 v_mov_b32 v231, v230
 v_lshrrev_b32 v226, 5, v0
 v_lshl_add_u32 v240, v226, 6, v240
 v_permlane16_swap_b32 v228, v229
 v_permlane16_swap_b32 v230, v231
 v_bfe_u32 v226, v0, 3, 1
 v_lshl_add_u32 v240, v226, 8, v240
 v_bfe_u32 v226, v0, 2, 1
 v_lshl_add_u32 v240, v226, 9, v240
 v_bfe_u32 v226, v0, 4, 1
 v_lshl_add_u32 v241, v226, 10, v240
 v_lshl_add_u32 v240, v226, 11, v240
 v_pk_fma_f32 v[96:97], v[96:97], v[228:229], v[230:231] op_sel:[0,0,0] op_sel_hi:[1,0,0]
 v_pk_fma_f32 v[98:99], v[98:99], v[228:229], v[230:231] op_sel:[0,0,0] op_sel_hi:[1,0,0]
 v_pk_fma_f32 v[100:101], v[100:101], v[228:229], v[230:231] op_sel:[0,1,1] op_sel_hi:[1,1,1]
 v_pk_fma_f32 v[102:103], v[102:103], v[228:229], v[230:231] op_sel:[0,1,1] op_sel_hi:[1,1,1]
 v_pk_fma_f32 v[104:105], v[104:105], v[228:229], v[230:231] op_sel:[0,0,0] op_sel_hi:[1,0,0]
 v_pk_fma_f32 v[106:107], v[106:107], v[228:229], v[230:231] op_sel:[0,0,0] op_sel_hi:[1,0,0]
 v_pk_fma_f32 v[108:109], v[108:109], v[228:229], v[230:231] op_sel:[0,1,1] op_sel_hi:[1,1,1]
 v_pk_fma_f32 v[110:111], v[110:111], v[228:229], v[230:231] op_sel:[0,1,1] op_sel_hi:[1,1,1]
 v_pk_fma_f32 v[112:113], v[112:113], v[228:229], v[230:231] op_sel:[0,0,0] op_sel_hi:[1,0,0]
 v_pk_fma_f32 v[114:115], v[114:115], v[228:229], v[230:231] op_sel:[0,0,0] op_sel_hi:[1,0,0]
 v_pk_fma_f32 v[116:117], v[116:117], v[228:229], v[230:231] op_sel:[0,1,1] op_sel_hi:[1,1,1]
 v_pk_fma_f32 v[118:119], v[118:119], v[228:229], v[230:231] op_sel:[0,1,1] op_sel_hi:[1,1,1]
 v_pk_fma_f32 v[120:121], v[120:121], v[228:229], v[230:231] op_sel:[0,0,0] op_sel_hi:[1,0,0]
 v_pk_fma_f32 v[122:123], v[122:123], v[228:229], v[230:231] op_sel:[0,0,0] op_sel_hi:[1,0,0]
 v_pk_fma_f32 v[124:125], v[124:125], v[228:229], v[230:231] op_sel:[0,1,1] op_sel_hi:[1,1,1]
 v_pk_fma_f32 v[126:127], v[126:127], v[228:229], v[230:231] op_sel:[0,1,1] op_sel_hi:[1,1,1]
 v_pk_fma_f32 v[128:129], v[128:129], v[228:229], v[230:231] op_sel:[0,0,0] op_sel_hi:[1,0,0]
 v_pk_fma_f32 v[130:131], v[130:131], v[228:229], v[230:231] op_sel:[0,0,0] op_sel_hi:[1,0,0]
 v_pk_fma_f32 v[132:133], v[132:133], v[228:229], v[230:231] op_sel:[0,1,1] op_sel_hi:[1,1,1]
 v_pk_fma_f32 v[134:135], v[134:135], v[228:229], v[230:231] op_sel:[0,1,1] op_sel_hi:[1,1,1]
 v_pk_fma_f32 v[136:137], v[136:137], v[228:229], v[230:231] op_sel:[0,0,0] op_sel_hi:[1,0,0]
 v_pk_fma_f32 v[138:139], v[138:139], v[228:229], v[230:231] op_sel:[0,0,0] op_sel_hi:[1,0,0]
 v_pk_fma_f32 v[140:141], v[140:141], v[228:229], v[230:231] op_sel:[0,1,1] op_sel_hi:[1,1,1]
 v_pk_fma_f32 v[142:143], v[142:143], v[228:229], v[230:231] op_sel:[0,1,1] op_sel_hi:[1,1,1]
 v_pk_fma_f32 v[144:145], v[144:145], v[228:229], v[230:231] op_sel:[0,0,0] op_sel_hi:[1,0,0]
 v_pk_fma_f32 v[146:147], v[146:147], v[228:229], v[230:231] op_sel:[0,0,0] op_sel_hi:[1,0,0]
 v_pk_fma_f32 v[148:149], v[148:149], v[228:229], v[230:231] op_sel:[0,1,1] op_sel_hi:[1,1,1]
 v_pk_fma_f32 v[150:151], v[150:151], v[228:229], v[230:231] op_sel:[0,1,1] op_sel_hi:[1,1,1]
 v_cvt_pk_bf16_f32 v96, v96, v97
 v_cvt_pk_bf16_f32 v97, v98, v99
 v_cvt_pk_bf16_f32 v98, v104, v105
 v_cvt_pk_bf16_f32 v99, v106, v107
 v_cvt_pk_bf16_f32 v100, v100, v101
 v_cvt_pk_bf16_f32 v101, v102, v103
 v_cvt_pk_bf16_f32 v102, v108, v109
 v_cvt_pk_bf16_f32 v103, v110, v111
 v_cvt_pk_bf16_f32 v112, v112, v113
 v_cvt_pk_bf16_f32 v113, v114, v115
 v_cvt_pk_bf16_f32 v114, v120, v121
 v_cvt_pk_bf16_f32 v115, v122, v123
 v_cvt_pk_bf16_f32 v116, v116, v117
 v_cvt_pk_bf16_f32 v117, v118, v119
 v_cvt_pk_bf16_f32 v118, v124, v125
 v_cvt_pk_bf16_f32 v119, v126, v127
 v_cvt_pk_bf16_f32 v128, v128, v129
 v_cvt_pk_bf16_f32 v129, v130, v131
 v_cvt_pk_bf16_f32 v130, v136, v137
 v_cvt_pk_bf16_f32 v131, v138, v139
 v_cvt_pk_bf16_f32 v132, v132, v133
 v_cvt_pk_bf16_f32 v133, v134, v135
 v_cvt_pk_bf16_f32 v134, v140, v141
 v_cvt_pk_bf16_f32 v135, v142, v143
 v_cvt_pk_bf16_f32 v144, v144, v145
 v_cvt_pk_bf16_f32 v145, v146, v147
 v_cvt_pk_bf16_f32 v146, v148, v149
 v_cvt_pk_bf16_f32 v147, v150, v151
 v_permlane16_swap_b32 v96, v98
 v_permlane16_swap_b32 v97, v99
 v_permlane16_swap_b32 v100, v102
 v_permlane16_swap_b32 v101, v103
 v_permlane16_swap_b32 v112, v114
 v_permlane16_swap_b32 v113, v115
 v_permlane16_swap_b32 v116, v118
 v_permlane16_swap_b32 v117, v119
 v_permlane16_swap_b32 v128, v130
 v_permlane16_swap_b32 v129, v131
 v_permlane16_swap_b32 v132, v134
 v_permlane16_swap_b32 v133, v135
 v_permlane16_swap_b32 v144, v146
 v_permlane16_swap_b32 v145, v147
 v_mfma_f32_16x16x32_bf16 v[160:163], v[80:83], a[120:123], v[160:163]
 s_barrier
 ds_read_b128 v[76:79], v12 offset:16384
 v_mfma_f32_16x16x32_bf16 v[164:167], v[80:83], a[124:127], v[164:167]
 ds_read_b128 a[28:31], v37 offset:2048
 s_add_u32 m0, s60, 0x8000
 v_mfma_f32_16x16x32_bf16 v[168:171], v[84:87], a[120:123], v[168:171]
 s_bfe_u32 s65, s85, 0x4000c
 ds_read_b128 v[80:83], v12 offset:17408
 v_mfma_f32_16x16x32_bf16 v[172:175], v[84:87], a[124:127], v[172:175]
 s_mul_i32 s65, s65, 0x7000
 s_add_u32 s65, s65, s17
 v_mfma_f32_16x16x32_bf16 v[176:179], v[88:91], a[120:123], v[176:179]
 s_waitcnt lgkmcnt(5)
 ds_read_b128 v[84:87], v12 offset:18432
 v_mfma_f32_16x16x32_bf16 v[180:183], v[88:91], a[124:127], v[180:183]
 buffer_load_dwordx4 v11, s[4:7], s65 offen offset:0 sc1 lds
 v_mfma_f32_16x16x32_bf16 v[184:187], v[92:95], a[120:123], v[184:187]
 ds_read_b128 v[88:91], v12 offset:19456
 v_mfma_f32_16x16x32_bf16 v[188:191], v[92:95], a[124:127], v[188:191]
 buffer_load_dwordx4 v252, s[4:7], s65 offen offset:1024 sc1 lds
 v_mfma_f32_16x16x32_bf16 v[192:195], v[64:67], a[120:123], v[192:195]
 ds_read_b128 v[92:95], v12 offset:20480
 v_mfma_f32_16x16x32_bf16 v[196:199], v[64:67], a[124:127], v[196:199]
 buffer_load_dwordx4 v253, s[4:7], s65 offen offset:2048 sc1 lds
 v_mfma_f32_16x16x32_bf16 v[200:203], v[68:71], a[120:123], v[200:203]
 s_waitcnt lgkmcnt(3)
 ds_read_b128 v[64:67], v12 offset:21504
 v_mfma_f32_16x16x32_bf16 v[204:207], v[68:71], a[124:127], v[204:207]
 v_mfma_f32_16x16x32_bf16 v[208:211], v[72:75], a[120:123], v[208:211]
 s_add_u32 s69, s44, 0x1800000
 ds_read_b128 v[68:71], v12 offset:22528
 v_mfma_f32_16x16x32_bf16 v[212:215], v[72:75], a[124:127], v[212:215]
 buffer_store_dwordx4 v[96:99], v240, s[4:7], s69 offen offset:0 sc1
 v_mfma_f32_16x16x32_bf16 v[160:163], v[76:79], a[128:131], v[160:163]
 ds_read_b128 v[72:75], v12 offset:23552
 v_mfma_f32_16x16x32_bf16 v[164:167], v[76:79], a[132:135], v[164:167]
 v_mfma_f32_16x16x32_bf16 v[168:171], v[80:83], a[128:131], v[168:171]
 s_waitcnt lgkmcnt(3)
 ds_read_b128 v[76:79], v12 offset:24576
 v_mfma_f32_16x16x32_bf16 v[172:175], v[80:83], a[132:135], v[172:175]
 buffer_store_dwordx4 v[100:103], v240, s[4:7], s69 offen offset:1024 sc1
 v_mfma_f32_16x16x32_bf16 v[176:179], v[84:87], a[128:131], v[176:179]
 ds_read_b128 v[80:83], v12 offset:25600
 v_mfma_f32_16x16x32_bf16 v[180:183], v[84:87], a[132:135], v[180:183]
 ds_read_b128 a[32:35], v36 offset:32768
 v_mfma_f32_16x16x32_bf16 v[184:187], v[88:91], a[128:131], v[184:187]
 ds_read_b128 v[84:87], v12 offset:26624
 v_mfma_f32_16x16x32_bf16 v[188:191], v[88:91], a[132:135], v[188:191]
 buffer_load_dwordx4 v254, s[4:7], s65 offen offset:3072 sc1 lds
 v_mfma_f32_16x16x32_bf16 v[192:195], v[92:95], a[128:131], v[192:195]
 s_waitcnt lgkmcnt(4)
 ds_read_b128 v[88:91], v12 offset:27648
 v_mfma_f32_16x16x32_bf16 v[196:199], v[92:95], a[132:135], v[196:199]
 ds_read_b128 a[36:39], v36 offset:34816
 s_add_u32 m0, s60, 0x10000
 v_mfma_f32_16x16x32_bf16 v[200:203], v[64:67], a[128:131], v[200:203]
 s_bfe_u32 s65, s85, 0x40010
 ds_read_b128 v[92:95], v12 offset:28672
 v_mfma_f32_16x16x32_bf16 v[204:207], v[64:67], a[132:135], v[204:207]
 ds_read_b128 a[40:43], v37 offset:32768
 s_mul_i32 s65, s65, 0x7000
 v_mfma_f32_16x16x32_bf16 v[208:211], v[68:71], a[128:131], v[208:211]
 s_add_u32 s65, s65, s17
 ds_read_b128 v[64:67], v12 offset:29696
 v_mfma_f32_16x16x32_bf16 v[212:215], v[68:71], a[132:135], v[212:215]
 buffer_load_dwordx4 v11, s[4:7], s65 offen offset:0 sc1 lds
 v_mfma_f32_16x16x32_bf16 v[160:163], v[72:75], a[136:139], v[160:163]
 s_waitcnt lgkmcnt(5)
 s_barrier
 ds_read_b128 v[68:71], v12 offset:49152
 v_mfma_f32_16x16x32_bf16 v[164:167], v[72:75], a[140:143], v[164:167]
 buffer_load_dwordx4 v252, s[4:7], s65 offen offset:1024 sc1 lds
 v_mfma_f32_16x16x32_bf16 v[168:171], v[76:79], a[136:139], v[168:171]
 ds_read_b128 v[72:75], v12 offset:50176
 v_mfma_f32_16x16x32_bf16 v[172:175], v[76:79], a[140:143], v[172:175]
 ds_read_b128 a[44:47], v37 offset:34816
 v_mfma_f32_16x16x32_bf16 v[176:179], v[80:83], a[136:139], v[176:179]
 ds_read_b128 v[76:79], v12 offset:51200
 v_mfma_f32_16x16x32_bf16 v[180:183], v[80:83], a[140:143], v[180:183]
 buffer_load_dwordx4 v253, s[4:7], s65 offen offset:2048 sc1 lds
 v_mfma_f32_16x16x32_bf16 v[184:187], v[84:87], a[136:139], v[184:187]
 s_waitcnt lgkmcnt(4)
 ds_read_b128 v[80:83], v12 offset:52224
 v_mfma_f32_16x16x32_bf16 v[188:191], v[84:87], a[140:143], v[188:191]
 buffer_load_dwordx4 v254, s[4:7], s65 offen offset:3072 sc1 lds
 v_mfma_f32_16x16x32_bf16 v[192:195], v[88:91], a[136:139], v[192:195]
 s_add_u32 m0, s60, 0xc000
 ds_read_b128 v[84:87], v12 offset:53248
 v_mfma_f32_16x16x32_bf16 v[196:199], v[88:91], a[140:143], v[196:199]
 s_bfe_u32 s34, s84, 0x40008
 s_mul_i32 s34, s34, 0x100
 v_mfma_f32_16x16x32_bf16 v[200:203], v[92:95], a[136:139], v[200:203]
 ds_read_b128 v[88:91], v12 offset:54272
 v_mfma_f32_16x16x32_bf16 v[204:207], v[92:95], a[140:143], v[204:207]
 buffer_load_dwordx4 v15, s[20:23], s34 offen offset:0  lds
 v_mfma_f32_16x16x32_bf16 v[208:211], v[64:67], a[136:139], v[208:211]
 s_waitcnt lgkmcnt(3)
 ds_read_b128 v[92:95], v12 offset:55296
 v_mfma_f32_16x16x32_bf16 v[212:215], v[64:67], a[140:143], v[212:215]
 v_mfma_f32_16x16x32_bf16 v[160:163], v[68:71], a[144:147], v[160:163]
 s_add_u32 s69, s44, 0x1801000
 ds_read_b128 v[64:67], v12 offset:56320
 v_mfma_f32_16x16x32_bf16 v[164:167], v[68:71], a[148:151], v[164:167]
 buffer_store_dwordx4 v[112:115], v240, s[4:7], s69 offen offset:0 sc1
 v_mfma_f32_16x16x32_bf16 v[168:171], v[72:75], a[144:147], v[168:171]
 ds_read_b128 v[68:71], v12 offset:57344
 v_mfma_f32_16x16x32_bf16 v[172:175], v[72:75], a[148:151], v[172:175]
 ds_read_b128 a[48:51], v38 offset:0
 v_mfma_f32_16x16x32_bf16 v[176:179], v[76:79], a[144:147], v[176:179]
 s_waitcnt lgkmcnt(4)
 ds_read_b128 v[72:75], v12 offset:58368
 v_mfma_f32_16x16x32_bf16 v[180:183], v[76:79], a[148:151], v[180:183]
 buffer_store_dwordx4 v[116:119], v240, s[4:7], s69 offen offset:1024 sc1
 v_mfma_f32_16x16x32_bf16 v[184:187], v[80:83], a[144:147], v[184:187]
 s_add_u32 s69, s44, 0x1802000
 ds_read_b128 v[76:79], v12 offset:59392
 v_mfma_f32_16x16x32_bf16 v[188:191], v[80:83], a[148:151], v[188:191]
 buffer_store_dwordx4 v[128:131], v240, s[4:7], s69 offen offset:0 sc1
 v_mfma_f32_16x16x32_bf16 v[192:195], v[84:87], a[144:147], v[192:195]
 ds_read_b128 v[80:83], v12 offset:60416
 v_mfma_f32_16x16x32_bf16 v[196:199], v[84:87], a[148:151], v[196:199]
 ds_read_b128 a[52:55], v38 offset:2048
 v_mfma_f32_16x16x32_bf16 v[200:203], v[88:91], a[144:147], v[200:203]
 s_waitcnt lgkmcnt(5)
 ds_read_b128 v[84:87], v12 offset:61440
 v_mfma_f32_16x16x32_bf16 v[204:207], v[88:91], a[148:151], v[204:207]
 buffer_load_dwordx4 v16, s[20:23], s34 offen offset:1024  lds
 v_mfma_f32_16x16x32_bf16 v[208:211], v[92:95], a[144:147], v[208:211]
 ds_read_b128 v[88:91], v12 offset:62464
 v_mfma_f32_16x16x32_bf16 v[212:215], v[92:95], a[148:151], v[212:215]
 ds_read_b128 a[56:59], v39 offset:0
 v_mfma_f32_16x16x32_bf16 v[160:163], v[64:67], a[152:155], v[160:163]
 s_barrier
 ds_read_b128 v[92:95], v1 offset:0
 v_mfma_f32_16x16x32_bf16 v[164:167], v[64:67], a[156:159], v[164:167]
 buffer_load_dwordx4 v17, s[20:23], s34 offen offset:2048  lds
 v_mfma_f32_16x16x32_bf16 v[168:171], v[68:71], a[152:155], v[168:171]
 s_waitcnt lgkmcnt(5)
 ds_read_b128 v[64:67], v1 offset:1024
 v_mfma_f32_16x16x32_bf16 v[172:175], v[68:71], a[156:159], v[172:175]
 ds_read_b128 a[60:63], v39 offset:2048
 v_mfma_f32_16x16x32_bf16 v[176:179], v[72:75], a[152:155], v[176:179]
 ds_read_b128 v[68:71], v1 offset:2048
 v_mfma_f32_16x16x32_bf16 v[180:183], v[72:75], a[156:159], v[180:183]
 buffer_load_dwordx4 v18, s[20:23], s34 offen offset:3072  lds
 v_mfma_f32_16x16x32_bf16 v[184:187], v[76:79], a[152:155], v[184:187]
 s_add_u32 m0, s60, 0x14000
 ds_read_b128 v[72:75], v1 offset:3072
 v_mfma_f32_16x16x32_bf16 v[188:191], v[76:79], a[156:159], v[188:191]
 s_add_u32 s34, s34, 0x80
 v_mfma_f32_16x16x32_bf16 v[192:195], v[80:83], a[152:155], v[192:195]
 s_waitcnt lgkmcnt(4)
 ds_read_b128 v[76:79], v1 offset:4096
 v_mfma_f32_16x16x32_bf16 v[196:199], v[80:83], a[156:159], v[196:199]
 buffer_load_dwordx4 v15, s[20:23], s34 offen offset:0  lds
 v_mfma_f32_16x16x32_bf16 v[200:203], v[84:87], a[152:155], v[200:203]
 ds_read_b128 v[80:83], v1 offset:5120
 v_mfma_f32_16x16x32_bf16 v[204:207], v[84:87], a[156:159], v[204:207]
 buffer_store_dwordx4 v[132:135], v240, s[4:7], s69 offen offset:1024 sc1
 v_mfma_f32_16x16x32_bf16 v[208:211], v[88:91], a[152:155], v[208:211]
 s_add_u32 s69, s44, 0x1803000
 ds_read_b128 v[84:87], v1 offset:6144
 v_mfma_f32_16x16x32_bf16 v[212:215], v[88:91], a[156:159], v[212:215]
 s_waitcnt lgkmcnt(5)
 v_mfma_f32_16x16x32_bf16 v[160:163], v[92:95], a[160:163], v[160:163]
 s_waitcnt lgkmcnt(3)
 ds_read_b128 v[88:91], v1 offset:7168
 v_mfma_f32_16x16x32_bf16 v[164:167], v[92:95], a[164:167], v[164:167]
 buffer_store_dwordx4 v[144:147], v241, s[4:7], s69 offen offset:0 sc1
 v_mfma_f32_16x16x32_bf16 v[168:171], v[64:67], a[160:163], v[168:171]
 ds_read_b128 v[92:95], v1 offset:8192
 v_mfma_f32_16x16x32_bf16 v[172:175], v[64:67], a[164:167], v[172:175]
 s_waitcnt vmcnt(20)
 ds_read_b128 a[64:67], v34 offset:16384
 v_mfma_f32_16x16x32_bf16 v[176:179], v[68:71], a[160:163], v[176:179]
 ds_read_b128 v[64:67], v1 offset:9216
 v_mfma_f32_16x16x32_bf16 v[180:183], v[68:71], a[164:167], v[180:183]
 buffer_load_dwordx4 v16, s[20:23], s34 offen offset:1024  lds
 v_mfma_f32_16x16x32_bf16 v[184:187], v[72:75], a[160:163], v[184:187]
 s_waitcnt lgkmcnt(4)
 ds_read_b128 v[68:71], v1 offset:10240
 v_mfma_f32_16x16x32_bf16 v[188:191], v[72:75], a[164:167], v[188:191]
 ds_read_b128 a[68:71], v34 offset:18432
 v_mfma_f32_16x16x32_bf16 v[192:195], v[76:79], a[160:163], v[192:195]
 ds_read_b128 v[72:75], v1 offset:11264
 v_mfma_f32_16x16x32_bf16 v[196:199], v[76:79], a[164:167], v[196:199]
 buffer_load_dwordx4 v17, s[20:23], s34 offen offset:2048  lds
 v_mfma_f32_16x16x32_bf16 v[200:203], v[80:83], a[160:163], v[200:203]
 ds_read_b128 v[76:79], v1 offset:12288
 v_mfma_f32_16x16x32_bf16 v[204:207], v[80:83], a[164:167], v[204:207]
 ds_read_b128 a[72:75], v35 offset:16384
 v_mfma_f32_16x16x32_bf16 v[208:211], v[84:87], a[160:163], v[208:211]
 s_waitcnt lgkmcnt(5)
 ds_read_b128 v[80:83], v1 offset:13312
 v_mfma_f32_16x16x32_bf16 v[212:215], v[84:87], a[164:167], v[212:215]
 buffer_load_dwordx4 v18, s[20:23], s34 offen offset:3072  lds
 v_mfma_f32_16x16x32_bf16 v[160:163], v[88:91], a[168:171], v[160:163]
 s_add_u32 m0, s60, 0x18000
 s_waitcnt vmcnt(17)
 s_barrier
 ds_read_b128 v[84:87], v1 offset:32768
 v_mfma_f32_16x16x32_bf16 v[164:167], v[88:91], a[172:175], v[164:167]
 ds_read_b128 a[76:79], v35 offset:18432
 s_bfe_u32 s65, s85, 0x40014
 v_mfma_f32_16x16x32_bf16 v[168:171], v[92:95], a[168:171], v[168:171]
 s_mul_i32 s65, s65, 0x7000
 ds_read_b128 v[88:91], v1 offset:33792
 v_mfma_f32_16x16x32_bf16 v[172:175], v[92:95], a[172:175], v[172:175]
 s_add_u32 s65, s65, s17
 v_mfma_f32_16x16x32_bf16 v[176:179], v[64:67], a[168:171], v[176:179]
 s_waitcnt lgkmcnt(5)
 ds_read_b128 v[92:95], v1 offset:34816
 v_mfma_f32_16x16x32_bf16 v[180:183], v[64:67], a[172:175], v[180:183]
 buffer_load_dwordx4 v11, s[4:7], s65 offen offset:0 sc1 lds
 v_mfma_f32_16x16x32_bf16 v[184:187], v[68:71], a[168:171], v[184:187]
 ds_read_b128 v[64:67], v1 offset:35840
 v_mfma_f32_16x16x32_bf16 v[188:191], v[68:71], a[172:175], v[188:191]
 buffer_load_dwordx4 v252, s[4:7], s65 offen offset:1024 sc1 lds
 v_mfma_f32_16x16x32_bf16 v[192:195], v[72:75], a[168:171], v[192:195]
 ds_read_b128 v[68:71], v1 offset:36864
 v_mfma_f32_16x16x32_bf16 v[196:199], v[72:75], a[172:175], v[196:199]
 buffer_load_dwordx4 v253, s[4:7], s65 offen offset:2048 sc1 lds
 v_mfma_f32_16x16x32_bf16 v[200:203], v[76:79], a[168:171], v[200:203]
 s_waitcnt lgkmcnt(3)
 ds_read_b128 v[72:75], v1 offset:37888
 v_mfma_f32_16x16x32_bf16 v[204:207], v[76:79], a[172:175], v[204:207]
 v_mfma_f32_16x16x32_bf16 v[208:211], v[80:83], a[168:171], v[208:211]
 ds_read_b128 v[76:79], v1 offset:38912
 v_mfma_f32_16x16x32_bf16 v[212:215], v[80:83], a[172:175], v[212:215]
 buffer_load_dwordx4 v254, s[4:7], s65 offen offset:3072 sc1 lds
 v_mfma_f32_16x16x32_bf16 v[160:163], v[84:87], a[176:179], v[160:163]
 s_add_u32 m0, s60, 0x1c000
 ds_read_b128 v[80:83], v1 offset:39936
 v_mfma_f32_16x16x32_bf16 v[164:167], v[84:87], a[180:183], v[164:167]
 s_bfe_u32 s34, s84, 0x4000c
 s_mul_i32 s34, s34, 0x100
 v_mfma_f32_16x16x32_bf16 v[168:171], v[88:91], a[176:179], v[168:171]
 s_waitcnt lgkmcnt(3)
 ds_read_b128 v[84:87], v1 offset:40960
 v_mfma_f32_16x16x32_bf16 v[172:175], v[88:91], a[180:183], v[172:175]
 buffer_load_dwordx4 v15, s[20:23], s34 offen offset:0  lds
 v_mfma_f32_16x16x32_bf16 v[176:179], v[92:95], a[176:179], v[176:179]
 ds_read_b128 v[88:91], v1 offset:41984
 v_mfma_f32_16x16x32_bf16 v[180:183], v[92:95], a[180:183], v[180:183]
 s_waitcnt vmcnt(11)
 ds_read_b128 a[80:83], v34 offset:49152
 v_mfma_f32_16x16x32_bf16 v[184:187], v[64:67], a[176:179], v[184:187]
 ds_read_b128 v[92:95], v1 offset:43008
 v_mfma_f32_16x16x32_bf16 v[188:191], v[64:67], a[180:183], v[188:191]
 buffer_load_dwordx4 v16, s[20:23], s34 offen offset:1024  lds
 v_mfma_f32_16x16x32_bf16 v[192:195], v[68:71], a[176:179], v[192:195]
 s_waitcnt lgkmcnt(4)
 ds_read_b128 v[64:67], v1 offset:44032
 v_mfma_f32_16x16x32_bf16 v[196:199], v[68:71], a[180:183], v[196:199]
 ds_read_b128 a[84:87], v34 offset:51200
 v_mfma_f32_16x16x32_bf16 v[200:203], v[72:75], a[176:179], v[200:203]
 ds_read_b128 v[68:71], v1 offset:45056
 v_mfma_f32_16x16x32_bf16 v[204:207], v[72:75], a[180:183], v[204:207]
 buffer_load_dwordx4 v17, s[20:23], s34 offen offset:2048  lds
 v_mfma_f32_16x16x32_bf16 v[208:211], v[76:79], a[176:179], v[208:211]
 ds_read_b128 v[72:75], v1 offset:46080
 v_mfma_f32_16x16x32_bf16 v[212:215], v[76:79], a[180:183], v[212:215]
 ds_read_b128 a[88:91], v35 offset:49152
 v_mfma_f32_16x16x32_bf16 v[160:163], v[80:83], a[184:187], v[160:163]
 s_waitcnt lgkmcnt(5)
 s_barrier
 ds_read_b128 v[76:79], v12 offset:0
 v_mfma_f32_16x16x32_bf16 v[164:167], v[80:83], a[188:191], v[164:167]
 buffer_load_dwordx4 v18, s[20:23], s34 offen offset:3072  lds
 v_mfma_f32_16x16x32_bf16 v[168:171], v[84:87], a[184:187], v[168:171]
 s_add_u32 m0, s60, 0x20000
 ds_read_b128 v[80:83], v12 offset:1024
 v_mfma_f32_16x16x32_bf16 v[172:175], v[84:87], a[188:191], v[172:175]
 ds_read_b128 a[92:95], v35 offset:51200
 s_bfe_u32 s65, s85, 0x40018
 v_mfma_f32_16x16x32_bf16 v[176:179], v[88:91], a[184:187], v[176:179]
 s_mul_i32 s65, s65, 0x7000
 ds_read_b128 v[84:87], v12 offset:2048
 v_mfma_f32_16x16x32_bf16 v[180:183], v[88:91], a[188:191], v[180:183]
 s_add_u32 s65, s65, s17
 v_mfma_f32_16x16x32_bf16 v[184:187], v[92:95], a[184:187], v[184:187]
 s_waitcnt lgkmcnt(5)
 ds_read_b128 v[88:91], v12 offset:3072
 v_mfma_f32_16x16x32_bf16 v[188:191], v[92:95], a[188:191], v[188:191]
 buffer_load_dwordx4 v11, s[4:7], s65 offen offset:0 sc1 lds
 v_mfma_f32_16x16x32_bf16 v[192:195], v[64:67], a[184:187], v[192:195]
 ds_read_b128 v[92:95], v12 offset:4096
 v_mfma_f32_16x16x32_bf16 v[196:199], v[64:67], a[188:191], v[196:199]
 buffer_load_dwordx4 v252, s[4:7], s65 offen offset:1024 sc1 lds
 v_mfma_f32_16x16x32_bf16 v[200:203], v[68:71], a[184:187], v[200:203]
 ds_read_b128 v[64:67], v12 offset:5120
 v_mfma_f32_16x16x32_bf16 v[204:207], v[68:71], a[188:191], v[204:207]
 buffer_load_dwordx4 v253, s[4:7], s65 offen offset:2048 sc1 lds
 v_mfma_f32_16x16x32_bf16 v[208:211], v[72:75], a[184:187], v[208:211]
 s_waitcnt lgkmcnt(3)
 ds_read_b128 v[68:71], v12 offset:6144
 v_mfma_f32_16x16x32_bf16 v[212:215], v[72:75], a[188:191], v[212:215]
 v_mfma_f32_16x16x32_bf16 v[160:163], v[76:79], a[192:195], v[160:163]
 ds_read_b128 v[72:75], v12 offset:7168
 v_mfma_f32_16x16x32_bf16 v[164:167], v[76:79], a[196:199], v[164:167]
 buffer_load_dwordx4 v254, s[4:7], s65 offen offset:3072 sc1 lds
 v_mfma_f32_16x16x32_bf16 v[168:171], v[80:83], a[192:195], v[168:171]
 s_add_u32 m0, s60, 0x0
 ds_read_b128 v[76:79], v12 offset:8192
 v_mfma_f32_16x16x32_bf16 v[172:175], v[80:83], a[196:199], v[172:175]
 s_waitcnt vmcnt(12)
 ds_read_b128 a[96:99], v36 offset:16384
 s_add_u32 s34, s34, 0x80
 v_mfma_f32_16x16x32_bf16 v[176:179], v[84:87], a[192:195], v[176:179]
 s_waitcnt lgkmcnt(4)
 ds_read_b128 v[80:83], v12 offset:9216
 v_mfma_f32_16x16x32_bf16 v[180:183], v[84:87], a[196:199], v[180:183]
 buffer_load_dwordx4 v15, s[20:23], s34 offen offset:0  lds
 v_mfma_f32_16x16x32_bf16 v[184:187], v[88:91], a[192:195], v[184:187]
 ds_read_b128 v[84:87], v12 offset:10240
 v_mfma_f32_16x16x32_bf16 v[188:191], v[88:91], a[196:199], v[188:191]
 ds_read_b128 a[100:103], v36 offset:18432
 v_mfma_f32_16x16x32_bf16 v[192:195], v[92:95], a[192:195], v[192:195]
 ds_read_b128 v[88:91], v12 offset:11264
 v_mfma_f32_16x16x32_bf16 v[196:199], v[92:95], a[196:199], v[196:199]
 buffer_load_dwordx4 v16, s[20:23], s34 offen offset:1024  lds
 v_mfma_f32_16x16x32_bf16 v[200:203], v[64:67], a[192:195], v[200:203]
 s_waitcnt lgkmcnt(5)
 ds_read_b128 v[92:95], v12 offset:12288
 v_mfma_f32_16x16x32_bf16 v[204:207], v[64:67], a[196:199], v[204:207]
 ds_read_b128 a[104:107], v37 offset:16384
 v_mfma_f32_16x16x32_bf16 v[208:211], v[68:71], a[192:195], v[208:211]
 ds_read_b128 v[64:67], v12 offset:13312
 v_mfma_f32_16x16x32_bf16 v[212:215], v[68:71], a[196:199], v[212:215]
 buffer_load_dwordx4 v17, s[20:23], s34 offen offset:2048  lds
 v_mfma_f32_16x16x32_bf16 v[160:163], v[72:75], a[200:203], v[160:163]
 s_waitcnt vmcnt(11)
 s_barrier
 ds_read_b128 v[68:71], v12 offset:32768
 v_mfma_f32_16x16x32_bf16 v[164:167], v[72:75], a[204:207], v[164:167]
 buffer_load_dwordx4 v18, s[20:23], s34 offen offset:3072  lds
 v_mfma_f32_16x16x32_bf16 v[168:171], v[76:79], a[200:203], v[168:171]
 s_waitcnt lgkmcnt(4)
 ds_read_b128 v[72:75], v12 offset:33792
 v_mfma_f32_16x16x32_bf16 v[172:175], v[76:79], a[204:207], v[172:175]
 ds_read_b128 a[108:111], v37 offset:18432
 s_add_u32 m0, s60, 0x4000
 v_mfma_f32_16x16x32_bf16 v[176:179], v[80:83], a[200:203], v[176:179]
 s_bfe_u32 s65, s85, 0x4001c
 ds_read_b128 v[76:79], v12 offset:34816
 v_mfma_f32_16x16x32_bf16 v[180:183], v[80:83], a[204:207], v[180:183]
 s_mul_i32 s65, s65, 0x7000
 s_add_u32 s65, s65, s17
 v_mfma_f32_16x16x32_bf16 v[184:187], v[84:87], a[200:203], v[184:187]
 ds_read_b128 v[80:83], v12 offset:35840
 v_mfma_f32_16x16x32_bf16 v[188:191], v[84:87], a[204:207], v[188:191]
 buffer_load_dwordx4 v11, s[4:7], s65 offen offset:0 sc1 lds
 v_mfma_f32_16x16x32_bf16 v[192:195], v[88:91], a[200:203], v[192:195]
 s_waitcnt lgkmcnt(4)
 ds_read_b128 v[84:87], v12 offset:36864
 v_mfma_f32_16x16x32_bf16 v[196:199], v[88:91], a[204:207], v[196:199]
 buffer_load_dwordx4 v252, s[4:7], s65 offen offset:1024 sc1 lds
 v_mfma_f32_16x16x32_bf16 v[200:203], v[92:95], a[200:203], v[200:203]
 ds_read_b128 v[88:91], v12 offset:37888
 v_mfma_f32_16x16x32_bf16 v[204:207], v[92:95], a[204:207], v[204:207]
 v_mfma_f32_16x16x32_bf16 v[208:211], v[64:67], a[200:203], v[208:211]
 ds_read_b128 v[92:95], v12 offset:38912
 v_mfma_f32_16x16x32_bf16 v[212:215], v[64:67], a[204:207], v[212:215]
 buffer_load_dwordx4 v253, s[4:7], s65 offen offset:2048 sc1 lds
 v_mfma_f32_16x16x32_bf16 v[160:163], v[68:71], a[208:211], v[160:163]
 s_waitcnt lgkmcnt(3)
 ds_read_b128 v[64:67], v12 offset:39936
 v_mfma_f32_16x16x32_bf16 v[164:167], v[68:71], a[212:215], v[164:167]
 s_atomic_add s93, s[58:59], 0
 v_mfma_f32_16x16x32_bf16 v[168:171], v[72:75], a[208:211], v[168:171]
 ds_read_b128 v[68:71], v12 offset:40960
 v_mfma_f32_16x16x32_bf16 v[172:175], v[72:75], a[212:215], v[172:175]
 buffer_load_dwordx4 v254, s[4:7], s65 offen offset:3072 sc1 lds
 v_mfma_f32_16x16x32_bf16 v[176:179], v[76:79], a[208:211], v[176:179]
 s_add_u32 m0, s60, 0x8000
 ds_read_b128 v[72:75], v12 offset:41984
 v_mfma_f32_16x16x32_bf16 v[180:183], v[76:79], a[212:215], v[180:183]
 s_waitcnt vmcnt(12)
 ds_read_b128 a[112:115], v36 offset:49152
 s_bfe_u32 s34, s84, 0x40010
 v_mfma_f32_16x16x32_bf16 v[184:187], v[80:83], a[208:211], v[184:187]
 s_waitcnt lgkmcnt(4)
 ds_read_b128 v[76:79], v12 offset:43008
 v_mfma_f32_16x16x32_bf16 v[188:191], v[80:83], a[212:215], v[188:191]
 ds_read_b128 a[116:119], v36 offset:51200
 s_mul_i32 s34, s34, 0x100
 v_mfma_f32_16x16x32_bf16 v[192:195], v[84:87], a[208:211], v[192:195]
 ds_read_b128 v[80:83], v12 offset:44032
 v_mfma_f32_16x16x32_bf16 v[196:199], v[84:87], a[212:215], v[196:199]
 buffer_load_dwordx4 v15, s[20:23], s34 offen offset:0  lds
 v_mfma_f32_16x16x32_bf16 v[200:203], v[88:91], a[208:211], v[200:203]
 ds_read_b128 v[84:87], v12 offset:45056
 v_mfma_f32_16x16x32_bf16 v[204:207], v[88:91], a[212:215], v[204:207]
 buffer_load_dwordx4 v16, s[20:23], s34 offen offset:1024  lds
 v_mfma_f32_16x16x32_bf16 v[208:211], v[92:95], a[208:211], v[208:211]
 s_waitcnt lgkmcnt(5)
 ds_read_b128 v[88:91], v12 offset:46080
 v_mfma_f32_16x16x32_bf16 v[212:215], v[92:95], a[212:215], v[212:215]
 ds_read_b128 a[120:123], v37 offset:49152
 v_mfma_f32_16x16x32_bf16 v[160:163], v[64:67], a[216:219], v[160:163]
 s_waitcnt vmcnt(10)
 s_barrier
 ds_read_b128 v[92:95], v13 offset:0
 v_mfma_f32_16x16x32_bf16 v[164:167], v[64:67], a[220:223], v[164:167]
 buffer_load_dwordx4 v17, s[20:23], s34 offen offset:2048  lds
 v_mfma_f32_16x16x32_bf16 v[168:171], v[68:71], a[216:219], v[168:171]
 ds_read_b128 v[64:67], v13 offset:1024
 v_mfma_f32_16x16x32_bf16 v[172:175], v[68:71], a[220:223], v[172:175]
 ds_read_b128 a[124:127], v37 offset:51200
 v_mfma_f32_16x16x32_bf16 v[176:179], v[72:75], a[216:219], v[176:179]
 s_waitcnt lgkmcnt(5)
 ds_read_b128 v[68:71], v13 offset:2048
 v_mfma_f32_16x16x32_bf16 v[180:183], v[72:75], a[220:223], v[180:183]
 buffer_load_dwordx4 v18, s[20:23], s34 offen offset:3072  lds
 v_mfma_f32_16x16x32_bf16 v[184:187], v[76:79], a[216:219], v[184:187]
 s_add_u32 m0, s60, 0x10000
 ds_read_b128 v[72:75], v13 offset:3072
 v_mfma_f32_16x16x32_bf16 v[188:191], v[76:79], a[220:223], v[188:191]
 s_add_u32 s34, s34, 0x80
 v_mfma_f32_16x16x32_bf16 v[192:195], v[80:83], a[216:219], v[192:195]
 ds_read_b128 v[76:79], v13 offset:4096
 v_mfma_f32_16x16x32_bf16 v[196:199], v[80:83], a[220:223], v[196:199]
 buffer_load_dwordx4 v15, s[20:23], s34 offen offset:0  lds
 v_mfma_f32_16x16x32_bf16 v[200:203], v[84:87], a[216:219], v[200:203]
 s_waitcnt lgkmcnt(4)
 ds_read_b128 v[80:83], v13 offset:5120
 v_mfma_f32_16x16x32_bf16 v[204:207], v[84:87], a[220:223], v[204:207]
 buffer_load_dwordx4 v16, s[20:23], s34 offen offset:1024  lds
 v_mfma_f32_16x16x32_bf16 v[208:211], v[88:91], a[216:219], v[208:211]
 ds_read_b128 v[84:87], v13 offset:6144
 v_mfma_f32_16x16x32_bf16 v[212:215], v[88:91], a[220:223], v[212:215]
 s_waitcnt lgkmcnt(5)
 v_mfma_f32_16x16x32_bf16 v[160:163], v[92:95], a[224:227], v[160:163]
 ds_read_b128 v[88:91], v13 offset:7168
 v_mfma_f32_16x16x32_bf16 v[164:167], v[92:95], a[228:231], v[164:167]
 buffer_load_dwordx4 v17, s[20:23], s34 offen offset:2048  lds
 v_mfma_f32_16x16x32_bf16 v[168:171], v[64:67], a[224:227], v[168:171]
 s_waitcnt lgkmcnt(3)
 ds_read_b128 v[92:95], v13 offset:8192
 v_mfma_f32_16x16x32_bf16 v[172:175], v[64:67], a[228:231], v[172:175]
 buffer_load_dwordx4 v18, s[20:23], s34 offen offset:3072  lds
 v_mfma_f32_16x16x32_bf16 v[176:179], v[68:71], a[224:227], v[176:179]
 ds_read_b128 v[64:67], v13 offset:9216
 v_mfma_f32_16x16x32_bf16 v[180:183], v[68:71], a[228:231], v[180:183]
 s_waitcnt vmcnt(12)
 ds_read_b128 a[128:131], v34 offset:0
 v_mfma_f32_16x16x32_bf16 v[184:187], v[72:75], a[224:227], v[184:187]
 ds_read_b128 v[68:71], v13 offset:10240
 v_mfma_f32_16x16x32_bf16 v[188:191], v[72:75], a[228:231], v[188:191]
 ds_read_b128 a[132:135], v34 offset:2048
 v_mfma_f32_16x16x32_bf16 v[192:195], v[76:79], a[224:227], v[192:195]
 s_waitcnt lgkmcnt(5)
 ds_read_b128 v[72:75], v13 offset:11264
 v_mfma_f32_16x16x32_bf16 v[196:199], v[76:79], a[228:231], v[196:199]
 v_mfma_f32_16x16x32_bf16 v[200:203], v[80:83], a[224:227], v[200:203]
 ds_read_b128 v[76:79], v13 offset:12288
 v_mfma_f32_16x16x32_bf16 v[204:207], v[80:83], a[228:231], v[204:207]
 ds_read_b128 a[136:139], v35 offset:0
 v_mfma_f32_16x16x32_bf16 v[208:211], v[84:87], a[224:227], v[208:211]
 ds_read_b128 v[80:83], v13 offset:13312
 v_mfma_f32_16x16x32_bf16 v[212:215], v[84:87], a[228:231], v[212:215]
 v_mfma_f32_16x16x32_bf16 v[160:163], v[88:91], a[232:235], v[160:163]
 s_waitcnt lgkmcnt(5)
 s_waitcnt vmcnt(8)
 s_barrier
 ds_read_b128 v[84:87], v1 offset:16384
 v_mfma_f32_16x16x32_bf16 v[164:167], v[88:91], a[236:239], v[164:167]
 ds_read_b128 a[140:143], v35 offset:2048
 s_add_u32 m0, s60, 0x18000
 v_mfma_f32_16x16x32_bf16 v[168:171], v[92:95], a[232:235], v[168:171]
 s_bfe_u32 s34, s84, 0x40014
 ds_read_b128 v[88:91], v1 offset:17408
 v_mfma_f32_16x16x32_bf16 v[172:175], v[92:95], a[236:239], v[172:175]
 s_mul_i32 s34, s34, 0x100
 v_mfma_f32_16x16x32_bf16 v[176:179], v[64:67], a[232:235], v[176:179]
 ds_read_b128 v[92:95], v1 offset:18432
 v_mfma_f32_16x16x32_bf16 v[180:183], v[64:67], a[236:239], v[180:183]
 buffer_load_dwordx4 v15, s[20:23], s34 offen offset:0  lds
 v_mfma_f32_16x16x32_bf16 v[184:187], v[68:71], a[232:235], v[184:187]
 s_waitcnt lgkmcnt(4)
 ds_read_b128 v[64:67], v1 offset:19456
 v_mfma_f32_16x16x32_bf16 v[188:191], v[68:71], a[236:239], v[188:191]
 buffer_load_dwordx4 v16, s[20:23], s34 offen offset:1024  lds
 v_mfma_f32_16x16x32_bf16 v[192:195], v[72:75], a[232:235], v[192:195]
 ds_read_b128 v[68:71], v1 offset:20480
 v_mfma_f32_16x16x32_bf16 v[196:199], v[72:75], a[236:239], v[196:199]
 buffer_load_dwordx4 v17, s[20:23], s34 offen offset:2048  lds
 v_mfma_f32_16x16x32_bf16 v[200:203], v[76:79], a[232:235], v[200:203]
 ds_read_b128 v[72:75], v1 offset:21504
 v_mfma_f32_16x16x32_bf16 v[204:207], v[76:79], a[236:239], v[204:207]
 v_mfma_f32_16x16x32_bf16 v[208:211], v[80:83], a[232:235], v[208:211]
 s_waitcnt lgkmcnt(3)
 ds_read_b128 v[76:79], v1 offset:22528
 v_mfma_f32_16x16x32_bf16 v[212:215], v[80:83], a[236:239], v[212:215]
 buffer_load_dwordx4 v18, s[20:23], s34 offen offset:3072  lds
 v_mfma_f32_16x16x32_bf16 v[160:163], v[84:87], a[240:243], v[160:163]
 ds_read_b128 v[80:83], v1 offset:23552
 v_mfma_f32_16x16x32_bf16 v[164:167], v[84:87], a[244:247], v[164:167]
 v_mfma_f32_16x16x32_bf16 v[168:171], v[88:91], a[240:243], v[168:171]
 ds_read_b128 v[84:87], v1 offset:24576
 v_mfma_f32_16x16x32_bf16 v[172:175], v[88:91], a[244:247], v[172:175]
 s_waitcnt vmcnt(8)
 ds_read_b128 a[144:147], v34 offset:32768
 v_mfma_f32_16x16x32_bf16 v[176:179], v[92:95], a[240:243], v[176:179]
 s_waitcnt lgkmcnt(4)
 ds_read_b128 v[88:91], v1 offset:25600
 v_mfma_f32_16x16x32_bf16 v[180:183], v[92:95], a[244:247], v[180:183]
 v_mfma_f32_16x16x32_bf16 v[184:187], v[64:67], a[240:243], v[184:187]
 ds_read_b128 v[92:95], v1 offset:26624
 v_mfma_f32_16x16x32_bf16 v[188:191], v[64:67], a[244:247], v[188:191]
 ds_read_b128 a[148:151], v34 offset:34816
 v_mfma_f32_16x16x32_bf16 v[192:195], v[68:71], a[240:243], v[192:195]
 ds_read_b128 v[64:67], v1 offset:27648
 v_mfma_f32_16x16x32_bf16 v[196:199], v[68:71], a[244:247], v[196:199]
 v_mfma_f32_16x16x32_bf16 v[200:203], v[72:75], a[240:243], v[200:203]
 s_waitcnt lgkmcnt(5)
 ds_read_b128 v[68:71], v1 offset:28672
 v_mfma_f32_16x16x32_bf16 v[204:207], v[72:75], a[244:247], v[204:207]
 ds_read_b128 a[152:155], v35 offset:32768
 v_mfma_f32_16x16x32_bf16 v[208:211], v[76:79], a[240:243], v[208:211]
 ds_read_b128 v[72:75], v1 offset:29696
 v_mfma_f32_16x16x32_bf16 v[212:215], v[76:79], a[244:247], v[212:215]
 v_mfma_f32_16x16x32_bf16 v[160:163], v[80:83], a[248:251], v[160:163]
 ds_read_b32 v76, v58 offset:1216
 ds_read_b32 v77, v58 offset:1216
 v_mfma_f32_16x16x32_bf16 v[164:167], v[80:83], a[252:255], v[164:167]
 ds_read_b128 a[156:159], v35 offset:34816
 v_mfma_f32_16x16x32_bf16 v[168:171], v[84:87], a[248:251], v[168:171]
 s_waitcnt lgkmcnt(6)
 ds_read_b32 v80, v58 offset:1280
 ds_read_b32 v81, v58 offset:1280
 v_mfma_f32_16x16x32_bf16 v[172:175], v[84:87], a[252:255], v[172:175]
 v_mfma_f32_16x16x32_bf16 v[176:179], v[88:91], a[248:251], v[176:179]
 ds_read_b32 v84, v58 offset:1344
 ds_read_b32 v85, v58 offset:1344
 v_mfma_f32_16x16x32_bf16 v[180:183], v[88:91], a[252:255], v[180:183]
 v_mfma_f32_16x16x32_bf16 v[184:187], v[92:95], a[248:251], v[184:187]
 ds_read_b32 v88, v58 offset:1408
 ds_read_b32 v89, v58 offset:1408
 v_mfma_f32_16x16x32_bf16 v[188:191], v[92:95], a[252:255], v[188:191]
 v_mfma_f32_16x16x32_bf16 v[192:195], v[64:67], a[248:251], v[192:195]
 s_waitcnt lgkmcnt(7)
 ds_read_b32 v92, v58 offset:1472
 ds_read_b32 v93, v58 offset:1472
 v_mfma_f32_16x16x32_bf16 v[196:199], v[64:67], a[252:255], v[196:199]
 v_mfma_f32_16x16x32_bf16 v[200:203], v[68:71], a[248:251], v[200:203]
 ds_read_b32 v64, v58 offset:1536
 ds_read_b32 v65, v58 offset:1536
 v_mfma_f32_16x16x32_bf16 v[204:207], v[68:71], a[252:255], v[204:207]
 v_mfma_f32_16x16x32_bf16 v[208:211], v[72:75], a[248:251], v[208:211]
 ds_read_b32 v68, v58 offset:1600
 ds_read_b32 v69, v58 offset:1600
 v_mfma_f32_16x16x32_bf16 v[212:215], v[72:75], a[252:255], v[212:215]
 s_waitcnt lgkmcnt(12)
 v_mfma_f32_16x16x32_bf16 v[160:163], v[76:79], v[48:51], v[160:163]
 s_waitcnt lgkmcnt(6)
 v_mfma_f32_16x16x32_bf16 v[164:167], v[76:79], v[52:55], v[164:167]
 v_mfma_f32_16x16x32_bf16 v[168:171], v[80:83], v[48:51], v[168:171]
 v_mfma_f32_16x16x32_bf16 v[172:175], v[80:83], v[52:55], v[172:175]
 v_mfma_f32_16x16x32_bf16 v[176:179], v[84:87], v[48:51], v[176:179]
 v_mfma_f32_16x16x32_bf16 v[180:183], v[84:87], v[52:55], v[180:183]
 v_mfma_f32_16x16x32_bf16 v[184:187], v[88:91], v[48:51], v[184:187]
 s_waitcnt lgkmcnt(0)
 v_mfma_f32_16x16x32_bf16 v[188:191], v[88:91], v[52:55], v[188:191]
 v_mfma_f32_16x16x32_bf16 v[192:195], v[92:95], v[48:51], v[192:195]
 v_mfma_f32_16x16x32_bf16 v[196:199], v[92:95], v[52:55], v[196:199]
 v_mfma_f32_16x16x32_bf16 v[200:203], v[64:67], v[48:51], v[200:203]
 v_mfma_f32_16x16x32_bf16 v[204:207], v[64:67], v[52:55], v[204:207]
 v_mfma_f32_16x16x32_bf16 v[208:211], v[68:71], v[48:51], v[208:211]
 v_mfma_f32_16x16x32_bf16 v[212:215], v[68:71], v[52:55], v[212:215]
 s_barrier
 v_pk_mul_f32 v[224:225], v[160:161], v[160:161]
 v_pk_fma_f32 v[224:225], v[224:225], v[44:45], v[44:45] op_sel:[0,1,0] op_sel_hi:[1,1,0]
 v_pk_mul_f32 v[224:225], v[224:225], v[160:161]
 v_exp_f32 v224, v224
 v_exp_f32 v225, v225
 v_pk_mul_f32 v[226:227], v[162:163], v[162:163]
 v_pk_fma_f32 v[226:227], v[226:227], v[44:45], v[44:45] op_sel:[0,1,0] op_sel_hi:[1,1,0]
 v_pk_mul_f32 v[226:227], v[226:227], v[162:163]
 v_exp_f32 v226, v226
 v_exp_f32 v227, v227
 v_pk_add_f32 v[224:225], v[224:225], s[74:75]
 v_rcp_f32 v224, v224
 v_rcp_f32 v225, v225
 v_pk_mul_f32 v[228:229], v[164:165], v[164:165]
 v_pk_fma_f32 v[228:229], v[228:229], v[46:47], v[46:47] op_sel:[0,1,0] op_sel_hi:[1,1,0]
 v_pk_mul_f32 v[228:229], v[228:229], v[164:165]
 v_exp_f32 v228, v228
 v_exp_f32 v229, v229
 v_pk_add_f32 v[226:227], v[226:227], s[74:75]
 v_rcp_f32 v226, v226
 s_add_u32 m0, s60, 0x20000
 s_add_u32 s34, s34, 0x80
 buffer_load_dwordx4 v15, s[20:23], s34 offen offset:0  lds
 v_rcp_f32 v227, v227
 v_pk_mul_f32 v[160:161], v[160:161], v[224:225]
 v_pk_mul_f32 v[230:231], v[166:167], v[166:167]
 v_pk_fma_f32 v[230:231], v[230:231], v[46:47], v[46:47] op_sel:[0,1,0] op_sel_hi:[1,1,0]
 v_pk_mul_f32 v[230:231], v[230:231], v[166:167]
 v_exp_f32 v230, v230
 v_exp_f32 v231, v231
 v_pk_add_f32 v[228:229], v[228:229], s[74:75]
 v_rcp_f32 v228, v228
 v_rcp_f32 v229, v229
 v_pk_mul_f32 v[162:163], v[162:163], v[226:227]
 v_pk_mul_f32 v[232:233], v[168:169], v[168:169]
 v_pk_fma_f32 v[232:233], v[232:233], v[44:45], v[44:45] op_sel:[0,1,0] op_sel_hi:[1,1,0]
 v_pk_mul_f32 v[232:233], v[232:233], v[168:169]
 v_exp_f32 v232, v232
 v_exp_f32 v233, v233
 v_pk_add_f32 v[230:231], v[230:231], s[74:75]
 v_rcp_f32 v230, v230
 v_rcp_f32 v231, v231
 v_pk_mul_f32 v[164:165], v[164:165], v[228:229]
 buffer_load_dwordx4 v16, s[20:23], s34 offen offset:1024  lds
 s_mov_b32 s79, 0
 s_atomic_add s79, s[58:59], 0 glc
 v_pk_mul_f32 v[234:235], v[170:171], v[170:171]
 v_pk_fma_f32 v[234:235], v[234:235], v[44:45], v[44:45] op_sel:[0,1,0] op_sel_hi:[1,1,0]
 v_pk_mul_f32 v[234:235], v[234:235], v[170:171]
 v_exp_f32 v234, v234
 v_exp_f32 v235, v235
 v_pk_add_f32 v[232:233], v[232:233], s[74:75]
 v_rcp_f32 v232, v232
 v_rcp_f32 v233, v233
 v_pk_mul_f32 v[166:167], v[166:167], v[230:231]
 v_pk_mul_f32 v[236:237], v[172:173], v[172:173]
 v_pk_fma_f32 v[236:237], v[236:237], v[46:47], v[46:47] op_sel:[0,1,0] op_sel_hi:[1,1,0]
 v_pk_mul_f32 v[236:237], v[236:237], v[172:173]
 v_exp_f32 v236, v236
 v_exp_f32 v237, v237
 v_pk_add_f32 v[234:235], v[234:235], s[74:75]
 v_rcp_f32 v234, v234
 v_rcp_f32 v235, v235
 v_pk_mul_f32 v[168:169], v[168:169], v[232:233]
 v_pk_mul_f32 v[238:239], v[174:175], v[174:175]
 v_pk_fma_f32 v[238:239], v[238:239], v[46:47], v[46:47] op_sel:[0,1,0] op_sel_hi:[1,1,0]
 buffer_load_dwordx4 v17, s[20:23], s34 offen offset:2048  lds
 v_pk_mul_f32 v[238:239], v[238:239], v[174:175]
 v_exp_f32 v238, v238
 v_exp_f32 v239, v239
 v_pk_add_f32 v[236:237], v[236:237], s[74:75]
 v_rcp_f32 v236, v236
 v_rcp_f32 v237, v237
 v_pk_mul_f32 v[170:171], v[170:171], v[234:235]
 v_pk_mul_f32 v[224:225], v[176:177], v[176:177]
 v_pk_fma_f32 v[224:225], v[224:225], v[44:45], v[44:45] op_sel:[0,1,0] op_sel_hi:[1,1,0]
 v_pk_mul_f32 v[224:225], v[224:225], v[176:177]
 v_exp_f32 v224, v224
 v_exp_f32 v225, v225
 v_pk_add_f32 v[238:239], v[238:239], s[74:75]
 v_rcp_f32 v238, v238
 v_rcp_f32 v239, v239
 v_pk_mul_f32 v[172:173], v[172:173], v[236:237]
 v_pk_mul_f32 v[226:227], v[178:179], v[178:179]
 v_pk_fma_f32 v[226:227], v[226:227], v[44:45], v[44:45] op_sel:[0,1,0] op_sel_hi:[1,1,0]
 v_pk_mul_f32 v[226:227], v[226:227], v[178:179]
 v_exp_f32 v226, v226
 buffer_load_dwordx4 v18, s[20:23], s34 offen offset:3072  lds
 v_exp_f32 v227, v227
 v_pk_add_f32 v[224:225], v[224:225], s[74:75]
 v_rcp_f32 v224, v224
 v_rcp_f32 v225, v225
 v_pk_mul_f32 v[174:175], v[174:175], v[238:239]
 v_pk_mul_f32 v[228:229], v[180:181], v[180:181]
 v_pk_fma_f32 v[228:229], v[228:229], v[46:47], v[46:47] op_sel:[0,1,0] op_sel_hi:[1,1,0]
 v_pk_mul_f32 v[228:229], v[228:229], v[180:181]
 v_exp_f32 v228, v228
 v_exp_f32 v229, v229
 v_pk_add_f32 v[226:227], v[226:227], s[74:75]
 v_rcp_f32 v226, v226
 v_rcp_f32 v227, v227
 v_pk_mul_f32 v[176:177], v[176:177], v[224:225]
 v_pk_mul_f32 v[230:231], v[182:183], v[182:183]
 v_pk_fma_f32 v[230:231], v[230:231], v[46:47], v[46:47] op_sel:[0,1,0] op_sel_hi:[1,1,0]
 v_pk_mul_f32 v[230:231], v[230:231], v[182:183]
 v_exp_f32 v230, v230
 v_exp_f32 v231, v231
 v_pk_add_f32 v[228:229], v[228:229], s[74:75]
 s_add_u32 m0, s60, 0x4000
 s_bfe_u32 s34, s84, 0x40018
 s_mul_i32 s34, s34, 0x100
 buffer_load_dwordx4 v15, s[20:23], s34 offen offset:0  lds
 v_rcp_f32 v228, v228
 v_rcp_f32 v229, v229
 v_pk_mul_f32 v[178:179], v[178:179], v[226:227]
 v_pk_mul_f32 v[232:233], v[184:185], v[184:185]
 v_pk_fma_f32 v[232:233], v[232:233], v[44:45], v[44:45] op_sel:[0,1,0] op_sel_hi:[1,1,0]
 v_pk_mul_f32 v[232:233], v[232:233], v[184:185]
 v_exp_f32 v232, v232
 v_exp_f32 v233, v233
 v_pk_add_f32 v[230:231], v[230:231], s[74:75]
 v_rcp_f32 v230, v230
 v_rcp_f32 v231, v231
 v_pk_mul_f32 v[180:181], v[180:181], v[228:229]
 v_pk_mul_f32 v[234:235], v[186:187], v[186:187]
 v_pk_fma_f32 v[234:235], v[234:235], v[44:45], v[44:45] op_sel:[0,1,0] op_sel_hi:[1,1,0]
 v_pk_mul_f32 v[234:235], v[234:235], v[186:187]
 v_exp_f32 v234, v234
 v_exp_f32 v235, v235
 v_pk_add_f32 v[232:233], v[232:233], s[74:75]
 v_rcp_f32 v232, v232
 v_rcp_f32 v233, v233
 buffer_load_dwordx4 v16, s[20:23], s34 offen offset:1024  lds
 v_pk_mul_f32 v[182:183], v[182:183], v[230:231]
 v_pk_mul_f32 v[236:237], v[188:189], v[188:189]
 v_pk_fma_f32 v[236:237], v[236:237], v[46:47], v[46:47] op_sel:[0,1,0] op_sel_hi:[1,1,0]
 v_pk_mul_f32 v[236:237], v[236:237], v[188:189]
 v_exp_f32 v236, v236
 v_exp_f32 v237, v237
 v_pk_add_f32 v[234:235], v[234:235], s[74:75]
 v_rcp_f32 v234, v234
 v_rcp_f32 v235, v235
 v_pk_mul_f32 v[184:185], v[184:185], v[232:233]
 v_pk_mul_f32 v[238:239], v[190:191], v[190:191]
 v_pk_fma_f32 v[238:239], v[238:239], v[46:47], v[46:47] op_sel:[0,1,0] op_sel_hi:[1,1,0]
 v_pk_mul_f32 v[238:239], v[238:239], v[190:191]
 v_exp_f32 v238, v238
 v_exp_f32 v239, v239
 v_pk_add_f32 v[236:237], v[236:237], s[74:75]
 v_rcp_f32 v236, v236
 v_rcp_f32 v237, v237
 v_pk_mul_f32 v[186:187], v[186:187], v[234:235]
 v_pk_mul_f32 v[224:225], v[192:193], v[192:193]
 buffer_load_dwordx4 v17, s[20:23], s34 offen offset:2048  lds
 s_mov_b32 s67, 0
mk_w21:
 s_waitcnt lgkmcnt(0)
 s_cmp_ge_u32 s79, 64
 s_cbranch_scc1 mk_d22
 s_mov_b32 s79, 0
 s_atomic_add s79, s[58:59], 0 glc
 s_add_u32 s67, s67, 1
 s_cmp_lt_u32 s67, 0x8000
 s_cbranch_scc1 mk_w21
mk_d22:
 v_pk_fma_f32 v[224:225], v[224:225], v[44:45], v[44:45] op_sel:[0,1,0] op_sel_hi:[1,1,0]
 v_pk_mul_f32 v[224:225], v[224:225], v[192:193]
 v_exp_f32 v224, v224
 v_exp_f32 v225, v225
 v_pk_add_f32 v[238:239], v[238:239], s[74:75]
 v_rcp_f32 v238, v238
 v_rcp_f32 v239, v239
 v_pk_mul_f32 v[188:189], v[188:189], v[236:237]
 buffer_load_dwordx4 v18, s[20:23], s34 offen offset:3072  lds
 v_pk_mul_f32 v[226:227], v[194:195], v[194:195]
 v_pk_fma_f32 v[226:227], v[226:227], v[44:45], v[44:45] op_sel:[0,1,0] op_sel_hi:[1,1,0]
 v_pk_mul_f32 v[226:227], v[226:227], v[194:195]
 v_exp_f32 v226, v226
 v_exp_f32 v227, v227
 v_pk_add_f32 v[224:225], v[224:225], s[74:75]
 v_rcp_f32 v224, v224
 v_rcp_f32 v225, v225
 s_add_u32 m0, s60, 0xc000
 s_bfe_u32 s35, s84, 0x40000
 s_mul_i32 s35, s35, 0xe000
 s_add_u32 s35, s35, s45
 buffer_load_dwordx4 v11, s[4:7], s35 offen offset:0 sc1 lds
 v_pk_mul_f32 v[190:191], v[190:191], v[238:239]
 v_pk_mul_f32 v[228:229], v[196:197], v[196:197]
 v_pk_fma_f32 v[228:229], v[228:229], v[46:47], v[46:47] op_sel:[0,1,0] op_sel_hi:[1,1,0]
 v_pk_mul_f32 v[228:229], v[228:229], v[196:197]
 v_exp_f32 v228, v228
 v_exp_f32 v229, v229
 v_pk_add_f32 v[226:227], v[226:227], s[74:75]
 v_rcp_f32 v226, v226
 buffer_load_dwordx4 v252, s[4:7], s35 offen offset:1024 sc1 lds
 v_rcp_f32 v227, v227
 v_pk_mul_f32 v[192:193], v[192:193], v[224:225]
 v_pk_mul_f32 v[230:231], v[198:199], v[198:199]
 v_pk_fma_f32 v[230:231], v[230:231], v[46:47], v[46:47] op_sel:[0,1,0] op_sel_hi:[1,1,0]
 v_pk_mul_f32 v[230:231], v[230:231], v[198:199]
 v_exp_f32 v230, v230
 v_exp_f32 v231, v231
 v_pk_add_f32 v[228:229], v[228:229], s[74:75]
 buffer_load_dwordx4 v253, s[4:7], s35 offen offset:2048 sc1 lds
 v_rcp_f32 v228, v228
 v_rcp_f32 v229, v229
 v_pk_mul_f32 v[194:195], v[194:195], v[226:227]
 v_pk_mul_f32 v[232:233], v[200:201], v[200:201]
 v_pk_fma_f32 v[232:233], v[232:233], v[44:45], v[44:45] op_sel:[0,1,0] op_sel_hi:[1,1,0]
 v_pk_mul_f32 v[232:233], v[232:233], v[200:201]
 v_exp_f32 v232, v232
 v_exp_f32 v233, v233
 buffer_load_dwordx4 v254, s[4:7], s35 offen offset:3072 sc1 lds
 v_pk_add_f32 v[230:231], v[230:231], s[74:75]
 v_rcp_f32 v230, v230
 v_rcp_f32 v231, v231
 v_pk_mul_f32 v[196:197], v[196:197], v[228:229]
 v_pk_mul_f32 v[234:235], v[202:203], v[202:203]
 v_pk_fma_f32 v[234:235], v[234:235], v[44:45], v[44:45] op_sel:[0,1,0] op_sel_hi:[1,1,0]
 v_pk_mul_f32 v[234:235], v[234:235], v[202:203]
 v_exp_f32 v234, v234
 s_add_u32 m0, s60, 0x14000
 s_add_u32 s35, s35, 0x7000
 buffer_load_dwordx4 v11, s[4:7], s35 offen offset:0 sc1 lds
 v_exp_f32 v235, v235
 v_pk_add_f32 v[232:233], v[232:233], s[74:75]
 v_rcp_f32 v232, v232
 v_rcp_f32 v233, v233
 v_pk_mul_f32 v[198:199], v[198:199], v[230:231]
 v_pk_mul_f32 v[236:237], v[204:205], v[204:205]
 v_pk_fma_f32 v[236:237], v[236:237], v[46:47], v[46:47] op_sel:[0,1,0] op_sel_hi:[1,1,0]
 v_pk_mul_f32 v[236:237], v[236:237], v[204:205]
 buffer_load_dwordx4 v252, s[4:7], s35 offen offset:1024 sc1 lds
 v_exp_f32 v236, v236
 v_exp_f32 v237, v237
 v_pk_add_f32 v[234:235], v[234:235], s[74:75]
 v_rcp_f32 v234, v234
 v_rcp_f32 v235, v235
 v_pk_mul_f32 v[200:201], v[200:201], v[232:233]
 v_pk_mul_f32 v[238:239], v[206:207], v[206:207]
 v_pk_fma_f32 v[238:239], v[238:239], v[46:47], v[46:47] op_sel:[0,1,0] op_sel_hi:[1,1,0]
 buffer_load_dwordx4 v253, s[4:7], s35 offen offset:2048 sc1 lds
 v_pk_mul_f32 v[238:239], v[238:239], v[206:207]
 v_exp_f32 v238, v238
 v_exp_f32 v239, v239
 v_pk_add_f32 v[236:237], v[236:237], s[74:75]
 v_rcp_f32 v236, v236
 v_rcp_f32 v237, v237
 v_pk_mul_f32 v[202:203], v[202:203], v[234:235]
 v_pk_mul_f32 v[224:225], v[208:209], v[208:209]
 buffer_load_dwordx4 v254, s[4:7], s35 offen offset:3072 sc1 lds
 v_pk_fma_f32 v[224:225], v[224:225], v[44:45], v[44:45] op_sel:[0,1,0] op_sel_hi:[1,1,0]
 v_pk_mul_f32 v[224:225], v[224:225], v[208:209]
 v_exp_f32 v224, v224
 v_exp_f32 v225, v225
 v_pk_add_f32 v[238:239], v[238:239], s[74:75]
 v_rcp_f32 v238, v238
 v_rcp_f32 v239, v239
 v_pk_mul_f32 v[204:205], v[204:205], v[236:237]
 s_add_u32 m0, s60, 0x1c000
 s_bfe_u32 s35, s84, 0x40004
 s_mul_i32 s35, s35, 0xe000
 s_add_u32 s35, s35, s45
 buffer_load_dwordx4 v11, s[4:7], s35 offen offset:0 sc1 lds
 v_pk_mul_f32 v[226:227], v[210:211], v[210:211]
 v_pk_fma_f32 v[226:227], v[226:227], v[44:45], v[44:45] op_sel:[0,1,0] op_sel_hi:[1,1,0]
 v_pk_mul_f32 v[226:227], v[226:227], v[210:211]
 v_exp_f32 v226, v226
 v_exp_f32 v227, v227
 v_pk_add_f32 v[224:225], v[224:225], s[74:75]
 v_rcp_f32 v224, v224
 v_rcp_f32 v225, v225
 buffer_load_dwordx4 v252, s[4:7], s35 offen offset:1024 sc1 lds
 v_pk_mul_f32 v[206:207], v[206:207], v[238:239]
 v_pk_mul_f32 v[228:229], v[212:213], v[212:213]
 v_pk_fma_f32 v[228:229], v[228:229], v[46:47], v[46:47] op_sel:[0,1,0] op_sel_hi:[1,1,0]
 v_pk_mul_f32 v[228:229], v[228:229], v[212:213]
 v_exp_f32 v228, v228
 v_exp_f32 v229, v229
 v_pk_add_f32 v[226:227], v[226:227], s[74:75]
 v_rcp_f32 v226, v226
 buffer_load_dwordx4 v253, s[4:7], s35 offen offset:2048 sc1 lds
 v_rcp_f32 v227, v227
 v_pk_mul_f32 v[208:209], v[208:209], v[224:225]
 v_pk_mul_f32 v[230:231], v[214:215], v[214:215]
 v_pk_fma_f32 v[230:231], v[230:231], v[46:47], v[46:47] op_sel:[0,1,0] op_sel_hi:[1,1,0]
 v_pk_mul_f32 v[230:231], v[230:231], v[214:215]
 v_exp_f32 v230, v230
 v_exp_f32 v231, v231
 v_pk_add_f32 v[228:229], v[228:229], s[74:75]
 buffer_load_dwordx4 v254, s[4:7], s35 offen offset:3072 sc1 lds
 v_rcp_f32 v228, v228
 v_rcp_f32 v229, v229
 v_pk_mul_f32 v[210:211], v[210:211], v[226:227]
 v_pk_add_f32 v[230:231], v[230:231], s[74:75]
 v_rcp_f32 v230, v230
 v_rcp_f32 v231, v231
 v_pk_mul_f32 v[212:213], v[212:213], v[228:229]
 v_pk_mul_f32 v[214:215], v[214:215], v[230:231]
 s_add_u32 m0, s60, 0x0
 s_add_u32 s35, s35, 0x7000
 buffer_load_dwordx4 v11, s[4:7], s35 offen offset:0 sc1 lds
mk_k5:
 v_accvgpr_read_b32 v224, a0
 v_accvgpr_read_b32 v225, a1
 v_accvgpr_read_b32 v226, a2
 v_accvgpr_read_b32 v227, a3
 v_accvgpr_read_b32 v228, a4
 v_accvgpr_read_b32 v229, a5
 v_accvgpr_read_b32 v230, a6
 v_accvgpr_read_b32 v231, a7
 v_accvgpr_read_b32 v232, a8
 v_accvgpr_read_b32 v233, a9
 v_accvgpr_read_b32 v234, a10
 v_accvgpr_read_b32 v235, a11
 v_accvgpr_read_b32 v236, a12
 v_accvgpr_read_b32 v237, a13
 v_accvgpr_read_b32 v238, a14
 v_accvgpr_read_b32 v239, a15
 s_waitcnt vmcnt(9)
 s_barrier
 ds_read_b64_tr_b16 v[72:73], v31 offset:49152
 ds_read_b64_tr_b16 v[74:75], v31 offset:49408
 ds_read_b64_tr_b16 v[76:77], v31 offset:50176
 ds_read_b64_tr_b16 v[78:79], v31 offset:50432
 ds_read_b64_tr_b16 v[80:81], v31 offset:51200
 ds_read_b64_tr_b16 v[82:83], v31 offset:51456
 ds_read_b64_tr_b16 v[84:85], v31 offset:52224
 ds_read_b64_tr_b16 v[86:87], v31 offset:52480
 ds_read_b64_tr_b16 v[88:89], v31 offset:53248
 ds_read_b64_tr_b16 v[90:91], v31 offset:53504
 ds_read_b64_tr_b16 v[92:93], v31 offset:54272
 ds_read_b64_tr_b16 v[94:95], v31 offset:54528
 ds_read_b64_tr_b16 v[64:65], v31 offset:55296
 ds_read_b64_tr_b16 v[66:67], v31 offset:55552
 s_waitcnt lgkmcnt(8)
 v_mfma_f32_16x16x32_bf16 v[96:99], v[72:75], a[16:19], 0
 ds_read_b64_tr_b16 v[68:69], v31 offset:56320
 ds_read_b64_tr_b16 v[70:71], v31 offset:56576
 v_mfma_f32_16x16x32_bf16 v[100:103], v[72:75], a[20:23], 0
 v_mfma_f32_16x16x32_bf16 v[104:107], v[76:79], a[16:19], 0
 ds_read_b64_tr_b16 v[72:73], v31 offset:57344
 ds_read_b64_tr_b16 v[74:75], v31 offset:57600
 v_mfma_f32_16x16x32_bf16 v[108:111], v[76:79], a[20:23], 0
 buffer_load_dwordx4 v252, s[4:7], s35 offen offset:1024 sc1 lds
 v_mfma_f32_16x16x32_bf16 v[112:115], v[80:83], a[16:19], 0
 s_waitcnt lgkmcnt(6)
 ds_read_b64_tr_b16 v[76:77], v31 offset:58368
 ds_read_b64_tr_b16 v[78:79], v31 offset:58624
 v_mfma_f32_16x16x32_bf16 v[116:119], v[80:83], a[20:23], 0
 ds_read_b128 a[160:163], v36 offset:0
 v_mfma_f32_16x16x32_bf16 v[120:123], v[84:87], a[16:19], 0
 ds_read_b64_tr_b16 v[80:81], v31 offset:59392
 ds_read_b64_tr_b16 v[82:83], v31 offset:59648
 v_mfma_f32_16x16x32_bf16 v[124:127], v[84:87], a[20:23], 0
 buffer_load_dwordx4 v253, s[4:7], s35 offen offset:2048 sc1 lds
 v_mfma_f32_16x16x32_bf16 v[128:131], v[88:91], a[16:19], 0
 ds_read_b64_tr_b16 v[84:85], v31 offset:60416
 ds_read_b64_tr_b16 v[86:87], v31 offset:60672
 v_mfma_f32_16x16x32_bf16 v[132:135], v[88:91], a[20:23], 0
 ds_read_b128 a[164:167], v36 offset:2048
 v_mfma_f32_16x16x32_bf16 v[136:139], v[92:95], a[16:19], 0
 s_waitcnt lgkmcnt(8)
 ds_read_b64_tr_b16 v[88:89], v31 offset:61440
 ds_read_b64_tr_b16 v[90:91], v31 offset:61696
 v_mfma_f32_16x16x32_bf16 v[140:143], v[92:95], a[20:23], 0
 buffer_load_dwordx4 v254, s[4:7], s35 offen offset:3072 sc1 lds
 v_mfma_f32_16x16x32_bf16 v[144:147], v[64:67], a[16:19], 0
 s_add_u32 m0, s60, 0x8000
 ds_read_b64_tr_b16 v[92:93], v31 offset:62464
 ds_read_b64_tr_b16 v[94:95], v31 offset:62720
 v_mfma_f32_16x16x32_bf16 v[148:151], v[64:67], a[20:23], 0
 ds_read_b128 a[168:171], v37 offset:0
 s_bfe_u32 s35, s84, 0x40008
 v_mfma_f32_16x16x32_bf16 v[96:99], v[68:71], a[24:27], v[96:99]
 s_mul_i32 s35, s35, 0xe000
 s_waitcnt vmcnt(8)
 s_barrier
 ds_read_b64_tr_b16 v[64:65], v32 offset:16384
 ds_read_b64_tr_b16 v[66:67], v32 offset:16640
 v_mfma_f32_16x16x32_bf16 v[100:103], v[68:71], a[28:31], v[100:103]
 ds_read_b128 a[172:175], v37 offset:2048
 s_add_u32 s35, s35, s45
 v_mfma_f32_16x16x32_bf16 v[104:107], v[72:75], a[24:27], v[104:107]
 s_waitcnt lgkmcnt(9)
 ds_read_b64_tr_b16 v[68:69], v32 offset:17408
 ds_read_b64_tr_b16 v[70:71], v32 offset:17664
 v_mfma_f32_16x16x32_bf16 v[108:111], v[72:75], a[28:31], v[108:111]
 buffer_load_dwordx4 v11, s[4:7], s35 offen offset:0 sc1 lds
 v_mfma_f32_16x16x32_bf16 v[112:115], v[76:79], a[24:27], v[112:115]
 ds_read_b64_tr_b16 v[72:73], v32 offset:18432
 ds_read_b64_tr_b16 v[74:75], v32 offset:18688
 v_mfma_f32_16x16x32_bf16 v[116:119], v[76:79], a[28:31], v[116:119]
 buffer_load_dwordx4 v252, s[4:7], s35 offen offset:1024 sc1 lds
 v_mfma_f32_16x16x32_bf16 v[120:123], v[80:83], a[24:27], v[120:123]
 ds_read_b64_tr_b16 v[76:77], v32 offset:19456
 ds_read_b64_tr_b16 v[78:79], v32 offset:19712
 v_mfma_f32_16x16x32_bf16 v[124:127], v[80:83], a[28:31], v[124:127]
 v_mfma_f32_16x16x32_bf16 v[128:131], v[84:87], a[24:27], v[128:131]
 s_waitcnt lgkmcnt(7)
 ds_read_b64_tr_b16 v[80:81], v32 offset:20480
 ds_read_b64_tr_b16 v[82:83], v32 offset:20736
 v_mfma_f32_16x16x32_bf16 v[132:135], v[84:87], a[28:31], v[132:135]
 buffer_load_dwordx4 v253, s[4:7], s35 offen offset:2048 sc1 lds
 v_mfma_f32_16x16x32_bf16 v[136:139], v[88:91], a[24:27], v[136:139]
 ds_read_b64_tr_b16 v[84:85], v32 offset:21504
 ds_read_b64_tr_b16 v[86:87], v32 offset:21760
 v_mfma_f32_16x16x32_bf16 v[140:143], v[88:91], a[28:31], v[140:143]
 v_mfma_f32_16x16x32_bf16 v[144:147], v[92:95], a[24:27], v[144:147]
 ds_read_b64_tr_b16 v[88:89], v32 offset:22528
 ds_read_b64_tr_b16 v[90:91], v32 offset:22784
 v_mfma_f32_16x16x32_bf16 v[148:151], v[92:95], a[28:31], v[148:151]
 buffer_load_dwordx4 v254, s[4:7], s35 offen offset:3072 sc1 lds
 v_mfma_f32_16x16x32_bf16 v[96:99], v[64:67], a[32:35], v[96:99]
 s_waitcnt lgkmcnt(6)
 ds_read_b64_tr_b16 v[92:93], v32 offset:23552
 ds_read_b64_tr_b16 v[94:95], v32 offset:23808
 v_mfma_f32_16x16x32_bf16 v[100:103], v[64:67], a[36:39], v[100:103]
 v_mfma_f32_16x16x32_bf16 v[104:107], v[68:71], a[32:35], v[104:107]
 s_add_u32 m0, s60, 0x10000
 ds_read_b64_tr_b16 v[64:65], v32 offset:24576
 ds_read_b64_tr_b16 v[66:67], v32 offset:24832
 v_mfma_f32_16x16x32_bf16 v[108:111], v[68:71], a[36:39], v[108:111]
 ds_read_b128 a[176:179], v36 offset:32768
 s_add_u32 s35, s35, 0x7000
 v_mfma_f32_16x16x32_bf16 v[112:115], v[72:75], a[32:35], v[112:115]
 ds_read_b64_tr_b16 v[68:69], v32 offset:25600
 ds_read_b64_tr_b16 v[70:71], v32 offset:25856
 v_mfma_f32_16x16x32_bf16 v[116:119], v[72:75], a[36:39], v[116:119]
 buffer_load_dwordx4 v11, s[4:7], s35 offen offset:0 sc1 lds
 v_mfma_f32_16x16x32_bf16 v[120:123], v[76:79], a[32:35], v[120:123]
 s_waitcnt lgkmcnt(7)
 ds_read_b64_tr_b16 v[72:73], v32 offset:26624
 ds_read_b64_tr_b16 v[74:75], v32 offset:26880
 v_mfma_f32_16x16x32_bf16 v[124:127], v[76:79], a[36:39], v[124:127]
 buffer_load_dwordx4 v252, s[4:7], s35 offen offset:1024 sc1 lds
 v_mfma_f32_16x16x32_bf16 v[128:131], v[80:83], a[32:35], v[128:131]
 ds_read_b64_tr_b16 v[76:77], v32 offset:27648
 ds_read_b64_tr_b16 v[78:79], v32 offset:27904
 v_mfma_f32_16x16x32_bf16 v[132:135], v[80:83], a[36:39], v[132:135]
 ds_read_b128 a[180:183], v36 offset:34816
 v_mfma_f32_16x16x32_bf16 v[136:139], v[84:87], a[32:35], v[136:139]
 ds_read_b64_tr_b16 v[80:81], v32 offset:28672
 ds_read_b64_tr_b16 v[82:83], v32 offset:28928
 v_mfma_f32_16x16x32_bf16 v[140:143], v[84:87], a[36:39], v[140:143]
 buffer_load_dwordx4 v253, s[4:7], s35 offen offset:2048 sc1 lds
 v_mfma_f32_16x16x32_bf16 v[144:147], v[88:91], a[32:35], v[144:147]
 s_waitcnt lgkmcnt(7)
 ds_read_b64_tr_b16 v[84:85], v32 offset:29696
 ds_read_b64_tr_b16 v[86:87], v32 offset:29952
 v_mfma_f32_16x16x32_bf16 v[148:151], v[88:91], a[36:39], v[148:151]
 ds_read_b128 a[184:187], v37 offset:32768
 v_mfma_f32_16x16x32_bf16 v[96:99], v[92:95], a[40:43], v[96:99]
 s_waitcnt vmcnt(11)
 s_barrier
 ds_read_b64_tr_b16 v[88:89], v32 offset:49152
 ds_read_b64_tr_b16 v[90:91], v32 offset:49408
 v_mfma_f32_16x16x32_bf16 v[100:103], v[92:95], a[44:47], v[100:103]
 buffer_load_dwordx4 v254, s[4:7], s35 offen offset:3072 sc1 lds
 v_mfma_f32_16x16x32_bf16 v[104:107], v[64:67], a[40:43], v[104:107]
 s_add_u32 m0, s60, 0xc000
 ds_read_b64_tr_b16 v[92:93], v32 offset:50176
 ds_read_b64_tr_b16 v[94:95], v32 offset:50432
 v_mfma_f32_16x16x32_bf16 v[108:111], v[64:67], a[44:47], v[108:111]
 ds_read_b128 a[188:191], v37 offset:34816
 s_add_u32 s34, s34, 0x80
 v_mfma_f32_16x16x32_bf16 v[112:115], v[68:71], a[40:43], v[112:115]
 s_waitcnt lgkmcnt(8)
 ds_read_b64_tr_b16 v[64:65], v32 offset:51200
 ds_read_b64_tr_b16 v[66:67], v32 offset:51456
 v_mfma_f32_16x16x32_bf16 v[116:119], v[68:71], a[44:47], v[116:119]
 buffer_load_dwordx4 v15, s[20:23], s34 offen offset:0  lds
 v_mfma_f32_16x16x32_bf16 v[120:123], v[72:75], a[40:43], v[120:123]
 ds_read_b64_tr_b16 v[68:69], v32 offset:52224
 ds_read_b64_tr_b16 v[70:71], v32 offset:52480
 v_mfma_f32_16x16x32_bf16 v[124:127], v[72:75], a[44:47], v[124:127]
 buffer_load_dwordx4 v16, s[20:23], s34 offen offset:1024  lds
 v_mfma_f32_16x16x32_bf16 v[128:131], v[76:79], a[40:43], v[128:131]
 ds_read_b64_tr_b16 v[72:73], v32 offset:53248
 ds_read_b64_tr_b16 v[74:75], v32 offset:53504
 v_mfma_f32_16x16x32_bf16 v[132:135], v[76:79], a[44:47], v[132:135]
 v_mfma_f32_16x16x32_bf16 v[136:139], v[80:83], a[40:43], v[136:139]
 s_waitcnt lgkmcnt(7)
 ds_read_b64_tr_b16 v[76:77], v32 offset:54272
 ds_read_b64_tr_b16 v[78:79], v32 offset:54528
 v_mfma_f32_16x16x32_bf16 v[140:143], v[80:83], a[44:47], v[140:143]
 buffer_load_dwordx4 v17, s[20:23], s34 offen offset:2048  lds
 v_mfma_f32_16x16x32_bf16 v[144:147], v[84:87], a[40:43], v[144:147]
 ds_read_b64_tr_b16 v[80:81], v32 offset:55296
 ds_read_b64_tr_b16 v[82:83], v32 offset:55552
 v_mfma_f32_16x16x32_bf16 v[148:151], v[84:87], a[44:47], v[148:151]
 s_waitcnt lgkmcnt(10)
 v_mfma_f32_16x16x32_bf16 v[96:99], v[88:91], a[48:51], v[96:99]
 ds_read_b64_tr_b16 v[84:85], v32 offset:56320
 ds_read_b64_tr_b16 v[86:87], v32 offset:56576
 v_mfma_f32_16x16x32_bf16 v[100:103], v[88:91], a[52:55], v[100:103]
 buffer_load_dwordx4 v18, s[20:23], s34 offen offset:3072  lds
 v_mfma_f32_16x16x32_bf16 v[104:107], v[92:95], a[48:51], v[104:107]
 s_waitcnt lgkmcnt(6)
 ds_read_b64_tr_b16 v[88:89], v32 offset:57344
 ds_read_b64_tr_b16 v[90:91], v32 offset:57600
 v_mfma_f32_16x16x32_bf16 v[108:111], v[92:95], a[52:55], v[108:111]
 ds_read_b128 a[192:195], v38 offset:0
 s_add_u32 m0, s60, 0x18000
 v_mfma_f32_16x16x32_bf16 v[112:115], v[64:67], a[48:51], v[112:115]
 s_bfe_u32 s35, s84, 0x4000c
 ds_read_b64_tr_b16 v[92:93], v32 offset:58368
 ds_read_b64_tr_b16 v[94:95], v32 offset:58624
 v_mfma_f32_16x16x32_bf16 v[116:119], v[64:67], a[52:55], v[116:119]
 s_mul_i32 s35, s35, 0xe000
 s_add_u32 s35, s35, s45
 v_mfma_f32_16x16x32_bf16 v[120:123], v[68:71], a[48:51], v[120:123]
 ds_read_b64_tr_b16 v[64:65], v32 offset:59392
 ds_read_b64_tr_b16 v[66:67], v32 offset:59648
 v_mfma_f32_16x16x32_bf16 v[124:127], v[68:71], a[52:55], v[124:127]
 buffer_load_dwordx4 v11, s[4:7], s35 offen offset:0 sc1 lds
 v_mfma_f32_16x16x32_bf16 v[128:131], v[72:75], a[48:51], v[128:131]
 s_waitcnt lgkmcnt(7)
 ds_read_b64_tr_b16 v[68:69], v32 offset:60416
 ds_read_b64_tr_b16 v[70:71], v32 offset:60672
 v_mfma_f32_16x16x32_bf16 v[132:135], v[72:75], a[52:55], v[132:135]
 ds_read_b128 a[196:199], v38 offset:2048
 v_mfma_f32_16x16x32_bf16 v[136:139], v[76:79], a[48:51], v[136:139]
 ds_read_b64_tr_b16 v[72:73], v32 offset:61440
 ds_read_b64_tr_b16 v[74:75], v32 offset:61696
 v_mfma_f32_16x16x32_bf16 v[140:143], v[76:79], a[52:55], v[140:143]
 buffer_load_dwordx4 v252, s[4:7], s35 offen offset:1024 sc1 lds
 v_mfma_f32_16x16x32_bf16 v[144:147], v[80:83], a[48:51], v[144:147]
 ds_read_b64_tr_b16 v[76:77], v32 offset:62464
 ds_read_b64_tr_b16 v[78:79], v32 offset:62720
 v_mfma_f32_16x16x32_bf16 v[148:151], v[80:83], a[52:55], v[148:151]
 ds_read_b128 a[200:203], v39 offset:0
 v_mfma_f32_16x16x32_bf16 v[96:99], v[84:87], a[56:59], v[96:99]
 s_waitcnt lgkmcnt(8)
 s_waitcnt vmcnt(14)
 s_barrier
 ds_read_b64_tr_b16 v[80:81], v31 offset:0
 ds_read_b64_tr_b16 v[82:83], v31 offset:256
 v_mfma_f32_16x16x32_bf16 v[100:103], v[84:87], a[60:63], v[100:103]
 buffer_load_dwordx4 v253, s[4:7], s35 offen offset:2048 sc1 lds
 v_mfma_f32_16x16x32_bf16 v[104:107], v[88:91], a[56:59], v[104:107]
 ds_read_b64_tr_b16 v[84:85], v31 offset:1024
 ds_read_b64_tr_b16 v[86:87], v31 offset:1280
 v_mfma_f32_16x16x32_bf16 v[108:111], v[88:91], a[60:63], v[108:111]
 ds_read_b128 a[204:207], v39 offset:2048
 v_mfma_f32_16x16x32_bf16 v[112:115], v[92:95], a[56:59], v[112:115]
 ds_read_b64_tr_b16 v[88:89], v31 offset:2048
 ds_read_b64_tr_b16 v[90:91], v31 offset:2304
 v_mfma_f32_16x16x32_bf16 v[116:119], v[92:95], a[60:63], v[116:119]
 buffer_load_dwordx4 v254, s[4:7], s35 offen offset:3072 sc1 lds
 v_mfma_f32_16x16x32_bf16 v[120:123], v[64:67], a[56:59], v[120:123]
 s_waitcnt lgkmcnt(8)
 ds_read_b64_tr_b16 v[92:93], v31 offset:3072
 ds_read_b64_tr_b16 v[94:95], v31 offset:3328
 v_mfma_f32_16x16x32_bf16 v[124:127], v[64:67], a[60:63], v[124:127]
 s_add_u32 m0, s60, 0x14000
 s_bfe_u32 s34, s84, 0x4001c
 s_mul_i32 s34, s34, 0x100
 v_mfma_f32_16x16x32_bf16 v[128:131], v[68:71], a[56:59], v[128:131]
 ds_read_b64_tr_b16 v[64:65], v31 offset:4096
 ds_read_b64_tr_b16 v[66:67], v31 offset:4352
 v_mfma_f32_16x16x32_bf16 v[132:135], v[68:71], a[60:63], v[132:135]
 buffer_load_dwordx4 v15, s[20:23], s34 offen offset:0  lds
 v_mfma_f32_16x16x32_bf16 v[136:139], v[72:75], a[56:59], v[136:139]
 ds_read_b64_tr_b16 v[68:69], v31 offset:5120
 ds_read_b64_tr_b16 v[70:71], v31 offset:5376
 v_mfma_f32_16x16x32_bf16 v[140:143], v[72:75], a[60:63], v[140:143]
 buffer_load_dwordx4 v16, s[20:23], s34 offen offset:1024  lds
 v_mfma_f32_16x16x32_bf16 v[144:147], v[76:79], a[56:59], v[144:147]
 s_waitcnt lgkmcnt(6)
 ds_read_b64_tr_b16 v[72:73], v31 offset:6144
 ds_read_b64_tr_b16 v[74:75], v31 offset:6400
 v_mfma_f32_16x16x32_bf16 v[148:151], v[76:79], a[60:63], v[148:151]
 buffer_load_dwordx4 v17, s[20:23], s34 offen offset:2048  lds
 v_mfma_f32_16x16x32_bf16 v[96:99], v[80:83], a[64:67], v[96:99]
 ds_read_b64_tr_b16 v[76:77], v31 offset:7168
 ds_read_b64_tr_b16 v[78:79], v31 offset:7424
 v_mfma_f32_16x16x32_bf16 v[100:103], v[80:83], a[68:71], v[100:103]
 v_mfma_f32_16x16x32_bf16 v[104:107], v[84:87], a[64:67], v[104:107]
 ds_read_b64_tr_b16 v[80:81], v31 offset:8192
 ds_read_b64_tr_b16 v[82:83], v31 offset:8448
 v_mfma_f32_16x16x32_bf16 v[108:111], v[84:87], a[68:71], v[108:111]
 buffer_load_dwordx4 v18, s[20:23], s34 offen offset:3072  lds
 v_mfma_f32_16x16x32_bf16 v[112:115], v[88:91], a[64:67], v[112:115]
 s_waitcnt lgkmcnt(6)
 ds_read_b64_tr_b16 v[84:85], v31 offset:9216
 ds_read_b64_tr_b16 v[86:87], v31 offset:9472
 v_mfma_f32_16x16x32_bf16 v[116:119], v[88:91], a[68:71], v[116:119]
 ds_read_b128 a[208:211], v34 offset:16384
 s_add_u32 m0, s60, 0x20000
 v_mfma_f32_16x16x32_bf16 v[120:123], v[92:95], a[64:67], v[120:123]
 s_add_u32 s35, s35, 0x7000
 ds_read_b64_tr_b16 v[88:89], v31 offset:10240
 ds_read_b64_tr_b16 v[90:91], v31 offset:10496
 v_mfma_f32_16x16x32_bf16 v[124:127], v[92:95], a[68:71], v[124:127]
 buffer_load_dwordx4 v11, s[4:7], s35 offen offset:0 sc1 lds
 v_mfma_f32_16x16x32_bf16 v[128:131], v[64:67], a[64:67], v[128:131]
 ds_read_b64_tr_b16 v[92:93], v31 offset:11264
 ds_read_b64_tr_b16 v[94:95], v31 offset:11520
 v_mfma_f32_16x16x32_bf16 v[132:135], v[64:67], a[68:71], v[132:135]
 ds_read_b128 a[212:215], v34 offset:18432
 v_mfma_f32_16x16x32_bf16 v[136:139], v[68:71], a[64:67], v[136:139]
 s_waitcnt lgkmcnt(8)
 ds_read_b64_tr_b16 v[64:65], v31 offset:12288
 ds_read_b64_tr_b16 v[66:67], v31 offset:12544
 v_mfma_f32_16x16x32_bf16 v[140:143], v[68:71], a[68:71], v[140:143]
 buffer_load_dwordx4 v252, s[4:7], s35 offen offset:1024 sc1 lds
 v_mfma_f32_16x16x32_bf16 v[144:147], v[72:75], a[64:67], v[144:147]
 ds_read_b64_tr_b16 v[68:69], v31 offset:13312
 ds_read_b64_tr_b16 v[70:71], v31 offset:13568
 v_mfma_f32_16x16x32_bf16 v[148:151], v[72:75], a[68:71], v[148:151]
 ds_read_b128 a[216:219], v35 offset:16384
 v_mfma_f32_16x16x32_bf16 v[96:99], v[76:79], a[72:75], v[96:99]
 s_waitcnt vmcnt(18)
 s_barrier
 ds_read_b64_tr_b16 v[72:73], v31 offset:32768
 ds_read_b64_tr_b16 v[74:75], v31 offset:33024
 v_mfma_f32_16x16x32_bf16 v[100:103], v[76:79], a[76:79], v[100:103]
 buffer_load_dwordx4 v253, s[4:7], s35 offen offset:2048 sc1 lds
 v_mfma_f32_16x16x32_bf16 v[104:107], v[80:83], a[72:75], v[104:107]
 s_waitcnt lgkmcnt(8)
 ds_read_b64_tr_b16 v[76:77], v31 offset:33792
 ds_read_b64_tr_b16 v[78:79], v31 offset:34048
 v_mfma_f32_16x16x32_bf16 v[108:111], v[80:83], a[76:79], v[108:111]
 ds_read_b128 a[220:223], v35 offset:18432
 v_mfma_f32_16x16x32_bf16 v[112:115], v[84:87], a[72:75], v[112:115]
 ds_read_b64_tr_b16 v[80:81], v31 offset:34816
 ds_read_b64_tr_b16 v[82:83], v31 offset:35072
 v_mfma_f32_16x16x32_bf16 v[116:119], v[84:87], a[76:79], v[116:119]
 buffer_load_dwordx4 v254, s[4:7], s35 offen offset:3072 sc1 lds
 v_mfma_f32_16x16x32_bf16 v[120:123], v[88:91], a[72:75], v[120:123]
 s_add_u32 m0, s60, 0x1c000
 ds_read_b64_tr_b16 v[84:85], v31 offset:35840
 ds_read_b64_tr_b16 v[86:87], v31 offset:36096
 v_mfma_f32_16x16x32_bf16 v[124:127], v[88:91], a[76:79], v[124:127]
 s_add_u32 s34, s34, 0x80
 v_mfma_f32_16x16x32_bf16 v[128:131], v[92:95], a[72:75], v[128:131]
 s_waitcnt lgkmcnt(7)
 ds_read_b64_tr_b16 v[88:89], v31 offset:36864
 ds_read_b64_tr_b16 v[90:91], v31 offset:37120
 v_mfma_f32_16x16x32_bf16 v[132:135], v[92:95], a[76:79], v[132:135]
 buffer_load_dwordx4 v15, s[20:23], s34 offen offset:0  lds
 v_mfma_f32_16x16x32_bf16 v[136:139], v[64:67], a[72:75], v[136:139]
 ds_read_b64_tr_b16 v[92:93], v31 offset:37888
 ds_read_b64_tr_b16 v[94:95], v31 offset:38144
 v_mfma_f32_16x16x32_bf16 v[140:143], v[64:67], a[76:79], v[140:143]
 v_mfma_f32_16x16x32_bf16 v[144:147], v[68:71], a[72:75], v[144:147]
 ds_read_b64_tr_b16 v[64:65], v31 offset:38912
 ds_read_b64_tr_b16 v[66:67], v31 offset:39168
 v_mfma_f32_16x16x32_bf16 v[148:151], v[68:71], a[76:79], v[148:151]
 buffer_load_dwordx4 v16, s[20:23], s34 offen offset:1024  lds
 v_mfma_f32_16x16x32_bf16 v[96:99], v[72:75], a[80:83], v[96:99]
 s_waitcnt lgkmcnt(6)
 ds_read_b64_tr_b16 v[68:69], v31 offset:39936
 ds_read_b64_tr_b16 v[70:71], v31 offset:40192
 v_mfma_f32_16x16x32_bf16 v[100:103], v[72:75], a[84:87], v[100:103]
 v_mfma_f32_16x16x32_bf16 v[104:107], v[76:79], a[80:83], v[104:107]
 ds_read_b64_tr_b16 v[72:73], v31 offset:40960
 ds_read_b64_tr_b16 v[74:75], v31 offset:41216
 v_mfma_f32_16x16x32_bf16 v[108:111], v[76:79], a[84:87], v[108:111]
 buffer_load_dwordx4 v17, s[20:23], s34 offen offset:2048  lds
 v_mfma_f32_16x16x32_bf16 v[112:115], v[80:83], a[80:83], v[112:115]
 ds_read_b64_tr_b16 v[76:77], v31 offset:41984
 ds_read_b64_tr_b16 v[78:79], v31 offset:42240
 v_mfma_f32_16x16x32_bf16 v[116:119], v[80:83], a[84:87], v[116:119]
 s_waitcnt vmcnt(15)
 ds_read_b128 a[224:227], v34 offset:49152
 v_mfma_f32_16x16x32_bf16 v[120:123], v[84:87], a[80:83], v[120:123]
 s_waitcnt lgkmcnt(7)
 ds_read_b64_tr_b16 v[80:81], v31 offset:43008
 ds_read_b64_tr_b16 v[82:83], v31 offset:43264
 v_mfma_f32_16x16x32_bf16 v[124:127], v[84:87], a[84:87], v[124:127]
 buffer_load_dwordx4 v18, s[20:23], s34 offen offset:3072  lds
 v_mfma_f32_16x16x32_bf16 v[128:131], v[88:91], a[80:83], v[128:131]
 s_add_u32 m0, s60, 0x4000
 ds_read_b64_tr_b16 v[84:85], v31 offset:44032
 ds_read_b64_tr_b16 v[86:87], v31 offset:44288
 v_mfma_f32_16x16x32_bf16 v[132:135], v[88:91], a[84:87], v[132:135]
 ds_read_b128 a[228:231], v34 offset:51200
 s_bfe_u32 s35, s84, 0x40010
 v_mfma_f32_16x16x32_bf16 v[136:139], v[92:95], a[80:83], v[136:139]
 s_mul_i32 s35, s35, 0xe000
 ds_read_b64_tr_b16 v[88:89], v31 offset:45056
 ds_read_b64_tr_b16 v[90:91], v31 offset:45312
 v_mfma_f32_16x16x32_bf16 v[140:143], v[92:95], a[84:87], v[140:143]
 ds_read_b128 a[232:235], v35 offset:49152
 s_add_u32 s35, s35, s45
 v_mfma_f32_16x16x32_bf16 v[144:147], v[64:67], a[80:83], v[144:147]
 s_waitcnt lgkmcnt(9)
 ds_read_b64_tr_b16 v[92:93], v31 offset:46080
 ds_read_b64_tr_b16 v[94:95], v31 offset:46336
 v_mfma_f32_16x16x32_bf16 v[148:151], v[64:67], a[84:87], v[148:151]
 buffer_load_dwordx4 v11, s[4:7], s35 offen offset:0 sc1 lds
 v_mfma_f32_16x16x32_bf16 v[96:99], v[68:71], a[88:91], v[96:99]
 s_barrier
 ds_read_b64_tr_b16 v[64:65], v32 offset:0
 ds_read_b64_tr_b16 v[66:67], v32 offset:256
 v_mfma_f32_16x16x32_bf16 v[100:103], v[68:71], a[92:95], v[100:103]
 buffer_load_dwordx4 v252, s[4:7], s35 offen offset:1024 sc1 lds
 v_mfma_f32_16x16x32_bf16 v[104:107], v[72:75], a[88:91], v[104:107]
 ds_read_b64_tr_b16 v[68:69], v32 offset:1024
 ds_read_b64_tr_b16 v[70:71], v32 offset:1280
 v_mfma_f32_16x16x32_bf16 v[108:111], v[72:75], a[92:95], v[108:111]
 ds_read_b128 a[236:239], v35 offset:51200
 v_mfma_f32_16x16x32_bf16 v[112:115], v[76:79], a[88:91], v[112:115]
 s_waitcnt lgkmcnt(8)
 ds_read_b64_tr_b16 v[72:73], v32 offset:2048
 ds_read_b64_tr_b16 v[74:75], v32 offset:2304
 v_mfma_f32_16x16x32_bf16 v[116:119], v[76:79], a[92:95], v[116:119]
 buffer_load_dwordx4 v253, s[4:7], s35 offen offset:2048 sc1 lds
 v_mfma_f32_16x16x32_bf16 v[120:123], v[80:83], a[88:91], v[120:123]
 ds_read_b64_tr_b16 v[76:77], v32 offset:3072
 ds_read_b64_tr_b16 v[78:79], v32 offset:3328
 v_mfma_f32_16x16x32_bf16 v[124:127], v[80:83], a[92:95], v[124:127]
 buffer_load_dwordx4 v254, s[4:7], s35 offen offset:3072 sc1 lds
 v_mfma_f32_16x16x32_bf16 v[128:131], v[84:87], a[88:91], v[128:131]
 s_add_u32 m0, s60, 0x0
 ds_read_b64_tr_b16 v[80:81], v32 offset:4096
 ds_read_b64_tr_b16 v[82:83], v32 offset:4352
 v_mfma_f32_16x16x32_bf16 v[132:135], v[84:87], a[92:95], v[132:135]
 s_bfe_u32 s34, s85, 0x40000
 s_mul_i32 s34, s34, 0x100
 v_mfma_f32_16x16x32_bf16 v[136:139], v[88:91], a[88:91], v[136:139]
 s_waitcnt lgkmcnt(7)
 ds_read_b64_tr_b16 v[84:85], v32 offset:5120
 ds_read_b64_tr_b16 v[86:87], v32 offset:5376
 v_mfma_f32_16x16x32_bf16 v[140:143], v[88:91], a[92:95], v[140:143]
 buffer_load_dwordx4 v15, s[20:23], s34 offen offset:0  lds
 v_mfma_f32_16x16x32_bf16 v[144:147], v[92:95], a[88:91], v[144:147]
 ds_read_b64_tr_b16 v[88:89], v32 offset:6144
 ds_read_b64_tr_b16 v[90:91], v32 offset:6400
 v_mfma_f32_16x16x32_bf16 v[148:151], v[92:95], a[92:95], v[148:151]
 s_waitcnt lgkmcnt(10)
 v_mfma_f32_16x16x32_bf16 v[96:99], v[64:67], a[96:99], v[96:99]
 ds_read_b64_tr_b16 v[92:93], v32 offset:7168
 ds_read_b64_tr_b16 v[94:95], v32 offset:7424
 v_mfma_f32_16x16x32_bf16 v[100:103], v[64:67], a[100:103], v[100:103]
 buffer_load_dwordx4 v16, s[20:23], s34 offen offset:1024  lds
 v_mfma_f32_16x16x32_bf16 v[104:107], v[68:71], a[96:99], v[104:107]
 s_waitcnt lgkmcnt(6)
 ds_read_b64_tr_b16 v[64:65], v32 offset:8192
 ds_read_b64_tr_b16 v[66:67], v32 offset:8448
 v_mfma_f32_16x16x32_bf16 v[108:111], v[68:71], a[100:103], v[108:111]
 s_waitcnt vmcnt(14)
 ds_read_b128 a[240:243], v36 offset:16384
 v_mfma_f32_16x16x32_bf16 v[112:115], v[72:75], a[96:99], v[112:115]
 ds_read_b64_tr_b16 v[68:69], v32 offset:9216
 ds_read_b64_tr_b16 v[70:71], v32 offset:9472
 v_mfma_f32_16x16x32_bf16 v[116:119], v[72:75], a[100:103], v[116:119]
 buffer_load_dwordx4 v17, s[20:23], s34 offen offset:2048  lds
 v_mfma_f32_16x16x32_bf16 v[120:123], v[76:79], a[96:99], v[120:123]
 ds_read_b64_tr_b16 v[72:73], v32 offset:10240
 ds_read_b64_tr_b16 v[74:75], v32 offset:10496
 v_mfma_f32_16x16x32_bf16 v[124:127], v[76:79], a[100:103], v[124:127]
 ds_read_b128 a[244:247], v36 offset:18432
 v_mfma_f32_16x16x32_bf16 v[128:131], v[80:83], a[96:99], v[128:131]
 s_waitcnt lgkmcnt(8)
 ds_read_b64_tr_b16 v[76:77], v32 offset:11264
 ds_read_b64_tr_b16 v[78:79], v32 offset:11520
 v_mfma_f32_16x16x32_bf16 v[132:135], v[80:83], a[100:103], v[132:135]
 buffer_load_dwordx4 v18, s[20:23], s34 offen offset:3072  lds
 v_mfma_f32_16x16x32_bf16 v[136:139], v[84:87], a[96:99], v[136:139]
 s_add_u32 m0, s60, 0xc000
 ds_read_b64_tr_b16 v[80:81], v32 offset:12288
 ds_read_b64_tr_b16 v[82:83], v32 offset:12544
 v_mfma_f32_16x16x32_bf16 v[140:143], v[84:87], a[100:103], v[140:143]
 ds_read_b128 a[248:251], v37 offset:16384
 s_add_u32 s35, s35, 0x7000
 v_mfma_f32_16x16x32_bf16 v[144:147], v[88:91], a[96:99], v[144:147]
 ds_read_b64_tr_b16 v[84:85], v32 offset:13312
 ds_read_b64_tr_b16 v[86:87], v32 offset:13568
 v_mfma_f32_16x16x32_bf16 v[148:151], v[88:91], a[100:103], v[148:151]
 buffer_load_dwordx4 v11, s[4:7], s35 offen offset:0 sc1 lds
 v_mfma_f32_16x16x32_bf16 v[96:99], v[92:95], a[104:107], v[96:99]
 s_waitcnt lgkmcnt(8)
 s_barrier
 ds_read_b64_tr_b16 v[88:89], v32 offset:32768
 ds_read_b64_tr_b16 v[90:91], v32 offset:33024
 v_mfma_f32_16x16x32_bf16 v[100:103], v[92:95], a[108:111], v[100:103]
 ds_read_b128 a[252:255], v37 offset:18432
 v_mfma_f32_16x16x32_bf16 v[104:107], v[64:67], a[104:107], v[104:107]
 ds_read_b64_tr_b16 v[92:93], v32 offset:33792
 ds_read_b64_tr_b16 v[94:95], v32 offset:34048
 v_mfma_f32_16x16x32_bf16 v[108:111], v[64:67], a[108:111], v[108:111]
 buffer_load_dwordx4 v252, s[4:7], s35 offen offset:1024 sc1 lds
 v_mfma_f32_16x16x32_bf16 v[112:115], v[68:71], a[104:107], v[112:115]
 ds_read_b64_tr_b16 v[64:65], v32 offset:34816
 ds_read_b64_tr_b16 v[66:67], v32 offset:35072
 v_mfma_f32_16x16x32_bf16 v[116:119], v[68:71], a[108:111], v[116:119]
 buffer_load_dwordx4 v253, s[4:7], s35 offen offset:2048 sc1 lds
 v_mfma_f32_16x16x32_bf16 v[120:123], v[72:75], a[104:107], v[120:123]
 s_waitcnt lgkmcnt(7)
 ds_read_b64_tr_b16 v[68:69], v32 offset:35840
 ds_read_b64_tr_b16 v[70:71], v32 offset:36096
 v_mfma_f32_16x16x32_bf16 v[124:127], v[72:75], a[108:111], v[124:127]
 v_mfma_f32_16x16x32_bf16 v[128:131], v[76:79], a[104:107], v[128:131]
 ds_read_b64_tr_b16 v[72:73], v32 offset:36864
 ds_read_b64_tr_b16 v[74:75], v32 offset:37120
 v_mfma_f32_16x16x32_bf16 v[132:135], v[76:79], a[108:111], v[132:135]
 buffer_load_dwordx4 v254, s[4:7], s35 offen offset:3072 sc1 lds
 v_mfma_f32_16x16x32_bf16 v[136:139], v[80:83], a[104:107], v[136:139]
 s_add_u32 m0, s60, 0x8000
 ds_read_b64_tr_b16 v[76:77], v32 offset:37888
 ds_read_b64_tr_b16 v[78:79], v32 offset:38144
 v_mfma_f32_16x16x32_bf16 v[140:143], v[80:83], a[108:111], v[140:143]
 s_add_u32 s34, s34, 0x80
 v_mfma_f32_16x16x32_bf16 v[144:147], v[84:87], a[104:107], v[144:147]
 s_waitcnt lgkmcnt(6)
 ds_read_b64_tr_b16 v[80:81], v32 offset:38912
 ds_read_b64_tr_b16 v[82:83], v32 offset:39168
 v_mfma_f32_16x16x32_bf16 v[148:151], v[84:87], a[108:111], v[148:151]
 buffer_load_dwordx4 v15, s[20:23], s34 offen offset:0  lds
 v_mfma_f32_16x16x32_bf16 v[96:99], v[88:91], a[112:115], v[96:99]
 ds_read_b64_tr_b16 v[84:85], v32 offset:39936
 ds_read_b64_tr_b16 v[86:87], v32 offset:40192
 v_mfma_f32_16x16x32_bf16 v[100:103], v[88:91], a[116:119], v[100:103]
 v_mfma_f32_16x16x32_bf16 v[104:107], v[92:95], a[112:115], v[104:107]
 ds_read_b64_tr_b16 v[88:89], v32 offset:40960
 ds_read_b64_tr_b16 v[90:91], v32 offset:41216
 v_mfma_f32_16x16x32_bf16 v[108:111], v[92:95], a[116:119], v[108:111]
 buffer_load_dwordx4 v16, s[20:23], s34 offen offset:1024  lds
 v_mfma_f32_16x16x32_bf16 v[112:115], v[64:67], a[112:115], v[112:115]
 s_waitcnt lgkmcnt(6)
 ds_read_b64_tr_b16 v[92:93], v32 offset:41984
 ds_read_b64_tr_b16 v[94:95], v32 offset:42240
 v_mfma_f32_16x16x32_bf16 v[116:119], v[64:67], a[116:119], v[116:119]
 s_waitcnt vmcnt(14)
 ds_read_b128 a[0:3], v36 offset:49152
 v_mfma_f32_16x16x32_bf16 v[120:123], v[68:71], a[112:115], v[120:123]
 ds_read_b64_tr_b16 v[64:65], v32 offset:43008
 ds_read_b64_tr_b16 v[66:67], v32 offset:43264
 v_mfma_f32_16x16x32_bf16 v[124:127], v[68:71], a[116:119], v[124:127]
 buffer_load_dwordx4 v17, s[20:23], s34 offen offset:2048  lds
 v_mfma_f32_16x16x32_bf16 v[128:131], v[72:75], a[112:115], v[128:131]
 ds_read_b64_tr_b16 v[68:69], v32 offset:44032
 ds_read_b64_tr_b16 v[70:71], v32 offset:44288
 v_mfma_f32_16x16x32_bf16 v[132:135], v[72:75], a[116:119], v[132:135]
 ds_read_b128 a[4:7], v36 offset:51200
 v_mfma_f32_16x16x32_bf16 v[136:139], v[76:79], a[112:115], v[136:139]
 s_waitcnt lgkmcnt(8)
 ds_read_b64_tr_b16 v[72:73], v32 offset:45056
 ds_read_b64_tr_b16 v[74:75], v32 offset:45312
 v_mfma_f32_16x16x32_bf16 v[140:143], v[76:79], a[116:119], v[140:143]
 buffer_load_dwordx4 v18, s[20:23], s34 offen offset:3072  lds
 v_mfma_f32_16x16x32_bf16 v[144:147], v[80:83], a[112:115], v[144:147]
 s_add_u32 m0, s60, 0x14000
 ds_read_b64_tr_b16 v[76:77], v32 offset:46080
 ds_read_b64_tr_b16 v[78:79], v32 offset:46336
 v_mfma_f32_16x16x32_bf16 v[148:151], v[80:83], a[116:119], v[148:151]
 ds_read_b128 a[8:11], v37 offset:49152
 s_bfe_u32 s35, s84, 0x40014
 v_mfma_f32_16x16x32_bf16 v[96:99], v[84:87], a[120:123], v[96:99]
 s_mul_i32 s35, s35, 0xe000
 s_barrier
 ds_read_b64_tr_b16 v[80:81], v33 offset:0
 ds_read_b64_tr_b16 v[82:83], v33 offset:256
 v_mfma_f32_16x16x32_bf16 v[100:103], v[84:87], a[124:127], v[100:103]
 ds_read_b128 a[12:15], v37 offset:51200
 s_add_u32 s35, s35, s45
 v_mfma_f32_16x16x32_bf16 v[104:107], v[88:91], a[120:123], v[104:107]
 s_waitcnt lgkmcnt(9)
 ds_read_b64_tr_b16 v[84:85], v33 offset:1024
 ds_read_b64_tr_b16 v[86:87], v33 offset:1280
 v_mfma_f32_16x16x32_bf16 v[108:111], v[88:91], a[124:127], v[108:111]
 buffer_load_dwordx4 v11, s[4:7], s35 offen offset:0 sc1 lds
 v_mfma_f32_16x16x32_bf16 v[112:115], v[92:95], a[120:123], v[112:115]
 ds_read_b64_tr_b16 v[88:89], v33 offset:2048
 ds_read_b64_tr_b16 v[90:91], v33 offset:2304
 v_mfma_f32_16x16x32_bf16 v[116:119], v[92:95], a[124:127], v[116:119]
 buffer_load_dwordx4 v252, s[4:7], s35 offen offset:1024 sc1 lds
 v_mfma_f32_16x16x32_bf16 v[120:123], v[64:67], a[120:123], v[120:123]
 ds_read_b64_tr_b16 v[92:93], v33 offset:3072
 ds_read_b64_tr_b16 v[94:95], v33 offset:3328
 v_mfma_f32_16x16x32_bf16 v[124:127], v[64:67], a[124:127], v[124:127]
 v_mfma_f32_16x16x32_bf16 v[128:131], v[68:71], a[120:123], v[128:131]
 s_waitcnt lgkmcnt(7)
 ds_read_b64_tr_b16 v[64:65], v33 offset:4096
 ds_read_b64_tr_b16 v[66:67], v33 offset:4352
 v_mfma_f32_16x16x32_bf16 v[132:135], v[68:71], a[124:127], v[132:135]
 buffer_load_dwordx4 v253, s[4:7], s35 offen offset:2048 sc1 lds
 v_mfma_f32_16x16x32_bf16 v[136:139], v[72:75], a[120:123], v[136:139]
 ds_read_b64_tr_b16 v[68:69], v33 offset:5120
 ds_read_b64_tr_b16 v[70:71], v33 offset:5376
 v_mfma_f32_16x16x32_bf16 v[140:143], v[72:75], a[124:127], v[140:143]
 buffer_load_dwordx4 v254, s[4:7], s35 offen offset:3072 sc1 lds
 v_mfma_f32_16x16x32_bf16 v[144:147], v[76:79], a[120:123], v[144:147]
 s_add_u32 m0, s60, 0x10000
 ds_read_b64_tr_b16 v[72:73], v33 offset:6144
 ds_read_b64_tr_b16 v[74:75], v33 offset:6400
 v_mfma_f32_16x16x32_bf16 v[148:151], v[76:79], a[124:127], v[148:151]
 s_waitcnt lgkmcnt(12)
 s_bfe_u32 s34, s85, 0x40004
 s_mul_i32 s34, s34, 0x100
 v_mfma_f32_16x16x32_bf16 v[96:99], v[80:83], a[128:131], v[96:99]
 s_waitcnt lgkmcnt(6)
 ds_read_b64_tr_b16 v[76:77], v33 offset:7168
 ds_read_b64_tr_b16 v[78:79], v33 offset:7424
 v_mfma_f32_16x16x32_bf16 v[100:103], v[80:83], a[132:135], v[100:103]
 buffer_load_dwordx4 v15, s[20:23], s34 offen offset:0  lds
 v_mfma_f32_16x16x32_bf16 v[104:107], v[84:87], a[128:131], v[104:107]
 ds_read_b64_tr_b16 v[80:81], v33 offset:8192
 ds_read_b64_tr_b16 v[82:83], v33 offset:8448
 v_mfma_f32_16x16x32_bf16 v[108:111], v[84:87], a[132:135], v[108:111]
 s_waitcnt vmcnt(13)
 ds_read_b128 a[16:19], v34 offset:0
 v_mfma_f32_16x16x32_bf16 v[112:115], v[88:91], a[128:131], v[112:115]
 ds_read_b64_tr_b16 v[84:85], v33 offset:9216
 ds_read_b64_tr_b16 v[86:87], v33 offset:9472
 v_mfma_f32_16x16x32_bf16 v[116:119], v[88:91], a[132:135], v[116:119]
 buffer_load_dwordx4 v16, s[20:23], s34 offen offset:1024  lds
 v_mfma_f32_16x16x32_bf16 v[120:123], v[92:95], a[128:131], v[120:123]
 s_waitcnt lgkmcnt(7)
 ds_read_b64_tr_b16 v[88:89], v33 offset:10240
 ds_read_b64_tr_b16 v[90:91], v33 offset:10496
 v_mfma_f32_16x16x32_bf16 v[124:127], v[92:95], a[132:135], v[124:127]
 ds_read_b128 a[20:23], v34 offset:2048
 v_mfma_f32_16x16x32_bf16 v[128:131], v[64:67], a[128:131], v[128:131]
 ds_read_b64_tr_b16 v[92:93], v33 offset:11264
 ds_read_b64_tr_b16 v[94:95], v33 offset:11520
 v_mfma_f32_16x16x32_bf16 v[132:135], v[64:67], a[132:135], v[132:135]
 buffer_load_dwordx4 v17, s[20:23], s34 offen offset:2048  lds
 v_mfma_f32_16x16x32_bf16 v[136:139], v[68:71], a[128:131], v[136:139]
 ds_read_b64_tr_b16 v[64:65], v33 offset:12288
 ds_read_b64_tr_b16 v[66:67], v33 offset:12544
 v_mfma_f32_16x16x32_bf16 v[140:143], v[68:71], a[132:135], v[140:143]
 ds_read_b128 a[24:27], v35 offset:0
 v_mfma_f32_16x16x32_bf16 v[144:147], v[72:75], a[128:131], v[144:147]
 s_waitcnt lgkmcnt(8)
 ds_read_b64_tr_b16 v[68:69], v33 offset:13312
 ds_read_b64_tr_b16 v[70:71], v33 offset:13568
 v_mfma_f32_16x16x32_bf16 v[148:151], v[72:75], a[132:135], v[148:151]
 buffer_load_dwordx4 v18, s[20:23], s34 offen offset:3072  lds
 v_mfma_f32_16x16x32_bf16 v[96:99], v[76:79], a[136:139], v[96:99]
 s_add_u32 m0, s60, 0x1c000
 s_barrier
 ds_read_b64_tr_b16 v[72:73], v31 offset:16384
 ds_read_b64_tr_b16 v[74:75], v31 offset:16640
 v_mfma_f32_16x16x32_bf16 v[100:103], v[76:79], a[140:143], v[100:103]
 ds_read_b128 a[28:31], v35 offset:2048
 s_add_u32 s35, s35, 0x7000
 v_mfma_f32_16x16x32_bf16 v[104:107], v[80:83], a[136:139], v[104:107]
 ds_read_b64_tr_b16 v[76:77], v31 offset:17408
 ds_read_b64_tr_b16 v[78:79], v31 offset:17664
 v_mfma_f32_16x16x32_bf16 v[108:111], v[80:83], a[140:143], v[108:111]
 buffer_load_dwordx4 v11, s[4:7], s35 offen offset:0 sc1 lds
 v_mfma_f32_16x16x32_bf16 v[112:115], v[84:87], a[136:139], v[112:115]
 s_waitcnt lgkmcnt(8)
 ds_read_b64_tr_b16 v[80:81], v31 offset:18432
 ds_read_b64_tr_b16 v[82:83], v31 offset:18688
 v_mfma_f32_16x16x32_bf16 v[116:119], v[84:87], a[140:143], v[116:119]
 v_mfma_f32_16x16x32_bf16 v[120:123], v[88:91], a[136:139], v[120:123]
 ds_read_b64_tr_b16 v[84:85], v31 offset:19456
 ds_read_b64_tr_b16 v[86:87], v31 offset:19712
 v_mfma_f32_16x16x32_bf16 v[124:127], v[88:91], a[140:143], v[124:127]
 buffer_load_dwordx4 v252, s[4:7], s35 offen offset:1024 sc1 lds
 v_mfma_f32_16x16x32_bf16 v[128:131], v[92:95], a[136:139], v[128:131]
 ds_read_b64_tr_b16 v[88:89], v31 offset:20480
 ds_read_b64_tr_b16 v[90:91], v31 offset:20736
 v_mfma_f32_16x16x32_bf16 v[132:135], v[92:95], a[140:143], v[132:135]
 v_mfma_f32_16x16x32_bf16 v[136:139], v[64:67], a[136:139], v[136:139]
 s_waitcnt lgkmcnt(6)
 ds_read_b64_tr_b16 v[92:93], v31 offset:21504
 ds_read_b64_tr_b16 v[94:95], v31 offset:21760
 v_mfma_f32_16x16x32_bf16 v[140:143], v[64:67], a[140:143], v[140:143]
 buffer_load_dwordx4 v253, s[4:7], s35 offen offset:2048 sc1 lds
 v_mfma_f32_16x16x32_bf16 v[144:147], v[68:71], a[136:139], v[144:147]
 ds_read_b64_tr_b16 v[64:65], v31 offset:22528
 ds_read_b64_tr_b16 v[66:67], v31 offset:22784
 v_mfma_f32_16x16x32_bf16 v[148:151], v[68:71], a[140:143], v[148:151]
 v_mfma_f32_16x16x32_bf16 v[96:99], v[72:75], a[144:147], v[96:99]
 ds_read_b64_tr_b16 v[68:69], v31 offset:23552
 ds_read_b64_tr_b16 v[70:71], v31 offset:23808
 v_mfma_f32_16x16x32_bf16 v[100:103], v[72:75], a[148:151], v[100:103]
 buffer_load_dwordx4 v254, s[4:7], s35 offen offset:3072 sc1 lds
 v_mfma_f32_16x16x32_bf16 v[104:107], v[76:79], a[144:147], v[104:107]
 s_waitcnt lgkmcnt(6)
 ds_read_b64_tr_b16 v[72:73], v31 offset:24576
 ds_read_b64_tr_b16 v[74:75], v31 offset:24832
 v_mfma_f32_16x16x32_bf16 v[108:111], v[76:79], a[148:151], v[108:111]
 s_waitcnt vmcnt(12)
 ds_read_b128 a[32:35], v34 offset:32768
 s_add_u32 m0, s60, 0x18000
 v_mfma_f32_16x16x32_bf16 v[112:115], v[80:83], a[144:147], v[112:115]
 s_add_u32 s34, s34, 0x80
 ds_read_b64_tr_b16 v[76:77], v31 offset:25600
 ds_read_b64_tr_b16 v[78:79], v31 offset:25856
 v_mfma_f32_16x16x32_bf16 v[116:119], v[80:83], a[148:151], v[116:119]
 buffer_load_dwordx4 v15, s[20:23], s34 offen offset:0  lds
 v_mfma_f32_16x16x32_bf16 v[120:123], v[84:87], a[144:147], v[120:123]
 ds_read_b64_tr_b16 v[80:81], v31 offset:26624
 ds_read_b64_tr_b16 v[82:83], v31 offset:26880
 v_mfma_f32_16x16x32_bf16 v[124:127], v[84:87], a[148:151], v[124:127]
 buffer_load_dwordx4 v16, s[20:23], s34 offen offset:1024  lds
 v_mfma_f32_16x16x32_bf16 v[128:131], v[88:91], a[144:147], v[128:131]
 s_waitcnt lgkmcnt(7)
 ds_read_b64_tr_b16 v[84:85], v31 offset:27648
 ds_read_b64_tr_b16 v[86:87], v31 offset:27904
 v_mfma_f32_16x16x32_bf16 v[132:135], v[88:91], a[148:151], v[132:135]
 ds_read_b128 a[36:39], v34 offset:34816
 v_mfma_f32_16x16x32_bf16 v[136:139], v[92:95], a[144:147], v[136:139]
 ds_read_b64_tr_b16 v[88:89], v31 offset:28672
 ds_read_b64_tr_b16 v[90:91], v31 offset:28928
 v_mfma_f32_16x16x32_bf16 v[140:143], v[92:95], a[148:151], v[140:143]
 buffer_load_dwordx4 v17, s[20:23], s34 offen offset:2048  lds
 v_mfma_f32_16x16x32_bf16 v[144:147], v[64:67], a[144:147], v[144:147]
 ds_read_b64_tr_b16 v[92:93], v31 offset:29696
 ds_read_b64_tr_b16 v[94:95], v31 offset:29952
 v_mfma_f32_16x16x32_bf16 v[148:151], v[64:67], a[148:151], v[148:151]
 ds_read_b128 a[40:43], v35 offset:32768
 v_mfma_f32_16x16x32_bf16 v[96:99], v[68:71], a[152:155], v[96:99]
 s_waitcnt lgkmcnt(8)
 s_barrier
 ds_read_b64_tr_b16 v[64:65], v31 offset:49152
 ds_read_b64_tr_b16 v[66:67], v31 offset:49408
 v_mfma_f32_16x16x32_bf16 v[100:103], v[68:71], a[156:159], v[100:103]
 buffer_load_dwordx4 v18, s[20:23], s34 offen offset:3072  lds
 v_mfma_f32_16x16x32_bf16 v[104:107], v[72:75], a[152:155], v[104:107]
 s_add_u32 m0, s60, 0x20000
 ds_read_b64_tr_b16 v[68:69], v31 offset:50176
 ds_read_b64_tr_b16 v[70:71], v31 offset:50432
 v_mfma_f32_16x16x32_bf16 v[108:111], v[72:75], a[156:159], v[108:111]
 ds_read_b128 a[44:47], v35 offset:34816
 s_bfe_u32 s34, s85, 0x40008
 v_mfma_f32_16x16x32_bf16 v[112:115], v[76:79], a[152:155], v[112:115]
 s_mul_i32 s34, s34, 0x100
 ds_read_b64_tr_b16 v[72:73], v31 offset:51200
 ds_read_b64_tr_b16 v[74:75], v31 offset:51456
 v_mfma_f32_16x16x32_bf16 v[116:119], v[76:79], a[156:159], v[116:119]
 buffer_load_dwordx4 v15, s[20:23], s34 offen offset:0  lds
 v_mfma_f32_16x16x32_bf16 v[120:123], v[80:83], a[152:155], v[120:123]
 s_waitcnt lgkmcnt(8)
 ds_read_b64_tr_b16 v[76:77], v31 offset:52224
 ds_read_b64_tr_b16 v[78:79], v31 offset:52480
 v_mfma_f32_16x16x32_bf16 v[124:127], v[80:83], a[156:159], v[124:127]
 v_mfma_f32_16x16x32_bf16 v[128:131], v[84:87], a[152:155], v[128:131]
 ds_read_b64_tr_b16 v[80:81], v31 offset:53248
 ds_read_b64_tr_b16 v[82:83], v31 offset:53504
 v_mfma_f32_16x16x32_bf16 v[132:135], v[84:87], a[156:159], v[132:135]
 buffer_load_dwordx4 v16, s[20:23], s34 offen offset:1024  lds
 v_mfma_f32_16x16x32_bf16 v[136:139], v[88:91], a[152:155], v[136:139]
 ds_read_b64_tr_b16 v[84:85], v31 offset:54272
 ds_read_b64_tr_b16 v[86:87], v31 offset:54528
 v_mfma_f32_16x16x32_bf16 v[140:143], v[88:91], a[156:159], v[140:143]
 v_mfma_f32_16x16x32_bf16 v[144:147], v[92:95], a[152:155], v[144:147]
 s_waitcnt lgkmcnt(6)
 ds_read_b64_tr_b16 v[88:89], v31 offset:55296
 ds_read_b64_tr_b16 v[90:91], v31 offset:55552
 v_mfma_f32_16x16x32_bf16 v[148:151], v[92:95], a[156:159], v[148:151]
 buffer_load_dwordx4 v17, s[20:23], s34 offen offset:2048  lds
 v_mfma_f32_16x16x32_bf16 v[96:99], v[64:67], a[160:163], v[96:99]
 ds_read_b64_tr_b16 v[92:93], v31 offset:56320
 ds_read_b64_tr_b16 v[94:95], v31 offset:56576
 v_mfma_f32_16x16x32_bf16 v[100:103], v[64:67], a[164:167], v[100:103]
 v_mfma_f32_16x16x32_bf16 v[104:107], v[68:71], a[160:163], v[104:107]
 ds_read_b64_tr_b16 v[64:65], v31 offset:57344
 ds_read_b64_tr_b16 v[66:67], v31 offset:57600
 v_mfma_f32_16x16x32_bf16 v[108:111], v[68:71], a[164:167], v[108:111]
 buffer_load_dwordx4 v18, s[20:23], s34 offen offset:3072  lds
 v_mfma_f32_16x16x32_bf16 v[112:115], v[72:75], a[160:163], v[112:115]
 s_waitcnt lgkmcnt(6)
 ds_read_b64_tr_b16 v[68:69], v31 offset:58368
 ds_read_b64_tr_b16 v[70:71], v31 offset:58624
 v_mfma_f32_16x16x32_bf16 v[116:119], v[72:75], a[164:167], v[116:119]
 s_waitcnt vmcnt(12)
 ds_read_b128 a[48:51], v36 offset:0
 s_add_u32 m0, s60, 0x0
 v_mfma_f32_16x16x32_bf16 v[120:123], v[76:79], a[160:163], v[120:123]
 s_bfe_u32 s35, s84, 0x40018
 ds_read_b64_tr_b16 v[72:73], v31 offset:59392
 ds_read_b64_tr_b16 v[74:75], v31 offset:59648
 v_mfma_f32_16x16x32_bf16 v[124:127], v[76:79], a[164:167], v[124:127]
 ds_read_b128 a[52:55], v36 offset:2048
 s_mul_i32 s35, s35, 0xe000
 v_mfma_f32_16x16x32_bf16 v[128:131], v[80:83], a[160:163], v[128:131]
 s_add_u32 s35, s35, s45
 ds_read_b64_tr_b16 v[76:77], v31 offset:60416
 ds_read_b64_tr_b16 v[78:79], v31 offset:60672
 v_mfma_f32_16x16x32_bf16 v[132:135], v[80:83], a[164:167], v[132:135]
 buffer_load_dwordx4 v11, s[4:7], s35 offen offset:0 sc1 lds
 v_mfma_f32_16x16x32_bf16 v[136:139], v[84:87], a[160:163], v[136:139]
 s_waitcnt lgkmcnt(8)
 ds_read_b64_tr_b16 v[80:81], v31 offset:61440
 ds_read_b64_tr_b16 v[82:83], v31 offset:61696
 v_mfma_f32_16x16x32_bf16 v[140:143], v[84:87], a[164:167], v[140:143]
 buffer_load_dwordx4 v252, s[4:7], s35 offen offset:1024 sc1 lds
 v_mfma_f32_16x16x32_bf16 v[144:147], v[88:91], a[160:163], v[144:147]
 ds_read_b64_tr_b16 v[84:85], v31 offset:62464
 ds_read_b64_tr_b16 v[86:87], v31 offset:62720
 v_mfma_f32_16x16x32_bf16 v[148:151], v[88:91], a[164:167], v[148:151]
 ds_read_b128 a[56:59], v37 offset:0
 v_mfma_f32_16x16x32_bf16 v[96:99], v[92:95], a[168:171], v[96:99]
 s_barrier
 ds_read_b64_tr_b16 v[88:89], v32 offset:16384
 ds_read_b64_tr_b16 v[90:91], v32 offset:16640
 v_mfma_f32_16x16x32_bf16 v[100:103], v[92:95], a[172:175], v[100:103]
 buffer_load_dwordx4 v253, s[4:7], s35 offen offset:2048 sc1 lds
 v_mfma_f32_16x16x32_bf16 v[104:107], v[64:67], a[168:171], v[104:107]
 s_waitcnt lgkmcnt(7)
 ds_read_b64_tr_b16 v[92:93], v32 offset:17408
 ds_read_b64_tr_b16 v[94:95], v32 offset:17664
 v_mfma_f32_16x16x32_bf16 v[108:111], v[64:67], a[172:175], v[108:111]
 ds_read_b128 a[60:63], v37 offset:2048
 v_mfma_f32_16x16x32_bf16 v[112:115], v[68:71], a[168:171], v[112:115]
 ds_read_b64_tr_b16 v[64:65], v32 offset:18432
 ds_read_b64_tr_b16 v[66:67], v32 offset:18688
 v_mfma_f32_16x16x32_bf16 v[116:119], v[68:71], a[172:175], v[116:119]
 buffer_load_dwordx4 v254, s[4:7], s35 offen offset:3072 sc1 lds
 v_mfma_f32_16x16x32_bf16 v[120:123], v[72:75], a[168:171], v[120:123]
 s_add_u32 m0, s60, 0x4000
 ds_read_b64_tr_b16 v[68:69], v32 offset:19456
 ds_read_b64_tr_b16 v[70:71], v32 offset:19712
 v_mfma_f32_16x16x32_bf16 v[124:127], v[72:75], a[172:175], v[124:127]
 s_add_u32 s34, s34, 0x80
 v_mfma_f32_16x16x32_bf16 v[128:131], v[76:79], a[168:171], v[128:131]
 s_waitcnt lgkmcnt(7)
 ds_read_b64_tr_b16 v[72:73], v32 offset:20480
 ds_read_b64_tr_b16 v[74:75], v32 offset:20736
 v_mfma_f32_16x16x32_bf16 v[132:135], v[76:79], a[172:175], v[132:135]
 buffer_load_dwordx4 v15, s[20:23], s34 offen offset:0  lds
 v_mfma_f32_16x16x32_bf16 v[136:139], v[80:83], a[168:171], v[136:139]
 ds_read_b64_tr_b16 v[76:77], v32 offset:21504
 ds_read_b64_tr_b16 v[78:79], v32 offset:21760
 v_mfma_f32_16x16x32_bf16 v[140:143], v[80:83], a[172:175], v[140:143]
 buffer_load_dwordx4 v16, s[20:23], s34 offen offset:1024  lds
 v_mfma_f32_16x16x32_bf16 v[144:147], v[84:87], a[168:171], v[144:147]
 ds_read_b64_tr_b16 v[80:81], v32 offset:22528
 ds_read_b64_tr_b16 v[82:83], v32 offset:22784
 v_mfma_f32_16x16x32_bf16 v[148:151], v[84:87], a[172:175], v[148:151]
 s_waitcnt lgkmcnt(10)
 v_mfma_f32_16x16x32_bf16 v[96:99], v[88:91], a[176:179], v[96:99]
 s_waitcnt lgkmcnt(6)
 ds_read_b64_tr_b16 v[84:85], v32 offset:23552
 ds_read_b64_tr_b16 v[86:87], v32 offset:23808
 v_mfma_f32_16x16x32_bf16 v[100:103], v[88:91], a[180:183], v[100:103]
 buffer_load_dwordx4 v17, s[20:23], s34 offen offset:2048  lds
 v_mfma_f32_16x16x32_bf16 v[104:107], v[92:95], a[176:179], v[104:107]
 ds_read_b64_tr_b16 v[88:89], v32 offset:24576
 ds_read_b64_tr_b16 v[90:91], v32 offset:24832
 v_mfma_f32_16x16x32_bf16 v[108:111], v[92:95], a[180:183], v[108:111]
 s_waitcnt vmcnt(11)
 ds_read_b128 a[64:67], v36 offset:32768
 v_mfma_f32_16x16x32_bf16 v[112:115], v[64:67], a[176:179], v[112:115]
 ds_read_b64_tr_b16 v[92:93], v32 offset:25600
 ds_read_b64_tr_b16 v[94:95], v32 offset:25856
 v_mfma_f32_16x16x32_bf16 v[116:119], v[64:67], a[180:183], v[116:119]
 buffer_load_dwordx4 v18, s[20:23], s34 offen offset:3072  lds
 v_mfma_f32_16x16x32_bf16 v[120:123], v[68:71], a[176:179], v[120:123]
 s_waitcnt lgkmcnt(7)
 ds_read_b64_tr_b16 v[64:65], v32 offset:26624
 ds_read_b64_tr_b16 v[66:67], v32 offset:26880
 v_mfma_f32_16x16x32_bf16 v[124:127], v[68:71], a[180:183], v[124:127]
 ds_read_b128 a[68:71], v36 offset:34816
 s_add_u32 m0, s60, 0x8000
 v_mfma_f32_16x16x32_bf16 v[128:131], v[72:75], a[176:179], v[128:131]
 s_add_u32 s35, s35, 0x7000
 ds_read_b64_tr_b16 v[68:69], v32 offset:27648
 ds_read_b64_tr_b16 v[70:71], v32 offset:27904
 v_mfma_f32_16x16x32_bf16 v[132:135], v[72:75], a[180:183], v[132:135]
 buffer_load_dwordx4 v11, s[4:7], s35 offen offset:0 sc1 lds
 v_mfma_f32_16x16x32_bf16 v[136:139], v[76:79], a[176:179], v[136:139]
 ds_read_b64_tr_b16 v[72:73], v32 offset:28672
 ds_read_b64_tr_b16 v[74:75], v32 offset:28928
 v_mfma_f32_16x16x32_bf16 v[140:143], v[76:79], a[180:183], v[140:143]
 ds_read_b128 a[72:75], v37 offset:32768
 v_mfma_f32_16x16x32_bf16 v[144:147], v[80:83], a[176:179], v[144:147]
 s_waitcnt lgkmcnt(8)
 ds_read_b64_tr_b16 v[76:77], v32 offset:29696
 ds_read_b64_tr_b16 v[78:79], v32 offset:29952
 v_mfma_f32_16x16x32_bf16 v[148:151], v[80:83], a[180:183], v[148:151]
 buffer_load_dwordx4 v252, s[4:7], s35 offen offset:1024 sc1 lds
 v_mfma_f32_16x16x32_bf16 v[96:99], v[84:87], a[184:187], v[96:99]
 s_barrier
 ds_read_b64_tr_b16 v[80:81], v32 offset:49152
 ds_read_b64_tr_b16 v[82:83], v32 offset:49408
 v_mfma_f32_16x16x32_bf16 v[100:103], v[84:87], a[188:191], v[100:103]
 buffer_load_dwordx4 v253, s[4:7], s35 offen offset:2048 sc1 lds
 v_mfma_f32_16x16x32_bf16 v[104:107], v[88:91], a[184:187], v[104:107]
 ds_read_b64_tr_b16 v[84:85], v32 offset:50176
 ds_read_b64_tr_b16 v[86:87], v32 offset:50432
 v_mfma_f32_16x16x32_bf16 v[108:111], v[88:91], a[188:191], v[108:111]
 ds_read_b128 a[76:79], v37 offset:34816
 v_mfma_f32_16x16x32_bf16 v[112:115], v[92:95], a[184:187], v[112:115]
 s_waitcnt lgkmcnt(8)
 ds_read_b64_tr_b16 v[88:89], v32 offset:51200
 ds_read_b64_tr_b16 v[90:91], v32 offset:51456
 v_mfma_f32_16x16x32_bf16 v[116:119], v[92:95], a[188:191], v[116:119]
 buffer_load_dwordx4 v254, s[4:7], s35 offen offset:3072 sc1 lds
 v_mfma_f32_16x16x32_bf16 v[120:123], v[64:67], a[184:187], v[120:123]
 s_add_u32 m0, s60, 0xc000
 ds_read_b64_tr_b16 v[92:93], v32 offset:52224
 ds_read_b64_tr_b16 v[94:95], v32 offset:52480
 v_mfma_f32_16x16x32_bf16 v[124:127], v[64:67], a[188:191], v[124:127]
 s_bfe_u32 s34, s85, 0x4000c
 s_mul_i32 s34, s34, 0x100
 v_mfma_f32_16x16x32_bf16 v[128:131], v[68:71], a[184:187], v[128:131]
 ds_read_b64_tr_b16 v[64:65], v32 offset:53248
 ds_read_b64_tr_b16 v[66:67], v32 offset:53504
 v_mfma_f32_16x16x32_bf16 v[132:135], v[68:71], a[188:191], v[132:135]
 buffer_load_dwordx4 v15, s[20:23], s34 offen offset:0  lds
 v_mfma_f32_16x16x32_bf16 v[136:139], v[72:75], a[184:187], v[136:139]
 s_waitcnt lgkmcnt(7)
 ds_read_b64_tr_b16 v[68:69], v32 offset:54272
 ds_read_b64_tr_b16 v[70:71], v32 offset:54528
 v_mfma_f32_16x16x32_bf16 v[140:143], v[72:75], a[188:191], v[140:143]
 v_add_u32 v61, mk_k5-mk_top+16384, v249
 v_min_u32 v61, mk_end-mk_top, v61
 global_load_dword v255, v61, s[18:19]
 v_mfma_f32_16x16x32_bf16 v[144:147], v[76:79], a[184:187], v[144:147]
 ds_read_b64_tr_b16 v[72:73], v32 offset:55296
 ds_read_b64_tr_b16 v[74:75], v32 offset:55552
 v_mfma_f32_16x16x32_bf16 v[148:151], v[76:79], a[188:191], v[148:151]
 buffer_load_dwordx4 v16, s[20:23], s34 offen offset:1024  lds
 v_mfma_f32_16x16x32_bf16 v[96:99], v[80:83], a[192:195], v[96:99]
 ds_read_b64_tr_b16 v[76:77], v32 offset:56320
 ds_read_b64_tr_b16 v[78:79], v32 offset:56576
 v_mfma_f32_16x16x32_bf16 v[100:103], v[80:83], a[196:199], v[100:103]
 s_waitcnt lgkmcnt(12)
 v_mfma_f32_16x16x32_bf16 v[104:107], v[84:87], a[192:195], v[104:107]
 s_waitcnt lgkmcnt(6)
 ds_read_b64_tr_b16 v[80:81], v32 offset:57344
 ds_read_b64_tr_b16 v[82:83], v32 offset:57600
 v_mfma_f32_16x16x32_bf16 v[108:111], v[84:87], a[196:199], v[108:111]
 buffer_load_dwordx4 v17, s[20:23], s34 offen offset:2048  lds
 v_mfma_f32_16x16x32_bf16 v[112:115], v[88:91], a[192:195], v[112:115]
 ds_read_b64_tr_b16 v[84:85], v32 offset:58368
 ds_read_b64_tr_b16 v[86:87], v32 offset:58624
 v_mfma_f32_16x16x32_bf16 v[116:119], v[88:91], a[196:199], v[116:119]
 s_waitcnt vmcnt(16)
 ds_read_b128 a[80:83], v38 offset:0
 v_mfma_f32_16x16x32_bf16 v[120:123], v[92:95], a[192:195], v[120:123]
 ds_read_b64_tr_b16 v[88:89], v32 offset:59392
 ds_read_b64_tr_b16 v[90:91], v32 offset:59648
 v_mfma_f32_16x16x32_bf16 v[124:127], v[92:95], a[196:199], v[124:127]
 buffer_load_dwordx4 v18, s[20:23], s34 offen offset:3072  lds
 v_mfma_f32_16x16x32_bf16 v[128:131], v[64:67], a[192:195], v[128:131]
 s_waitcnt lgkmcnt(7)
 ds_read_b64_tr_b16 v[92:93], v32 offset:60416
 ds_read_b64_tr_b16 v[94:95], v32 offset:60672
 v_mfma_f32_16x16x32_bf16 v[132:135], v[64:67], a[196:199], v[132:135]
 ds_read_b128 a[84:87], v38 offset:2048
 s_add_u32 m0, s60, 0x10000
 v_mfma_f32_16x16x32_bf16 v[136:139], v[68:71], a[192:195], v[136:139]
 s_bfe_u32 s35, s84, 0x4001c
 ds_read_b64_tr_b16 v[64:65], v32 offset:61440
 ds_read_b64_tr_b16 v[66:67], v32 offset:61696
 v_mfma_f32_16x16x32_bf16 v[140:143], v[68:71], a[196:199], v[140:143]
 ds_read_b128 a[88:91], v39 offset:0
 s_mul_i32 s35, s35, 0xe000
 v_mfma_f32_16x16x32_bf16 v[144:147], v[72:75], a[192:195], v[144:147]
 s_add_u32 s35, s35, s45
 ds_read_b64_tr_b16 v[68:69], v32 offset:62464
 ds_read_b64_tr_b16 v[70:71], v32 offset:62720
 v_mfma_f32_16x16x32_bf16 v[148:151], v[72:75], a[196:199], v[148:151]
 buffer_load_dwordx4 v11, s[4:7], s35 offen offset:0 sc1 lds
 v_mfma_f32_16x16x32_bf16 v[96:99], v[76:79], a[200:203], v[96:99]
 s_waitcnt lgkmcnt(8)
 s_waitcnt vmcnt(14)
 s_barrier
 ds_read_b64_tr_b16 v[72:73], v31 offset:0
 ds_read_b64_tr_b16 v[74:75], v31 offset:256
 v_mfma_f32_16x16x32_bf16 v[100:103], v[76:79], a[204:207], v[100:103]
 buffer_load_dwordx4 v252, s[4:7], s35 offen offset:1024 sc1 lds
 v_mfma_f32_16x16x32_bf16 v[104:107], v[80:83], a[200:203], v[104:107]
 ds_read_b64_tr_b16 v[76:77], v31 offset:1024
 ds_read_b64_tr_b16 v[78:79], v31 offset:1280
 v_mfma_f32_16x16x32_bf16 v[108:111], v[80:83], a[204:207], v[108:111]
 ds_read_b128 a[92:95], v39 offset:2048
 v_mfma_f32_16x16x32_bf16 v[112:115], v[84:87], a[200:203], v[112:115]
 ds_read_b64_tr_b16 v[80:81], v31 offset:2048
 ds_read_b64_tr_b16 v[82:83], v31 offset:2304
 v_mfma_f32_16x16x32_bf16 v[116:119], v[84:87], a[204:207], v[116:119]
 buffer_load_dwordx4 v253, s[4:7], s35 offen offset:2048 sc1 lds
 v_mfma_f32_16x16x32_bf16 v[120:123], v[88:91], a[200:203], v[120:123]
 s_waitcnt lgkmcnt(7)
 ds_read_b64_tr_b16 v[84:85], v31 offset:3072
 ds_read_b64_tr_b16 v[86:87], v31 offset:3328
 v_mfma_f32_16x16x32_bf16 v[124:127], v[88:91], a[204:207], v[124:127]
 buffer_load_dwordx4 v254, s[4:7], s35 offen offset:3072 sc1 lds
 v_mfma_f32_16x16x32_bf16 v[128:131], v[92:95], a[200:203], v[128:131]
 s_add_u32 m0, s60, 0x14000
 ds_read_b64_tr_b16 v[88:89], v31 offset:4096
 ds_read_b64_tr_b16 v[90:91], v31 offset:4352
 v_mfma_f32_16x16x32_bf16 v[132:135], v[92:95], a[204:207], v[132:135]
 s_add_u32 s34, s34, 0x80
 v_mfma_f32_16x16x32_bf16 v[136:139], v[64:67], a[200:203], v[136:139]
 ds_read_b64_tr_b16 v[92:93], v31 offset:5120
 ds_read_b64_tr_b16 v[94:95], v31 offset:5376
 v_mfma_f32_16x16x32_bf16 v[140:143], v[64:67], a[204:207], v[140:143]
 buffer_load_dwordx4 v15, s[20:23], s34 offen offset:0  lds
 v_mfma_f32_16x16x32_bf16 v[144:147], v[68:71], a[200:203], v[144:147]
 s_waitcnt lgkmcnt(6)
 ds_read_b64_tr_b16 v[64:65], v31 offset:6144
 ds_read_b64_tr_b16 v[66:67], v31 offset:6400
 v_mfma_f32_16x16x32_bf16 v[148:151], v[68:71], a[204:207], v[148:151]
 v_mfma_f32_16x16x32_bf16 v[96:99], v[72:75], a[208:211], v[96:99]
 ds_read_b64_tr_b16 v[68:69], v31 offset:7168
 ds_read_b64_tr_b16 v[70:71], v31 offset:7424
 v_mfma_f32_16x16x32_bf16 v[100:103], v[72:75], a[212:215], v[100:103]
 buffer_load_dwordx4 v16, s[20:23], s34 offen offset:1024  lds
 v_mfma_f32_16x16x32_bf16 v[104:107], v[76:79], a[208:211], v[104:107]
 ds_read_b64_tr_b16 v[72:73], v31 offset:8192
 ds_read_b64_tr_b16 v[74:75], v31 offset:8448
 v_mfma_f32_16x16x32_bf16 v[108:111], v[76:79], a[212:215], v[108:111]
 s_waitcnt vmcnt(15)
 ds_read_b128 a[96:99], v34 offset:16384
 v_mfma_f32_16x16x32_bf16 v[112:115], v[80:83], a[208:211], v[112:115]
 s_waitcnt lgkmcnt(7)
 ds_read_b64_tr_b16 v[76:77], v31 offset:9216
 ds_read_b64_tr_b16 v[78:79], v31 offset:9472
 v_mfma_f32_16x16x32_bf16 v[116:119], v[80:83], a[212:215], v[116:119]
 buffer_load_dwordx4 v17, s[20:23], s34 offen offset:2048  lds
 v_mfma_f32_16x16x32_bf16 v[120:123], v[84:87], a[208:211], v[120:123]
 ds_read_b64_tr_b16 v[80:81], v31 offset:10240
 ds_read_b64_tr_b16 v[82:83], v31 offset:10496
 v_mfma_f32_16x16x32_bf16 v[124:127], v[84:87], a[212:215], v[124:127]
 ds_read_b128 a[100:103], v34 offset:18432
 v_mfma_f32_16x16x32_bf16 v[128:131], v[88:91], a[208:211], v[128:131]
 ds_read_b64_tr_b16 v[84:85], v31 offset:11264
 ds_read_b64_tr_b16 v[86:87], v31 offset:11520
 v_mfma_f32_16x16x32_bf16 v[132:135], v[88:91], a[212:215], v[132:135]
 buffer_load_dwordx4 v18, s[20:23], s34 offen offset:3072  lds
 v_mfma_f32_16x16x32_bf16 v[136:139], v[92:95], a[208:211], v[136:139]
 s_waitcnt lgkmcnt(8)
 ds_read_b64_tr_b16 v[88:89], v31 offset:12288
 ds_read_b64_tr_b16 v[90:91], v31 offset:12544
 v_mfma_f32_16x16x32_bf16 v[140:143], v[92:95], a[212:215], v[140:143]
 ds_read_b128 a[104:107], v35 offset:16384
 s_add_u32 m0, s60, 0x18000
 v_mfma_f32_16x16x32_bf16 v[144:147], v[64:67], a[208:211], v[144:147]
 s_add_u32 s35, s35, 0x7000
 ds_read_b64_tr_b16 v[92:93], v31 offset:13312
 ds_read_b64_tr_b16 v[94:95], v31 offset:13568
 v_mfma_f32_16x16x32_bf16 v[148:151], v[64:67], a[212:215], v[148:151]
 buffer_load_dwordx4 v11, s[4:7], s35 offen offset:0 sc1 lds
 v_mfma_f32_16x16x32_bf16 v[96:99], v[68:71], a[216:219], v[96:99]
 s_waitcnt vmcnt(14)
 s_barrier
 ds_read_b64_tr_b16 v[64:65], v31 offset:32768
 ds_read_b64_tr_b16 v[66:67], v31 offset:33024
 v_mfma_f32_16x16x32_bf16 v[100:103], v[68:71], a[220:223], v[100:103]
 ds_read_b128 a[108:111], v35 offset:18432
 v_mfma_f32_16x16x32_bf16 v[104:107], v[72:75], a[216:219], v[104:107]
 s_waitcnt lgkmcnt(8)
 ds_read_b64_tr_b16 v[68:69], v31 offset:33792
 ds_read_b64_tr_b16 v[70:71], v31 offset:34048
 v_mfma_f32_16x16x32_bf16 v[108:111], v[72:75], a[220:223], v[108:111]
 buffer_load_dwordx4 v252, s[4:7], s35 offen offset:1024 sc1 lds
 v_mfma_f32_16x16x32_bf16 v[112:115], v[76:79], a[216:219], v[112:115]
 ds_read_b64_tr_b16 v[72:73], v31 offset:34816
 ds_read_b64_tr_b16 v[74:75], v31 offset:35072
 v_mfma_f32_16x16x32_bf16 v[116:119], v[76:79], a[220:223], v[116:119]
 v_mfma_f32_16x16x32_bf16 v[120:123], v[80:83], a[216:219], v[120:123]
 ds_read_b64_tr_b16 v[76:77], v31 offset:35840
 ds_read_b64_tr_b16 v[78:79], v31 offset:36096
 v_mfma_f32_16x16x32_bf16 v[124:127], v[80:83], a[220:223], v[124:127]
 buffer_load_dwordx4 v253, s[4:7], s35 offen offset:2048 sc1 lds
 v_mfma_f32_16x16x32_bf16 v[128:131], v[84:87], a[216:219], v[128:131]
 s_waitcnt lgkmcnt(7)
 ds_read_b64_tr_b16 v[80:81], v31 offset:36864
 ds_read_b64_tr_b16 v[82:83], v31 offset:37120
 v_mfma_f32_16x16x32_bf16 v[132:135], v[84:87], a[220:223], v[132:135]
 v_mfma_f32_16x16x32_bf16 v[136:139], v[88:91], a[216:219], v[136:139]
 ds_read_b64_tr_b16 v[84:85], v31 offset:37888
 ds_read_b64_tr_b16 v[86:87], v31 offset:38144
 v_mfma_f32_16x16x32_bf16 v[140:143], v[88:91], a[220:223], v[140:143]
 buffer_load_dwordx4 v254, s[4:7], s35 offen offset:3072 sc1 lds
 v_mfma_f32_16x16x32_bf16 v[144:147], v[92:95], a[216:219], v[144:147]
 s_add_u32 m0, s60, 0x1c000
 ds_read_b64_tr_b16 v[88:89], v31 offset:38912
 ds_read_b64_tr_b16 v[90:91], v31 offset:39168
 v_mfma_f32_16x16x32_bf16 v[148:151], v[92:95], a[220:223], v[148:151]
 s_waitcnt lgkmcnt(12)
 s_bfe_u32 s34, s85, 0x40010
 s_mul_i32 s34, s34, 0x100
 v_mfma_f32_16x16x32_bf16 v[96:99], v[64:67], a[224:227], v[96:99]
 s_waitcnt lgkmcnt(6)
 ds_read_b64_tr_b16 v[92:93], v31 offset:39936
 ds_read_b64_tr_b16 v[94:95], v31 offset:40192
 v_mfma_f32_16x16x32_bf16 v[100:103], v[64:67], a[228:231], v[100:103]
 buffer_load_dwordx4 v15, s[20:23], s34 offen offset:0  lds
 v_mfma_f32_16x16x32_bf16 v[104:107], v[68:71], a[224:227], v[104:107]
 ds_read_b64_tr_b16 v[64:65], v31 offset:40960
 ds_read_b64_tr_b16 v[66:67], v31 offset:41216
 v_mfma_f32_16x16x32_bf16 v[108:111], v[68:71], a[228:231], v[108:111]
 buffer_load_dwordx4 v16, s[20:23], s34 offen offset:1024  lds
 v_mfma_f32_16x16x32_bf16 v[112:115], v[72:75], a[224:227], v[112:115]
 ds_read_b64_tr_b16 v[68:69], v31 offset:41984
 ds_read_b64_tr_b16 v[70:71], v31 offset:42240
 v_mfma_f32_16x16x32_bf16 v[116:119], v[72:75], a[228:231], v[116:119]
 s_waitcnt vmcnt(14)
 ds_read_b128 a[112:115], v34 offset:49152
 v_mfma_f32_16x16x32_bf16 v[120:123], v[76:79], a[224:227], v[120:123]
 s_waitcnt lgkmcnt(7)
 ds_read_b64_tr_b16 v[72:73], v31 offset:43008
 ds_read_b64_tr_b16 v[74:75], v31 offset:43264
 v_mfma_f32_16x16x32_bf16 v[124:127], v[76:79], a[228:231], v[124:127]
 buffer_load_dwordx4 v17, s[20:23], s34 offen offset:2048  lds
 v_mfma_f32_16x16x32_bf16 v[128:131], v[80:83], a[224:227], v[128:131]
 ds_read_b64_tr_b16 v[76:77], v31 offset:44032
 ds_read_b64_tr_b16 v[78:79], v31 offset:44288
 v_mfma_f32_16x16x32_bf16 v[132:135], v[80:83], a[228:231], v[132:135]
 ds_read_b128 a[116:119], v34 offset:51200
 v_mfma_f32_16x16x32_bf16 v[136:139], v[84:87], a[224:227], v[136:139]
 ds_read_b64_tr_b16 v[80:81], v31 offset:45056
 ds_read_b64_tr_b16 v[82:83], v31 offset:45312
 v_mfma_f32_16x16x32_bf16 v[140:143], v[84:87], a[228:231], v[140:143]
 buffer_load_dwordx4 v18, s[20:23], s34 offen offset:3072  lds
 v_mfma_f32_16x16x32_bf16 v[144:147], v[88:91], a[224:227], v[144:147]
 s_waitcnt lgkmcnt(8)
 ds_read_b64_tr_b16 v[84:85], v31 offset:46080
 ds_read_b64_tr_b16 v[86:87], v31 offset:46336
 v_mfma_f32_16x16x32_bf16 v[148:151], v[88:91], a[228:231], v[148:151]
 ds_read_b128 a[120:123], v35 offset:49152
 s_add_u32 m0, s60, 0x20000
 v_mfma_f32_16x16x32_bf16 v[96:99], v[92:95], a[232:235], v[96:99]
 s_bfe_u32 s35, s85, 0x40000
 s_waitcnt vmcnt(12)
 s_barrier
 ds_read_b64_tr_b16 v[88:89], v32 offset:0
 ds_read_b64_tr_b16 v[90:91], v32 offset:256
 v_mfma_f32_16x16x32_bf16 v[100:103], v[92:95], a[236:239], v[100:103]
 ds_read_b128 a[124:127], v35 offset:51200
 s_mul_i32 s35, s35, 0xe000
 v_mfma_f32_16x16x32_bf16 v[104:107], v[64:67], a[232:235], v[104:107]
 s_add_u32 s35, s35, s45
 ds_read_b64_tr_b16 v[92:93], v32 offset:1024
 ds_read_b64_tr_b16 v[94:95], v32 offset:1280
 v_mfma_f32_16x16x32_bf16 v[108:111], v[64:67], a[236:239], v[108:111]
 buffer_load_dwordx4 v11, s[4:7], s35 offen offset:0 sc1 lds
 v_mfma_f32_16x16x32_bf16 v[112:115], v[68:71], a[232:235], v[112:115]
 s_waitcnt lgkmcnt(8)
 ds_read_b64_tr_b16 v[64:65], v32 offset:2048
 ds_read_b64_tr_b16 v[66:67], v32 offset:2304
 v_mfma_f32_16x16x32_bf16 v[116:119], v[68:71], a[236:239], v[116:119]
 buffer_load_dwordx4 v252, s[4:7], s35 offen offset:1024 sc1 lds
 v_mfma_f32_16x16x32_bf16 v[120:123], v[72:75], a[232:235], v[120:123]
 ds_read_b64_tr_b16 v[68:69], v32 offset:3072
 ds_read_b64_tr_b16 v[70:71], v32 offset:3328
 v_mfma_f32_16x16x32_bf16 v[124:127], v[72:75], a[236:239], v[124:127]
 v_mfma_f32_16x16x32_bf16 v[128:131], v[76:79], a[232:235], v[128:131]
 ds_read_b64_tr_b16 v[72:73], v32 offset:4096
 ds_read_b64_tr_b16 v[74:75], v32 offset:4352
 v_mfma_f32_16x16x32_bf16 v[132:135], v[76:79], a[236:239], v[132:135]
 buffer_load_dwordx4 v253, s[4:7], s35 offen offset:2048 sc1 lds
 v_mfma_f32_16x16x32_bf16 v[136:139], v[80:83], a[232:235], v[136:139]
 s_waitcnt lgkmcnt(6)
 ds_read_b64_tr_b16 v[76:77], v32 offset:5120
 ds_read_b64_tr_b16 v[78:79], v32 offset:5376
 v_mfma_f32_16x16x32_bf16 v[140:143], v[80:83], a[236:239], v[140:143]
 buffer_load_dwordx4 v254, s[4:7], s35 offen offset:3072 sc1 lds
 v_mfma_f32_16x16x32_bf16 v[144:147], v[84:87], a[232:235], v[144:147]
 s_add_u32 m0, s60, 0x0
 ds_read_b64_tr_b16 v[80:81], v32 offset:6144
 ds_read_b64_tr_b16 v[82:83], v32 offset:6400
 v_mfma_f32_16x16x32_bf16 v[148:151], v[84:87], a[236:239], v[148:151]
 s_add_u32 s34, s34, 0x80
 v_mfma_f32_16x16x32_bf16 v[96:99], v[88:91], a[240:243], v[96:99]
 ds_read_b64_tr_b16 v[84:85], v32 offset:7168
 ds_read_b64_tr_b16 v[86:87], v32 offset:7424
 v_mfma_f32_16x16x32_bf16 v[100:103], v[88:91], a[244:247], v[100:103]
 v_mfma_f32_16x16x32_bf16 v[104:107], v[92:95], a[240:243], v[104:107]
 s_waitcnt lgkmcnt(6)
 ds_read_b64_tr_b16 v[88:89], v32 offset:8192
 ds_read_b64_tr_b16 v[90:91], v32 offset:8448
 v_mfma_f32_16x16x32_bf16 v[108:111], v[92:95], a[244:247], v[108:111]
 buffer_load_dwordx4 v15, s[20:23], s34 offen offset:0  lds
 v_mfma_f32_16x16x32_bf16 v[112:115], v[64:67], a[240:243], v[112:115]
 ds_read_b64_tr_b16 v[92:93], v32 offset:9216
 ds_read_b64_tr_b16 v[94:95], v32 offset:9472
 v_mfma_f32_16x16x32_bf16 v[116:119], v[64:67], a[244:247], v[116:119]
 s_waitcnt vmcnt(13)
 ds_read_b128 a[128:131], v36 offset:16384
 v_mfma_f32_16x16x32_bf16 v[120:123], v[68:71], a[240:243], v[120:123]
 ds_read_b64_tr_b16 v[64:65], v32 offset:10240
 ds_read_b64_tr_b16 v[66:67], v32 offset:10496
 v_mfma_f32_16x16x32_bf16 v[124:127], v[68:71], a[244:247], v[124:127]
 buffer_load_dwordx4 v16, s[20:23], s34 offen offset:1024  lds
 v_mfma_f32_16x16x32_bf16 v[128:131], v[72:75], a[240:243], v[128:131]
 s_waitcnt lgkmcnt(7)
 ds_read_b64_tr_b16 v[68:69], v32 offset:11264
 ds_read_b64_tr_b16 v[70:71], v32 offset:11520
 v_mfma_f32_16x16x32_bf16 v[132:135], v[72:75], a[244:247], v[132:135]
 ds_read_b128 a[132:135], v36 offset:18432
 v_mfma_f32_16x16x32_bf16 v[136:139], v[76:79], a[240:243], v[136:139]
 ds_read_b64_tr_b16 v[72:73], v32 offset:12288
 ds_read_b64_tr_b16 v[74:75], v32 offset:12544
 v_mfma_f32_16x16x32_bf16 v[140:143], v[76:79], a[244:247], v[140:143]
 buffer_load_dwordx4 v17, s[20:23], s34 offen offset:2048  lds
 v_mfma_f32_16x16x32_bf16 v[144:147], v[80:83], a[240:243], v[144:147]
 ds_read_b64_tr_b16 v[76:77], v32 offset:13312
 ds_read_b64_tr_b16 v[78:79], v32 offset:13568
 v_mfma_f32_16x16x32_bf16 v[148:151], v[80:83], a[244:247], v[148:151]
 ds_read_b128 a[136:139], v37 offset:16384
 v_mfma_f32_16x16x32_bf16 v[96:99], v[84:87], a[248:251], v[96:99]
 s_waitcnt lgkmcnt(8)
 s_waitcnt vmcnt(11)
 s_barrier
 ds_read_b64_tr_b16 v[80:81], v32 offset:32768
 ds_read_b64_tr_b16 v[82:83], v32 offset:33024
 v_mfma_f32_16x16x32_bf16 v[100:103], v[84:87], a[252:255], v[100:103]
 buffer_load_dwordx4 v18, s[20:23], s34 offen offset:3072  lds
 v_mfma_f32_16x16x32_bf16 v[104:107], v[88:91], a[248:251], v[104:107]
 s_add_u32 m0, s60, 0x4000
 ds_read_b64_tr_b16 v[84:85], v32 offset:33792
 ds_read_b64_tr_b16 v[86:87], v32 offset:34048
 v_mfma_f32_16x16x32_bf16 v[108:111], v[88:91], a[252:255], v[108:111]
 ds_read_b128 a[140:143], v37 offset:18432
 s_add_u32 s35, s35, 0x7000
 v_mfma_f32_16x16x32_bf16 v[112:115], v[92:95], a[248:251], v[112:115]
 ds_read_b64_tr_b16 v[88:89], v32 offset:34816
 ds_read_b64_tr_b16 v[90:91], v32 offset:35072
 v_mfma_f32_16x16x32_bf16 v[116:119], v[92:95], a[252:255], v[116:119]
 buffer_load_dwordx4 v11, s[4:7], s35 offen offset:0 sc1 lds
 v_mfma_f32_16x16x32_bf16 v[120:123], v[64:67], a[248:251], v[120:123]
 s_waitcnt lgkmcnt(8)
 ds_read_b64_tr_b16 v[92:93], v32 offset:35840
 ds_read_b64_tr_b16 v[94:95], v32 offset:36096
 v_mfma_f32_16x16x32_bf16 v[124:127], v[64:67], a[252:255], v[124:127]
 buffer_load_dwordx4 v252, s[4:7], s35 offen offset:1024 sc1 lds
 v_mfma_f32_16x16x32_bf16 v[128:131], v[68:71], a[248:251], v[128:131]
 ds_read_b64_tr_b16 v[64:65], v32 offset:36864
 ds_read_b64_tr_b16 v[66:67], v32 offset:37120
 v_mfma_f32_16x16x32_bf16 v[132:135], v[68:71], a[252:255], v[132:135]
 v_mfma_f32_16x16x32_bf16 v[136:139], v[72:75], a[248:251], v[136:139]
 ds_read_b64_tr_b16 v[68:69], v32 offset:37888
 ds_read_b64_tr_b16 v[70:71], v32 offset:38144
 v_mfma_f32_16x16x32_bf16 v[140:143], v[72:75], a[252:255], v[140:143]
 buffer_load_dwordx4 v253, s[4:7], s35 offen offset:2048 sc1 lds
 v_mfma_f32_16x16x32_bf16 v[144:147], v[76:79], a[248:251], v[144:147]
 s_waitcnt lgkmcnt(6)
 ds_read_b64_tr_b16 v[72:73], v32 offset:38912
 ds_read_b64_tr_b16 v[74:75], v32 offset:39168
 v_mfma_f32_16x16x32_bf16 v[148:151], v[76:79], a[252:255], v[148:151]
 buffer_load_dwordx4 v254, s[4:7], s35 offen offset:3072 sc1 lds
 v_mfma_f32_16x16x32_bf16 v[96:99], v[80:83], a[0:3], v[96:99]
 s_add_u32 m0, s60, 0x8000
 ds_read_b64_tr_b16 v[76:77], v32 offset:39936
 ds_read_b64_tr_b16 v[78:79], v32 offset:40192
 v_mfma_f32_16x16x32_bf16 v[100:103], v[80:83], a[4:7], v[100:103]
 s_bfe_u32 s34, s85, 0x40014
 s_mul_i32 s34, s34, 0x100
 v_mfma_f32_16x16x32_bf16 v[104:107], v[84:87], a[0:3], v[104:107]
 ds_read_b64_tr_b16 v[80:81], v32 offset:40960
 ds_read_b64_tr_b16 v[82:83], v32 offset:41216
 v_mfma_f32_16x16x32_bf16 v[108:111], v[84:87], a[4:7], v[108:111]
 s_waitcnt vmcnt(12)
 ds_read_b128 a[144:147], v36 offset:49152
 v_mfma_f32_16x16x32_bf16 v[112:115], v[88:91], a[0:3], v[112:115]
 s_waitcnt lgkmcnt(7)
 ds_read_b64_tr_b16 v[84:85], v32 offset:41984
 ds_read_b64_tr_b16 v[86:87], v32 offset:42240
 v_mfma_f32_16x16x32_bf16 v[116:119], v[88:91], a[4:7], v[116:119]
 buffer_load_dwordx4 v15, s[20:23], s34 offen offset:0  lds
 v_mfma_f32_16x16x32_bf16 v[120:123], v[92:95], a[0:3], v[120:123]
 ds_read_b64_tr_b16 v[88:89], v32 offset:43008
 ds_read_b64_tr_b16 v[90:91], v32 offset:43264
 v_mfma_f32_16x16x32_bf16 v[124:127], v[92:95], a[4:7], v[124:127]
 ds_read_b128 a[148:151], v36 offset:51200
 v_mfma_f32_16x16x32_bf16 v[128:131], v[64:67], a[0:3], v[128:131]
 ds_read_b64_tr_b16 v[92:93], v32 offset:44032
 ds_read_b64_tr_b16 v[94:95], v32 offset:44288
 v_mfma_f32_16x16x32_bf16 v[132:135], v[64:67], a[4:7], v[132:135]
 buffer_load_dwordx4 v16, s[20:23], s34 offen offset:1024  lds
 v_mfma_f32_16x16x32_bf16 v[136:139], v[68:71], a[0:3], v[136:139]
 s_waitcnt lgkmcnt(8)
 ds_read_b64_tr_b16 v[64:65], v32 offset:45056
 ds_read_b64_tr_b16 v[66:67], v32 offset:45312
 v_mfma_f32_16x16x32_bf16 v[140:143], v[68:71], a[4:7], v[140:143]
 buffer_load_dwordx4 v17, s[20:23], s34 offen offset:2048  lds
 v_mfma_f32_16x16x32_bf16 v[144:147], v[72:75], a[0:3], v[144:147]
 ds_read_b64_tr_b16 v[68:69], v32 offset:46080
 ds_read_b64_tr_b16 v[70:71], v32 offset:46336
 v_mfma_f32_16x16x32_bf16 v[148:151], v[72:75], a[4:7], v[148:151]
 ds_read_b128 a[152:155], v37 offset:49152
 v_mfma_f32_16x16x32_bf16 v[96:99], v[76:79], a[8:11], v[96:99]
 s_waitcnt vmcnt(11)
 s_barrier
 ds_read_b64_tr_b16 v[72:73], v33 offset:0
 ds_read_b64_tr_b16 v[74:75], v33 offset:256
 v_mfma_f32_16x16x32_bf16 v[100:103], v[76:79], a[12:15], v[100:103]
 buffer_load_dwordx4 v18, s[20:23], s34 offen offset:3072  lds
 v_mfma_f32_16x16x32_bf16 v[104:107], v[80:83], a[8:11], v[104:107]
 s_waitcnt lgkmcnt(7)
 ds_read_b64_tr_b16 v[76:77], v33 offset:1024
 ds_read_b64_tr_b16 v[78:79], v33 offset:1280
 v_mfma_f32_16x16x32_bf16 v[108:111], v[80:83], a[12:15], v[108:111]
 ds_read_b128 a[156:159], v37 offset:51200
 s_add_u32 m0, s60, 0xc000
 v_mfma_f32_16x16x32_bf16 v[112:115], v[84:87], a[8:11], v[112:115]
 s_bfe_u32 s35, s85, 0x40004
 ds_read_b64_tr_b16 v[80:81], v33 offset:2048
 ds_read_b64_tr_b16 v[82:83], v33 offset:2304
 v_mfma_f32_16x16x32_bf16 v[116:119], v[84:87], a[12:15], v[116:119]
 s_mul_i32 s35, s35, 0xe000
 s_add_u32 s35, s35, s45
 v_mfma_f32_16x16x32_bf16 v[120:123], v[88:91], a[8:11], v[120:123]
 ds_read_b64_tr_b16 v[84:85], v33 offset:3072
 ds_read_b64_tr_b16 v[86:87], v33 offset:3328
 v_mfma_f32_16x16x32_bf16 v[124:127], v[88:91], a[12:15], v[124:127]
 buffer_load_dwordx4 v11, s[4:7], s35 offen offset:0 sc1 lds
 v_mfma_f32_16x16x32_bf16 v[128:131], v[92:95], a[8:11], v[128:131]
 s_waitcnt lgkmcnt(7)
 ds_read_b64_tr_b16 v[88:89], v33 offset:4096
 ds_read_b64_tr_b16 v[90:91], v33 offset:4352
 v_mfma_f32_16x16x32_bf16 v[132:135], v[92:95], a[12:15], v[132:135]
 buffer_load_dwordx4 v252, s[4:7], s35 offen offset:1024 sc1 lds
 v_mfma_f32_16x16x32_bf16 v[136:139], v[64:67], a[8:11], v[136:139]
 ds_read_b64_tr_b16 v[92:93], v33 offset:5120
 ds_read_b64_tr_b16 v[94:95], v33 offset:5376
 v_mfma_f32_16x16x32_bf16 v[140:143], v[64:67], a[12:15], v[140:143]
 buffer_load_dwordx4 v253, s[4:7], s35 offen offset:2048 sc1 lds
 v_mfma_f32_16x16x32_bf16 v[144:147], v[68:71], a[8:11], v[144:147]
 ds_read_b64_tr_b16 v[64:65], v33 offset:6144
 ds_read_b64_tr_b16 v[66:67], v33 offset:6400
 v_mfma_f32_16x16x32_bf16 v[148:151], v[68:71], a[12:15], v[148:151]
 buffer_load_dwordx4 v254, s[4:7], s35 offen offset:3072 sc1 lds
 v_mfma_f32_16x16x32_bf16 v[96:99], v[72:75], a[16:19], v[96:99]
 s_waitcnt lgkmcnt(6)
 ds_read_b64_tr_b16 v[68:69], v33 offset:7168
 ds_read_b64_tr_b16 v[70:71], v33 offset:7424
 v_mfma_f32_16x16x32_bf16 v[100:103], v[72:75], a[20:23], v[100:103]
 s_add_u32 m0, s60, 0x10000
 s_add_u32 s34, s34, 0x80
 v_mfma_f32_16x16x32_bf16 v[104:107], v[76:79], a[16:19], v[104:107]
 ds_read_b64_tr_b16 v[72:73], v33 offset:8192
 ds_read_b64_tr_b16 v[74:75], v33 offset:8448
 v_mfma_f32_16x16x32_bf16 v[108:111], v[76:79], a[20:23], v[108:111]
 s_waitcnt vmcnt(12)
 ds_read_b128 a[160:163], v34 offset:0
 v_mfma_f32_16x16x32_bf16 v[112:115], v[80:83], a[16:19], v[112:115]
 ds_read_b64_tr_b16 v[76:77], v33 offset:9216
 ds_read_b64_tr_b16 v[78:79], v33 offset:9472
 v_mfma_f32_16x16x32_bf16 v[116:119], v[80:83], a[20:23], v[116:119]
 v_mfma_f32_16x16x32_bf16 v[120:123], v[84:87], a[16:19], v[120:123]
 s_waitcnt lgkmcnt(7)
 ds_read_b64_tr_b16 v[80:81], v33 offset:10240
 ds_read_b64_tr_b16 v[82:83], v33 offset:10496
 v_mfma_f32_16x16x32_bf16 v[124:127], v[84:87], a[20:23], v[124:127]
 buffer_load_dwordx4 v15, s[20:23], s34 offen offset:0  lds
 v_mfma_f32_16x16x32_bf16 v[128:131], v[88:91], a[16:19], v[128:131]
 ds_read_b64_tr_b16 v[84:85], v33 offset:11264
 ds_read_b64_tr_b16 v[86:87], v33 offset:11520
 v_mfma_f32_16x16x32_bf16 v[132:135], v[88:91], a[20:23], v[132:135]
 ds_read_b128 a[164:167], v34 offset:2048
 v_mfma_f32_16x16x32_bf16 v[136:139], v[92:95], a[16:19], v[136:139]
 ds_read_b64_tr_b16 v[88:89], v33 offset:12288
 ds_read_b64_tr_b16 v[90:91], v33 offset:12544
 v_mfma_f32_16x16x32_bf16 v[140:143], v[92:95], a[20:23], v[140:143]
 buffer_load_dwordx4 v16, s[20:23], s34 offen offset:1024  lds
 v_mfma_f32_16x16x32_bf16 v[144:147], v[64:67], a[16:19], v[144:147]
 s_waitcnt lgkmcnt(7)
 ds_read_b64_tr_b16 v[92:93], v33 offset:13312
 ds_read_b64_tr_b16 v[94:95], v33 offset:13568
 v_mfma_f32_16x16x32_bf16 v[148:151], v[64:67], a[20:23], v[148:151]
 ds_read_b128 a[168:171], v35 offset:0
 v_mfma_f32_16x16x32_bf16 v[96:99], v[68:71], a[24:27], v[96:99]
 s_waitcnt vmcnt(10)
 s_barrier
 ds_read_b64_tr_b16 v[64:65], v31 offset:16384
 ds_read_b64_tr_b16 v[66:67], v31 offset:16640
 v_mfma_f32_16x16x32_bf16 v[100:103], v[68:71], a[28:31], v[100:103]
 buffer_load_dwordx4 v17, s[20:23], s34 offen offset:2048  lds
 v_mfma_f32_16x16x32_bf16 v[104:107], v[72:75], a[24:27], v[104:107]
 ds_read_b64_tr_b16 v[68:69], v31 offset:17408
 ds_read_b64_tr_b16 v[70:71], v31 offset:17664
 v_mfma_f32_16x16x32_bf16 v[108:111], v[72:75], a[28:31], v[108:111]
 ds_read_b128 a[172:175], v35 offset:2048
 v_mfma_f32_16x16x32_bf16 v[112:115], v[76:79], a[24:27], v[112:115]
 s_waitcnt lgkmcnt(8)
 ds_read_b64_tr_b16 v[72:73], v31 offset:18432
 ds_read_b64_tr_b16 v[74:75], v31 offset:18688
 v_mfma_f32_16x16x32_bf16 v[116:119], v[76:79], a[28:31], v[116:119]
 buffer_load_dwordx4 v18, s[20:23], s34 offen offset:3072  lds
 v_mfma_f32_16x16x32_bf16 v[120:123], v[80:83], a[24:27], v[120:123]
 s_add_u32 m0, s60, 0x14000
 ds_read_b64_tr_b16 v[76:77], v31 offset:19456
 ds_read_b64_tr_b16 v[78:79], v31 offset:19712
 v_mfma_f32_16x16x32_bf16 v[124:127], v[80:83], a[28:31], v[124:127]
 s_add_u32 s35, s35, 0x7000
 v_mfma_f32_16x16x32_bf16 v[128:131], v[84:87], a[24:27], v[128:131]
 ds_read_b64_tr_b16 v[80:81], v31 offset:20480
 ds_read_b64_tr_b16 v[82:83], v31 offset:20736
 v_mfma_f32_16x16x32_bf16 v[132:135], v[84:87], a[28:31], v[132:135]
 buffer_load_dwordx4 v11, s[4:7], s35 offen offset:0 sc1 lds
 v_mfma_f32_16x16x32_bf16 v[136:139], v[88:91], a[24:27], v[136:139]
 s_waitcnt lgkmcnt(7)
 ds_read_b64_tr_b16 v[84:85], v31 offset:21504
 ds_read_b64_tr_b16 v[86:87], v31 offset:21760
 v_mfma_f32_16x16x32_bf16 v[140:143], v[88:91], a[28:31], v[140:143]
 buffer_load_dwordx4 v252, s[4:7], s35 offen offset:1024 sc1 lds
 v_mfma_f32_16x16x32_bf16 v[144:147], v[92:95], a[24:27], v[144:147]
 ds_read_b64_tr_b16 v[88:89], v31 offset:22528
 ds_read_b64_tr_b16 v[90:91], v31 offset:22784
 v_mfma_f32_16x16x32_bf16 v[148:151], v[92:95], a[28:31], v[148:151]
 buffer_load_dwordx4 v253, s[4:7], s35 offen offset:2048 sc1 lds
 v_mfma_f32_16x16x32_bf16 v[96:99], v[64:67], a[32:35], v[96:99]
 ds_read_b64_tr_b16 v[92:93], v31 offset:23552
 ds_read_b64_tr_b16 v[94:95], v31 offset:23808
 v_mfma_f32_16x16x32_bf16 v[100:103], v[64:67], a[36:39], v[100:103]
 s_waitcnt lgkmcnt(12)
 v_mfma_f32_16x16x32_bf16 v[104:107], v[68:71], a[32:35], v[104:107]
 s_waitcnt lgkmcnt(6)
 ds_read_b64_tr_b16 v[64:65], v31 offset:24576
 ds_read_b64_tr_b16 v[66:67], v31 offset:24832
 v_mfma_f32_16x16x32_bf16 v[108:111], v[68:71], a[36:39], v[108:111]
 buffer_load_dwordx4 v254, s[4:7], s35 offen offset:3072 sc1 lds
 v_mfma_f32_16x16x32_bf16 v[112:115], v[72:75], a[32:35], v[112:115]
 s_add_u32 m0, s60, 0x18000
 ds_read_b64_tr_b16 v[68:69], v31 offset:25600
 ds_read_b64_tr_b16 v[70:71], v31 offset:25856
 v_mfma_f32_16x16x32_bf16 v[116:119], v[72:75], a[36:39], v[116:119]
 s_waitcnt vmcnt(12)
 ds_read_b128 a[176:179], v34 offset:32768
 s_bfe_u32 s34, s85, 0x40018
 v_mfma_f32_16x16x32_bf16 v[120:123], v[76:79], a[32:35], v[120:123]
 s_mul_i32 s34, s34, 0x100
 ds_read_b64_tr_b16 v[72:73], v31 offset:26624
 ds_read_b64_tr_b16 v[74:75], v31 offset:26880
 v_mfma_f32_16x16x32_bf16 v[124:127], v[76:79], a[36:39], v[124:127]
 ds_read_b128 a[180:183], v34 offset:34816
 v_mfma_f32_16x16x32_bf16 v[128:131], v[80:83], a[32:35], v[128:131]
 s_waitcnt lgkmcnt(8)
 ds_read_b64_tr_b16 v[76:77], v31 offset:27648
 ds_read_b64_tr_b16 v[78:79], v31 offset:27904
 v_mfma_f32_16x16x32_bf16 v[132:135], v[80:83], a[36:39], v[132:135]
 buffer_load_dwordx4 v15, s[20:23], s34 offen offset:0  lds
 v_mfma_f32_16x16x32_bf16 v[136:139], v[84:87], a[32:35], v[136:139]
 ds_read_b64_tr_b16 v[80:81], v31 offset:28672
 ds_read_b64_tr_b16 v[82:83], v31 offset:28928
 v_mfma_f32_16x16x32_bf16 v[140:143], v[84:87], a[36:39], v[140:143]
 ds_read_b128 a[184:187], v35 offset:32768
 v_mfma_f32_16x16x32_bf16 v[144:147], v[88:91], a[32:35], v[144:147]
 ds_read_b64_tr_b16 v[84:85], v31 offset:29696
 ds_read_b64_tr_b16 v[86:87], v31 offset:29952
 v_mfma_f32_16x16x32_bf16 v[148:151], v[88:91], a[36:39], v[148:151]
 buffer_load_dwordx4 v16, s[20:23], s34 offen offset:1024  lds
 v_mfma_f32_16x16x32_bf16 v[96:99], v[92:95], a[40:43], v[96:99]
 s_waitcnt lgkmcnt(8)
 s_waitcnt vmcnt(10)
 s_barrier
 ds_read_b64_tr_b16 v[88:89], v31 offset:49152
 ds_read_b64_tr_b16 v[90:91], v31 offset:49408
 v_mfma_f32_16x16x32_bf16 v[100:103], v[92:95], a[44:47], v[100:103]
 buffer_load_dwordx4 v17, s[20:23], s34 offen offset:2048  lds
 v_mfma_f32_16x16x32_bf16 v[104:107], v[64:67], a[40:43], v[104:107]
 ds_read_b64_tr_b16 v[92:93], v31 offset:50176
 ds_read_b64_tr_b16 v[94:95], v31 offset:50432
 v_mfma_f32_16x16x32_bf16 v[108:111], v[64:67], a[44:47], v[108:111]
 ds_read_b128 a[188:191], v35 offset:34816
 v_mfma_f32_16x16x32_bf16 v[112:115], v[68:71], a[40:43], v[112:115]
 ds_read_b64_tr_b16 v[64:65], v31 offset:51200
 ds_read_b64_tr_b16 v[66:67], v31 offset:51456
 v_mfma_f32_16x16x32_bf16 v[116:119], v[68:71], a[44:47], v[116:119]
 buffer_load_dwordx4 v18, s[20:23], s34 offen offset:3072  lds
 v_mfma_f32_16x16x32_bf16 v[120:123], v[72:75], a[40:43], v[120:123]
 s_waitcnt lgkmcnt(7)
 ds_read_b64_tr_b16 v[68:69], v31 offset:52224
 ds_read_b64_tr_b16 v[70:71], v31 offset:52480
 v_mfma_f32_16x16x32_bf16 v[124:127], v[72:75], a[44:47], v[124:127]
 s_add_u32 m0, s60, 0x1c000
 s_bfe_u32 s35, s85, 0x40008
 s_mul_i32 s35, s35, 0xe000
 v_mfma_f32_16x16x32_bf16 v[128:131], v[76:79], a[40:43], v[128:131]
 s_add_u32 s35, s35, s45
 ds_read_b64_tr_b16 v[72:73], v31 offset:53248
 ds_read_b64_tr_b16 v[74:75], v31 offset:53504
 v_mfma_f32_16x16x32_bf16 v[132:135], v[76:79], a[44:47], v[132:135]
 buffer_load_dwordx4 v11, s[4:7], s35 offen offset:0 sc1 lds
 v_mfma_f32_16x16x32_bf16 v[136:139], v[80:83], a[40:43], v[136:139]
 ds_read_b64_tr_b16 v[76:77], v31 offset:54272
 ds_read_b64_tr_b16 v[78:79], v31 offset:54528
 v_mfma_f32_16x16x32_bf16 v[140:143], v[80:83], a[44:47], v[140:143]
 buffer_load_dwordx4 v252, s[4:7], s35 offen offset:1024 sc1 lds
 v_mfma_f32_16x16x32_bf16 v[144:147], v[84:87], a[40:43], v[144:147]
 s_waitcnt lgkmcnt(6)
 ds_read_b64_tr_b16 v[80:81], v31 offset:55296
 ds_read_b64_tr_b16 v[82:83], v31 offset:55552
 v_mfma_f32_16x16x32_bf16 v[148:151], v[84:87], a[44:47], v[148:151]
 buffer_load_dwordx4 v253, s[4:7], s35 offen offset:2048 sc1 lds
 v_mfma_f32_16x16x32_bf16 v[96:99], v[88:91], a[48:51], v[96:99]
 ds_read_b64_tr_b16 v[84:85], v31 offset:56320
 ds_read_b64_tr_b16 v[86:87], v31 offset:56576
 v_mfma_f32_16x16x32_bf16 v[100:103], v[88:91], a[52:55], v[100:103]
 v_mfma_f32_16x16x32_bf16 v[104:107], v[92:95], a[48:51], v[104:107]
 ds_read_b64_tr_b16 v[88:89], v31 offset:57344
 ds_read_b64_tr_b16 v[90:91], v31 offset:57600
 v_mfma_f32_16x16x32_bf16 v[108:111], v[92:95], a[52:55], v[108:111]
 buffer_load_dwordx4 v254, s[4:7], s35 offen offset:3072 sc1 lds
 v_mfma_f32_16x16x32_bf16 v[112:115], v[64:67], a[48:51], v[112:115]
 s_waitcnt lgkmcnt(6)
 ds_read_b64_tr_b16 v[92:93], v31 offset:58368
 ds_read_b64_tr_b16 v[94:95], v31 offset:58624
 v_mfma_f32_16x16x32_bf16 v[116:119], v[64:67], a[52:55], v[116:119]
 s_waitcnt vmcnt(12)
 ds_read_b128 a[192:195], v36 offset:0
 s_add_u32 m0, s60, 0x20000
 v_mfma_f32_16x16x32_bf16 v[120:123], v[68:71], a[48:51], v[120:123]
 s_add_u32 s34, s34, 0x80
 ds_read_b64_tr_b16 v[64:65], v31 offset:59392
 ds_read_b64_tr_b16 v[66:67], v31 offset:59648
 v_mfma_f32_16x16x32_bf16 v[124:127], v[68:71], a[52:55], v[124:127]
 ds_read_b128 a[196:199], v36 offset:2048
 v_mfma_f32_16x16x32_bf16 v[128:131], v[72:75], a[48:51], v[128:131]
 ds_read_b64_tr_b16 v[68:69], v31 offset:60416
 ds_read_b64_tr_b16 v[70:71], v31 offset:60672
 v_mfma_f32_16x16x32_bf16 v[132:135], v[72:75], a[52:55], v[132:135]
 v_mfma_f32_16x16x32_bf16 v[136:139], v[76:79], a[48:51], v[136:139]
 s_waitcnt lgkmcnt(8)
 ds_read_b64_tr_b16 v[72:73], v31 offset:61440
 ds_read_b64_tr_b16 v[74:75], v31 offset:61696
 v_mfma_f32_16x16x32_bf16 v[140:143], v[76:79], a[52:55], v[140:143]
 buffer_load_dwordx4 v15, s[20:23], s34 offen offset:0  lds
 v_mfma_f32_16x16x32_bf16 v[144:147], v[80:83], a[48:51], v[144:147]
 ds_read_b64_tr_b16 v[76:77], v31 offset:62464
 ds_read_b64_tr_b16 v[78:79], v31 offset:62720
 v_mfma_f32_16x16x32_bf16 v[148:151], v[80:83], a[52:55], v[148:151]
 ds_read_b128 a[200:203], v37 offset:0
 v_mfma_f32_16x16x32_bf16 v[96:99], v[84:87], a[56:59], v[96:99]
 s_waitcnt vmcnt(9)
 s_barrier
 ds_read_b64_tr_b16 v[80:81], v32 offset:16384
 ds_read_b64_tr_b16 v[82:83], v32 offset:16640
 v_mfma_f32_16x16x32_bf16 v[100:103], v[84:87], a[60:63], v[100:103]
 buffer_load_dwordx4 v16, s[20:23], s34 offen offset:1024  lds
 v_mfma_f32_16x16x32_bf16 v[104:107], v[88:91], a[56:59], v[104:107]
 s_waitcnt lgkmcnt(7)
 ds_read_b64_tr_b16 v[84:85], v32 offset:17408
 ds_read_b64_tr_b16 v[86:87], v32 offset:17664
 v_mfma_f32_16x16x32_bf16 v[108:111], v[88:91], a[60:63], v[108:111]
 ds_read_b128 a[204:207], v37 offset:2048
 v_mfma_f32_16x16x32_bf16 v[112:115], v[92:95], a[56:59], v[112:115]
 ds_read_b64_tr_b16 v[88:89], v32 offset:18432
 ds_read_b64_tr_b16 v[90:91], v32 offset:18688
 v_mfma_f32_16x16x32_bf16 v[116:119], v[92:95], a[60:63], v[116:119]
 buffer_load_dwordx4 v17, s[20:23], s34 offen offset:2048  lds
 v_mfma_f32_16x16x32_bf16 v[120:123], v[64:67], a[56:59], v[120:123]
 ds_read_b64_tr_b16 v[92:93], v32 offset:19456
 ds_read_b64_tr_b16 v[94:95], v32 offset:19712
 v_mfma_f32_16x16x32_bf16 v[124:127], v[64:67], a[60:63], v[124:127]
 buffer_load_dwordx4 v18, s[20:23], s34 offen offset:3072  lds
 v_mfma_f32_16x16x32_bf16 v[128:131], v[68:71], a[56:59], v[128:131]
 s_waitcnt lgkmcnt(7)
 ds_read_b64_tr_b16 v[64:65], v32 offset:20480
 ds_read_b64_tr_b16 v[66:67], v32 offset:20736
 v_mfma_f32_16x16x32_bf16 v[132:135], v[68:71], a[60:63], v[132:135]
 s_add_u32 m0, s60, 0x0
 s_add_u32 s35, s35, 0x7000
 v_mfma_f32_16x16x32_bf16 v[136:139], v[72:75], a[56:59], v[136:139]
 ds_read_b64_tr_b16 v[68:69], v32 offset:21504
 ds_read_b64_tr_b16 v[70:71], v32 offset:21760
 v_mfma_f32_16x16x32_bf16 v[140:143], v[72:75], a[60:63], v[140:143]
 buffer_load_dwordx4 v11, s[4:7], s35 offen offset:0 sc1 lds
 v_mfma_f32_16x16x32_bf16 v[144:147], v[76:79], a[56:59], v[144:147]
 ds_read_b64_tr_b16 v[72:73], v32 offset:22528
 ds_read_b64_tr_b16 v[74:75], v32 offset:22784
 v_mfma_f32_16x16x32_bf16 v[148:151], v[76:79], a[60:63], v[148:151]
 buffer_load_dwordx4 v252, s[4:7], s35 offen offset:1024 sc1 lds
 v_mfma_f32_16x16x32_bf16 v[96:99], v[80:83], a[64:67], v[96:99]
 s_waitcnt lgkmcnt(6)
 ds_read_b64_tr_b16 v[76:77], v32 offset:23552
 ds_read_b64_tr_b16 v[78:79], v32 offset:23808
 v_mfma_f32_16x16x32_bf16 v[100:103], v[80:83], a[68:71], v[100:103]
 v_mfma_f32_16x16x32_bf16 v[104:107], v[84:87], a[64:67], v[104:107]
 ds_read_b64_tr_b16 v[80:81], v32 offset:24576
 ds_read_b64_tr_b16 v[82:83], v32 offset:24832
 v_mfma_f32_16x16x32_bf16 v[108:111], v[84:87], a[68:71], v[108:111]
 buffer_load_dwordx4 v253, s[4:7], s35 offen offset:2048 sc1 lds
 v_mfma_f32_16x16x32_bf16 v[112:115], v[88:91], a[64:67], v[112:115]
 ds_read_b64_tr_b16 v[84:85], v32 offset:25600
 ds_read_b64_tr_b16 v[86:87], v32 offset:25856
 v_mfma_f32_16x16x32_bf16 v[116:119], v[88:91], a[68:71], v[116:119]
 s_waitcnt vmcnt(11)
 ds_read_b128 a[208:211], v36 offset:32768
 v_mfma_f32_16x16x32_bf16 v[120:123], v[92:95], a[64:67], v[120:123]
 s_waitcnt lgkmcnt(7)
 ds_read_b64_tr_b16 v[88:89], v32 offset:26624
 ds_read_b64_tr_b16 v[90:91], v32 offset:26880
 v_mfma_f32_16x16x32_bf16 v[124:127], v[92:95], a[68:71], v[124:127]
 buffer_load_dwordx4 v254, s[4:7], s35 offen offset:3072 sc1 lds
 v_mfma_f32_16x16x32_bf16 v[128:131], v[64:67], a[64:67], v[128:131]
 s_add_u32 m0, s60, 0x4000
 ds_read_b64_tr_b16 v[92:93], v32 offset:27648
 ds_read_b64_tr_b16 v[94:95], v32 offset:27904
 v_mfma_f32_16x16x32_bf16 v[132:135], v[64:67], a[68:71], v[132:135]
 ds_read_b128 a[212:215], v36 offset:34816
 s_bfe_u32 s34, s85, 0x4001c
 v_mfma_f32_16x16x32_bf16 v[136:139], v[68:71], a[64:67], v[136:139]
 s_mul_i32 s34, s34, 0x100
 ds_read_b64_tr_b16 v[64:65], v32 offset:28672
 ds_read_b64_tr_b16 v[66:67], v32 offset:28928
 v_mfma_f32_16x16x32_bf16 v[140:143], v[68:71], a[68:71], v[140:143]
 ds_read_b128 a[216:219], v37 offset:32768
 v_mfma_f32_16x16x32_bf16 v[144:147], v[72:75], a[64:67], v[144:147]
 s_waitcnt lgkmcnt(9)
 ds_read_b64_tr_b16 v[68:69], v32 offset:29696
 ds_read_b64_tr_b16 v[70:71], v32 offset:29952
 v_mfma_f32_16x16x32_bf16 v[148:151], v[72:75], a[68:71], v[148:151]
 buffer_load_dwordx4 v15, s[20:23], s34 offen offset:0  lds
 v_mfma_f32_16x16x32_bf16 v[96:99], v[76:79], a[72:75], v[96:99]
 s_waitcnt vmcnt(9)
 s_barrier
 ds_read_b64_tr_b16 v[72:73], v32 offset:49152
 ds_read_b64_tr_b16 v[74:75], v32 offset:49408
 v_mfma_f32_16x16x32_bf16 v[100:103], v[76:79], a[76:79], v[100:103]
 buffer_load_dwordx4 v16, s[20:23], s34 offen offset:1024  lds
 v_mfma_f32_16x16x32_bf16 v[104:107], v[80:83], a[72:75], v[104:107]
 ds_read_b64_tr_b16 v[76:77], v32 offset:50176
 ds_read_b64_tr_b16 v[78:79], v32 offset:50432
 v_mfma_f32_16x16x32_bf16 v[108:111], v[80:83], a[76:79], v[108:111]
 ds_read_b128 a[220:223], v37 offset:34816
 v_mfma_f32_16x16x32_bf16 v[112:115], v[84:87], a[72:75], v[112:115]
 s_waitcnt lgkmcnt(8)
 ds_read_b64_tr_b16 v[80:81], v32 offset:51200
 ds_read_b64_tr_b16 v[82:83], v32 offset:51456
 v_mfma_f32_16x16x32_bf16 v[116:119], v[84:87], a[76:79], v[116:119]
 buffer_load_dwordx4 v17, s[20:23], s34 offen offset:2048  lds
 v_mfma_f32_16x16x32_bf16 v[120:123], v[88:91], a[72:75], v[120:123]
 ds_read_b64_tr_b16 v[84:85], v32 offset:52224
 ds_read_b64_tr_b16 v[86:87], v32 offset:52480
 v_mfma_f32_16x16x32_bf16 v[124:127], v[88:91], a[76:79], v[124:127]
 buffer_load_dwordx4 v18, s[20:23], s34 offen offset:3072  lds
 v_mfma_f32_16x16x32_bf16 v[128:131], v[92:95], a[72:75], v[128:131]
 ds_read_b64_tr_b16 v[88:89], v32 offset:53248
 ds_read_b64_tr_b16 v[90:91], v32 offset:53504
 v_mfma_f32_16x16x32_bf16 v[132:135], v[92:95], a[76:79], v[132:135]
 s_add_u32 m0, s60, 0x8000
 s_bfe_u32 s35, s85, 0x4000c
 s_mul_i32 s35, s35, 0xe000
 v_mfma_f32_16x16x32_bf16 v[136:139], v[64:67], a[72:75], v[136:139]
 s_waitcnt lgkmcnt(7)
 ds_read_b64_tr_b16 v[92:93], v32 offset:54272
 ds_read_b64_tr_b16 v[94:95], v32 offset:54528
 v_mfma_f32_16x16x32_bf16 v[140:143], v[64:67], a[76:79], v[140:143]
 s_add_u32 s35, s35, s45
 buffer_load_dwordx4 v11, s[4:7], s35 offen offset:0 sc1 lds
 v_mfma_f32_16x16x32_bf16 v[144:147], v[68:71], a[72:75], v[144:147]
 ds_read_b64_tr_b16 v[64:65], v32 offset:55296
 ds_read_b64_tr_b16 v[66:67], v32 offset:55552
 v_mfma_f32_16x16x32_bf16 v[148:151], v[68:71], a[76:79], v[148:151]
 buffer_load_dwordx4 v252, s[4:7], s35 offen offset:1024 sc1 lds
 v_mfma_f32_16x16x32_bf16 v[96:99], v[72:75], a[80:83], v[96:99]
 ds_read_b64_tr_b16 v[68:69], v32 offset:56320
 ds_read_b64_tr_b16 v[70:71], v32 offset:56576
 v_mfma_f32_16x16x32_bf16 v[100:103], v[72:75], a[84:87], v[100:103]
 s_waitcnt lgkmcnt(12)
 v_mfma_f32_16x16x32_bf16 v[104:107], v[76:79], a[80:83], v[104:107]
 s_waitcnt lgkmcnt(6)
 ds_read_b64_tr_b16 v[72:73], v32 offset:57344
 ds_read_b64_tr_b16 v[74:75], v32 offset:57600
 v_mfma_f32_16x16x32_bf16 v[108:111], v[76:79], a[84:87], v[108:111]
 buffer_load_dwordx4 v253, s[4:7], s35 offen offset:2048 sc1 lds
 v_mfma_f32_16x16x32_bf16 v[112:115], v[80:83], a[80:83], v[112:115]
 ds_read_b64_tr_b16 v[76:77], v32 offset:58368
 ds_read_b64_tr_b16 v[78:79], v32 offset:58624
 v_mfma_f32_16x16x32_bf16 v[116:119], v[80:83], a[84:87], v[116:119]
 s_waitcnt vmcnt(11)
 ds_read_b128 a[224:227], v38 offset:0
 v_mfma_f32_16x16x32_bf16 v[120:123], v[84:87], a[80:83], v[120:123]
 ds_read_b64_tr_b16 v[80:81], v32 offset:59392
 ds_read_b64_tr_b16 v[82:83], v32 offset:59648
 v_mfma_f32_16x16x32_bf16 v[124:127], v[84:87], a[84:87], v[124:127]
 buffer_load_dwordx4 v254, s[4:7], s35 offen offset:3072 sc1 lds
 v_mfma_f32_16x16x32_bf16 v[128:131], v[88:91], a[80:83], v[128:131]
 s_waitcnt lgkmcnt(7)
 ds_read_b64_tr_b16 v[84:85], v32 offset:60416
 ds_read_b64_tr_b16 v[86:87], v32 offset:60672
 v_mfma_f32_16x16x32_bf16 v[132:135], v[88:91], a[84:87], v[132:135]
 ds_read_b128 a[228:231], v38 offset:2048
 s_add_u32 m0, s60, 0xc000
 v_mfma_f32_16x16x32_bf16 v[136:139], v[92:95], a[80:83], v[136:139]
 s_add_u32 s34, s34, 0x80
 ds_read_b64_tr_b16 v[88:89], v32 offset:61440
 ds_read_b64_tr_b16 v[90:91], v32 offset:61696
 v_mfma_f32_16x16x32_bf16 v[140:143], v[92:95], a[84:87], v[140:143]
 ds_read_b128 a[232:235], v39 offset:0
 v_mfma_f32_16x16x32_bf16 v[144:147], v[64:67], a[80:83], v[144:147]
 ds_read_b64_tr_b16 v[92:93], v32 offset:62464
 ds_read_b64_tr_b16 v[94:95], v32 offset:62720
 v_mfma_f32_16x16x32_bf16 v[148:151], v[64:67], a[84:87], v[148:151]
 buffer_load_dwordx4 v15, s[20:23], s34 offen offset:0  lds
 v_mfma_f32_16x16x32_bf16 v[96:99], v[68:71], a[88:91], v[96:99]
 s_waitcnt lgkmcnt(8)
 s_waitcnt vmcnt(9)
 s_barrier
 ds_read_b64_tr_b16 v[64:65], v31 offset:0
 ds_read_b64_tr_b16 v[66:67], v31 offset:256
 v_mfma_f32_16x16x32_bf16 v[100:103], v[68:71], a[92:95], v[100:103]
 buffer_load_dwordx4 v16, s[20:23], s34 offen offset:1024  lds
 v_mfma_f32_16x16x32_bf16 v[104:107], v[72:75], a[88:91], v[104:107]
 ds_read_b64_tr_b16 v[68:69], v31 offset:1024
 ds_read_b64_tr_b16 v[70:71], v31 offset:1280
 v_mfma_f32_16x16x32_bf16 v[108:111], v[72:75], a[92:95], v[108:111]
 ds_read_b128 a[236:239], v39 offset:2048
 v_mfma_f32_16x16x32_bf16 v[112:115], v[76:79], a[88:91], v[112:115]
 ds_read_b64_tr_b16 v[72:73], v31 offset:2048
 ds_read_b64_tr_b16 v[74:75], v31 offset:2304
 v_mfma_f32_16x16x32_bf16 v[116:119], v[76:79], a[92:95], v[116:119]
 buffer_load_dwordx4 v17, s[20:23], s34 offen offset:2048  lds
 v_mfma_f32_16x16x32_bf16 v[120:123], v[80:83], a[88:91], v[120:123]
 s_waitcnt lgkmcnt(7)
 ds_read_b64_tr_b16 v[76:77], v31 offset:3072
 ds_read_b64_tr_b16 v[78:79], v31 offset:3328
 v_mfma_f32_16x16x32_bf16 v[124:127], v[80:83], a[92:95], v[124:127]
 buffer_load_dwordx4 v18, s[20:23], s34 offen offset:3072  lds
 v_mfma_f32_16x16x32_bf16 v[128:131], v[84:87], a[88:91], v[128:131]
 ds_read_b64_tr_b16 v[80:81], v31 offset:4096
 ds_read_b64_tr_b16 v[82:83], v31 offset:4352
 v_mfma_f32_16x16x32_bf16 v[132:135], v[84:87], a[92:95], v[132:135]
 s_add_u32 m0, s60, 0x10000
 s_add_u32 s35, s35, 0x7000
 v_mfma_f32_16x16x32_bf16 v[136:139], v[88:91], a[88:91], v[136:139]
 ds_read_b64_tr_b16 v[84:85], v31 offset:5120
 ds_read_b64_tr_b16 v[86:87], v31 offset:5376
 v_mfma_f32_16x16x32_bf16 v[140:143], v[88:91], a[92:95], v[140:143]
 buffer_load_dwordx4 v11, s[4:7], s35 offen offset:0 sc1 lds
 v_mfma_f32_16x16x32_bf16 v[144:147], v[92:95], a[88:91], v[144:147]
 s_waitcnt lgkmcnt(6)
 ds_read_b64_tr_b16 v[88:89], v31 offset:6144
 ds_read_b64_tr_b16 v[90:91], v31 offset:6400
 v_mfma_f32_16x16x32_bf16 v[148:151], v[92:95], a[92:95], v[148:151]
 buffer_load_dwordx4 v252, s[4:7], s35 offen offset:1024 sc1 lds
 v_mfma_f32_16x16x32_bf16 v[96:99], v[64:67], a[96:99], v[96:99]
 ds_read_b64_tr_b16 v[92:93], v31 offset:7168
 ds_read_b64_tr_b16 v[94:95], v31 offset:7424
 v_mfma_f32_16x16x32_bf16 v[100:103], v[64:67], a[100:103], v[100:103]
 v_mfma_f32_16x16x32_bf16 v[104:107], v[68:71], a[96:99], v[104:107]
 ds_read_b64_tr_b16 v[64:65], v31 offset:8192
 ds_read_b64_tr_b16 v[66:67], v31 offset:8448
 v_mfma_f32_16x16x32_bf16 v[108:111], v[68:71], a[100:103], v[108:111]
 buffer_load_dwordx4 v253, s[4:7], s35 offen offset:2048 sc1 lds
 v_mfma_f32_16x16x32_bf16 v[112:115], v[72:75], a[96:99], v[112:115]
 s_waitcnt lgkmcnt(6)
 ds_read_b64_tr_b16 v[68:69], v31 offset:9216
 ds_read_b64_tr_b16 v[70:71], v31 offset:9472
 v_mfma_f32_16x16x32_bf16 v[116:119], v[72:75], a[100:103], v[116:119]
 s_waitcnt vmcnt(11)
 ds_read_b128 a[240:243], v34 offset:16384
 v_mfma_f32_16x16x32_bf16 v[120:123], v[76:79], a[96:99], v[120:123]
 ds_read_b64_tr_b16 v[72:73], v31 offset:10240
 ds_read_b64_tr_b16 v[74:75], v31 offset:10496
 v_mfma_f32_16x16x32_bf16 v[124:127], v[76:79], a[100:103], v[124:127]
 buffer_load_dwordx4 v254, s[4:7], s35 offen offset:3072 sc1 lds
 v_mfma_f32_16x16x32_bf16 v[128:131], v[80:83], a[96:99], v[128:131]
 ds_read_b64_tr_b16 v[76:77], v31 offset:11264
 ds_read_b64_tr_b16 v[78:79], v31 offset:11520
 v_mfma_f32_16x16x32_bf16 v[132:135], v[80:83], a[100:103], v[132:135]
 ds_read_b128 a[244:247], v34 offset:18432
 s_add_u32 m0, s60, 0x14000
 v_mfma_f32_16x16x32_bf16 v[136:139], v[84:87], a[96:99], v[136:139]
 s_waitcnt lgkmcnt(8)
 ds_read_b64_tr_b16 v[80:81], v31 offset:12288
 ds_read_b64_tr_b16 v[82:83], v31 offset:12544
 v_mfma_f32_16x16x32_bf16 v[140:143], v[84:87], a[100:103], v[140:143]
 ds_read_b128 a[248:251], v35 offset:16384
 s_bfe_u32 s35, s85, 0x40010
 v_mfma_f32_16x16x32_bf16 v[144:147], v[88:91], a[96:99], v[144:147]
 s_mul_i32 s35, s35, 0xe000
 ds_read_b64_tr_b16 v[84:85], v31 offset:13312
 ds_read_b64_tr_b16 v[86:87], v31 offset:13568
 v_mfma_f32_16x16x32_bf16 v[148:151], v[88:91], a[100:103], v[148:151]
 s_add_u32 s35, s35, s45
 v_mfma_f32_16x16x32_bf16 v[96:99], v[92:95], a[104:107], v[96:99]
 s_waitcnt vmcnt(8)
 s_barrier
 ds_read_b64_tr_b16 v[88:89], v31 offset:32768
 ds_read_b64_tr_b16 v[90:91], v31 offset:33024
 v_mfma_f32_16x16x32_bf16 v[100:103], v[92:95], a[108:111], v[100:103]
 buffer_load_dwordx4 v11, s[4:7], s35 offen offset:0 sc1 lds
 v_mfma_f32_16x16x32_bf16 v[104:107], v[64:67], a[104:107], v[104:107]
 s_waitcnt lgkmcnt(8)
 ds_read_b64_tr_b16 v[92:93], v31 offset:33792
 ds_read_b64_tr_b16 v[94:95], v31 offset:34048
 v_mfma_f32_16x16x32_bf16 v[108:111], v[64:67], a[108:111], v[108:111]
 ds_read_b128 a[252:255], v35 offset:18432
 v_mfma_f32_16x16x32_bf16 v[112:115], v[68:71], a[104:107], v[112:115]
 ds_read_b64_tr_b16 v[64:65], v31 offset:34816
 ds_read_b64_tr_b16 v[66:67], v31 offset:35072
 v_mfma_f32_16x16x32_bf16 v[116:119], v[68:71], a[108:111], v[116:119]
 buffer_load_dwordx4 v252, s[4:7], s35 offen offset:1024 sc1 lds
 v_mfma_f32_16x16x32_bf16 v[120:123], v[72:75], a[104:107], v[120:123]
 ds_read_b64_tr_b16 v[68:69], v31 offset:35840
 ds_read_b64_tr_b16 v[70:71], v31 offset:36096
 v_mfma_f32_16x16x32_bf16 v[124:127], v[72:75], a[108:111], v[124:127]
 v_mfma_f32_16x16x32_bf16 v[128:131], v[76:79], a[104:107], v[128:131]
 s_waitcnt lgkmcnt(7)
 ds_read_b64_tr_b16 v[72:73], v31 offset:36864
 ds_read_b64_tr_b16 v[74:75], v31 offset:37120
 v_mfma_f32_16x16x32_bf16 v[132:135], v[76:79], a[108:111], v[132:135]
 buffer_load_dwordx4 v253, s[4:7], s35 offen offset:2048 sc1 lds
 v_mfma_f32_16x16x32_bf16 v[136:139], v[80:83], a[104:107], v[136:139]
 ds_read_b64_tr_b16 v[76:77], v31 offset:37888
 ds_read_b64_tr_b16 v[78:79], v31 offset:38144
 v_mfma_f32_16x16x32_bf16 v[140:143], v[80:83], a[108:111], v[140:143]
 buffer_load_dwordx4 v254, s[4:7], s35 offen offset:3072 sc1 lds
 v_mfma_f32_16x16x32_bf16 v[144:147], v[84:87], a[104:107], v[144:147]
 s_add_u32 m0, s60, 0x18000
 ds_read_b64_tr_b16 v[80:81], v31 offset:38912
 ds_read_b64_tr_b16 v[82:83], v31 offset:39168
 v_mfma_f32_16x16x32_bf16 v[148:151], v[84:87], a[108:111], v[148:151]
 s_waitcnt lgkmcnt(10)
 s_add_u32 s35, s35, 0x7000
 v_mfma_f32_16x16x32_bf16 v[96:99], v[88:91], a[112:115], v[96:99]
 s_waitcnt lgkmcnt(6)
 ds_read_b64_tr_b16 v[84:85], v31 offset:39936
 ds_read_b64_tr_b16 v[86:87], v31 offset:40192
 v_mfma_f32_16x16x32_bf16 v[100:103], v[88:91], a[116:119], v[100:103]
 v_mfma_f32_16x16x32_bf16 v[104:107], v[92:95], a[112:115], v[104:107]
 ds_read_b64_tr_b16 v[88:89], v31 offset:40960
 ds_read_b64_tr_b16 v[90:91], v31 offset:41216
 v_mfma_f32_16x16x32_bf16 v[108:111], v[92:95], a[116:119], v[108:111]
 buffer_load_dwordx4 v11, s[4:7], s35 offen offset:0 sc1 lds
 v_mfma_f32_16x16x32_bf16 v[112:115], v[64:67], a[112:115], v[112:115]
 ds_read_b64_tr_b16 v[92:93], v31 offset:41984
 ds_read_b64_tr_b16 v[94:95], v31 offset:42240
 v_mfma_f32_16x16x32_bf16 v[116:119], v[64:67], a[116:119], v[116:119]
 s_waitcnt vmcnt(9)
 ds_read_b128 a[0:3], v34 offset:49152
 v_mfma_f32_16x16x32_bf16 v[120:123], v[68:71], a[112:115], v[120:123]
 s_waitcnt lgkmcnt(7)
 ds_read_b64_tr_b16 v[64:65], v31 offset:43008
 ds_read_b64_tr_b16 v[66:67], v31 offset:43264
 v_mfma_f32_16x16x32_bf16 v[124:127], v[68:71], a[116:119], v[124:127]
 buffer_load_dwordx4 v252, s[4:7], s35 offen offset:1024 sc1 lds
 v_mfma_f32_16x16x32_bf16 v[128:131], v[72:75], a[112:115], v[128:131]
 ds_read_b64_tr_b16 v[68:69], v31 offset:44032
 ds_read_b64_tr_b16 v[70:71], v31 offset:44288
 v_mfma_f32_16x16x32_bf16 v[132:135], v[72:75], a[116:119], v[132:135]
 ds_read_b128 a[4:7], v34 offset:51200
 v_mfma_f32_16x16x32_bf16 v[136:139], v[76:79], a[112:115], v[136:139]
 ds_read_b64_tr_b16 v[72:73], v31 offset:45056
 ds_read_b64_tr_b16 v[74:75], v31 offset:45312
 v_mfma_f32_16x16x32_bf16 v[140:143], v[76:79], a[116:119], v[140:143]
 buffer_load_dwordx4 v253, s[4:7], s35 offen offset:2048 sc1 lds
 v_mfma_f32_16x16x32_bf16 v[144:147], v[80:83], a[112:115], v[144:147]
 s_waitcnt lgkmcnt(8)
 ds_read_b64_tr_b16 v[76:77], v31 offset:46080
 ds_read_b64_tr_b16 v[78:79], v31 offset:46336
 v_mfma_f32_16x16x32_bf16 v[148:151], v[80:83], a[116:119], v[148:151]
 ds_read_b128 a[8:11], v35 offset:49152
 v_mfma_f32_16x16x32_bf16 v[96:99], v[84:87], a[120:123], v[96:99]
 s_waitcnt vmcnt(7)
 s_barrier
 ds_read_b64_tr_b16 v[80:81], v32 offset:0
 ds_read_b64_tr_b16 v[82:83], v32 offset:256
 v_mfma_f32_16x16x32_bf16 v[100:103], v[84:87], a[124:127], v[100:103]
 buffer_load_dwordx4 v254, s[4:7], s35 offen offset:3072 sc1 lds
 v_mfma_f32_16x16x32_bf16 v[104:107], v[88:91], a[120:123], v[104:107]
 s_add_u32 m0, s60, 0x1c000
 ds_read_b64_tr_b16 v[84:85], v32 offset:1024
 ds_read_b64_tr_b16 v[86:87], v32 offset:1280
 v_mfma_f32_16x16x32_bf16 v[108:111], v[88:91], a[124:127], v[108:111]
 ds_read_b128 a[12:15], v35 offset:51200
 s_bfe_u32 s35, s85, 0x40014
 v_mfma_f32_16x16x32_bf16 v[112:115], v[92:95], a[120:123], v[112:115]
 s_waitcnt lgkmcnt(8)
 ds_read_b64_tr_b16 v[88:89], v32 offset:2048
 ds_read_b64_tr_b16 v[90:91], v32 offset:2304
 v_mfma_f32_16x16x32_bf16 v[116:119], v[92:95], a[124:127], v[116:119]
 s_mul_i32 s35, s35, 0xe000
 s_add_u32 s35, s35, s45
 v_mfma_f32_16x16x32_bf16 v[120:123], v[64:67], a[120:123], v[120:123]
 ds_read_b64_tr_b16 v[92:93], v32 offset:3072
 ds_read_b64_tr_b16 v[94:95], v32 offset:3328
 v_mfma_f32_16x16x32_bf16 v[124:127], v[64:67], a[124:127], v[124:127]
 buffer_load_dwordx4 v11, s[4:7], s35 offen offset:0 sc1 lds
 v_mfma_f32_16x16x32_bf16 v[128:131], v[68:71], a[120:123], v[128:131]
 ds_read_b64_tr_b16 v[64:65], v32 offset:4096
 ds_read_b64_tr_b16 v[66:67], v32 offset:4352
 v_mfma_f32_16x16x32_bf16 v[132:135], v[68:71], a[124:127], v[132:135]
 buffer_load_dwordx4 v252, s[4:7], s35 offen offset:1024 sc1 lds
 v_mfma_f32_16x16x32_bf16 v[136:139], v[72:75], a[120:123], v[136:139]
 s_waitcnt lgkmcnt(7)
 ds_read_b64_tr_b16 v[68:69], v32 offset:5120
 ds_read_b64_tr_b16 v[70:71], v32 offset:5376
 v_mfma_f32_16x16x32_bf16 v[140:143], v[72:75], a[124:127], v[140:143]
 buffer_load_dwordx4 v253, s[4:7], s35 offen offset:2048 sc1 lds
 v_mfma_f32_16x16x32_bf16 v[144:147], v[76:79], a[120:123], v[144:147]
 ds_read_b64_tr_b16 v[72:73], v32 offset:6144
 ds_read_b64_tr_b16 v[74:75], v32 offset:6400
 v_mfma_f32_16x16x32_bf16 v[148:151], v[76:79], a[124:127], v[148:151]
 s_waitcnt lgkmcnt(10)
 v_mfma_f32_16x16x32_bf16 v[96:99], v[80:83], a[128:131], v[96:99]
 ds_read_b64_tr_b16 v[76:77], v32 offset:7168
 ds_read_b64_tr_b16 v[78:79], v32 offset:7424
 v_mfma_f32_16x16x32_bf16 v[100:103], v[80:83], a[132:135], v[100:103]
 buffer_load_dwordx4 v254, s[4:7], s35 offen offset:3072 sc1 lds
 v_mfma_f32_16x16x32_bf16 v[104:107], v[84:87], a[128:131], v[104:107]
 s_waitcnt lgkmcnt(6)
 ds_read_b64_tr_b16 v[80:81], v32 offset:8192
 ds_read_b64_tr_b16 v[82:83], v32 offset:8448
 v_mfma_f32_16x16x32_bf16 v[108:111], v[84:87], a[132:135], v[108:111]
 s_add_u32 m0, s60, 0x20000
 s_add_u32 s35, s35, 0x7000
 v_mfma_f32_16x16x32_bf16 v[112:115], v[88:91], a[128:131], v[112:115]
 ds_read_b64_tr_b16 v[84:85], v32 offset:9216
 ds_read_b64_tr_b16 v[86:87], v32 offset:9472
 v_mfma_f32_16x16x32_bf16 v[116:119], v[88:91], a[132:135], v[116:119]
 buffer_load_dwordx4 v11, s[4:7], s35 offen offset:0 sc1 lds
 v_mfma_f32_16x16x32_bf16 v[120:123], v[92:95], a[128:131], v[120:123]
 ds_read_b64_tr_b16 v[88:89], v32 offset:10240
 ds_read_b64_tr_b16 v[90:91], v32 offset:10496
 v_mfma_f32_16x16x32_bf16 v[124:127], v[92:95], a[132:135], v[124:127]
 v_mfma_f32_16x16x32_bf16 v[128:131], v[64:67], a[128:131], v[128:131]
 s_waitcnt lgkmcnt(6)
 ds_read_b64_tr_b16 v[92:93], v32 offset:11264
 ds_read_b64_tr_b16 v[94:95], v32 offset:11520
 v_mfma_f32_16x16x32_bf16 v[132:135], v[64:67], a[132:135], v[132:135]
 buffer_load_dwordx4 v252, s[4:7], s35 offen offset:1024 sc1 lds
 v_mfma_f32_16x16x32_bf16 v[136:139], v[68:71], a[128:131], v[136:139]
 ds_read_b64_tr_b16 v[64:65], v32 offset:12288
 ds_read_b64_tr_b16 v[66:67], v32 offset:12544
 v_mfma_f32_16x16x32_bf16 v[140:143], v[68:71], a[132:135], v[140:143]
 v_mfma_f32_16x16x32_bf16 v[144:147], v[72:75], a[128:131], v[144:147]
 ds_read_b64_tr_b16 v[68:69], v32 offset:13312
 ds_read_b64_tr_b16 v[70:71], v32 offset:13568
 v_mfma_f32_16x16x32_bf16 v[148:151], v[72:75], a[132:135], v[148:151]
 buffer_load_dwordx4 v253, s[4:7], s35 offen offset:2048 sc1 lds
 v_mfma_f32_16x16x32_bf16 v[96:99], v[76:79], a[136:139], v[96:99]
 s_waitcnt lgkmcnt(6)
 s_waitcnt vmcnt(11)
 s_barrier
 ds_read_b64_tr_b16 v[72:73], v32 offset:16384
 ds_read_b64_tr_b16 v[74:75], v32 offset:16640
 v_mfma_f32_16x16x32_bf16 v[100:103], v[76:79], a[140:143], v[100:103]
 v_mfma_f32_16x16x32_bf16 v[104:107], v[80:83], a[136:139], v[104:107]
 ds_read_b64_tr_b16 v[76:77], v32 offset:17408
 ds_read_b64_tr_b16 v[78:79], v32 offset:17664
 v_mfma_f32_16x16x32_bf16 v[108:111], v[80:83], a[140:143], v[108:111]
 buffer_load_dwordx4 v254, s[4:7], s35 offen offset:3072 sc1 lds
 v_mfma_f32_16x16x32_bf16 v[112:115], v[84:87], a[136:139], v[112:115]
 s_add_u32 m0, s60, 0x0
 ds_read_b64_tr_b16 v[80:81], v32 offset:18432
 ds_read_b64_tr_b16 v[82:83], v32 offset:18688
 v_mfma_f32_16x16x32_bf16 v[116:119], v[84:87], a[140:143], v[116:119]
 s_bfe_u32 s35, s85, 0x40018
 s_mul_i32 s35, s35, 0xe000
 s_add_u32 s35, s35, s45
 v_mfma_f32_16x16x32_bf16 v[120:123], v[88:91], a[136:139], v[120:123]
 s_waitcnt lgkmcnt(6)
 ds_read_b64_tr_b16 v[84:85], v32 offset:19456
 ds_read_b64_tr_b16 v[86:87], v32 offset:19712
 v_mfma_f32_16x16x32_bf16 v[124:127], v[88:91], a[140:143], v[124:127]
 buffer_load_dwordx4 v11, s[4:7], s35 offen offset:0 sc1 lds
 v_mfma_f32_16x16x32_bf16 v[128:131], v[92:95], a[136:139], v[128:131]
 ds_read_b64_tr_b16 v[88:89], v32 offset:20480
 ds_read_b64_tr_b16 v[90:91], v32 offset:20736
 v_mfma_f32_16x16x32_bf16 v[132:135], v[92:95], a[140:143], v[132:135]
 v_mfma_f32_16x16x32_bf16 v[136:139], v[64:67], a[136:139], v[136:139]
 ds_read_b64_tr_b16 v[92:93], v32 offset:21504
 ds_read_b64_tr_b16 v[94:95], v32 offset:21760
 v_mfma_f32_16x16x32_bf16 v[140:143], v[64:67], a[140:143], v[140:143]
 buffer_load_dwordx4 v252, s[4:7], s35 offen offset:1024 sc1 lds
 v_mfma_f32_16x16x32_bf16 v[144:147], v[68:71], a[136:139], v[144:147]
 s_waitcnt lgkmcnt(6)
 ds_read_b64_tr_b16 v[64:65], v32 offset:22528
 ds_read_b64_tr_b16 v[66:67], v32 offset:22784
 v_mfma_f32_16x16x32_bf16 v[148:151], v[68:71], a[140:143], v[148:151]
 buffer_load_dwordx4 v253, s[4:7], s35 offen offset:2048 sc1 lds
 v_mfma_f32_16x16x32_bf16 v[96:99], v[72:75], a[144:147], v[96:99]
 ds_read_b64_tr_b16 v[68:69], v32 offset:23552
 ds_read_b64_tr_b16 v[70:71], v32 offset:23808
 v_mfma_f32_16x16x32_bf16 v[100:103], v[72:75], a[148:151], v[100:103]
 v_mfma_f32_16x16x32_bf16 v[104:107], v[76:79], a[144:147], v[104:107]
 ds_read_b64_tr_b16 v[72:73], v32 offset:24576
 ds_read_b64_tr_b16 v[74:75], v32 offset:24832
 v_mfma_f32_16x16x32_bf16 v[108:111], v[76:79], a[148:151], v[108:111]
 buffer_load_dwordx4 v254, s[4:7], s35 offen offset:3072 sc1 lds
 v_mfma_f32_16x16x32_bf16 v[112:115], v[80:83], a[144:147], v[112:115]
 s_waitcnt lgkmcnt(6)
 ds_read_b64_tr_b16 v[76:77], v32 offset:25600
 ds_read_b64_tr_b16 v[78:79], v32 offset:25856
 v_mfma_f32_16x16x32_bf16 v[116:119], v[80:83], a[148:151], v[116:119]
 s_add_u32 m0, s60, 0x4000
 s_add_u32 s35, s35, 0x7000
 v_mfma_f32_16x16x32_bf16 v[120:123], v[84:87], a[144:147], v[120:123]
 ds_read_b64_tr_b16 v[80:81], v32 offset:26624
 ds_read_b64_tr_b16 v[82:83], v32 offset:26880
 v_mfma_f32_16x16x32_bf16 v[124:127], v[84:87], a[148:151], v[124:127]
 buffer_load_dwordx4 v11, s[4:7], s35 offen offset:0 sc1 lds
 v_mfma_f32_16x16x32_bf16 v[128:131], v[88:91], a[144:147], v[128:131]
 ds_read_b64_tr_b16 v[84:85], v32 offset:27648
 ds_read_b64_tr_b16 v[86:87], v32 offset:27904
 v_mfma_f32_16x16x32_bf16 v[132:135], v[88:91], a[148:151], v[132:135]
 v_mfma_f32_16x16x32_bf16 v[136:139], v[92:95], a[144:147], v[136:139]
 s_waitcnt lgkmcnt(6)
 ds_read_b64_tr_b16 v[88:89], v32 offset:28672
 ds_read_b64_tr_b16 v[90:91], v32 offset:28928
 v_mfma_f32_16x16x32_bf16 v[140:143], v[92:95], a[148:151], v[140:143]
 buffer_load_dwordx4 v252, s[4:7], s35 offen offset:1024 sc1 lds
 v_mfma_f32_16x16x32_bf16 v[144:147], v[64:67], a[144:147], v[144:147]
 ds_read_b64_tr_b16 v[92:93], v32 offset:29696
 ds_read_b64_tr_b16 v[94:95], v32 offset:29952
 v_mfma_f32_16x16x32_bf16 v[148:151], v[64:67], a[148:151], v[148:151]
 v_mfma_f32_16x16x32_bf16 v[96:99], v[68:71], a[152:155], v[96:99]
 s_waitcnt vmcnt(14)
 s_barrier
 ds_read_b64_tr_b16 v[64:65], v32 offset:32768
 ds_read_b64_tr_b16 v[66:67], v32 offset:33024
 v_mfma_f32_16x16x32_bf16 v[100:103], v[68:71], a[156:159], v[100:103]
 buffer_load_dwordx4 v253, s[4:7], s35 offen offset:2048 sc1 lds
 v_mfma_f32_16x16x32_bf16 v[104:107], v[72:75], a[152:155], v[104:107]
 s_waitcnt lgkmcnt(6)
 ds_read_b64_tr_b16 v[68:69], v32 offset:33792
 ds_read_b64_tr_b16 v[70:71], v32 offset:34048
 v_mfma_f32_16x16x32_bf16 v[108:111], v[72:75], a[156:159], v[108:111]
 v_mfma_f32_16x16x32_bf16 v[112:115], v[76:79], a[152:155], v[112:115]
 ds_read_b64_tr_b16 v[72:73], v32 offset:34816
 ds_read_b64_tr_b16 v[74:75], v32 offset:35072
 v_mfma_f32_16x16x32_bf16 v[116:119], v[76:79], a[156:159], v[116:119]
 buffer_load_dwordx4 v254, s[4:7], s35 offen offset:3072 sc1 lds
 v_mfma_f32_16x16x32_bf16 v[120:123], v[80:83], a[152:155], v[120:123]
 s_add_u32 m0, s60, 0x8000
 ds_read_b64_tr_b16 v[76:77], v32 offset:35840
 ds_read_b64_tr_b16 v[78:79], v32 offset:36096
 v_mfma_f32_16x16x32_bf16 v[124:127], v[80:83], a[156:159], v[124:127]
 s_bfe_u32 s35, s85, 0x4001c
 s_mul_i32 s35, s35, 0xe000
 s_add_u32 s35, s35, s45
 v_mfma_f32_16x16x32_bf16 v[128:131], v[84:87], a[152:155], v[128:131]
 s_waitcnt lgkmcnt(6)
 ds_read_b64_tr_b16 v[80:81], v32 offset:36864
 ds_read_b64_tr_b16 v[82:83], v32 offset:37120
 v_mfma_f32_16x16x32_bf16 v[132:135], v[84:87], a[156:159], v[132:135]
 buffer_load_dwordx4 v11, s[4:7], s35 offen offset:0 sc1 lds
 v_mfma_f32_16x16x32_bf16 v[136:139], v[88:91], a[152:155], v[136:139]
 ds_read_b64_tr_b16 v[84:85], v32 offset:37888
 ds_read_b64_tr_b16 v[86:87], v32 offset:38144
 v_mfma_f32_16x16x32_bf16 v[140:143], v[88:91], a[156:159], v[140:143]
 v_mfma_f32_16x16x32_bf16 v[144:147], v[92:95], a[152:155], v[144:147]
 ds_read_b64_tr_b16 v[88:89], v32 offset:38912
 ds_read_b64_tr_b16 v[90:91], v32 offset:39168
 v_mfma_f32_16x16x32_bf16 v[148:151], v[92:95], a[156:159], v[148:151]
 buffer_load_dwordx4 v252, s[4:7], s35 offen offset:1024 sc1 lds
 v_mfma_f32_16x16x32_bf16 v[96:99], v[64:67], a[160:163], v[96:99]
 s_waitcnt lgkmcnt(6)
 ds_read_b64_tr_b16 v[92:93], v32 offset:39936
 ds_read_b64_tr_b16 v[94:95], v32 offset:40192
 v_mfma_f32_16x16x32_bf16 v[100:103], v[64:67], a[164:167], v[100:103]
 v_mfma_f32_16x16x32_bf16 v[104:107], v[68:71], a[160:163], v[104:107]
 ds_read_b64_tr_b16 v[64:65], v32 offset:40960
 ds_read_b64_tr_b16 v[66:67], v32 offset:41216
 v_mfma_f32_16x16x32_bf16 v[108:111], v[68:71], a[164:167], v[108:111]
 buffer_load_dwordx4 v253, s[4:7], s35 offen offset:2048 sc1 lds
 v_mfma_f32_16x16x32_bf16 v[112:115], v[72:75], a[160:163], v[112:115]
 ds_read_b64_tr_b16 v[68:69], v32 offset:41984
 ds_read_b64_tr_b16 v[70:71], v32 offset:42240
 v_mfma_f32_16x16x32_bf16 v[116:119], v[72:75], a[164:167], v[116:119]
 buffer_load_dwordx4 v254, s[4:7], s35 offen offset:3072 sc1 lds
 v_mfma_f32_16x16x32_bf16 v[120:123], v[76:79], a[160:163], v[120:123]
 s_waitcnt lgkmcnt(6)
 ds_read_b64_tr_b16 v[72:73], v32 offset:43008
 ds_read_b64_tr_b16 v[74:75], v32 offset:43264
 v_mfma_f32_16x16x32_bf16 v[124:127], v[76:79], a[164:167], v[124:127]
 s_add_u32 m0, s60, 0xc000
 s_add_u32 s35, s35, 0x7000
 v_mfma_f32_16x16x32_bf16 v[128:131], v[80:83], a[160:163], v[128:131]
 ds_read_b64_tr_b16 v[76:77], v32 offset:44032
 ds_read_b64_tr_b16 v[78:79], v32 offset:44288
 v_mfma_f32_16x16x32_bf16 v[132:135], v[80:83], a[164:167], v[132:135]
 buffer_load_dwordx4 v11, s[4:7], s35 offen offset:0 sc1 lds
 v_mfma_f32_16x16x32_bf16 v[136:139], v[84:87], a[160:163], v[136:139]
 ds_read_b64_tr_b16 v[80:81], v32 offset:45056
 ds_read_b64_tr_b16 v[82:83], v32 offset:45312
 v_mfma_f32_16x16x32_bf16 v[140:143], v[84:87], a[164:167], v[140:143]
 v_mfma_f32_16x16x32_bf16 v[144:147], v[88:91], a[160:163], v[144:147]
 s_waitcnt lgkmcnt(6)
 ds_read_b64_tr_b16 v[84:85], v32 offset:46080
 ds_read_b64_tr_b16 v[86:87], v32 offset:46336
 v_mfma_f32_16x16x32_bf16 v[148:151], v[88:91], a[164:167], v[148:151]
 buffer_load_dwordx4 v252, s[4:7], s35 offen offset:1024 sc1 lds
 v_mfma_f32_16x16x32_bf16 v[96:99], v[92:95], a[168:171], v[96:99]
 s_waitcnt vmcnt(18)
 s_barrier
 ds_read_b64_tr_b16 v[88:89], v32 offset:49152
 ds_read_b64_tr_b16 v[90:91], v32 offset:49408
 v_mfma_f32_16x16x32_bf16 v[100:103], v[92:95], a[172:175], v[100:103]
 v_mfma_f32_16x16x32_bf16 v[104:107], v[64:67], a[168:171], v[104:107]
 ds_read_b64_tr_b16 v[92:93], v32 offset:50176
 ds_read_b64_tr_b16 v[94:95], v32 offset:50432
 v_mfma_f32_16x16x32_bf16 v[108:111], v[64:67], a[172:175], v[108:111]
 buffer_load_dwordx4 v253, s[4:7], s35 offen offset:2048 sc1 lds
 v_mfma_f32_16x16x32_bf16 v[112:115], v[68:71], a[168:171], v[112:115]
 s_waitcnt lgkmcnt(6)
 ds_read_b64_tr_b16 v[64:65], v32 offset:51200
 ds_read_b64_tr_b16 v[66:67], v32 offset:51456
 v_mfma_f32_16x16x32_bf16 v[116:119], v[68:71], a[172:175], v[116:119]
 v_mfma_f32_16x16x32_bf16 v[120:123], v[72:75], a[168:171], v[120:123]
 ds_read_b64_tr_b16 v[68:69], v32 offset:52224
 ds_read_b64_tr_b16 v[70:71], v32 offset:52480
 v_mfma_f32_16x16x32_bf16 v[124:127], v[72:75], a[172:175], v[124:127]
 buffer_load_dwordx4 v254, s[4:7], s35 offen offset:3072 sc1 lds
 v_mfma_f32_16x16x32_bf16 v[128:131], v[76:79], a[168:171], v[128:131]
 s_add_u32 m0, s60, 0x10000
 ds_read_b64_tr_b16 v[72:73], v32 offset:53248
 ds_read_b64_tr_b16 v[74:75], v32 offset:53504
 v_mfma_f32_16x16x32_bf16 v[132:135], v[76:79], a[172:175], v[132:135]
 s_bfe_u32 s65, s90, 0x40000
 s_mul_i32 s65, s65, 0x40000
 s_add_u32 s65, s65, s63
 v_mfma_f32_16x16x32_bf16 v[136:139], v[80:83], a[168:171], v[136:139]
 s_waitcnt lgkmcnt(6)
 ds_read_b64_tr_b16 v[76:77], v32 offset:54272
 ds_read_b64_tr_b16 v[78:79], v32 offset:54528
 v_mfma_f32_16x16x32_bf16 v[140:143], v[80:83], a[172:175], v[140:143]
 buffer_load_dwordx4 v7, s[24:27], s65 offen offset:0  lds
 v_mfma_f32_16x16x32_bf16 v[144:147], v[84:87], a[168:171], v[144:147]
 ds_read_b64_tr_b16 v[80:81], v32 offset:55296
 ds_read_b64_tr_b16 v[82:83], v32 offset:55552
 v_mfma_f32_16x16x32_bf16 v[148:151], v[84:87], a[172:175], v[148:151]
 v_mfma_f32_16x16x32_bf16 v[96:99], v[88:91], a[176:179], v[96:99]
 ds_read_b64_tr_b16 v[84:85], v32 offset:56320
 ds_read_b64_tr_b16 v[86:87], v32 offset:56576
 v_mfma_f32_16x16x32_bf16 v[100:103], v[88:91], a[180:183], v[100:103]
 buffer_load_dwordx4 v8, s[24:27], s65 offen offset:1024  lds
 v_mfma_f32_16x16x32_bf16 v[104:107], v[92:95], a[176:179], v[104:107]
 s_waitcnt lgkmcnt(6)
 ds_read_b64_tr_b16 v[88:89], v32 offset:57344
 ds_read_b64_tr_b16 v[90:91], v32 offset:57600
 v_mfma_f32_16x16x32_bf16 v[108:111], v[92:95], a[180:183], v[108:111]
 v_mfma_f32_16x16x32_bf16 v[112:115], v[64:67], a[176:179], v[112:115]
 ds_read_b64_tr_b16 v[92:93], v32 offset:58368
 ds_read_b64_tr_b16 v[94:95], v32 offset:58624
 v_mfma_f32_16x16x32_bf16 v[116:119], v[64:67], a[180:183], v[116:119]
 buffer_load_dwordx4 v9, s[24:27], s65 offen offset:2048  lds
 v_mfma_f32_16x16x32_bf16 v[120:123], v[68:71], a[176:179], v[120:123]
 ds_read_b64_tr_b16 v[64:65], v32 offset:59392
 ds_read_b64_tr_b16 v[66:67], v32 offset:59648
 v_mfma_f32_16x16x32_bf16 v[124:127], v[68:71], a[180:183], v[124:127]
 v_mfma_f32_16x16x32_bf16 v[128:131], v[72:75], a[176:179], v[128:131]
 s_waitcnt lgkmcnt(6)
 ds_read_b64_tr_b16 v[68:69], v32 offset:60416
 ds_read_b64_tr_b16 v[70:71], v32 offset:60672
 v_mfma_f32_16x16x32_bf16 v[132:135], v[72:75], a[180:183], v[132:135]
 buffer_load_dwordx4 v10, s[24:27], s65 offen offset:3072  lds
 v_mfma_f32_16x16x32_bf16 v[136:139], v[76:79], a[176:179], v[136:139]
 s_add_u32 m0, s60, 0x14000
 ds_read_b64_tr_b16 v[72:73], v32 offset:61440
 ds_read_b64_tr_b16 v[74:75], v32 offset:61696
 v_mfma_f32_16x16x32_bf16 v[140:143], v[76:79], a[180:183], v[140:143]
 s_bfe_u32 s65, s90, 0x40004
 s_mul_i32 s65, s65, 0x40000
 s_add_u32 s65, s65, s63
 v_mfma_f32_16x16x32_bf16 v[144:147], v[80:83], a[176:179], v[144:147]
 ds_read_b64_tr_b16 v[76:77], v32 offset:62464
 ds_read_b64_tr_b16 v[78:79], v32 offset:62720
 v_mfma_f32_16x16x32_bf16 v[148:151], v[80:83], a[180:183], v[148:151]
 buffer_load_dwordx4 v7, s[24:27], s65 offen offset:0  lds
 v_mfma_f32_16x16x32_bf16 v[96:99], v[84:87], a[184:187], v[96:99]
 s_waitcnt lgkmcnt(6)
 s_waitcnt vmcnt(21)
 s_barrier
 ds_read_b64_tr_b16 v[80:81], v33 offset:0
 ds_read_b64_tr_b16 v[82:83], v33 offset:256
 v_mfma_f32_16x16x32_bf16 v[100:103], v[84:87], a[188:191], v[100:103]
 buffer_load_dwordx4 v8, s[24:27], s65 offen offset:1024  lds
 v_mfma_f32_16x16x32_bf16 v[104:107], v[88:91], a[184:187], v[104:107]
 ds_read_b64_tr_b16 v[84:85], v33 offset:1024
 ds_read_b64_tr_b16 v[86:87], v33 offset:1280
 v_mfma_f32_16x16x32_bf16 v[108:111], v[88:91], a[188:191], v[108:111]
 v_mfma_f32_16x16x32_bf16 v[112:115], v[92:95], a[184:187], v[112:115]
 ds_read_b64_tr_b16 v[88:89], v33 offset:2048
 ds_read_b64_tr_b16 v[90:91], v33 offset:2304
 v_mfma_f32_16x16x32_bf16 v[116:119], v[92:95], a[188:191], v[116:119]
 buffer_load_dwordx4 v9, s[24:27], s65 offen offset:2048  lds
 v_mfma_f32_16x16x32_bf16 v[120:123], v[64:67], a[184:187], v[120:123]
 s_waitcnt lgkmcnt(6)
 ds_read_b64_tr_b16 v[92:93], v33 offset:3072
 ds_read_b64_tr_b16 v[94:95], v33 offset:3328
 v_mfma_f32_16x16x32_bf16 v[124:127], v[64:67], a[188:191], v[124:127]
 v_mfma_f32_16x16x32_bf16 v[128:131], v[68:71], a[184:187], v[128:131]
 ds_read_b64_tr_b16 v[64:65], v33 offset:4096
 ds_read_b64_tr_b16 v[66:67], v33 offset:4352
 v_mfma_f32_16x16x32_bf16 v[132:135], v[68:71], a[188:191], v[132:135]
 buffer_load_dwordx4 v10, s[24:27], s65 offen offset:3072  lds
 v_mfma_f32_16x16x32_bf16 v[136:139], v[72:75], a[184:187], v[136:139]
 s_add_u32 m0, s60, 0x18000
 ds_read_b64_tr_b16 v[68:69], v33 offset:5120
 ds_read_b64_tr_b16 v[70:71], v33 offset:5376
 v_mfma_f32_16x16x32_bf16 v[140:143], v[72:75], a[188:191], v[140:143]
 s_bfe_u32 s65, s90, 0x40008
 s_mul_i32 s65, s65, 0x40000
 s_add_u32 s65, s65, s63
 v_mfma_f32_16x16x32_bf16 v[144:147], v[76:79], a[184:187], v[144:147]
 s_waitcnt lgkmcnt(6)
 ds_read_b64_tr_b16 v[72:73], v33 offset:6144
 ds_read_b64_tr_b16 v[74:75], v33 offset:6400
 v_mfma_f32_16x16x32_bf16 v[148:151], v[76:79], a[188:191], v[148:151]
 buffer_load_dwordx4 v7, s[24:27], s65 offen offset:0  lds
 v_mfma_f32_16x16x32_bf16 v[96:99], v[80:83], a[192:195], v[96:99]
 ds_read_b64_tr_b16 v[76:77], v33 offset:7168
 ds_read_b64_tr_b16 v[78:79], v33 offset:7424
 v_mfma_f32_16x16x32_bf16 v[100:103], v[80:83], a[196:199], v[100:103]
 v_mfma_f32_16x16x32_bf16 v[104:107], v[84:87], a[192:195], v[104:107]
 ds_read_b64_tr_b16 v[80:81], v33 offset:8192
 ds_read_b64_tr_b16 v[82:83], v33 offset:8448
 v_mfma_f32_16x16x32_bf16 v[108:111], v[84:87], a[196:199], v[108:111]
 buffer_load_dwordx4 v8, s[24:27], s65 offen offset:1024  lds
 v_mfma_f32_16x16x32_bf16 v[112:115], v[88:91], a[192:195], v[112:115]
 s_waitcnt lgkmcnt(6)
 ds_read_b64_tr_b16 v[84:85], v33 offset:9216
 ds_read_b64_tr_b16 v[86:87], v33 offset:9472
 v_mfma_f32_16x16x32_bf16 v[116:119], v[88:91], a[196:199], v[116:119]
 v_add_u32 v61, mk_k5-mk_top+26624, v249
 v_min_u32 v61, mk_end-mk_top, v61
 global_load_dword v255, v61, s[18:19]
 v_mfma_f32_16x16x32_bf16 v[120:123], v[92:95], a[192:195], v[120:123]
 ds_read_b64_tr_b16 v[88:89], v33 offset:10240
 ds_read_b64_tr_b16 v[90:91], v33 offset:10496
 v_mfma_f32_16x16x32_bf16 v[124:127], v[92:95], a[196:199], v[124:127]
 buffer_load_dwordx4 v9, s[24:27], s65 offen offset:2048  lds
 v_mfma_f32_16x16x32_bf16 v[128:131], v[64:67], a[192:195], v[128:131]
 ds_read_b64_tr_b16 v[92:93], v33 offset:11264
 ds_read_b64_tr_b16 v[94:95], v33 offset:11520
 v_mfma_f32_16x16x32_bf16 v[132:135], v[64:67], a[196:199], v[132:135]
 v_mfma_f32_16x16x32_bf16 v[136:139], v[68:71], a[192:195], v[136:139]
 s_waitcnt lgkmcnt(6)
 ds_read_b64_tr_b16 v[64:65], v33 offset:12288
 ds_read_b64_tr_b16 v[66:67], v33 offset:12544
 v_mfma_f32_16x16x32_bf16 v[140:143], v[68:71], a[196:199], v[140:143]
 buffer_load_dwordx4 v10, s[24:27], s65 offen offset:3072  lds
 v_mfma_f32_16x16x32_bf16 v[144:147], v[72:75], a[192:195], v[144:147]
 ds_read_b64_tr_b16 v[68:69], v33 offset:13312
 ds_read_b64_tr_b16 v[70:71], v33 offset:13568
 v_mfma_f32_16x16x32_bf16 v[148:151], v[72:75], a[196:199], v[148:151]
 v_mfma_f32_16x16x32_bf16 v[96:99], v[76:79], a[200:203], v[96:99]
 s_waitcnt vmcnt(25)
 s_barrier
 ds_read_b64_tr_b16 v[72:73], v31 offset:0
 ds_read_b64_tr_b16 v[74:75], v31 offset:256
 v_mfma_f32_16x16x32_bf16 v[100:103], v[76:79], a[204:207], v[100:103]
 s_add_u32 m0, s60, 0x1c000
 s_bfe_u32 s65, s90, 0x4000c
 s_mul_i32 s65, s65, 0x40000
 v_mfma_f32_16x16x32_bf16 v[104:107], v[80:83], a[200:203], v[104:107]
 s_waitcnt lgkmcnt(6)
 ds_read_b64_tr_b16 v[76:77], v31 offset:1024
 ds_read_b64_tr_b16 v[78:79], v31 offset:1280
 v_mfma_f32_16x16x32_bf16 v[108:111], v[80:83], a[204:207], v[108:111]
 s_add_u32 s65, s65, s63
 v_mfma_f32_16x16x32_bf16 v[112:115], v[84:87], a[200:203], v[112:115]
 ds_read_b64_tr_b16 v[80:81], v31 offset:2048
 ds_read_b64_tr_b16 v[82:83], v31 offset:2304
 v_mfma_f32_16x16x32_bf16 v[116:119], v[84:87], a[204:207], v[116:119]
 buffer_load_dwordx4 v7, s[24:27], s65 offen offset:0  lds
 v_mfma_f32_16x16x32_bf16 v[120:123], v[88:91], a[200:203], v[120:123]
 ds_read_b64_tr_b16 v[84:85], v31 offset:3072
 ds_read_b64_tr_b16 v[86:87], v31 offset:3328
 v_mfma_f32_16x16x32_bf16 v[124:127], v[88:91], a[204:207], v[124:127]
 buffer_load_dwordx4 v8, s[24:27], s65 offen offset:1024  lds
 v_mfma_f32_16x16x32_bf16 v[128:131], v[92:95], a[200:203], v[128:131]
 s_waitcnt lgkmcnt(6)
 ds_read_b64_tr_b16 v[88:89], v31 offset:4096
 ds_read_b64_tr_b16 v[90:91], v31 offset:4352
 v_mfma_f32_16x16x32_bf16 v[132:135], v[92:95], a[204:207], v[132:135]
 buffer_load_dwordx4 v9, s[24:27], s65 offen offset:2048  lds
 v_mfma_f32_16x16x32_bf16 v[136:139], v[64:67], a[200:203], v[136:139]
 ds_read_b64_tr_b16 v[92:93], v31 offset:5120
 ds_read_b64_tr_b16 v[94:95], v31 offset:5376
 v_mfma_f32_16x16x32_bf16 v[140:143], v[64:67], a[204:207], v[140:143]
 v_mfma_f32_16x16x32_bf16 v[144:147], v[68:71], a[200:203], v[144:147]
 ds_read_b64_tr_b16 v[64:65], v31 offset:6144
 ds_read_b64_tr_b16 v[66:67], v31 offset:6400
 v_mfma_f32_16x16x32_bf16 v[148:151], v[68:71], a[204:207], v[148:151]
 buffer_load_dwordx4 v10, s[24:27], s65 offen offset:3072  lds
 v_mfma_f32_16x16x32_bf16 v[96:99], v[72:75], a[208:211], v[96:99]
 s_waitcnt lgkmcnt(6)
 ds_read_b64_tr_b16 v[68:69], v31 offset:7168
 ds_read_b64_tr_b16 v[70:71], v31 offset:7424
 v_mfma_f32_16x16x32_bf16 v[100:103], v[72:75], a[212:215], v[100:103]
 v_mfma_f32_16x16x32_bf16 v[104:107], v[76:79], a[208:211], v[104:107]
 ds_read_b64_tr_b16 v[72:73], v31 offset:8192
 ds_read_b64_tr_b16 v[74:75], v31 offset:8448
 v_mfma_f32_16x16x32_bf16 v[108:111], v[76:79], a[212:215], v[108:111]
 v_mfma_f32_16x16x32_bf16 v[112:115], v[80:83], a[208:211], v[112:115]
 ds_read_b64_tr_b16 v[76:77], v31 offset:9216
 ds_read_b64_tr_b16 v[78:79], v31 offset:9472
 v_mfma_f32_16x16x32_bf16 v[116:119], v[80:83], a[212:215], v[116:119]
 v_mfma_f32_16x16x32_bf16 v[120:123], v[84:87], a[208:211], v[120:123]
 s_waitcnt lgkmcnt(6)
 ds_read_b64_tr_b16 v[80:81], v31 offset:10240
 ds_read_b64_tr_b16 v[82:83], v31 offset:10496
 v_mfma_f32_16x16x32_bf16 v[124:127], v[84:87], a[212:215], v[124:127]
 v_mfma_f32_16x16x32_bf16 v[128:131], v[88:91], a[208:211], v[128:131]
 ds_read_b64_tr_b16 v[84:85], v31 offset:11264
 ds_read_b64_tr_b16 v[86:87], v31 offset:11520
 v_mfma_f32_16x16x32_bf16 v[132:135], v[88:91], a[212:215], v[132:135]
 v_mfma_f32_16x16x32_bf16 v[136:139], v[92:95], a[208:211], v[136:139]
 ds_read_b64_tr_b16 v[88:89], v31 offset:12288
 ds_read_b64_tr_b16 v[90:91], v31 offset:12544
 v_mfma_f32_16x16x32_bf16 v[140:143], v[92:95], a[212:215], v[140:143]
 v_mfma_f32_16x16x32_bf16 v[144:147], v[64:67], a[208:211], v[144:147]
 s_waitcnt lgkmcnt(6)
 ds_read_b64_tr_b16 v[92:93], v31 offset:13312
 ds_read_b64_tr_b16 v[94:95], v31 offset:13568
 v_mfma_f32_16x16x32_bf16 v[148:151], v[64:67], a[212:215], v[148:151]
 v_mfma_f32_16x16x32_bf16 v[96:99], v[68:71], a[216:219], v[96:99]
 s_waitcnt vmcnt(25)
 s_barrier
 ds_read_b64_tr_b16 v[64:65], v31 offset:16384
 ds_read_b64_tr_b16 v[66:67], v31 offset:16640
 v_mfma_f32_16x16x32_bf16 v[100:103], v[68:71], a[220:223], v[100:103]
 s_add_u32 m0, s60, 0x20000
 s_bfe_u32 s65, s90, 0x40010
 s_mul_i32 s65, s65, 0x40000
 v_mfma_f32_16x16x32_bf16 v[104:107], v[72:75], a[216:219], v[104:107]
 s_add_u32 s65, s65, s63
 ds_read_b64_tr_b16 v[68:69], v31 offset:17408
 ds_read_b64_tr_b16 v[70:71], v31 offset:17664
 v_mfma_f32_16x16x32_bf16 v[108:111], v[72:75], a[220:223], v[108:111]
 buffer_load_dwordx4 v7, s[24:27], s65 offen offset:0  lds
 v_mfma_f32_16x16x32_bf16 v[112:115], v[76:79], a[216:219], v[112:115]
 s_waitcnt lgkmcnt(6)
 ds_read_b64_tr_b16 v[72:73], v31 offset:23552
 ds_read_b64_tr_b16 v[74:75], v31 offset:23808
 v_mfma_f32_16x16x32_bf16 v[116:119], v[76:79], a[220:223], v[116:119]
 buffer_load_dwordx4 v8, s[24:27], s65 offen offset:1024  lds
 v_mfma_f32_16x16x32_bf16 v[120:123], v[80:83], a[216:219], v[120:123]
 ds_read_b64_tr_b16 v[76:77], v31 offset:24576
 ds_read_b64_tr_b16 v[78:79], v31 offset:24832
 v_mfma_f32_16x16x32_bf16 v[124:127], v[80:83], a[220:223], v[124:127]
 buffer_load_dwordx4 v9, s[24:27], s65 offen offset:2048  lds
 v_mfma_f32_16x16x32_bf16 v[128:131], v[84:87], a[216:219], v[128:131]
 s_waitcnt vmcnt(24)
 s_barrier
 ds_read_b64_tr_b16 v[80:81], v31 offset:32768
 ds_read_b64_tr_b16 v[82:83], v31 offset:33024
 v_mfma_f32_16x16x32_bf16 v[132:135], v[84:87], a[220:223], v[132:135]
 v_mfma_f32_16x16x32_bf16 v[136:139], v[88:91], a[216:219], v[136:139]
 s_waitcnt lgkmcnt(6)
 ds_read_b64_tr_b16 v[84:85], v31 offset:33792
 ds_read_b64_tr_b16 v[86:87], v31 offset:34048
 v_mfma_f32_16x16x32_bf16 v[140:143], v[88:91], a[220:223], v[140:143]
 buffer_load_dwordx4 v10, s[24:27], s65 offen offset:3072  lds
 v_mfma_f32_16x16x32_bf16 v[144:147], v[92:95], a[216:219], v[144:147]
 ds_read_b64_tr_b16 v[88:89], v31 offset:39936
 ds_read_b64_tr_b16 v[90:91], v31 offset:40192
 v_mfma_f32_16x16x32_bf16 v[148:151], v[92:95], a[220:223], v[148:151]
 v_mfma_f32_16x16x32_bf16 v[96:99], v[64:67], a[224:227], v[96:99]
 ds_read_b64_tr_b16 v[92:93], v31 offset:40960
 ds_read_b64_tr_b16 v[94:95], v31 offset:41216
 v_mfma_f32_16x16x32_bf16 v[100:103], v[64:67], a[228:231], v[100:103]
 v_mfma_f32_16x16x32_bf16 v[104:107], v[68:71], a[224:227], v[104:107]
 s_waitcnt lgkmcnt(6)
 s_waitcnt vmcnt(21)
 s_barrier
 ds_read_b64_tr_b16 v[64:65], v31 offset:49152
 ds_read_b64_tr_b16 v[66:67], v31 offset:49408
 v_mfma_f32_16x16x32_bf16 v[108:111], v[68:71], a[228:231], v[108:111]
 s_add_u32 m0, s60, 0x0
 s_bfe_u32 s65, s90, 0x40014
 s_mul_i32 s65, s65, 0x40000
 v_mfma_f32_16x16x32_bf16 v[96:99], v[72:75], a[232:235], v[96:99]
 s_add_u32 s65, s65, s63
 ds_read_b64_tr_b16 v[68:69], v31 offset:50176
 ds_read_b64_tr_b16 v[70:71], v31 offset:50432
 v_mfma_f32_16x16x32_bf16 v[100:103], v[72:75], a[236:239], v[100:103]
 buffer_load_dwordx4 v7, s[24:27], s65 offen offset:0  lds
 v_mfma_f32_16x16x32_bf16 v[104:107], v[76:79], a[232:235], v[104:107]
 ds_read_b64_tr_b16 v[72:73], v31 offset:56320
 ds_read_b64_tr_b16 v[74:75], v31 offset:56576
 v_mfma_f32_16x16x32_bf16 v[108:111], v[76:79], a[236:239], v[108:111]
 buffer_load_dwordx4 v8, s[24:27], s65 offen offset:1024  lds
 v_mfma_f32_16x16x32_bf16 v[96:99], v[80:83], a[240:243], v[96:99]
 s_waitcnt lgkmcnt(6)
 ds_read_b64_tr_b16 v[76:77], v31 offset:57344
 ds_read_b64_tr_b16 v[78:79], v31 offset:57600
 v_mfma_f32_16x16x32_bf16 v[100:103], v[80:83], a[244:247], v[100:103]
 buffer_load_dwordx4 v9, s[24:27], s65 offen offset:2048  lds
 v_mfma_f32_16x16x32_bf16 v[104:107], v[84:87], a[240:243], v[104:107]
 ds_read_b64_tr_b16 v[80:81], v31 offset:18432
 ds_read_b64_tr_b16 v[82:83], v31 offset:18688
 v_mfma_f32_16x16x32_bf16 v[108:111], v[84:87], a[244:247], v[108:111]
 v_mfma_f32_16x16x32_bf16 v[96:99], v[88:91], a[248:251], v[96:99]
 ds_read_b64_tr_b16 v[84:85], v31 offset:19456
 ds_read_b64_tr_b16 v[86:87], v31 offset:19712
 v_mfma_f32_16x16x32_bf16 v[100:103], v[88:91], a[252:255], v[100:103]
 buffer_load_dwordx4 v10, s[24:27], s65 offen offset:3072  lds
 v_mfma_f32_16x16x32_bf16 v[104:107], v[92:95], a[248:251], v[104:107]
 s_waitcnt lgkmcnt(6)
 ds_read_b64_tr_b16 v[88:89], v31 offset:25600
 ds_read_b64_tr_b16 v[90:91], v31 offset:25856
 v_mfma_f32_16x16x32_bf16 v[108:111], v[92:95], a[252:255], v[108:111]
 v_mfma_f32_16x16x32_bf16 v[96:99], v[64:67], a[0:3], v[96:99]
 ds_read_b64_tr_b16 v[92:93], v31 offset:26624
 ds_read_b64_tr_b16 v[94:95], v31 offset:26880
 v_mfma_f32_16x16x32_bf16 v[100:103], v[64:67], a[4:7], v[100:103]
 v_mfma_f32_16x16x32_bf16 v[104:107], v[68:71], a[0:3], v[104:107]
 ds_read_b64_tr_b16 v[64:65], v31 offset:34816
 ds_read_b64_tr_b16 v[66:67], v31 offset:35072
 v_mfma_f32_16x16x32_bf16 v[108:111], v[68:71], a[4:7], v[108:111]
 v_mfma_f32_16x16x32_bf16 v[96:99], v[72:75], a[8:11], v[96:99]
 s_waitcnt lgkmcnt(6)
 ds_read_b64_tr_b16 v[68:69], v31 offset:35840
 ds_read_b64_tr_b16 v[70:71], v31 offset:36096
 v_mfma_f32_16x16x32_bf16 v[100:103], v[72:75], a[12:15], v[100:103]
 v_mfma_f32_16x16x32_bf16 v[104:107], v[76:79], a[8:11], v[104:107]
 ds_read_b64_tr_b16 v[72:73], v31 offset:41984
 ds_read_b64_tr_b16 v[74:75], v31 offset:42240
 v_mfma_f32_16x16x32_bf16 v[108:111], v[76:79], a[12:15], v[108:111]
 v_mfma_f32_16x16x32_bf16 v[112:115], v[80:83], a[224:227], v[112:115]
 ds_read_b64_tr_b16 v[76:77], v31 offset:43008
 ds_read_b64_tr_b16 v[78:79], v31 offset:43264
 v_mfma_f32_16x16x32_bf16 v[116:119], v[80:83], a[228:231], v[116:119]
 v_mfma_f32_16x16x32_bf16 v[120:123], v[84:87], a[224:227], v[120:123]
 s_waitcnt lgkmcnt(6)
 ds_read_b64_tr_b16 v[80:81], v31 offset:51200
 ds_read_b64_tr_b16 v[82:83], v31 offset:51456
 v_mfma_f32_16x16x32_bf16 v[124:127], v[84:87], a[228:231], v[124:127]
 v_pk_fma_f32 v[96:97], v[96:97], v[40:41], v[40:41] op_sel:[0,0,1] op_sel_hi:[1,0,1]
 v_pk_fma_f32 v[98:99], v[98:99], v[40:41], v[40:41] op_sel:[0,0,1] op_sel_hi:[1,0,1]
 v_pk_fma_f32 v[104:105], v[104:105], v[40:41], v[40:41] op_sel:[0,0,1] op_sel_hi:[1,0,1]
 v_pk_fma_f32 v[106:107], v[106:107], v[40:41], v[40:41] op_sel:[0,0,1] op_sel_hi:[1,0,1]
 v_pk_mul_f32 v[96:97], v[96:97], v[160:161]
 v_pk_mul_f32 v[98:99], v[98:99], v[162:163]
 v_pk_mul_f32 v[104:105], v[104:105], v[168:169]
 v_pk_mul_f32 v[106:107], v[106:107], v[170:171]
 v_cvt_pk_bf16_f32 v96, v96, v97
 v_cvt_pk_bf16_f32 v97, v98, v99
 v_cvt_pk_bf16_f32 v98, v104, v105
 v_cvt_pk_bf16_f32 v99, v106, v107
 buffer_store_dwordx4 v[96:99], v11, s[4:7], s50 offen offset:0 sc1
 v_pk_fma_f32 v[100:101], v[100:101], v[42:43], v[42:43] op_sel:[0,0,1] op_sel_hi:[1,0,1]
 v_pk_fma_f32 v[102:103], v[102:103], v[42:43], v[42:43] op_sel:[0,0,1] op_sel_hi:[1,0,1]
 v_pk_fma_f32 v[108:109], v[108:109], v[42:43], v[42:43] op_sel:[0,0,1] op_sel_hi:[1,0,1]
 v_pk_fma_f32 v[110:111], v[110:111], v[42:43], v[42:43] op_sel:[0,0,1] op_sel_hi:[1,0,1]
 v_pk_mul_f32 v[100:101], v[100:101], v[164:165]
 v_pk_mul_f32 v[102:103], v[102:103], v[166:167]
 v_pk_mul_f32 v[108:109], v[108:109], v[172:173]
 v_pk_mul_f32 v[110:111], v[110:111], v[174:175]
 v_cvt_pk_bf16_f32 v100, v100, v101
 v_cvt_pk_bf16_f32 v101, v102, v103
 v_cvt_pk_bf16_f32 v102, v108, v109
 v_cvt_pk_bf16_f32 v103, v110, v111
 buffer_store_dwordx4 v[100:103], v11, s[4:7], s50 offen offset:2048 sc1
 v_mfma_f32_16x16x32_bf16 v[112:115], v[88:91], a[232:235], v[112:115]
 ds_read_b64_tr_b16 v[84:85], v31 offset:52224
 ds_read_b64_tr_b16 v[86:87], v31 offset:52480
 v_mfma_f32_16x16x32_bf16 v[116:119], v[88:91], a[236:239], v[116:119]
 v_mfma_f32_16x16x32_bf16 v[120:123], v[92:95], a[232:235], v[120:123]
 ds_read_b64_tr_b16 v[88:89], v31 offset:58368
 ds_read_b64_tr_b16 v[90:91], v31 offset:58624
 v_mfma_f32_16x16x32_bf16 v[124:127], v[92:95], a[236:239], v[124:127]
 v_mfma_f32_16x16x32_bf16 v[112:115], v[64:67], a[240:243], v[112:115]
 s_waitcnt lgkmcnt(6)
 ds_read_b64_tr_b16 v[92:93], v31 offset:59392
 ds_read_b64_tr_b16 v[94:95], v31 offset:59648
 v_mfma_f32_16x16x32_bf16 v[116:119], v[64:67], a[244:247], v[116:119]
 v_mfma_f32_16x16x32_bf16 v[120:123], v[68:71], a[240:243], v[120:123]
 ds_read_b64_tr_b16 v[64:65], v31 offset:20480
 ds_read_b64_tr_b16 v[66:67], v31 offset:20736
 v_mfma_f32_16x16x32_bf16 v[124:127], v[68:71], a[244:247], v[124:127]
 v_mfma_f32_16x16x32_bf16 v[112:115], v[72:75], a[248:251], v[112:115]
 ds_read_b64_tr_b16 v[68:69], v31 offset:21504
 ds_read_b64_tr_b16 v[70:71], v31 offset:21760
 v_mfma_f32_16x16x32_bf16 v[116:119], v[72:75], a[252:255], v[116:119]
 v_mfma_f32_16x16x32_bf16 v[120:123], v[76:79], a[248:251], v[120:123]
 s_waitcnt lgkmcnt(6)
 ds_read_b64_tr_b16 v[72:73], v31 offset:27648
 ds_read_b64_tr_b16 v[74:75], v31 offset:27904
 v_mfma_f32_16x16x32_bf16 v[124:127], v[76:79], a[252:255], v[124:127]
 v_mfma_f32_16x16x32_bf16 v[112:115], v[80:83], a[0:3], v[112:115]
 ds_read_b64_tr_b16 v[76:77], v31 offset:28672
 ds_read_b64_tr_b16 v[78:79], v31 offset:28928
 v_mfma_f32_16x16x32_bf16 v[116:119], v[80:83], a[4:7], v[116:119]
 v_mfma_f32_16x16x32_bf16 v[120:123], v[84:87], a[0:3], v[120:123]
 ds_read_b64_tr_b16 v[80:81], v31 offset:36864
 ds_read_b64_tr_b16 v[82:83], v31 offset:37120
 v_mfma_f32_16x16x32_bf16 v[124:127], v[84:87], a[4:7], v[124:127]
 v_mfma_f32_16x16x32_bf16 v[112:115], v[88:91], a[8:11], v[112:115]
 s_waitcnt lgkmcnt(6)
 ds_read_b64_tr_b16 v[84:85], v31 offset:37888
 ds_read_b64_tr_b16 v[86:87], v31 offset:38144
 v_mfma_f32_16x16x32_bf16 v[116:119], v[88:91], a[12:15], v[116:119]
 v_mfma_f32_16x16x32_bf16 v[120:123], v[92:95], a[8:11], v[120:123]
 ds_read_b64_tr_b16 v[88:89], v31 offset:44032
 ds_read_b64_tr_b16 v[90:91], v31 offset:44288
 v_mfma_f32_16x16x32_bf16 v[124:127], v[92:95], a[12:15], v[124:127]
 v_mfma_f32_16x16x32_bf16 v[128:131], v[64:67], a[224:227], v[128:131]
 ds_read_b64_tr_b16 v[92:93], v31 offset:45056
 ds_read_b64_tr_b16 v[94:95], v31 offset:45312
 v_mfma_f32_16x16x32_bf16 v[132:135], v[64:67], a[228:231], v[132:135]
 v_mfma_f32_16x16x32_bf16 v[136:139], v[68:71], a[224:227], v[136:139]
 s_waitcnt lgkmcnt(6)
 ds_read_b64_tr_b16 v[64:65], v31 offset:53248
 ds_read_b64_tr_b16 v[66:67], v31 offset:53504
 v_mfma_f32_16x16x32_bf16 v[140:143], v[68:71], a[228:231], v[140:143]
 v_pk_fma_f32 v[112:113], v[112:113], v[40:41], v[40:41] op_sel:[0,0,1] op_sel_hi:[1,0,1]
 v_pk_fma_f32 v[114:115], v[114:115], v[40:41], v[40:41] op_sel:[0,0,1] op_sel_hi:[1,0,1]
 v_pk_fma_f32 v[120:121], v[120:121], v[40:41], v[40:41] op_sel:[0,0,1] op_sel_hi:[1,0,1]
 v_pk_fma_f32 v[122:123], v[122:123], v[40:41], v[40:41] op_sel:[0,0,1] op_sel_hi:[1,0,1]
 v_pk_mul_f32 v[112:113], v[112:113], v[176:177]
 v_pk_mul_f32 v[114:115], v[114:115], v[178:179]
 v_pk_mul_f32 v[120:121], v[120:121], v[184:185]
 v_pk_mul_f32 v[122:123], v[122:123], v[186:187]
 v_cvt_pk_bf16_f32 v112, v112, v113
 v_cvt_pk_bf16_f32 v113, v114, v115
 v_cvt_pk_bf16_f32 v114, v120, v121
 v_cvt_pk_bf16_f32 v115, v122, v123
 buffer_store_dwordx4 v[112:115], v11, s[4:7], s52 offen offset:0 sc1
 v_pk_fma_f32 v[116:117], v[116:117], v[42:43], v[42:43] op_sel:[0,0,1] op_sel_hi:[1,0,1]
 v_pk_fma_f32 v[118:119], v[118:119], v[42:43], v[42:43] op_sel:[0,0,1] op_sel_hi:[1,0,1]
 v_pk_fma_f32 v[124:125], v[124:125], v[42:43], v[42:43] op_sel:[0,0,1] op_sel_hi:[1,0,1]
 v_pk_fma_f32 v[126:127], v[126:127], v[42:43], v[42:43] op_sel:[0,0,1] op_sel_hi:[1,0,1]
 v_pk_mul_f32 v[116:117], v[116:117], v[180:181]
 v_pk_mul_f32 v[118:119], v[118:119], v[182:183]
 v_pk_mul_f32 v[124:125], v[124:125], v[188:189]
 v_pk_mul_f32 v[126:127], v[126:127], v[190:191]
 v_cvt_pk_bf16_f32 v116, v116, v117
 v_cvt_pk_bf16_f32 v117, v118, v119
 v_cvt_pk_bf16_f32 v118, v124, v125
 v_cvt_pk_bf16_f32 v119, v126, v127
 buffer_store_dwordx4 v[116:119], v11, s[4:7], s52 offen offset:2048 sc1
 v_mfma_f32_16x16x32_bf16 v[128:131], v[72:75], a[232:235], v[128:131]
 ds_read_b64_tr_b16 v[68:69], v31 offset:54272
 ds_read_b64_tr_b16 v[70:71], v31 offset:54528
 v_mfma_f32_16x16x32_bf16 v[132:135], v[72:75], a[236:239], v[132:135]
 v_mfma_f32_16x16x32_bf16 v[136:139], v[76:79], a[232:235], v[136:139]
 ds_read_b64_tr_b16 v[72:73], v31 offset:60416
 ds_read_b64_tr_b16 v[74:75], v31 offset:60672
 v_mfma_f32_16x16x32_bf16 v[140:143], v[76:79], a[236:239], v[140:143]
 v_mfma_f32_16x16x32_bf16 v[128:131], v[80:83], a[240:243], v[128:131]
 s_waitcnt lgkmcnt(6)
 ds_read_b64_tr_b16 v[76:77], v31 offset:61440
 ds_read_b64_tr_b16 v[78:79], v31 offset:61696
 v_mfma_f32_16x16x32_bf16 v[132:135], v[80:83], a[244:247], v[132:135]
 v_mfma_f32_16x16x32_bf16 v[136:139], v[84:87], a[240:243], v[136:139]
 ds_read_b64_tr_b16 v[80:81], v31 offset:22528
 ds_read_b64_tr_b16 v[82:83], v31 offset:22784
 v_mfma_f32_16x16x32_bf16 v[140:143], v[84:87], a[244:247], v[140:143]
 v_mfma_f32_16x16x32_bf16 v[128:131], v[88:91], a[248:251], v[128:131]
 ds_read_b64_tr_b16 v[84:85], v31 offset:29696
 ds_read_b64_tr_b16 v[86:87], v31 offset:29952
 v_mfma_f32_16x16x32_bf16 v[132:135], v[88:91], a[252:255], v[132:135]
 v_mfma_f32_16x16x32_bf16 v[136:139], v[92:95], a[248:251], v[136:139]
 s_waitcnt lgkmcnt(6)
 ds_read_b64_tr_b16 v[88:89], v31 offset:38912
 ds_read_b64_tr_b16 v[90:91], v31 offset:39168
 v_mfma_f32_16x16x32_bf16 v[140:143], v[92:95], a[252:255], v[140:143]
 v_mfma_f32_16x16x32_bf16 v[128:131], v[64:67], a[0:3], v[128:131]
 ds_read_b64_tr_b16 v[92:93], v31 offset:46080
 ds_read_b64_tr_b16 v[94:95], v31 offset:46336
 v_mfma_f32_16x16x32_bf16 v[132:135], v[64:67], a[4:7], v[132:135]
 v_mfma_f32_16x16x32_bf16 v[136:139], v[68:71], a[0:3], v[136:139]
 ds_read_b64_tr_b16 v[64:65], v31 offset:55296
 ds_read_b64_tr_b16 v[66:67], v31 offset:55552
 v_mfma_f32_16x16x32_bf16 v[140:143], v[68:71], a[4:7], v[140:143]
 v_mfma_f32_16x16x32_bf16 v[128:131], v[72:75], a[8:11], v[128:131]
 s_waitcnt lgkmcnt(6)
 ds_read_b64_tr_b16 v[68:69], v31 offset:62464
 ds_read_b64_tr_b16 v[70:71], v31 offset:62720
 v_mfma_f32_16x16x32_bf16 v[132:135], v[72:75], a[12:15], v[132:135]
 v_mfma_f32_16x16x32_bf16 v[136:139], v[76:79], a[8:11], v[136:139]
 v_mfma_f32_16x16x32_bf16 v[140:143], v[76:79], a[12:15], v[140:143]
 v_mfma_f32_16x16x32_bf16 v[144:147], v[80:83], a[224:227], v[144:147]
 v_mfma_f32_16x16x32_bf16 v[148:151], v[80:83], a[228:231], v[148:151]
 v_mfma_f32_16x16x32_bf16 v[144:147], v[84:87], a[232:235], v[144:147]
 s_waitcnt lgkmcnt(2)
 v_mfma_f32_16x16x32_bf16 v[148:151], v[84:87], a[236:239], v[148:151]
 v_pk_fma_f32 v[128:129], v[128:129], v[40:41], v[40:41] op_sel:[0,0,1] op_sel_hi:[1,0,1]
 v_pk_fma_f32 v[130:131], v[130:131], v[40:41], v[40:41] op_sel:[0,0,1] op_sel_hi:[1,0,1]
 v_pk_fma_f32 v[136:137], v[136:137], v[40:41], v[40:41] op_sel:[0,0,1] op_sel_hi:[1,0,1]
 v_pk_fma_f32 v[138:139], v[138:139], v[40:41], v[40:41] op_sel:[0,0,1] op_sel_hi:[1,0,1]
 v_pk_mul_f32 v[128:129], v[128:129], v[192:193]
 v_pk_mul_f32 v[130:131], v[130:131], v[194:195]
 v_pk_mul_f32 v[136:137], v[136:137], v[200:201]
 v_pk_mul_f32 v[138:139], v[138:139], v[202:203]
 v_cvt_pk_bf16_f32 v128, v128, v129
 v_cvt_pk_bf16_f32 v129, v130, v131
 v_cvt_pk_bf16_f32 v130, v136, v137
 v_cvt_pk_bf16_f32 v131, v138, v139
 buffer_store_dwordx4 v[128:131], v11, s[4:7], s98 offen offset:0 sc1
 v_pk_fma_f32 v[132:133], v[132:133], v[42:43], v[42:43] op_sel:[0,0,1] op_sel_hi:[1,0,1]
 v_pk_fma_f32 v[134:135], v[134:135], v[42:43], v[42:43] op_sel:[0,0,1] op_sel_hi:[1,0,1]
 v_pk_fma_f32 v[140:141], v[140:141], v[42:43], v[42:43] op_sel:[0,0,1] op_sel_hi:[1,0,1]
 v_pk_fma_f32 v[142:143], v[142:143], v[42:43], v[42:43] op_sel:[0,0,1] op_sel_hi:[1,0,1]
 v_pk_mul_f32 v[132:133], v[132:133], v[196:197]
 v_pk_mul_f32 v[134:135], v[134:135], v[198:199]
 v_pk_mul_f32 v[140:141], v[140:141], v[204:205]
 v_pk_mul_f32 v[142:143], v[142:143], v[206:207]
 v_cvt_pk_bf16_f32 v132, v132, v133
 v_cvt_pk_bf16_f32 v133, v134, v135
 v_cvt_pk_bf16_f32 v134, v140, v141
 v_cvt_pk_bf16_f32 v135, v142, v143
 buffer_store_dwordx4 v[132:135], v11, s[4:7], s98 offen offset:2048 sc1
 v_mfma_f32_16x16x32_bf16 v[144:147], v[88:91], a[240:243], v[144:147]
 v_mfma_f32_16x16x32_bf16 v[148:151], v[88:91], a[244:247], v[148:151]
 v_mfma_f32_16x16x32_bf16 v[144:147], v[92:95], a[248:251], v[144:147]
 v_mfma_f32_16x16x32_bf16 v[148:151], v[92:95], a[252:255], v[148:151]
 v_mfma_f32_16x16x32_bf16 v[144:147], v[64:67], a[0:3], v[144:147]
 s_waitcnt lgkmcnt(0)
 v_mfma_f32_16x16x32_bf16 v[148:151], v[64:67], a[4:7], v[148:151]
 v_mfma_f32_16x16x32_bf16 v[144:147], v[68:71], a[8:11], v[144:147]
 v_mfma_f32_16x16x32_bf16 v[148:151], v[68:71], a[12:15], v[148:151]
 s_barrier
 s_nop 5
 v_pk_fma_f32 v[144:145], v[144:145], v[40:41], v[40:41] op_sel:[0,0,1] op_sel_hi:[1,0,1]
 v_pk_fma_f32 v[146:147], v[146:147], v[40:41], v[40:41] op_sel:[0,0,1] op_sel_hi:[1,0,1]
 v_pk_fma_f32 v[148:149], v[148:149], v[42:43], v[42:43] op_sel:[0,0,1] op_sel_hi:[1,0,1]
 v_pk_fma_f32 v[150:151], v[150:151], v[42:43], v[42:43] op_sel:[0,0,1] op_sel_hi:[1,0,1]
 v_pk_mul_f32 v[144:145], v[144:145], v[208:209]
 v_pk_mul_f32 v[146:147], v[146:147], v[210:211]
 v_pk_mul_f32 v[148:149], v[148:149], v[212:213]
 v_pk_mul_f32 v[150:151], v[150:151], v[214:215]
 v_cvt_pk_bf16_f32 v144, v144, v145
 v_cvt_pk_bf16_f32 v145, v146, v147
 v_cvt_pk_bf16_f32 v146, v148, v149
 v_cvt_pk_bf16_f32 v147, v150, v151
 buffer_store_dwordx4 v[144:147], v11, s[4:7], s99 offen offset:0 sc1
 s_add_u32 m0, s60, 0x4000
 s_bfe_u32 s65, s90, 0x40018
 s_mul_i32 s65, s65, 0x40000
 s_add_u32 s65, s65, s63
 buffer_load_dwordx4 v7, s[24:27], s65 offen offset:0  lds
 buffer_load_dwordx4 v8, s[24:27], s65 offen offset:1024  lds
 s_waitcnt vmcnt(2)
 s_atomic_add s93, s[54:55], 768
 buffer_load_dwordx4 v9, s[24:27], s65 offen offset:2048  lds
 buffer_load_dwordx4 v10, s[24:27], s65 offen offset:3072  lds
 s_add_u32 m0, s60, 0x8000
 s_bfe_u32 s65, s90, 0x4001c
 s_mul_i32 s65, s65, 0x40000
 s_add_u32 s65, s65, s63
 buffer_load_dwordx4 v7, s[24:27], s65 offen offset:0  lds
 buffer_load_dwordx4 v8, s[24:27], s65 offen offset:1024  lds
 buffer_load_dwordx4 v9, s[24:27], s65 offen offset:2048  lds
 buffer_load_dwordx4 v10, s[24:27], s65 offen offset:3072  lds
 s_mov_b32 s79, 0
 s_atomic_add s79, s[54:55], 768 glc
 v_lshlrev_b32 v96, 16, v224
 v_and_b32 v97, s78, v224
 v_lshlrev_b32 v98, 16, v225
 v_and_b32 v99, s78, v225
 v_lshlrev_b32 v104, 16, v226
 v_and_b32 v105, s78, v226
 v_lshlrev_b32 v106, 16, v227
 v_and_b32 v107, s78, v227
 s_add_u32 m0, s60, 0xc000
 s_bfe_u32 s65, s91, 0x40000
 s_mul_i32 s65, s65, 0x40000
 s_add_u32 s65, s65, s63
 buffer_load_dwordx4 v7, s[24:27], s65 offen offset:0  lds
 v_lshlrev_b32 v100, 16, v228
 v_and_b32 v101, s78, v228
 v_lshlrev_b32 v102, 16, v229
 v_and_b32 v103, s78, v229
 v_lshlrev_b32 v108, 16, v230
 v_and_b32 v109, s78, v230
 v_lshlrev_b32 v110, 16, v231
 v_and_b32 v111, s78, v231
 buffer_load_dwordx4 v8, s[24:27], s65 offen offset:1024  lds
 v_lshlrev_b32 v112, 16, v232
 v_and_b32 v113, s78, v232
 v_lshlrev_b32 v114, 16, v233
 v_and_b32 v115, s78, v233
 v_lshlrev_b32 v120, 16, v234
 v_and_b32 v121, s78, v234
 v_lshlrev_b32 v122, 16, v235
 v_and_b32 v123, s78, v235
 buffer_load_dwordx4 v9, s[24:27], s65 offen offset:2048  lds
 v_lshlrev_b32 v116, 16, v236
 v_and_b32 v117, s78, v236
 v_lshlrev_b32 v118, 16, v237
 v_and_b32 v119, s78, v237
 v_lshlrev_b32 v124, 16, v238
 v_and_b32 v125, s78, v238
 v_lshlrev_b32 v126, 16, v239
 v_and_b32 v127, s78, v239
 buffer_load_dwordx4 v10, s[24:27], s65 offen offset:3072  lds
 s_barrier
 ds_read_b64_tr_b16 v[72:73], v23 offset:0
 ds_read_b64_tr_b16 v[74:75], v23 offset:2048
 ds_read_b64_tr_b16 v[76:77], v24 offset:0
 ds_read_b64_tr_b16 v[78:79], v24 offset:2048
 ds_read_b64_tr_b16 v[80:81], v25 offset:0
 ds_read_b64_tr_b16 v[82:83], v25 offset:2048
 ds_read_b64_tr_b16 v[84:85], v26 offset:0
 ds_read_b64_tr_b16 v[86:87], v26 offset:2048
 ds_read_b64_tr_b16 v[88:89], v23 offset:4096
 ds_read_b64_tr_b16 v[90:91], v23 offset:6144
 ds_read_b64_tr_b16 v[92:93], v24 offset:4096
 ds_read_b64_tr_b16 v[94:95], v24 offset:6144
 ds_read_b64_tr_b16 v[64:65], v25 offset:4096
 ds_read_b64_tr_b16 v[66:67], v25 offset:6144
 s_mov_b32 s67, 0
mk_w23:
 s_waitcnt lgkmcnt(0)
 s_cmp_ge_u32 s79, 16
 s_cbranch_scc1 mk_d24
 s_mov_b32 s79, 0
 s_atomic_add s79, s[54:55], 768 glc
 s_add_u32 s67, s67, 1
 s_cmp_lt_u32 s67, 0x8000
 s_cbranch_scc1 mk_w23
mk_d24:
 s_cmp_eq_u32 s41, 1
 s_cselect_b32 s10, 0, s10
 s_add_u32 s16, s3, 0x2800000
 s_bfe_u32 s64, s90, 0x40000
 s_mul_i32 s64, s64, 0x100000
 s_add_u32 s64, s64, s16
 buffer_load_dwordx4 a[0:3], v11, s[4:7], s64 offen offset:0 sc1
 buffer_load_dwordx4 a[4:7], v11, s[4:7], s64 offen offset:2048 sc1
 buffer_load_dwordx4 a[8:11], v14, s[4:7], s64 offen offset:0 sc1
 buffer_load_dwordx4 a[12:15], v14, s[4:7], s64 offen offset:2048 sc1
 s_add_u32 s64, s64, 0x80000
 buffer_load_dwordx4 a[16:19], v11, s[4:7], s64 offen offset:0 sc1
 buffer_load_dwordx4 a[20:23], v11, s[4:7], s64 offen offset:2048 sc1
 buffer_load_dwordx4 a[24:27], v14, s[4:7], s64 offen offset:0 sc1
 buffer_load_dwordx4 a[28:31], v14, s[4:7], s64 offen offset:2048 sc1
 s_bfe_u32 s64, s90, 0x40004
 s_mul_i32 s64, s64, 0x100000
 s_add_u32 s64, s64, s16
 buffer_load_dwordx4 a[32:35], v11, s[4:7], s64 offen offset:0 sc1
 buffer_load_dwordx4 a[36:39], v11, s[4:7], s64 offen offset:2048 sc1
 buffer_load_dwordx4 a[40:43], v14, s[4:7], s64 offen offset:0 sc1
 buffer_load_dwordx4 a[44:47], v14, s[4:7], s64 offen offset:2048 sc1
 s_waitcnt vmcnt(10)
 v_mfma_f32_16x16x32_bf16 v[96:99], v[72:75], a[0:3], v[96:99]
 s_add_u32 s64, s64, 0x80000
 ds_read_b64_tr_b16 v[68:69], v26 offset:4096
 ds_read_b64_tr_b16 v[70:71], v26 offset:6144
 v_mfma_f32_16x16x32_bf16 v[100:103], v[72:75], a[4:7], v[100:103]
 v_mfma_f32_16x16x32_bf16 v[104:107], v[76:79], a[0:3], v[104:107]
 ds_read_b64_tr_b16 v[72:73], v23 offset:8192
 ds_read_b64_tr_b16 v[74:75], v23 offset:10240
 v_mfma_f32_16x16x32_bf16 v[108:111], v[76:79], a[4:7], v[108:111]
 buffer_load_dwordx4 a[48:51], v11, s[4:7], s64 offen offset:0 sc1
 v_mfma_f32_16x16x32_bf16 v[112:115], v[80:83], a[0:3], v[112:115]
 ds_read_b64_tr_b16 v[76:77], v24 offset:8192
 ds_read_b64_tr_b16 v[78:79], v24 offset:10240
 v_mfma_f32_16x16x32_bf16 v[116:119], v[80:83], a[4:7], v[116:119]
 v_mfma_f32_16x16x32_bf16 v[120:123], v[84:87], a[0:3], v[120:123]
 s_waitcnt vmcnt(9)
 ds_read_b64_tr_b16 v[80:81], v25 offset:8192
 ds_read_b64_tr_b16 v[82:83], v25 offset:10240
 v_mfma_f32_16x16x32_bf16 v[124:127], v[84:87], a[4:7], v[124:127]
 buffer_load_dwordx4 a[52:55], v11, s[4:7], s64 offen offset:2048 sc1
 v_mfma_f32_16x16x32_bf16 v[96:99], v[88:91], a[8:11], v[96:99]
 ds_read_b64_tr_b16 v[84:85], v26 offset:8192
 ds_read_b64_tr_b16 v[86:87], v26 offset:10240
 v_mfma_f32_16x16x32_bf16 v[100:103], v[88:91], a[12:15], v[100:103]
 v_mfma_f32_16x16x32_bf16 v[104:107], v[92:95], a[8:11], v[104:107]
 s_waitcnt lgkmcnt(6)
 ds_read_b64_tr_b16 v[88:89], v23 offset:12288
 ds_read_b64_tr_b16 v[90:91], v23 offset:14336
 v_mfma_f32_16x16x32_bf16 v[108:111], v[92:95], a[12:15], v[108:111]
 buffer_load_dwordx4 a[56:59], v14, s[4:7], s64 offen offset:0 sc1
 v_mfma_f32_16x16x32_bf16 v[112:115], v[64:67], a[8:11], v[112:115]
 s_waitcnt vmcnt(9)
 ds_read_b64_tr_b16 v[92:93], v24 offset:12288
 ds_read_b64_tr_b16 v[94:95], v24 offset:14336
 v_mfma_f32_16x16x32_bf16 v[116:119], v[64:67], a[12:15], v[116:119]
 buffer_load_dwordx4 a[60:63], v14, s[4:7], s64 offen offset:2048 sc1
 v_mfma_f32_16x16x32_bf16 v[120:123], v[68:71], a[8:11], v[120:123]
 s_bfe_u32 s64, s90, 0x40008
 ds_read_b64_tr_b16 v[64:65], v25 offset:12288
 ds_read_b64_tr_b16 v[66:67], v25 offset:14336
 v_mfma_f32_16x16x32_bf16 v[124:127], v[68:71], a[12:15], v[124:127]
 s_mul_i32 s64, s64, 0x100000
 s_add_u32 s64, s64, s16
 s_bitcmp1_b64 s[32:33], 2
 s_cbranch_scc0 mk_x25
 v_accvgpr_read_b32 v60, a18
 v_accvgpr_read_b32 v61, a19
 v_accvgpr_mov_b32 a18, a20
 v_accvgpr_mov_b32 a19, a21
 v_accvgpr_write_b32 a20, v60
 v_accvgpr_write_b32 a21, v61
 s_nop 1
mk_x25:
 v_mfma_f32_16x16x32_bf16 v[96:99], v[72:75], a[16:19], v[96:99]
 s_waitcnt lgkmcnt(6)
 ds_read_b64_tr_b16 v[68:69], v26 offset:12288
 ds_read_b64_tr_b16 v[70:71], v26 offset:14336
 v_mfma_f32_16x16x32_bf16 v[100:103], v[72:75], a[20:23], v[100:103]
 buffer_load_dwordx4 a[64:67], v11, s[4:7], s64 offen offset:0 sc1
 v_mfma_f32_16x16x32_bf16 v[104:107], v[76:79], a[16:19], v[104:107]
 s_barrier
 ds_read_b64_tr_b16 v[72:73], v23 offset:16384
 ds_read_b64_tr_b16 v[74:75], v23 offset:18432
 v_mfma_f32_16x16x32_bf16 v[108:111], v[76:79], a[20:23], v[108:111]
 v_mfma_f32_16x16x32_bf16 v[112:115], v[80:83], a[16:19], v[112:115]
 s_waitcnt vmcnt(9)
 ds_read_b64_tr_b16 v[76:77], v24 offset:16384
 ds_read_b64_tr_b16 v[78:79], v24 offset:18432
 v_mfma_f32_16x16x32_bf16 v[116:119], v[80:83], a[20:23], v[116:119]
 buffer_load_dwordx4 a[68:71], v11, s[4:7], s64 offen offset:2048 sc1
 v_mfma_f32_16x16x32_bf16 v[120:123], v[84:87], a[16:19], v[120:123]
 s_waitcnt lgkmcnt(6)
 ds_read_b64_tr_b16 v[80:81], v25 offset:16384
 ds_read_b64_tr_b16 v[82:83], v25 offset:18432
 v_mfma_f32_16x16x32_bf16 v[124:127], v[84:87], a[20:23], v[124:127]
 buffer_load_dwordx4 a[72:75], v14, s[4:7], s64 offen offset:0 sc1
 s_bitcmp1_b64 s[32:33], 3
 s_cbranch_scc0 mk_x26
 v_accvgpr_read_b32 v60, a26
 v_accvgpr_read_b32 v61, a27
 v_accvgpr_mov_b32 a26, a28
 v_accvgpr_mov_b32 a27, a29
 v_accvgpr_write_b32 a28, v60
 v_accvgpr_write_b32 a29, v61
 s_nop 1
mk_x26:
 v_mfma_f32_16x16x32_bf16 v[96:99], v[88:91], a[24:27], v[96:99]
 ds_read_b64_tr_b16 v[84:85], v26 offset:16384
 ds_read_b64_tr_b16 v[86:87], v26 offset:18432
 v_mfma_f32_16x16x32_bf16 v[100:103], v[88:91], a[28:31], v[100:103]
 v_mfma_f32_16x16x32_bf16 v[104:107], v[92:95], a[24:27], v[104:107]
 ds_read_b64_tr_b16 v[88:89], v23 offset:20480
 ds_read_b64_tr_b16 v[90:91], v23 offset:22528
 v_mfma_f32_16x16x32_bf16 v[108:111], v[92:95], a[28:31], v[108:111]
 buffer_load_dwordx4 a[76:79], v14, s[4:7], s64 offen offset:2048 sc1
 v_mfma_f32_16x16x32_bf16 v[112:115], v[64:67], a[24:27], v[112:115]
 s_waitcnt lgkmcnt(6)
 ds_read_b64_tr_b16 v[92:93], v24 offset:20480
 ds_read_b64_tr_b16 v[94:95], v24 offset:22528
 v_mfma_f32_16x16x32_bf16 v[116:119], v[64:67], a[28:31], v[116:119]
 s_add_u32 s64, s64, 0x80000
 v_mfma_f32_16x16x32_bf16 v[120:123], v[68:71], a[24:27], v[120:123]
 s_waitcnt vmcnt(10)
 ds_read_b64_tr_b16 v[64:65], v25 offset:20480
 ds_read_b64_tr_b16 v[66:67], v25 offset:22528
 v_mfma_f32_16x16x32_bf16 v[124:127], v[68:71], a[28:31], v[124:127]
 buffer_load_dwordx4 a[80:83], v11, s[4:7], s64 offen offset:0 sc1
 v_mfma_f32_16x16x32_bf16 v[96:99], v[72:75], a[32:35], v[96:99]
 ds_read_b64_tr_b16 v[68:69], v26 offset:20480
 ds_read_b64_tr_b16 v[70:71], v26 offset:22528
 v_mfma_f32_16x16x32_bf16 v[100:103], v[72:75], a[36:39], v[100:103]
 buffer_load_dwordx4 a[84:87], v11, s[4:7], s64 offen offset:2048 sc1
 v_mfma_f32_16x16x32_bf16 v[104:107], v[76:79], a[32:35], v[104:107]
 s_waitcnt lgkmcnt(6)
 ds_read_b64_tr_b16 v[72:73], v23 offset:24576
 ds_read_b64_tr_b16 v[74:75], v23 offset:26624
 v_mfma_f32_16x16x32_bf16 v[108:111], v[76:79], a[36:39], v[108:111]
 v_mfma_f32_16x16x32_bf16 v[112:115], v[80:83], a[32:35], v[112:115]
 s_waitcnt vmcnt(10)
 ds_read_b64_tr_b16 v[76:77], v24 offset:24576
 ds_read_b64_tr_b16 v[78:79], v24 offset:26624
 v_mfma_f32_16x16x32_bf16 v[116:119], v[80:83], a[36:39], v[116:119]
 buffer_load_dwordx4 a[88:91], v14, s[4:7], s64 offen offset:0 sc1
 v_mfma_f32_16x16x32_bf16 v[120:123], v[84:87], a[32:35], v[120:123]
 ds_read_b64_tr_b16 v[80:81], v25 offset:24576
 ds_read_b64_tr_b16 v[82:83], v25 offset:26624
 v_mfma_f32_16x16x32_bf16 v[124:127], v[84:87], a[36:39], v[124:127]
 s_bitcmp1_b64 s[32:33], 5
 s_cbranch_scc0 mk_x27
 v_accvgpr_read_b32 v60, a42
 v_accvgpr_read_b32 v61, a43
 v_accvgpr_mov_b32 a42, a44
 v_accvgpr_mov_b32 a43, a45
 v_accvgpr_write_b32 a44, v60
 v_accvgpr_write_b32 a45, v61
 s_nop 1
mk_x27:
 v_mfma_f32_16x16x32_bf16 v[96:99], v[88:91], a[40:43], v[96:99]
 s_waitcnt lgkmcnt(6)
 ds_read_b64_tr_b16 v[84:85], v26 offset:24576
 ds_read_b64_tr_b16 v[86:87], v26 offset:26624
 v_mfma_f32_16x16x32_bf16 v[100:103], v[88:91], a[44:47], v[100:103]
 buffer_load_dwordx4 a[92:95], v14, s[4:7], s64 offen offset:2048 sc1
 v_mfma_f32_16x16x32_bf16 v[104:107], v[92:95], a[40:43], v[104:107]
 s_bfe_u32 s64, s90, 0x4000c
 ds_read_b64_tr_b16 v[88:89], v23 offset:28672
 ds_read_b64_tr_b16 v[90:91], v23 offset:30720
 v_mfma_f32_16x16x32_bf16 v[108:111], v[92:95], a[44:47], v[108:111]
 s_mul_i32 s64, s64, 0x100000
 s_add_u32 s64, s64, s16
 v_mfma_f32_16x16x32_bf16 v[112:115], v[64:67], a[40:43], v[112:115]
 s_waitcnt vmcnt(10)
 ds_read_b64_tr_b16 v[92:93], v24 offset:28672
 ds_read_b64_tr_b16 v[94:95], v24 offset:30720
 v_mfma_f32_16x16x32_bf16 v[116:119], v[64:67], a[44:47], v[116:119]
 buffer_load_dwordx4 a[96:99], v11, s[4:7], s64 offen offset:0 sc1
 v_mfma_f32_16x16x32_bf16 v[120:123], v[68:71], a[40:43], v[120:123]
 s_waitcnt lgkmcnt(6)
 ds_read_b64_tr_b16 v[64:65], v25 offset:28672
 ds_read_b64_tr_b16 v[66:67], v25 offset:30720
 v_mfma_f32_16x16x32_bf16 v[124:127], v[68:71], a[44:47], v[124:127]
 buffer_load_dwordx4 a[100:103], v11, s[4:7], s64 offen offset:2048 sc1
 v_mfma_f32_16x16x32_bf16 v[96:99], v[72:75], a[48:51], v[96:99]
 ds_read_b64_tr_b16 v[68:69], v26 offset:28672
 ds_read_b64_tr_b16 v[70:71], v26 offset:30720
 v_mfma_f32_16x16x32_bf16 v[100:103], v[72:75], a[52:55], v[100:103]
 v_mfma_f32_16x16x32_bf16 v[104:107], v[76:79], a[48:51], v[104:107]
 s_barrier
 ds_read_b64_tr_b16 v[72:73], v23 offset:32768
 ds_read_b64_tr_b16 v[74:75], v23 offset:34816
 v_mfma_f32_16x16x32_bf16 v[108:111], v[76:79], a[52:55], v[108:111]
 buffer_load_dwordx4 a[104:107], v14, s[4:7], s64 offen offset:0 sc1
 v_mfma_f32_16x16x32_bf16 v[112:115], v[80:83], a[48:51], v[112:115]
 s_waitcnt lgkmcnt(6)
 ds_read_b64_tr_b16 v[76:77], v24 offset:32768
 ds_read_b64_tr_b16 v[78:79], v24 offset:34816
 v_mfma_f32_16x16x32_bf16 v[116:119], v[80:83], a[52:55], v[116:119]
 buffer_load_dwordx4 a[108:111], v14, s[4:7], s64 offen offset:2048 sc1
 v_mfma_f32_16x16x32_bf16 v[120:123], v[84:87], a[48:51], v[120:123]
 s_waitcnt vmcnt(12)
 ds_read_b64_tr_b16 v[80:81], v25 offset:32768
 ds_read_b64_tr_b16 v[82:83], v25 offset:34816
 v_mfma_f32_16x16x32_bf16 v[124:127], v[84:87], a[52:55], v[124:127]
 s_add_u32 s64, s64, 0x80000
 s_bitcmp1_b64 s[32:33], 7
 s_cbranch_scc0 mk_x28
 v_accvgpr_read_b32 v60, a58
 v_accvgpr_read_b32 v61, a59
 v_accvgpr_mov_b32 a58, a60
 v_accvgpr_mov_b32 a59, a61
 v_accvgpr_write_b32 a60, v60
 v_accvgpr_write_b32 a61, v61
 s_nop 1
mk_x28:
 v_mfma_f32_16x16x32_bf16 v[96:99], v[88:91], a[56:59], v[96:99]
 ds_read_b64_tr_b16 v[84:85], v26 offset:32768
 ds_read_b64_tr_b16 v[86:87], v26 offset:34816
 v_mfma_f32_16x16x32_bf16 v[100:103], v[88:91], a[60:63], v[100:103]
 buffer_load_dwordx4 a[112:115], v11, s[4:7], s64 offen offset:0 sc1
 v_mfma_f32_16x16x32_bf16 v[104:107], v[92:95], a[56:59], v[104:107]
 s_waitcnt lgkmcnt(6)
 ds_read_b64_tr_b16 v[88:89], v23 offset:36864
 ds_read_b64_tr_b16 v[90:91], v23 offset:38912
 v_mfma_f32_16x16x32_bf16 v[108:111], v[92:95], a[60:63], v[108:111]
 v_mfma_f32_16x16x32_bf16 v[112:115], v[64:67], a[56:59], v[112:115]
 s_waitcnt vmcnt(11)
 ds_read_b64_tr_b16 v[92:93], v24 offset:36864
 ds_read_b64_tr_b16 v[94:95], v24 offset:38912
 v_mfma_f32_16x16x32_bf16 v[116:119], v[64:67], a[60:63], v[116:119]
 buffer_load_dwordx4 a[116:119], v11, s[4:7], s64 offen offset:2048 sc1
 v_mfma_f32_16x16x32_bf16 v[120:123], v[68:71], a[56:59], v[120:123]
 ds_read_b64_tr_b16 v[64:65], v25 offset:36864
 ds_read_b64_tr_b16 v[66:67], v25 offset:38912
 v_mfma_f32_16x16x32_bf16 v[124:127], v[68:71], a[60:63], v[124:127]
 buffer_load_dwordx4 a[120:123], v14, s[4:7], s64 offen offset:0 sc1
 v_mfma_f32_16x16x32_bf16 v[96:99], v[72:75], a[64:67], v[96:99]
 s_waitcnt lgkmcnt(6)
 ds_read_b64_tr_b16 v[68:69], v26 offset:36864
 ds_read_b64_tr_b16 v[70:71], v26 offset:38912
 v_mfma_f32_16x16x32_bf16 v[100:103], v[72:75], a[68:71], v[100:103]
 v_mfma_f32_16x16x32_bf16 v[104:107], v[76:79], a[64:67], v[104:107]
 ds_read_b64_tr_b16 v[72:73], v23 offset:40960
 ds_read_b64_tr_b16 v[74:75], v23 offset:43008
 v_mfma_f32_16x16x32_bf16 v[108:111], v[76:79], a[68:71], v[108:111]
 buffer_load_dwordx4 a[124:127], v14, s[4:7], s64 offen offset:2048 sc1
 v_mfma_f32_16x16x32_bf16 v[112:115], v[80:83], a[64:67], v[112:115]
 s_waitcnt vmcnt(12)
 ds_read_b64_tr_b16 v[76:77], v24 offset:40960
 ds_read_b64_tr_b16 v[78:79], v24 offset:43008
 v_mfma_f32_16x16x32_bf16 v[116:119], v[80:83], a[68:71], v[116:119]
 s_bfe_u32 s64, s90, 0x40010
 s_mul_i32 s64, s64, 0x100000
 s_add_u32 s64, s64, s16
 v_mfma_f32_16x16x32_bf16 v[120:123], v[84:87], a[64:67], v[120:123]
 s_waitcnt lgkmcnt(6)
 ds_read_b64_tr_b16 v[80:81], v25 offset:40960
 ds_read_b64_tr_b16 v[82:83], v25 offset:43008
 v_mfma_f32_16x16x32_bf16 v[124:127], v[84:87], a[68:71], v[124:127]
 buffer_load_dwordx4 a[128:131], v11, s[4:7], s64 offen offset:0 sc1
 v_mfma_f32_16x16x32_bf16 v[96:99], v[88:91], a[72:75], v[96:99]
 ds_read_b64_tr_b16 v[84:85], v26 offset:40960
 ds_read_b64_tr_b16 v[86:87], v26 offset:43008
 v_mfma_f32_16x16x32_bf16 v[100:103], v[88:91], a[76:79], v[100:103]
 buffer_load_dwordx4 a[132:135], v11, s[4:7], s64 offen offset:2048 sc1
 v_mfma_f32_16x16x32_bf16 v[104:107], v[92:95], a[72:75], v[104:107]
 ds_read_b64_tr_b16 v[88:89], v23 offset:45056
 ds_read_b64_tr_b16 v[90:91], v23 offset:47104
 v_mfma_f32_16x16x32_bf16 v[108:111], v[92:95], a[76:79], v[108:111]
 v_mfma_f32_16x16x32_bf16 v[112:115], v[64:67], a[72:75], v[112:115]
 s_waitcnt lgkmcnt(6)
 ds_read_b64_tr_b16 v[92:93], v24 offset:45056
 ds_read_b64_tr_b16 v[94:95], v24 offset:47104
 v_mfma_f32_16x16x32_bf16 v[116:119], v[64:67], a[76:79], v[116:119]
 buffer_load_dwordx4 a[136:139], v14, s[4:7], s64 offen offset:0 sc1
 v_mfma_f32_16x16x32_bf16 v[120:123], v[68:71], a[72:75], v[120:123]
 s_waitcnt vmcnt(13)
 ds_read_b64_tr_b16 v[64:65], v25 offset:45056
 ds_read_b64_tr_b16 v[66:67], v25 offset:47104
 v_mfma_f32_16x16x32_bf16 v[124:127], v[68:71], a[76:79], v[124:127]
 v_mfma_f32_16x16x32_bf16 v[96:99], v[72:75], a[80:83], v[96:99]
 ds_read_b64_tr_b16 v[68:69], v26 offset:45056
 ds_read_b64_tr_b16 v[70:71], v26 offset:47104
 v_mfma_f32_16x16x32_bf16 v[100:103], v[72:75], a[84:87], v[100:103]
 buffer_load_dwordx4 a[140:143], v14, s[4:7], s64 offen offset:2048 sc1
 v_mfma_f32_16x16x32_bf16 v[104:107], v[76:79], a[80:83], v[104:107]
 s_waitcnt lgkmcnt(6)
 s_barrier
 ds_read_b64_tr_b16 v[72:73], v23 offset:49152
 ds_read_b64_tr_b16 v[74:75], v23 offset:51200
 v_mfma_f32_16x16x32_bf16 v[108:111], v[76:79], a[84:87], v[108:111]
 s_add_u32 s64, s64, 0x80000
 v_mfma_f32_16x16x32_bf16 v[112:115], v[80:83], a[80:83], v[112:115]
 s_waitcnt vmcnt(12)
 ds_read_b64_tr_b16 v[76:77], v24 offset:49152
 ds_read_b64_tr_b16 v[78:79], v24 offset:51200
 v_mfma_f32_16x16x32_bf16 v[116:119], v[80:83], a[84:87], v[116:119]
 buffer_load_dwordx4 a[144:147], v11, s[4:7], s64 offen offset:0 sc1
 v_mfma_f32_16x16x32_bf16 v[120:123], v[84:87], a[80:83], v[120:123]
 ds_read_b64_tr_b16 v[80:81], v25 offset:49152
 ds_read_b64_tr_b16 v[82:83], v25 offset:51200
 v_mfma_f32_16x16x32_bf16 v[124:127], v[84:87], a[84:87], v[124:127]
 buffer_load_dwordx4 a[148:151], v11, s[4:7], s64 offen offset:2048 sc1
 v_mfma_f32_16x16x32_bf16 v[96:99], v[88:91], a[88:91], v[96:99]
 s_waitcnt lgkmcnt(6)
 ds_read_b64_tr_b16 v[84:85], v26 offset:49152
 ds_read_b64_tr_b16 v[86:87], v26 offset:51200
 v_mfma_f32_16x16x32_bf16 v[100:103], v[88:91], a[92:95], v[100:103]
 v_mfma_f32_16x16x32_bf16 v[104:107], v[92:95], a[88:91], v[104:107]
 ds_read_b64_tr_b16 v[88:89], v23 offset:53248
 ds_read_b64_tr_b16 v[90:91], v23 offset:55296
 v_mfma_f32_16x16x32_bf16 v[108:111], v[92:95], a[92:95], v[108:111]
 buffer_load_dwordx4 a[152:155], v14, s[4:7], s64 offen offset:0 sc1
 v_mfma_f32_16x16x32_bf16 v[112:115], v[64:67], a[88:91], v[112:115]
 s_waitcnt vmcnt(13)
 ds_read_b64_tr_b16 v[92:93], v24 offset:53248
 ds_read_b64_tr_b16 v[94:95], v24 offset:55296
 v_mfma_f32_16x16x32_bf16 v[116:119], v[64:67], a[92:95], v[116:119]
 buffer_load_dwordx4 a[156:159], v14, s[4:7], s64 offen offset:2048 sc1
 v_mfma_f32_16x16x32_bf16 v[120:123], v[68:71], a[88:91], v[120:123]
 s_waitcnt lgkmcnt(6)
 ds_read_b64_tr_b16 v[64:65], v25 offset:53248
 ds_read_b64_tr_b16 v[66:67], v25 offset:55296
 v_mfma_f32_16x16x32_bf16 v[124:127], v[68:71], a[92:95], v[124:127]
 s_bfe_u32 s64, s90, 0x40014
 s_mul_i32 s64, s64, 0x100000
 s_add_u32 s64, s64, s16
 s_bitcmp1_b64 s[32:33], 12
 s_cbranch_scc0 mk_x29
 v_accvgpr_read_b32 v60, a98
 v_accvgpr_read_b32 v61, a99
 v_accvgpr_mov_b32 a98, a100
 v_accvgpr_mov_b32 a99, a101
 v_accvgpr_write_b32 a100, v60
 v_accvgpr_write_b32 a101, v61
 s_nop 1
mk_x29:
 v_mfma_f32_16x16x32_bf16 v[96:99], v[72:75], a[96:99], v[96:99]
 ds_read_b64_tr_b16 v[68:69], v26 offset:53248
 ds_read_b64_tr_b16 v[70:71], v26 offset:55296
 v_mfma_f32_16x16x32_bf16 v[100:103], v[72:75], a[100:103], v[100:103]
 buffer_load_dwordx4 a[160:163], v11, s[4:7], s64 offen offset:0 sc1
 v_mfma_f32_16x16x32_bf16 v[104:107], v[76:79], a[96:99], v[104:107]
 ds_read_b64_tr_b16 v[72:73], v23 offset:57344
 ds_read_b64_tr_b16 v[74:75], v23 offset:59392
 v_mfma_f32_16x16x32_bf16 v[108:111], v[76:79], a[100:103], v[108:111]
 v_mfma_f32_16x16x32_bf16 v[112:115], v[80:83], a[96:99], v[112:115]
 s_waitcnt lgkmcnt(6)
 ds_read_b64_tr_b16 v[76:77], v24 offset:57344
 ds_read_b64_tr_b16 v[78:79], v24 offset:59392
 v_mfma_f32_16x16x32_bf16 v[116:119], v[80:83], a[100:103], v[116:119]
 buffer_load_dwordx4 a[164:167], v11, s[4:7], s64 offen offset:2048 sc1
 v_mfma_f32_16x16x32_bf16 v[120:123], v[84:87], a[96:99], v[120:123]
 s_waitcnt vmcnt(14)
 ds_read_b64_tr_b16 v[80:81], v25 offset:57344
 ds_read_b64_tr_b16 v[82:83], v25 offset:59392
 v_mfma_f32_16x16x32_bf16 v[124:127], v[84:87], a[100:103], v[124:127]
 buffer_load_dwordx4 a[168:171], v14, s[4:7], s64 offen offset:0 sc1
 v_mfma_f32_16x16x32_bf16 v[96:99], v[88:91], a[104:107], v[96:99]
 ds_read_b64_tr_b16 v[84:85], v26 offset:57344
 ds_read_b64_tr_b16 v[86:87], v26 offset:59392
 v_mfma_f32_16x16x32_bf16 v[100:103], v[88:91], a[108:111], v[100:103]
 v_mfma_f32_16x16x32_bf16 v[104:107], v[92:95], a[104:107], v[104:107]
 s_waitcnt lgkmcnt(6)
 ds_read_b64_tr_b16 v[88:89], v23 offset:61440
 ds_read_b64_tr_b16 v[90:91], v23 offset:63488
 v_mfma_f32_16x16x32_bf16 v[108:111], v[92:95], a[108:111], v[108:111]
 buffer_load_dwordx4 a[172:175], v14, s[4:7], s64 offen offset:2048 sc1
 v_mfma_f32_16x16x32_bf16 v[112:115], v[64:67], a[104:107], v[112:115]
 s_waitcnt vmcnt(14)
 ds_read_b64_tr_b16 v[92:93], v24 offset:61440
 ds_read_b64_tr_b16 v[94:95], v24 offset:63488
 v_mfma_f32_16x16x32_bf16 v[116:119], v[64:67], a[108:111], v[116:119]
 s_add_u32 s64, s64, 0x80000
 v_mfma_f32_16x16x32_bf16 v[120:123], v[68:71], a[104:107], v[120:123]
 ds_read_b64_tr_b16 v[64:65], v25 offset:61440
 ds_read_b64_tr_b16 v[66:67], v25 offset:63488
 v_mfma_f32_16x16x32_bf16 v[124:127], v[68:71], a[108:111], v[124:127]
 buffer_load_dwordx4 a[176:179], v11, s[4:7], s64 offen offset:0 sc1
 s_bitcmp1_b64 s[32:33], 14
 s_cbranch_scc0 mk_x30
 v_accvgpr_read_b32 v60, a114
 v_accvgpr_read_b32 v61, a115
 v_accvgpr_mov_b32 a114, a116
 v_accvgpr_mov_b32 a115, a117
 v_accvgpr_write_b32 a116, v60
 v_accvgpr_write_b32 a117, v61
 s_nop 1
mk_x30:
 v_mfma_f32_16x16x32_bf16 v[96:99], v[72:75], a[112:115], v[96:99]
 s_waitcnt lgkmcnt(6)
 ds_read_b64_tr_b16 v[68:69], v26 offset:61440
 ds_read_b64_tr_b16 v[70:71], v26 offset:63488
 v_mfma_f32_16x16x32_bf16 v[100:103], v[72:75], a[116:119], v[100:103]
 buffer_load_dwordx4 a[180:183], v11, s[4:7], s64 offen offset:2048 sc1
 v_mfma_f32_16x16x32_bf16 v[104:107], v[76:79], a[112:115], v[104:107]
 s_barrier
 ds_read_b64_tr_b16 v[72:73], v27 offset:0
 ds_read_b64_tr_b16 v[74:75], v27 offset:2048
 v_mfma_f32_16x16x32_bf16 v[108:111], v[76:79], a[116:119], v[108:111]
 v_mfma_f32_16x16x32_bf16 v[112:115], v[80:83], a[112:115], v[112:115]
 s_waitcnt vmcnt(14)
 ds_read_b64_tr_b16 v[76:77], v28 offset:0
 ds_read_b64_tr_b16 v[78:79], v28 offset:2048
 v_mfma_f32_16x16x32_bf16 v[116:119], v[80:83], a[116:119], v[116:119]
 buffer_load_dwordx4 a[184:187], v14, s[4:7], s64 offen offset:0 sc1
 v_mfma_f32_16x16x32_bf16 v[120:123], v[84:87], a[112:115], v[120:123]
 s_waitcnt lgkmcnt(6)
 ds_read_b64_tr_b16 v[80:81], v29 offset:0
 ds_read_b64_tr_b16 v[82:83], v29 offset:2048
 v_mfma_f32_16x16x32_bf16 v[124:127], v[84:87], a[116:119], v[124:127]
 v_mfma_f32_16x16x32_bf16 v[96:99], v[88:91], a[120:123], v[96:99]
 ds_read_b64_tr_b16 v[84:85], v30 offset:0
 ds_read_b64_tr_b16 v[86:87], v30 offset:2048
 v_mfma_f32_16x16x32_bf16 v[100:103], v[88:91], a[124:127], v[100:103]
 buffer_load_dwordx4 a[188:191], v14, s[4:7], s64 offen offset:2048 sc1
 v_mfma_f32_16x16x32_bf16 v[104:107], v[92:95], a[120:123], v[104:107]
 s_bfe_u32 s64, s90, 0x40018
 ds_read_b64_tr_b16 v[88:89], v27 offset:4096
 ds_read_b64_tr_b16 v[90:91], v27 offset:6144
 v_mfma_f32_16x16x32_bf16 v[108:111], v[92:95], a[124:127], v[108:111]
 s_mul_i32 s64, s64, 0x100000
 s_add_u32 s64, s64, s16
 v_mfma_f32_16x16x32_bf16 v[112:115], v[64:67], a[120:123], v[112:115]
 s_waitcnt lgkmcnt(6)
 ds_read_b64_tr_b16 v[92:93], v28 offset:4096
 ds_read_b64_tr_b16 v[94:95], v28 offset:6144
 v_mfma_f32_16x16x32_bf16 v[116:119], v[64:67], a[124:127], v[116:119]
 buffer_load_dwordx4 a[192:195], v11, s[4:7], s64 offen offset:0 sc1
 v_mfma_f32_16x16x32_bf16 v[120:123], v[68:71], a[120:123], v[120:123]
 s_waitcnt vmcnt(15)
 ds_read_b64_tr_b16 v[64:65], v29 offset:4096
 ds_read_b64_tr_b16 v[66:67], v29 offset:6144
 v_mfma_f32_16x16x32_bf16 v[124:127], v[68:71], a[124:127], v[124:127]
 buffer_load_dwordx4 a[196:199], v11, s[4:7], s64 offen offset:2048 sc1
 v_mfma_f32_16x16x32_bf16 v[96:99], v[72:75], a[128:131], v[96:99]
 ds_read_b64_tr_b16 v[68:69], v30 offset:4096
 ds_read_b64_tr_b16 v[70:71], v30 offset:6144
 v_mfma_f32_16x16x32_bf16 v[100:103], v[72:75], a[132:135], v[100:103]
 v_mfma_f32_16x16x32_bf16 v[104:107], v[76:79], a[128:131], v[104:107]
 s_waitcnt lgkmcnt(6)
 ds_read_b64_tr_b16 v[72:73], v27 offset:8192
 ds_read_b64_tr_b16 v[74:75], v27 offset:10240
 v_mfma_f32_16x16x32_bf16 v[108:111], v[76:79], a[132:135], v[108:111]
 buffer_load_dwordx4 a[200:203], v14, s[4:7], s64 offen offset:0 sc1
 v_mfma_f32_16x16x32_bf16 v[112:115], v[80:83], a[128:131], v[112:115]
 s_waitcnt vmcnt(15)
 ds_read_b64_tr_b16 v[76:77], v28 offset:8192
 ds_read_b64_tr_b16 v[78:79], v28 offset:10240
 v_mfma_f32_16x16x32_bf16 v[116:119], v[80:83], a[132:135], v[116:119]
 buffer_load_dwordx4 a[204:207], v14, s[4:7], s64 offen offset:2048 sc1
 v_mfma_f32_16x16x32_bf16 v[120:123], v[84:87], a[128:131], v[120:123]
 s_add_u32 s64, s64, 0x80000
 ds_read_b64_tr_b16 v[80:81], v29 offset:8192
 ds_read_b64_tr_b16 v[82:83], v29 offset:10240
 v_mfma_f32_16x16x32_bf16 v[124:127], v[84:87], a[132:135], v[124:127]
 v_mfma_f32_16x16x32_bf16 v[96:99], v[88:91], a[136:139], v[96:99]
 s_waitcnt lgkmcnt(6)
 ds_read_b64_tr_b16 v[84:85], v30 offset:8192
 ds_read_b64_tr_b16 v[86:87], v30 offset:10240
 v_mfma_f32_16x16x32_bf16 v[100:103], v[88:91], a[140:143], v[100:103]
 buffer_load_dwordx4 a[208:211], v11, s[4:7], s64 offen offset:0 sc1
 v_mfma_f32_16x16x32_bf16 v[104:107], v[92:95], a[136:139], v[104:107]
 ds_read_b64_tr_b16 v[88:89], v27 offset:12288
 ds_read_b64_tr_b16 v[90:91], v27 offset:14336
 v_mfma_f32_16x16x32_bf16 v[108:111], v[92:95], a[140:143], v[108:111]
 v_mfma_f32_16x16x32_bf16 v[112:115], v[64:67], a[136:139], v[112:115]
 s_waitcnt vmcnt(15)
 ds_read_b64_tr_b16 v[92:93], v28 offset:12288
 ds_read_b64_tr_b16 v[94:95], v28 offset:14336
 v_mfma_f32_16x16x32_bf16 v[116:119], v[64:67], a[140:143], v[116:119]
 buffer_load_dwordx4 a[212:215], v11, s[4:7], s64 offen offset:2048 sc1
 v_mfma_f32_16x16x32_bf16 v[120:123], v[68:71], a[136:139], v[120:123]
 s_waitcnt lgkmcnt(6)
 ds_read_b64_tr_b16 v[64:65], v29 offset:12288
 ds_read_b64_tr_b16 v[66:67], v29 offset:14336
 v_mfma_f32_16x16x32_bf16 v[124:127], v[68:71], a[140:143], v[124:127]
 buffer_load_dwordx4 a[216:219], v14, s[4:7], s64 offen offset:0 sc1
 v_mfma_f32_16x16x32_bf16 v[96:99], v[72:75], a[144:147], v[96:99]
 ds_read_b64_tr_b16 v[68:69], v30 offset:12288
 ds_read_b64_tr_b16 v[70:71], v30 offset:14336
 v_mfma_f32_16x16x32_bf16 v[100:103], v[72:75], a[148:151], v[100:103]
 v_mfma_f32_16x16x32_bf16 v[104:107], v[76:79], a[144:147], v[104:107]
 s_barrier
 ds_read_b64_tr_b16 v[72:73], v19 offset:0
 ds_read_b64_tr_b16 v[74:75], v19 offset:2048
 v_mfma_f32_16x16x32_bf16 v[108:111], v[76:79], a[148:151], v[108:111]
 buffer_load_dwordx4 a[220:223], v14, s[4:7], s64 offen offset:2048 sc1
 v_mfma_f32_16x16x32_bf16 v[112:115], v[80:83], a[144:147], v[112:115]
 s_waitcnt lgkmcnt(6)
 ds_read_b64_tr_b16 v[76:77], v20 offset:0
 ds_read_b64_tr_b16 v[78:79], v20 offset:2048
 v_mfma_f32_16x16x32_bf16 v[116:119], v[80:83], a[148:151], v[116:119]
 s_bfe_u32 s64, s90, 0x4001c
 s_mul_i32 s64, s64, 0x100000
 s_add_u32 s64, s64, s16
 v_mfma_f32_16x16x32_bf16 v[120:123], v[84:87], a[144:147], v[120:123]
 s_waitcnt vmcnt(16)
 ds_read_b64_tr_b16 v[80:81], v21 offset:0
 ds_read_b64_tr_b16 v[82:83], v21 offset:2048
 v_mfma_f32_16x16x32_bf16 v[124:127], v[84:87], a[148:151], v[124:127]
 buffer_load_dwordx4 a[224:227], v11, s[4:7], s64 offen offset:0 sc1
 s_bitcmp1_b64 s[32:33], 19
 s_cbranch_scc0 mk_x31
 v_accvgpr_read_b32 v60, a154
 v_accvgpr_read_b32 v61, a155
 v_accvgpr_mov_b32 a154, a156
 v_accvgpr_mov_b32 a155, a157
 v_accvgpr_write_b32 a156, v60
 v_accvgpr_write_b32 a157, v61
 s_nop 1
mk_x31:
 v_mfma_f32_16x16x32_bf16 v[96:99], v[88:91], a[152:155], v[96:99]
 ds_read_b64_tr_b16 v[84:85], v22 offset:0
 ds_read_b64_tr_b16 v[86:87], v22 offset:2048
 v_mfma_f32_16x16x32_bf16 v[100:103], v[88:91], a[156:159], v[100:103]
 buffer_load_dwordx4 a[228:231], v11, s[4:7], s64 offen offset:2048 sc1
 v_mfma_f32_16x16x32_bf16 v[104:107], v[92:95], a[152:155], v[104:107]
 s_waitcnt lgkmcnt(6)
 ds_read_b64_tr_b16 v[88:89], v19 offset:4096
 ds_read_b64_tr_b16 v[90:91], v19 offset:6144
 v_mfma_f32_16x16x32_bf16 v[108:111], v[92:95], a[156:159], v[108:111]
 v_mfma_f32_16x16x32_bf16 v[112:115], v[64:67], a[152:155], v[112:115]
 s_waitcnt vmcnt(16)
 ds_read_b64_tr_b16 v[92:93], v20 offset:4096
 ds_read_b64_tr_b16 v[94:95], v20 offset:6144
 v_mfma_f32_16x16x32_bf16 v[116:119], v[64:67], a[156:159], v[116:119]
 buffer_load_dwordx4 a[232:235], v14, s[4:7], s64 offen offset:0 sc1
 v_mfma_f32_16x16x32_bf16 v[120:123], v[68:71], a[152:155], v[120:123]
 ds_read_b64_tr_b16 v[64:65], v21 offset:4096
 ds_read_b64_tr_b16 v[66:67], v21 offset:6144
 v_mfma_f32_16x16x32_bf16 v[124:127], v[68:71], a[156:159], v[124:127]
 v_mfma_f32_16x16x32_bf16 v[96:99], v[72:75], a[160:163], v[96:99]
 s_waitcnt lgkmcnt(6)
 ds_read_b64_tr_b16 v[68:69], v22 offset:4096
 ds_read_b64_tr_b16 v[70:71], v22 offset:6144
 v_mfma_f32_16x16x32_bf16 v[100:103], v[72:75], a[164:167], v[100:103]
 buffer_load_dwordx4 a[236:239], v14, s[4:7], s64 offen offset:2048 sc1
 v_mfma_f32_16x16x32_bf16 v[104:107], v[76:79], a[160:163], v[104:107]
 s_add_u32 s64, s64, 0x80000
 ds_read_b64_tr_b16 v[72:73], v19 offset:8192
 ds_read_b64_tr_b16 v[74:75], v19 offset:10240
 v_mfma_f32_16x16x32_bf16 v[108:111], v[76:79], a[164:167], v[108:111]
 buffer_load_dwordx4 a[240:243], v11, s[4:7], s64 offen offset:0 sc1
 v_mfma_f32_16x16x32_bf16 v[112:115], v[80:83], a[160:163], v[112:115]
 s_waitcnt vmcnt(17)
 ds_read_b64_tr_b16 v[76:77], v20 offset:8192
 ds_read_b64_tr_b16 v[78:79], v20 offset:10240
 v_mfma_f32_16x16x32_bf16 v[116:119], v[80:83], a[164:167], v[116:119]
 v_mfma_f32_16x16x32_bf16 v[120:123], v[84:87], a[160:163], v[120:123]
 s_waitcnt lgkmcnt(6)
 ds_read_b64_tr_b16 v[80:81], v21 offset:8192
 ds_read_b64_tr_b16 v[82:83], v21 offset:10240
 v_mfma_f32_16x16x32_bf16 v[124:127], v[84:87], a[164:167], v[124:127]
 buffer_load_dwordx4 a[244:247], v11, s[4:7], s64 offen offset:2048 sc1
 s_bitcmp1_b64 s[32:33], 21
 s_cbranch_scc0 mk_x32
 v_accvgpr_read_b32 v60, a170
 v_accvgpr_read_b32 v61, a171
 v_accvgpr_mov_b32 a170, a172
 v_accvgpr_mov_b32 a171, a173
 v_accvgpr_write_b32 a172, v60
 v_accvgpr_write_b32 a173, v61
 s_nop 1
mk_x32:
 v_mfma_f32_16x16x32_bf16 v[96:99], v[88:91], a[168:171], v[96:99]
 ds_read_b64_tr_b16 v[84:85], v22 offset:8192
 ds_read_b64_tr_b16 v[86:87], v22 offset:10240
 v_mfma_f32_16x16x32_bf16 v[100:103], v[88:91], a[172:175], v[100:103]
 v_mfma_f32_16x16x32_bf16 v[104:107], v[92:95], a[168:171], v[104:107]
 ds_read_b64_tr_b16 v[88:89], v19 offset:12288
 ds_read_b64_tr_b16 v[90:91], v19 offset:14336
 v_mfma_f32_16x16x32_bf16 v[108:111], v[92:95], a[172:175], v[108:111]
 buffer_load_dwordx4 a[248:251], v14, s[4:7], s64 offen offset:0 sc1
 v_mfma_f32_16x16x32_bf16 v[112:115], v[64:67], a[168:171], v[112:115]
 s_waitcnt lgkmcnt(6)
 ds_read_b64_tr_b16 v[92:93], v20 offset:12288
 ds_read_b64_tr_b16 v[94:95], v20 offset:14336
 v_mfma_f32_16x16x32_bf16 v[116:119], v[64:67], a[172:175], v[116:119]
 buffer_load_dwordx4 a[252:255], v14, s[4:7], s64 offen offset:2048 sc1
 v_mfma_f32_16x16x32_bf16 v[120:123], v[68:71], a[168:171], v[120:123]
 s_waitcnt vmcnt(18)
 ds_read_b64_tr_b16 v[64:65], v21 offset:12288
 ds_read_b64_tr_b16 v[66:67], v21 offset:14336
 v_mfma_f32_16x16x32_bf16 v[124:127], v[68:71], a[172:175], v[124:127]
 s_bfe_u32 s64, s91, 0x40000
 s_mul_i32 s64, s64, 0x100000
 s_add_u32 s64, s64, s16
 v_mfma_f32_16x16x32_bf16 v[96:99], v[72:75], a[176:179], v[96:99]
 ds_read_b64_tr_b16 v[68:69], v22 offset:12288
 ds_read_b64_tr_b16 v[70:71], v22 offset:14336
 v_mfma_f32_16x16x32_bf16 v[100:103], v[72:75], a[180:183], v[100:103]
 buffer_load_dwordx4 a[0:3], v11, s[4:7], s64 offen offset:0 sc1
 v_mfma_f32_16x16x32_bf16 v[104:107], v[76:79], a[176:179], v[104:107]
 s_waitcnt lgkmcnt(6)
 s_barrier
 ds_read_b64_tr_b16 v[72:73], v19 offset:16384
 ds_read_b64_tr_b16 v[74:75], v19 offset:18432
 v_mfma_f32_16x16x32_bf16 v[108:111], v[76:79], a[180:183], v[108:111]
 v_mfma_f32_16x16x32_bf16 v[112:115], v[80:83], a[176:179], v[112:115]
 s_waitcnt vmcnt(17)
 ds_read_b64_tr_b16 v[76:77], v20 offset:16384
 ds_read_b64_tr_b16 v[78:79], v20 offset:18432
 v_mfma_f32_16x16x32_bf16 v[116:119], v[80:83], a[180:183], v[116:119]
 buffer_load_dwordx4 a[4:7], v11, s[4:7], s64 offen offset:2048 sc1
 v_mfma_f32_16x16x32_bf16 v[120:123], v[84:87], a[176:179], v[120:123]
 s_add_u32 m0, s60, 0x10000
 ds_read_b64_tr_b16 v[80:81], v21 offset:16384
 ds_read_b64_tr_b16 v[82:83], v21 offset:18432
 v_mfma_f32_16x16x32_bf16 v[124:127], v[84:87], a[180:183], v[124:127]
 s_bfe_u32 s65, s91, 0x40004
 s_mul_i32 s65, s65, 0x40000
 s_add_u32 s65, s65, s63
 v_mfma_f32_16x16x32_bf16 v[96:99], v[88:91], a[184:187], v[96:99]
 s_waitcnt lgkmcnt(6)
 ds_read_b64_tr_b16 v[84:85], v22 offset:16384
 ds_read_b64_tr_b16 v[86:87], v22 offset:18432
 v_mfma_f32_16x16x32_bf16 v[100:103], v[88:91], a[188:191], v[100:103]
 buffer_load_dwordx4 v7, s[24:27], s65 offen offset:0  lds
 v_mfma_f32_16x16x32_bf16 v[104:107], v[92:95], a[184:187], v[104:107]
 ds_read_b64_tr_b16 v[88:89], v19 offset:20480
 ds_read_b64_tr_b16 v[90:91], v19 offset:22528
 v_mfma_f32_16x16x32_bf16 v[108:111], v[92:95], a[188:191], v[108:111]
 buffer_load_dwordx4 v8, s[24:27], s65 offen offset:1024  lds
 v_mfma_f32_16x16x32_bf16 v[112:115], v[64:67], a[184:187], v[112:115]
 s_waitcnt vmcnt(18)
 ds_read_b64_tr_b16 v[92:93], v20 offset:20480
 ds_read_b64_tr_b16 v[94:95], v20 offset:22528
 v_mfma_f32_16x16x32_bf16 v[116:119], v[64:67], a[188:191], v[116:119]
 v_mfma_f32_16x16x32_bf16 v[120:123], v[68:71], a[184:187], v[120:123]
 s_waitcnt lgkmcnt(6)
 ds_read_b64_tr_b16 v[64:65], v21 offset:20480
 ds_read_b64_tr_b16 v[66:67], v21 offset:22528
 v_mfma_f32_16x16x32_bf16 v[124:127], v[68:71], a[188:191], v[124:127]
 buffer_load_dwordx4 v9, s[24:27], s65 offen offset:2048  lds
 v_mfma_f32_16x16x32_bf16 v[96:99], v[72:75], a[192:195], v[96:99]
 ds_read_b64_tr_b16 v[68:69], v22 offset:20480
 ds_read_b64_tr_b16 v[70:71], v22 offset:22528
 v_mfma_f32_16x16x32_bf16 v[100:103], v[72:75], a[196:199], v[100:103]
 buffer_load_dwordx4 v10, s[24:27], s65 offen offset:3072  lds
 v_mfma_f32_16x16x32_bf16 v[104:107], v[76:79], a[192:195], v[104:107]
 ds_read_b64_tr_b16 v[72:73], v19 offset:24576
 ds_read_b64_tr_b16 v[74:75], v19 offset:26624
 v_mfma_f32_16x16x32_bf16 v[108:111], v[76:79], a[196:199], v[108:111]
 v_mfma_f32_16x16x32_bf16 v[112:115], v[80:83], a[192:195], v[112:115]
 s_waitcnt lgkmcnt(6)
 ds_read_b64_tr_b16 v[76:77], v20 offset:24576
 ds_read_b64_tr_b16 v[78:79], v20 offset:26624
 v_mfma_f32_16x16x32_bf16 v[116:119], v[80:83], a[196:199], v[116:119]
 buffer_load_dwordx4 a[8:11], v14, s[4:7], s64 offen offset:0 sc1
 v_mfma_f32_16x16x32_bf16 v[120:123], v[84:87], a[192:195], v[120:123]
 s_waitcnt vmcnt(19)
 ds_read_b64_tr_b16 v[80:81], v21 offset:24576
 ds_read_b64_tr_b16 v[82:83], v21 offset:26624
 v_mfma_f32_16x16x32_bf16 v[124:127], v[84:87], a[196:199], v[124:127]
 v_mfma_f32_16x16x32_bf16 v[96:99], v[88:91], a[200:203], v[96:99]
 ds_read_b64_tr_b16 v[84:85], v22 offset:24576
 ds_read_b64_tr_b16 v[86:87], v22 offset:26624
 v_mfma_f32_16x16x32_bf16 v[100:103], v[88:91], a[204:207], v[100:103]
 buffer_load_dwordx4 a[12:15], v14, s[4:7], s64 offen offset:2048 sc1
 v_mfma_f32_16x16x32_bf16 v[104:107], v[92:95], a[200:203], v[104:107]
 s_waitcnt lgkmcnt(6)
 ds_read_b64_tr_b16 v[88:89], v19 offset:28672
 ds_read_b64_tr_b16 v[90:91], v19 offset:30720
 v_mfma_f32_16x16x32_bf16 v[108:111], v[92:95], a[204:207], v[108:111]
 s_add_u32 s64, s64, 0x80000
 v_add_u32 v61, mk_top-mk_top+0, v249
 v_min_u32 v61, mk_end-mk_top, v61
 global_load_dword v255, v61, s[18:19]
 v_mfma_f32_16x16x32_bf16 v[112:115], v[64:67], a[200:203], v[112:115]
 s_waitcnt vmcnt(19)
 ds_read_b64_tr_b16 v[92:93], v20 offset:28672
 ds_read_b64_tr_b16 v[94:95], v20 offset:30720
 v_mfma_f32_16x16x32_bf16 v[116:119], v[64:67], a[204:207], v[116:119]
 buffer_load_dwordx4 a[16:19], v11, s[4:7], s64 offen offset:0 sc1
 v_mfma_f32_16x16x32_bf16 v[120:123], v[68:71], a[200:203], v[120:123]
 ds_read_b64_tr_b16 v[64:65], v21 offset:28672
 ds_read_b64_tr_b16 v[66:67], v21 offset:30720
 v_mfma_f32_16x16x32_bf16 v[124:127], v[68:71], a[204:207], v[124:127]
 buffer_load_dwordx4 a[20:23], v11, s[4:7], s64 offen offset:2048 sc1
 s_bitcmp1_b64 s[32:33], 26
 s_cbranch_scc0 mk_x33
 v_accvgpr_read_b32 v60, a210
 v_accvgpr_read_b32 v61, a211
 v_accvgpr_mov_b32 a210, a212
 v_accvgpr_mov_b32 a211, a213
 v_accvgpr_write_b32 a212, v60
 v_accvgpr_write_b32 a213, v61
 s_nop 1
mk_x33:
 v_mfma_f32_16x16x32_bf16 v[96:99], v[72:75], a[208:211], v[96:99]
 s_waitcnt lgkmcnt(6)
 ds_read_b64_tr_b16 v[68:69], v22 offset:28672
 ds_read_b64_tr_b16 v[70:71], v22 offset:30720
 v_mfma_f32_16x16x32_bf16 v[100:103], v[72:75], a[212:215], v[100:103]
 v_mfma_f32_16x16x32_bf16 v[104:107], v[76:79], a[208:211], v[104:107]
 s_barrier
 ds_read_b64_tr_b16 v[72:73], v19 offset:32768
 ds_read_b64_tr_b16 v[74:75], v19 offset:34816
 v_mfma_f32_16x16x32_bf16 v[108:111], v[76:79], a[212:215], v[108:111]
 buffer_load_dwordx4 a[24:27], v14, s[4:7], s64 offen offset:0 sc1
 v_mfma_f32_16x16x32_bf16 v[112:115], v[80:83], a[208:211], v[112:115]
 s_waitcnt vmcnt(20)
 ds_read_b64_tr_b16 v[76:77], v20 offset:32768
 ds_read_b64_tr_b16 v[78:79], v20 offset:34816
 v_mfma_f32_16x16x32_bf16 v[116:119], v[80:83], a[212:215], v[116:119]
 buffer_load_dwordx4 a[28:31], v14, s[4:7], s64 offen offset:2048 sc1
 v_mfma_f32_16x16x32_bf16 v[120:123], v[84:87], a[208:211], v[120:123]
 s_waitcnt lgkmcnt(6)
 ds_read_b64_tr_b16 v[80:81], v21 offset:32768
 ds_read_b64_tr_b16 v[82:83], v21 offset:34816
 v_mfma_f32_16x16x32_bf16 v[124:127], v[84:87], a[212:215], v[124:127]
 s_bfe_u32 s64, s91, 0x40004
 s_mul_i32 s64, s64, 0x100000
 s_add_u32 s64, s64, s16
 v_mfma_f32_16x16x32_bf16 v[96:99], v[88:91], a[216:219], v[96:99]
 ds_read_b64_tr_b16 v[84:85], v22 offset:32768
 ds_read_b64_tr_b16 v[86:87], v22 offset:34816
 v_mfma_f32_16x16x32_bf16 v[100:103], v[88:91], a[220:223], v[100:103]
 buffer_load_dwordx4 a[32:35], v11, s[4:7], s64 offen offset:0 sc1
 v_mfma_f32_16x16x32_bf16 v[104:107], v[92:95], a[216:219], v[104:107]
 ds_read_b64_tr_b16 v[88:89], v19 offset:36864
 ds_read_b64_tr_b16 v[90:91], v19 offset:38912
 v_mfma_f32_16x16x32_bf16 v[108:111], v[92:95], a[220:223], v[108:111]
 v_mfma_f32_16x16x32_bf16 v[112:115], v[64:67], a[216:219], v[112:115]
 s_waitcnt lgkmcnt(6)
 ds_read_b64_tr_b16 v[92:93], v20 offset:36864
 ds_read_b64_tr_b16 v[94:95], v20 offset:38912
 v_mfma_f32_16x16x32_bf16 v[116:119], v[64:67], a[220:223], v[116:119]
 buffer_load_dwordx4 a[36:39], v11, s[4:7], s64 offen offset:2048 sc1
 v_mfma_f32_16x16x32_bf16 v[120:123], v[68:71], a[216:219], v[120:123]
 s_waitcnt vmcnt(21)
 ds_read_b64_tr_b16 v[64:65], v21 offset:36864
 ds_read_b64_tr_b16 v[66:67], v21 offset:38912
 v_mfma_f32_16x16x32_bf16 v[124:127], v[68:71], a[220:223], v[124:127]
 s_add_u32 m0, s60, 0x14000
 s_bfe_u32 s65, s91, 0x40008
 s_mul_i32 s65, s65, 0x40000
 s_bitcmp1_b64 s[32:33], 28
 s_cbranch_scc0 mk_x34
 v_accvgpr_read_b32 v60, a226
 v_accvgpr_read_b32 v61, a227
 v_accvgpr_mov_b32 a226, a228
 v_accvgpr_mov_b32 a227, a229
 v_accvgpr_write_b32 a228, v60
 v_accvgpr_write_b32 a229, v61
 s_nop 1
mk_x34:
 v_mfma_f32_16x16x32_bf16 v[96:99], v[72:75], a[224:227], v[96:99]
 s_add_u32 s65, s65, s63
 ds_read_b64_tr_b16 v[68:69], v22 offset:36864
 ds_read_b64_tr_b16 v[70:71], v22 offset:38912
 v_mfma_f32_16x16x32_bf16 v[100:103], v[72:75], a[228:231], v[100:103]
 buffer_load_dwordx4 v7, s[24:27], s65 offen offset:0  lds
 v_mfma_f32_16x16x32_bf16 v[104:107], v[76:79], a[224:227], v[104:107]
 s_waitcnt lgkmcnt(6)
 ds_read_b64_tr_b16 v[72:73], v19 offset:40960
 ds_read_b64_tr_b16 v[74:75], v19 offset:43008
 v_mfma_f32_16x16x32_bf16 v[108:111], v[76:79], a[228:231], v[108:111]
 buffer_load_dwordx4 v8, s[24:27], s65 offen offset:1024  lds
 v_mfma_f32_16x16x32_bf16 v[112:115], v[80:83], a[224:227], v[112:115]
 s_waitcnt vmcnt(21)
 ds_read_b64_tr_b16 v[76:77], v20 offset:40960
 ds_read_b64_tr_b16 v[78:79], v20 offset:43008
 v_mfma_f32_16x16x32_bf16 v[116:119], v[80:83], a[228:231], v[116:119]
 v_mfma_f32_16x16x32_bf16 v[120:123], v[84:87], a[224:227], v[120:123]
 ds_read_b64_tr_b16 v[80:81], v21 offset:40960
 ds_read_b64_tr_b16 v[82:83], v21 offset:43008
 v_mfma_f32_16x16x32_bf16 v[124:127], v[84:87], a[228:231], v[124:127]
 buffer_load_dwordx4 v9, s[24:27], s65 offen offset:2048  lds
 v_mfma_f32_16x16x32_bf16 v[96:99], v[88:91], a[232:235], v[96:99]
 s_waitcnt lgkmcnt(6)
 ds_read_b64_tr_b16 v[84:85], v22 offset:40960
 ds_read_b64_tr_b16 v[86:87], v22 offset:43008
 v_mfma_f32_16x16x32_bf16 v[100:103], v[88:91], a[236:239], v[100:103]
 buffer_load_dwordx4 v10, s[24:27], s65 offen offset:3072  lds
 v_mfma_f32_16x16x32_bf16 v[104:107], v[92:95], a[232:235], v[104:107]
 ds_read_b64_tr_b16 v[88:89], v19 offset:45056
 ds_read_b64_tr_b16 v[90:91], v19 offset:47104
 v_mfma_f32_16x16x32_bf16 v[108:111], v[92:95], a[236:239], v[108:111]
 v_mfma_f32_16x16x32_bf16 v[112:115], v[64:67], a[232:235], v[112:115]
 s_waitcnt vmcnt(21)
 ds_read_b64_tr_b16 v[92:93], v20 offset:45056
 ds_read_b64_tr_b16 v[94:95], v20 offset:47104
 v_mfma_f32_16x16x32_bf16 v[116:119], v[64:67], a[236:239], v[116:119]
 buffer_load_dwordx4 a[40:43], v14, s[4:7], s64 offen offset:0 sc1
 v_mfma_f32_16x16x32_bf16 v[120:123], v[68:71], a[232:235], v[120:123]
 s_waitcnt lgkmcnt(6)
 ds_read_b64_tr_b16 v[64:65], v21 offset:45056
 ds_read_b64_tr_b16 v[66:67], v21 offset:47104
 v_mfma_f32_16x16x32_bf16 v[124:127], v[68:71], a[236:239], v[124:127]
 v_mfma_f32_16x16x32_bf16 v[96:99], v[72:75], a[240:243], v[96:99]
 ds_read_b64_tr_b16 v[68:69], v22 offset:45056
 ds_read_b64_tr_b16 v[70:71], v22 offset:47104
 v_mfma_f32_16x16x32_bf16 v[100:103], v[72:75], a[244:247], v[100:103]
 buffer_load_dwordx4 a[44:47], v14, s[4:7], s64 offen offset:2048 sc1
 v_mfma_f32_16x16x32_bf16 v[104:107], v[76:79], a[240:243], v[104:107]
 s_add_u32 s64, s64, 0x80000
 s_barrier
 ds_read_b64_tr_b16 v[72:73], v19 offset:49152
 ds_read_b64_tr_b16 v[74:75], v19 offset:51200
 v_mfma_f32_16x16x32_bf16 v[108:111], v[76:79], a[244:247], v[108:111]
 buffer_load_dwordx4 a[48:51], v11, s[4:7], s64 offen offset:0 sc1
 v_mfma_f32_16x16x32_bf16 v[112:115], v[80:83], a[240:243], v[112:115]
 s_waitcnt lgkmcnt(6)
 ds_read_b64_tr_b16 v[76:77], v20 offset:49152
 ds_read_b64_tr_b16 v[78:79], v20 offset:51200
 v_mfma_f32_16x16x32_bf16 v[116:119], v[80:83], a[244:247], v[116:119]
 v_mfma_f32_16x16x32_bf16 v[120:123], v[84:87], a[240:243], v[120:123]
 s_waitcnt vmcnt(22)
 ds_read_b64_tr_b16 v[80:81], v21 offset:49152
 ds_read_b64_tr_b16 v[82:83], v21 offset:51200
 v_mfma_f32_16x16x32_bf16 v[124:127], v[84:87], a[244:247], v[124:127]
 buffer_load_dwordx4 a[52:55], v11, s[4:7], s64 offen offset:2048 sc1
 v_mfma_f32_16x16x32_bf16 v[96:99], v[88:91], a[248:251], v[96:99]
 ds_read_b64_tr_b16 v[84:85], v22 offset:49152
 ds_read_b64_tr_b16 v[86:87], v22 offset:51200
 v_mfma_f32_16x16x32_bf16 v[100:103], v[88:91], a[252:255], v[100:103]
 v_mfma_f32_16x16x32_bf16 v[104:107], v[92:95], a[248:251], v[104:107]
 s_waitcnt lgkmcnt(6)
 ds_read_b64_tr_b16 v[88:89], v19 offset:53248
 ds_read_b64_tr_b16 v[90:91], v19 offset:55296
 v_mfma_f32_16x16x32_bf16 v[108:111], v[92:95], a[252:255], v[108:111]
 buffer_load_dwordx4 a[56:59], v14, s[4:7], s64 offen offset:0 sc1
 v_mfma_f32_16x16x32_bf16 v[112:115], v[64:67], a[248:251], v[112:115]
 s_waitcnt vmcnt(22)
 ds_read_b64_tr_b16 v[92:93], v20 offset:53248
 ds_read_b64_tr_b16 v[94:95], v20 offset:55296
 v_mfma_f32_16x16x32_bf16 v[116:119], v[64:67], a[252:255], v[116:119]
 buffer_load_dwordx4 a[60:63], v14, s[4:7], s64 offen offset:2048 sc1
 v_mfma_f32_16x16x32_bf16 v[120:123], v[68:71], a[248:251], v[120:123]
 s_bfe_u32 s64, s91, 0x40008
 ds_read_b64_tr_b16 v[64:65], v21 offset:53248
 ds_read_b64_tr_b16 v[66:67], v21 offset:55296
 v_mfma_f32_16x16x32_bf16 v[124:127], v[68:71], a[252:255], v[124:127]
 s_mul_i32 s64, s64, 0x100000
 s_add_u32 s64, s64, s16
 v_mfma_f32_16x16x32_bf16 v[96:99], v[72:75], a[0:3], v[96:99]
 s_waitcnt lgkmcnt(6)
 ds_read_b64_tr_b16 v[68:69], v22 offset:53248
 ds_read_b64_tr_b16 v[70:71], v22 offset:55296
 v_mfma_f32_16x16x32_bf16 v[100:103], v[72:75], a[4:7], v[100:103]
 buffer_load_dwordx4 a[64:67], v11, s[4:7], s64 offen offset:0 sc1
 v_mfma_f32_16x16x32_bf16 v[104:107], v[76:79], a[0:3], v[104:107]
 ds_read_b64_tr_b16 v[72:73], v19 offset:57344
 ds_read_b64_tr_b16 v[74:75], v19 offset:59392
 v_mfma_f32_16x16x32_bf16 v[108:111], v[76:79], a[4:7], v[108:111]
 v_mfma_f32_16x16x32_bf16 v[112:115], v[80:83], a[0:3], v[112:115]
 s_waitcnt vmcnt(18)
 ds_read_b64_tr_b16 v[76:77], v20 offset:57344
 ds_read_b64_tr_b16 v[78:79], v20 offset:59392
 v_mfma_f32_16x16x32_bf16 v[116:119], v[80:83], a[4:7], v[116:119]
 buffer_load_dwordx4 a[68:71], v11, s[4:7], s64 offen offset:2048 sc1
 v_mfma_f32_16x16x32_bf16 v[120:123], v[84:87], a[0:3], v[120:123]
 s_waitcnt lgkmcnt(6)
 ds_read_b64_tr_b16 v[80:81], v21 offset:57344
 ds_read_b64_tr_b16 v[82:83], v21 offset:59392
 v_mfma_f32_16x16x32_bf16 v[124:127], v[84:87], a[4:7], v[124:127]
 s_add_u32 m0, s60, 0x18000
 s_bfe_u32 s65, s91, 0x4000c
 s_mul_i32 s65, s65, 0x40000
 s_bitcmp1_b64 s[32:33], 33
 s_cbranch_scc0 mk_x35
 v_accvgpr_read_b32 v60, a10
 v_accvgpr_read_b32 v61, a11
 v_accvgpr_mov_b32 a10, a12
 v_accvgpr_mov_b32 a11, a13
 v_accvgpr_write_b32 a12, v60
 v_accvgpr_write_b32 a13, v61
 s_nop 1
mk_x35:
 v_mfma_f32_16x16x32_bf16 v[96:99], v[88:91], a[8:11], v[96:99]
 s_add_u32 s65, s65, s63
 ds_read_b64_tr_b16 v[84:85], v22 offset:57344
 ds_read_b64_tr_b16 v[86:87], v22 offset:59392
 v_mfma_f32_16x16x32_bf16 v[100:103], v[88:91], a[12:15], v[100:103]
 buffer_load_dwordx4 v7, s[24:27], s65 offen offset:0  lds
 v_mfma_f32_16x16x32_bf16 v[104:107], v[92:95], a[8:11], v[104:107]
 ds_read_b64_tr_b16 v[88:89], v19 offset:61440
 ds_read_b64_tr_b16 v[90:91], v19 offset:63488
 v_mfma_f32_16x16x32_bf16 v[108:111], v[92:95], a[12:15], v[108:111]
 buffer_load_dwordx4 v8, s[24:27], s65 offen offset:1024  lds
 v_mfma_f32_16x16x32_bf16 v[112:115], v[64:67], a[8:11], v[112:115]
 s_waitcnt lgkmcnt(6)
 ds_read_b64_tr_b16 v[92:93], v20 offset:61440
 ds_read_b64_tr_b16 v[94:95], v20 offset:63488
 v_mfma_f32_16x16x32_bf16 v[116:119], v[64:67], a[12:15], v[116:119]
 v_mfma_f32_16x16x32_bf16 v[120:123], v[68:71], a[8:11], v[120:123]
 s_waitcnt vmcnt(18)
 ds_read_b64_tr_b16 v[64:65], v21 offset:61440
 ds_read_b64_tr_b16 v[66:67], v21 offset:63488
 v_mfma_f32_16x16x32_bf16 v[124:127], v[68:71], a[12:15], v[124:127]
 buffer_load_dwordx4 v9, s[24:27], s65 offen offset:2048  lds
 v_mfma_f32_16x16x32_bf16 v[96:99], v[72:75], a[16:19], v[96:99]
 ds_read_b64_tr_b16 v[68:69], v22 offset:61440
 ds_read_b64_tr_b16 v[70:71], v22 offset:63488
 v_mfma_f32_16x16x32_bf16 v[100:103], v[72:75], a[20:23], v[100:103]
 buffer_load_dwordx4 v10, s[24:27], s65 offen offset:3072  lds
 v_mfma_f32_16x16x32_bf16 v[104:107], v[76:79], a[16:19], v[104:107]
 s_waitcnt lgkmcnt(6)
 s_barrier
 ds_read_b64_tr_b16 v[72:73], v23 offset:0
 ds_read_b64_tr_b16 v[74:75], v23 offset:2048
 v_mfma_f32_16x16x32_bf16 v[108:111], v[76:79], a[20:23], v[108:111]
 v_mfma_f32_16x16x32_bf16 v[112:115], v[80:83], a[16:19], v[112:115]
 s_waitcnt vmcnt(18)
 ds_read_b64_tr_b16 v[76:77], v24 offset:0
 ds_read_b64_tr_b16 v[78:79], v24 offset:2048
 v_mfma_f32_16x16x32_bf16 v[116:119], v[80:83], a[20:23], v[116:119]
 buffer_load_dwordx4 a[72:75], v14, s[4:7], s64 offen offset:0 sc1
 v_mfma_f32_16x16x32_bf16 v[120:123], v[84:87], a[16:19], v[120:123]
 ds_read_b64_tr_b16 v[80:81], v25 offset:0
 ds_read_b64_tr_b16 v[82:83], v25 offset:2048
 v_mfma_f32_16x16x32_bf16 v[124:127], v[84:87], a[20:23], v[124:127]
 s_bitcmp1_b64 s[32:33], 35
 s_cbranch_scc0 mk_x36
 v_accvgpr_read_b32 v60, a26
 v_accvgpr_read_b32 v61, a27
 v_accvgpr_mov_b32 a26, a28
 v_accvgpr_mov_b32 a27, a29
 v_accvgpr_write_b32 a28, v60
 v_accvgpr_write_b32 a29, v61
 s_nop 1
mk_x36:
 v_mfma_f32_16x16x32_bf16 v[96:99], v[88:91], a[24:27], v[96:99]
 s_waitcnt lgkmcnt(6)
 ds_read_b64_tr_b16 v[84:85], v26 offset:0
 ds_read_b64_tr_b16 v[86:87], v26 offset:2048
 v_mfma_f32_16x16x32_bf16 v[100:103], v[88:91], a[28:31], v[100:103]
 buffer_load_dwordx4 a[76:79], v14, s[4:7], s64 offen offset:2048 sc1
 v_mfma_f32_16x16x32_bf16 v[104:107], v[92:95], a[24:27], v[104:107]
 s_add_u32 s64, s64, 0x80000
 ds_read_b64_tr_b16 v[88:89], v23 offset:4096
 ds_read_b64_tr_b16 v[90:91], v23 offset:6144
 v_mfma_f32_16x16x32_bf16 v[108:111], v[92:95], a[28:31], v[108:111]
 buffer_load_dwordx4 a[80:83], v11, s[4:7], s64 offen offset:0 sc1
 v_mfma_f32_16x16x32_bf16 v[112:115], v[64:67], a[24:27], v[112:115]
 s_waitcnt vmcnt(19)
 ds_read_b64_tr_b16 v[92:93], v24 offset:4096
 ds_read_b64_tr_b16 v[94:95], v24 offset:6144
 v_mfma_f32_16x16x32_bf16 v[116:119], v[64:67], a[28:31], v[116:119]
 v_mfma_f32_16x16x32_bf16 v[120:123], v[68:71], a[24:27], v[120:123]
 s_waitcnt lgkmcnt(6)
 ds_read_b64_tr_b16 v[64:65], v25 offset:4096
 ds_read_b64_tr_b16 v[66:67], v25 offset:6144
 v_mfma_f32_16x16x32_bf16 v[124:127], v[68:71], a[28:31], v[124:127]
 buffer_load_dwordx4 a[84:87], v11, s[4:7], s64 offen offset:2048 sc1
 v_mfma_f32_16x16x32_bf16 v[96:99], v[72:75], a[32:35], v[96:99]
 ds_read_b64_tr_b16 v[68:69], v26 offset:4096
 ds_read_b64_tr_b16 v[70:71], v26 offset:6144
 v_mfma_f32_16x16x32_bf16 v[100:103], v[72:75], a[36:39], v[100:103]
 v_mfma_f32_16x16x32_bf16 v[104:107], v[76:79], a[32:35], v[104:107]
 ds_read_b64_tr_b16 v[72:73], v23 offset:8192
 ds_read_b64_tr_b16 v[74:75], v23 offset:10240
 v_mfma_f32_16x16x32_bf16 v[108:111], v[76:79], a[36:39], v[108:111]
 buffer_load_dwordx4 a[88:91], v14, s[4:7], s64 offen offset:0 sc1
 v_mfma_f32_16x16x32_bf16 v[112:115], v[80:83], a[32:35], v[112:115]
 s_waitcnt lgkmcnt(6)
 ds_read_b64_tr_b16 v[76:77], v24 offset:8192
 ds_read_b64_tr_b16 v[78:79], v24 offset:10240
 v_mfma_f32_16x16x32_bf16 v[116:119], v[80:83], a[36:39], v[116:119]
 buffer_load_dwordx4 a[92:95], v14, s[4:7], s64 offen offset:2048 sc1
 v_mfma_f32_16x16x32_bf16 v[120:123], v[84:87], a[32:35], v[120:123]
 s_waitcnt vmcnt(16)
 ds_read_b64_tr_b16 v[80:81], v25 offset:8192
 ds_read_b64_tr_b16 v[82:83], v25 offset:10240
 v_mfma_f32_16x16x32_bf16 v[124:127], v[84:87], a[36:39], v[124:127]
 s_bfe_u32 s64, s91, 0x4000c
 s_mul_i32 s64, s64, 0x100000
 s_add_u32 s64, s64, s16
 v_mfma_f32_16x16x32_bf16 v[96:99], v[88:91], a[40:43], v[96:99]
 ds_read_b64_tr_b16 v[84:85], v26 offset:8192
 ds_read_b64_tr_b16 v[86:87], v26 offset:10240
 v_mfma_f32_16x16x32_bf16 v[100:103], v[88:91], a[44:47], v[100:103]
 buffer_load_dwordx4 a[96:99], v11, s[4:7], s64 offen offset:0 sc1
 v_mfma_f32_16x16x32_bf16 v[104:107], v[92:95], a[40:43], v[104:107]
 s_waitcnt lgkmcnt(6)
 ds_read_b64_tr_b16 v[88:89], v23 offset:12288
 ds_read_b64_tr_b16 v[90:91], v23 offset:14336
 v_mfma_f32_16x16x32_bf16 v[108:111], v[92:95], a[44:47], v[108:111]
 v_mfma_f32_16x16x32_bf16 v[112:115], v[64:67], a[40:43], v[112:115]
 s_waitcnt vmcnt(15)
 ds_read_b64_tr_b16 v[92:93], v24 offset:12288
 ds_read_b64_tr_b16 v[94:95], v24 offset:14336
 v_mfma_f32_16x16x32_bf16 v[116:119], v[64:67], a[44:47], v[116:119]
 buffer_load_dwordx4 a[100:103], v11, s[4:7], s64 offen offset:2048 sc1
 v_mfma_f32_16x16x32_bf16 v[120:123], v[68:71], a[40:43], v[120:123]
 s_add_u32 m0, s60, 0x1c000
 ds_read_b64_tr_b16 v[64:65], v25 offset:12288
 ds_read_b64_tr_b16 v[66:67], v25 offset:14336
 v_mfma_f32_16x16x32_bf16 v[124:127], v[68:71], a[44:47], v[124:127]
 s_bfe_u32 s65, s91, 0x40010
 s_mul_i32 s65, s65, 0x40000
 s_add_u32 s65, s65, s63
 v_mfma_f32_16x16x32_bf16 v[96:99], v[72:75], a[48:51], v[96:99]
 s_waitcnt lgkmcnt(6)
 ds_read_b64_tr_b16 v[68:69], v26 offset:12288
 ds_read_b64_tr_b16 v[70:71], v26 offset:14336
 v_mfma_f32_16x16x32_bf16 v[100:103], v[72:75], a[52:55], v[100:103]
 buffer_load_dwordx4 v7, s[24:27], s65 offen offset:0  lds
 v_mfma_f32_16x16x32_bf16 v[104:107], v[76:79], a[48:51], v[104:107]
 s_barrier
 ds_read_b64_tr_b16 v[72:73], v23 offset:16384
 ds_read_b64_tr_b16 v[74:75], v23 offset:18432
 v_mfma_f32_16x16x32_bf16 v[108:111], v[76:79], a[52:55], v[108:111]
 buffer_load_dwordx4 v8, s[24:27], s65 offen offset:1024  lds
 v_mfma_f32_16x16x32_bf16 v[112:115], v[80:83], a[48:51], v[112:115]
 s_waitcnt vmcnt(16)
 ds_read_b64_tr_b16 v[76:77], v24 offset:16384
 ds_read_b64_tr_b16 v[78:79], v24 offset:18432
 v_mfma_f32_16x16x32_bf16 v[116:119], v[80:83], a[52:55], v[116:119]
 v_mfma_f32_16x16x32_bf16 v[120:123], v[84:87], a[48:51], v[120:123]
 s_waitcnt lgkmcnt(6)
 ds_read_b64_tr_b16 v[80:81], v25 offset:16384
 ds_read_b64_tr_b16 v[82:83], v25 offset:18432
 v_mfma_f32_16x16x32_bf16 v[124:127], v[84:87], a[52:55], v[124:127]
 buffer_load_dwordx4 v9, s[24:27], s65 offen offset:2048  lds
 v_mfma_f32_16x16x32_bf16 v[96:99], v[88:91], a[56:59], v[96:99]
 ds_read_b64_tr_b16 v[84:85], v26 offset:16384
 ds_read_b64_tr_b16 v[86:87], v26 offset:18432
 v_mfma_f32_16x16x32_bf16 v[100:103], v[88:91], a[60:63], v[100:103]
 buffer_load_dwordx4 v10, s[24:27], s65 offen offset:3072  lds
 v_mfma_f32_16x16x32_bf16 v[104:107], v[92:95], a[56:59], v[104:107]
 ds_read_b64_tr_b16 v[88:89], v23 offset:20480
 ds_read_b64_tr_b16 v[90:91], v23 offset:22528
 v_mfma_f32_16x16x32_bf16 v[108:111], v[92:95], a[60:63], v[108:111]
 v_mfma_f32_16x16x32_bf16 v[112:115], v[64:67], a[56:59], v[112:115]
 s_waitcnt lgkmcnt(6)
 ds_read_b64_tr_b16 v[92:93], v24 offset:20480
 ds_read_b64_tr_b16 v[94:95], v24 offset:22528
 v_mfma_f32_16x16x32_bf16 v[116:119], v[64:67], a[60:63], v[116:119]
 buffer_load_dwordx4 a[104:107], v14, s[4:7], s64 offen offset:0 sc1
 v_mfma_f32_16x16x32_bf16 v[120:123], v[68:71], a[56:59], v[120:123]
 s_waitcnt vmcnt(17)
 ds_read_b64_tr_b16 v[64:65], v25 offset:20480
 ds_read_b64_tr_b16 v[66:67], v25 offset:22528
 v_mfma_f32_16x16x32_bf16 v[124:127], v[68:71], a[60:63], v[124:127]
 s_bitcmp1_b64 s[32:33], 40
 s_cbranch_scc0 mk_x37
 v_accvgpr_read_b32 v60, a66
 v_accvgpr_read_b32 v61, a67
 v_accvgpr_mov_b32 a66, a68
 v_accvgpr_mov_b32 a67, a69
 v_accvgpr_write_b32 a68, v60
 v_accvgpr_write_b32 a69, v61
 s_nop 1
mk_x37:
 v_mfma_f32_16x16x32_bf16 v[96:99], v[72:75], a[64:67], v[96:99]
 ds_read_b64_tr_b16 v[68:69], v26 offset:20480
 ds_read_b64_tr_b16 v[70:71], v26 offset:22528
 v_mfma_f32_16x16x32_bf16 v[100:103], v[72:75], a[68:71], v[100:103]
 buffer_load_dwordx4 a[108:111], v14, s[4:7], s64 offen offset:2048 sc1
 v_mfma_f32_16x16x32_bf16 v[104:107], v[76:79], a[64:67], v[104:107]
 s_waitcnt lgkmcnt(6)
 ds_read_b64_tr_b16 v[72:73], v23 offset:24576
 ds_read_b64_tr_b16 v[74:75], v23 offset:26624
 v_mfma_f32_16x16x32_bf16 v[108:111], v[76:79], a[68:71], v[108:111]
 s_add_u32 s64, s64, 0x80000
 v_mfma_f32_16x16x32_bf16 v[112:115], v[80:83], a[64:67], v[112:115]
 s_waitcnt vmcnt(12)
 ds_read_b64_tr_b16 v[76:77], v24 offset:24576
 ds_read_b64_tr_b16 v[78:79], v24 offset:26624
 v_mfma_f32_16x16x32_bf16 v[116:119], v[80:83], a[68:71], v[116:119]
 buffer_load_dwordx4 a[112:115], v11, s[4:7], s64 offen offset:0 sc1
 v_mfma_f32_16x16x32_bf16 v[120:123], v[84:87], a[64:67], v[120:123]
 ds_read_b64_tr_b16 v[80:81], v25 offset:24576
 ds_read_b64_tr_b16 v[82:83], v25 offset:26624
 v_mfma_f32_16x16x32_bf16 v[124:127], v[84:87], a[68:71], v[124:127]
 buffer_load_dwordx4 a[116:119], v11, s[4:7], s64 offen offset:2048 sc1
 v_mfma_f32_16x16x32_bf16 v[96:99], v[88:91], a[72:75], v[96:99]
 s_waitcnt lgkmcnt(6)
 ds_read_b64_tr_b16 v[84:85], v26 offset:24576
 ds_read_b64_tr_b16 v[86:87], v26 offset:26624
 v_mfma_f32_16x16x32_bf16 v[100:103], v[88:91], a[76:79], v[100:103]
 v_mfma_f32_16x16x32_bf16 v[104:107], v[92:95], a[72:75], v[104:107]
 ds_read_b64_tr_b16 v[88:89], v23 offset:28672
 ds_read_b64_tr_b16 v[90:91], v23 offset:30720
 v_mfma_f32_16x16x32_bf16 v[108:111], v[92:95], a[76:79], v[108:111]
 buffer_load_dwordx4 a[120:123], v14, s[4:7], s64 offen offset:0 sc1
 v_mfma_f32_16x16x32_bf16 v[112:115], v[64:67], a[72:75], v[112:115]
 s_waitcnt vmcnt(13)
 ds_read_b64_tr_b16 v[92:93], v24 offset:28672
 ds_read_b64_tr_b16 v[94:95], v24 offset:30720
 v_mfma_f32_16x16x32_bf16 v[116:119], v[64:67], a[76:79], v[116:119]
 buffer_load_dwordx4 a[124:127], v14, s[4:7], s64 offen offset:2048 sc1
 v_mfma_f32_16x16x32_bf16 v[120:123], v[68:71], a[72:75], v[120:123]
 s_waitcnt lgkmcnt(6)
 ds_read_b64_tr_b16 v[64:65], v25 offset:28672
 ds_read_b64_tr_b16 v[66:67], v25 offset:30720
 v_mfma_f32_16x16x32_bf16 v[124:127], v[68:71], a[76:79], v[124:127]
 s_bfe_u32 s64, s91, 0x40010
 s_mul_i32 s64, s64, 0x100000
 s_add_u32 s64, s64, s16
 s_bitcmp1_b64 s[32:33], 42
 s_cbranch_scc0 mk_x38
 v_accvgpr_read_b32 v60, a82
 v_accvgpr_read_b32 v61, a83
 v_accvgpr_mov_b32 a82, a84
 v_accvgpr_mov_b32 a83, a85
 v_accvgpr_write_b32 a84, v60
 v_accvgpr_write_b32 a85, v61
 s_nop 1
mk_x38:
 v_mfma_f32_16x16x32_bf16 v[96:99], v[72:75], a[80:83], v[96:99]
 ds_read_b64_tr_b16 v[68:69], v26 offset:28672
 ds_read_b64_tr_b16 v[70:71], v26 offset:30720
 v_mfma_f32_16x16x32_bf16 v[100:103], v[72:75], a[84:87], v[100:103]
 buffer_load_dwordx4 a[128:131], v11, s[4:7], s64 offen offset:0 sc1
 v_mfma_f32_16x16x32_bf16 v[104:107], v[76:79], a[80:83], v[104:107]
 s_barrier
 ds_read_b64_tr_b16 v[72:73], v23 offset:32768
 ds_read_b64_tr_b16 v[74:75], v23 offset:34816
 v_mfma_f32_16x16x32_bf16 v[108:111], v[76:79], a[84:87], v[108:111]
 v_mfma_f32_16x16x32_bf16 v[112:115], v[80:83], a[80:83], v[112:115]
 s_waitcnt lgkmcnt(6)
 ds_read_b64_tr_b16 v[76:77], v24 offset:32768
 ds_read_b64_tr_b16 v[78:79], v24 offset:34816
 v_mfma_f32_16x16x32_bf16 v[116:119], v[80:83], a[84:87], v[116:119]
 buffer_load_dwordx4 a[132:135], v11, s[4:7], s64 offen offset:2048 sc1
 v_mfma_f32_16x16x32_bf16 v[120:123], v[84:87], a[80:83], v[120:123]
 s_waitcnt vmcnt(14)
 ds_read_b64_tr_b16 v[80:81], v25 offset:32768
 ds_read_b64_tr_b16 v[82:83], v25 offset:34816
 v_mfma_f32_16x16x32_bf16 v[124:127], v[84:87], a[84:87], v[124:127]
 s_add_u32 m0, s60, 0x20000
 s_bfe_u32 s65, s91, 0x40014
 s_mul_i32 s65, s65, 0x40000
 v_mfma_f32_16x16x32_bf16 v[96:99], v[88:91], a[88:91], v[96:99]
 s_add_u32 s65, s65, s63
 ds_read_b64_tr_b16 v[84:85], v26 offset:32768
 ds_read_b64_tr_b16 v[86:87], v26 offset:34816
 v_mfma_f32_16x16x32_bf16 v[100:103], v[88:91], a[92:95], v[100:103]
 buffer_load_dwordx4 v7, s[24:27], s65 offen offset:0  lds
 v_mfma_f32_16x16x32_bf16 v[104:107], v[92:95], a[88:91], v[104:107]
 s_waitcnt lgkmcnt(6)
 ds_read_b64_tr_b16 v[88:89], v23 offset:36864
 ds_read_b64_tr_b16 v[90:91], v23 offset:38912
 v_mfma_f32_16x16x32_bf16 v[108:111], v[92:95], a[92:95], v[108:111]
 buffer_load_dwordx4 v8, s[24:27], s65 offen offset:1024  lds
 v_mfma_f32_16x16x32_bf16 v[112:115], v[64:67], a[88:91], v[112:115]
 s_waitcnt vmcnt(14)
 ds_read_b64_tr_b16 v[92:93], v24 offset:36864
 ds_read_b64_tr_b16 v[94:95], v24 offset:38912
 v_mfma_f32_16x16x32_bf16 v[116:119], v[64:67], a[92:95], v[116:119]
 v_mfma_f32_16x16x32_bf16 v[120:123], v[68:71], a[88:91], v[120:123]
 ds_read_b64_tr_b16 v[64:65], v25 offset:36864
 ds_read_b64_tr_b16 v[66:67], v25 offset:38912
 v_mfma_f32_16x16x32_bf16 v[124:127], v[68:71], a[92:95], v[124:127]
 buffer_load_dwordx4 v9, s[24:27], s65 offen offset:2048  lds
 v_mfma_f32_16x16x32_bf16 v[96:99], v[72:75], a[96:99], v[96:99]
 s_waitcnt lgkmcnt(6)
 ds_read_b64_tr_b16 v[68:69], v26 offset:36864
 ds_read_b64_tr_b16 v[70:71], v26 offset:38912
 v_mfma_f32_16x16x32_bf16 v[100:103], v[72:75], a[100:103], v[100:103]
 buffer_load_dwordx4 v10, s[24:27], s65 offen offset:3072  lds
 v_mfma_f32_16x16x32_bf16 v[104:107], v[76:79], a[96:99], v[104:107]
 ds_read_b64_tr_b16 v[72:73], v23 offset:40960
 ds_read_b64_tr_b16 v[74:75], v23 offset:43008
 v_mfma_f32_16x16x32_bf16 v[108:111], v[76:79], a[100:103], v[108:111]
 v_mfma_f32_16x16x32_bf16 v[112:115], v[80:83], a[96:99], v[112:115]
 s_waitcnt vmcnt(10)
 ds_read_b64_tr_b16 v[76:77], v24 offset:40960
 ds_read_b64_tr_b16 v[78:79], v24 offset:43008
 v_mfma_f32_16x16x32_bf16 v[116:119], v[80:83], a[100:103], v[116:119]
 buffer_load_dwordx4 a[136:139], v14, s[4:7], s64 offen offset:0 sc1
 v_mfma_f32_16x16x32_bf16 v[120:123], v[84:87], a[96:99], v[120:123]
 s_waitcnt lgkmcnt(6)
 ds_read_b64_tr_b16 v[80:81], v25 offset:40960
 ds_read_b64_tr_b16 v[82:83], v25 offset:43008
 v_mfma_f32_16x16x32_bf16 v[124:127], v[84:87], a[100:103], v[124:127]
 s_bitcmp1_b64 s[32:33], 45
 s_cbranch_scc0 mk_x39
 v_accvgpr_read_b32 v60, a106
 v_accvgpr_read_b32 v61, a107
 v_accvgpr_mov_b32 a106, a108
 v_accvgpr_mov_b32 a107, a109
 v_accvgpr_write_b32 a108, v60
 v_accvgpr_write_b32 a109, v61
 s_nop 1
mk_x39:
 v_mfma_f32_16x16x32_bf16 v[96:99], v[88:91], a[104:107], v[96:99]
 ds_read_b64_tr_b16 v[84:85], v26 offset:40960
 ds_read_b64_tr_b16 v[86:87], v26 offset:43008
 v_mfma_f32_16x16x32_bf16 v[100:103], v[88:91], a[108:111], v[100:103]
 buffer_load_dwordx4 a[140:143], v14, s[4:7], s64 offen offset:2048 sc1
 v_mfma_f32_16x16x32_bf16 v[104:107], v[92:95], a[104:107], v[104:107]
 s_add_u32 s64, s64, 0x80000
 ds_read_b64_tr_b16 v[88:89], v23 offset:45056
 ds_read_b64_tr_b16 v[90:91], v23 offset:47104
 v_mfma_f32_16x16x32_bf16 v[108:111], v[92:95], a[108:111], v[108:111]
 buffer_load_dwordx4 a[144:147], v11, s[4:7], s64 offen offset:0 sc1
 v_mfma_f32_16x16x32_bf16 v[112:115], v[64:67], a[104:107], v[112:115]
 s_waitcnt lgkmcnt(6)
 ds_read_b64_tr_b16 v[92:93], v24 offset:45056
 ds_read_b64_tr_b16 v[94:95], v24 offset:47104
 v_mfma_f32_16x16x32_bf16 v[116:119], v[64:67], a[108:111], v[116:119]
 v_mfma_f32_16x16x32_bf16 v[120:123], v[68:71], a[104:107], v[120:123]
 s_waitcnt vmcnt(11)
 ds_read_b64_tr_b16 v[64:65], v25 offset:45056
 ds_read_b64_tr_b16 v[66:67], v25 offset:47104
 v_mfma_f32_16x16x32_bf16 v[124:127], v[68:71], a[108:111], v[124:127]
 buffer_load_dwordx4 a[148:151], v11, s[4:7], s64 offen offset:2048 sc1
 v_mfma_f32_16x16x32_bf16 v[96:99], v[72:75], a[112:115], v[96:99]
 ds_read_b64_tr_b16 v[68:69], v26 offset:45056
 ds_read_b64_tr_b16 v[70:71], v26 offset:47104
 v_mfma_f32_16x16x32_bf16 v[100:103], v[72:75], a[116:119], v[100:103]
 v_mfma_f32_16x16x32_bf16 v[104:107], v[76:79], a[112:115], v[104:107]
 s_waitcnt lgkmcnt(6)
 s_barrier
 ds_read_b64_tr_b16 v[72:73], v23 offset:49152
 ds_read_b64_tr_b16 v[74:75], v23 offset:51200
 v_mfma_f32_16x16x32_bf16 v[108:111], v[76:79], a[116:119], v[108:111]
 buffer_load_dwordx4 a[152:155], v14, s[4:7], s64 offen offset:0 sc1
 v_mfma_f32_16x16x32_bf16 v[112:115], v[80:83], a[112:115], v[112:115]
 s_waitcnt vmcnt(11)
 ds_read_b64_tr_b16 v[76:77], v24 offset:49152
 ds_read_b64_tr_b16 v[78:79], v24 offset:51200
 v_mfma_f32_16x16x32_bf16 v[116:119], v[80:83], a[116:119], v[116:119]
 buffer_load_dwordx4 a[156:159], v14, s[4:7], s64 offen offset:2048 sc1
 v_mfma_f32_16x16x32_bf16 v[120:123], v[84:87], a[112:115], v[120:123]
 s_bfe_u32 s64, s91, 0x40014
 ds_read_b64_tr_b16 v[80:81], v25 offset:49152
 ds_read_b64_tr_b16 v[82:83], v25 offset:51200
 v_mfma_f32_16x16x32_bf16 v[124:127], v[84:87], a[116:119], v[124:127]
 s_mul_i32 s64, s64, 0x100000
 s_add_u32 s64, s64, s16
 v_mfma_f32_16x16x32_bf16 v[96:99], v[88:91], a[120:123], v[96:99]
 s_waitcnt lgkmcnt(6)
 ds_read_b64_tr_b16 v[84:85], v26 offset:49152
 ds_read_b64_tr_b16 v[86:87], v26 offset:51200
 v_mfma_f32_16x16x32_bf16 v[100:103], v[88:91], a[124:127], v[100:103]
 buffer_load_dwordx4 a[160:163], v11, s[4:7], s64 offen offset:0 sc1
 v_mfma_f32_16x16x32_bf16 v[104:107], v[92:95], a[120:123], v[104:107]
 ds_read_b64_tr_b16 v[88:89], v23 offset:53248
 ds_read_b64_tr_b16 v[90:91], v23 offset:55296
 v_mfma_f32_16x16x32_bf16 v[108:111], v[92:95], a[124:127], v[108:111]
 v_mfma_f32_16x16x32_bf16 v[112:115], v[64:67], a[120:123], v[112:115]
 s_waitcnt vmcnt(11)
 ds_read_b64_tr_b16 v[92:93], v24 offset:53248
 ds_read_b64_tr_b16 v[94:95], v24 offset:55296
 v_mfma_f32_16x16x32_bf16 v[116:119], v[64:67], a[124:127], v[116:119]
 buffer_load_dwordx4 a[164:167], v11, s[4:7], s64 offen offset:2048 sc1
 v_mfma_f32_16x16x32_bf16 v[120:123], v[68:71], a[120:123], v[120:123]
 s_waitcnt lgkmcnt(6)
 ds_read_b64_tr_b16 v[64:65], v25 offset:53248
 ds_read_b64_tr_b16 v[66:67], v25 offset:55296
 v_mfma_f32_16x16x32_bf16 v[124:127], v[68:71], a[124:127], v[124:127]
 s_add_u32 m0, s60, 0x0
 s_bfe_u32 s65, s84, 0x40000
 s_mul_i32 s65, s65, 0x60000
 v_mfma_f32_16x16x32_bf16 v[96:99], v[72:75], a[128:131], v[96:99]
 s_add_u32 s65, s65, s61
 ds_read_b64_tr_b16 v[68:69], v26 offset:53248
 ds_read_b64_tr_b16 v[70:71], v26 offset:55296
 v_mfma_f32_16x16x32_bf16 v[100:103], v[72:75], a[132:135], v[100:103]
 buffer_load_dwordx4 v3, s[8:11], s65 offen offset:0  lds
 v_mfma_f32_16x16x32_bf16 v[104:107], v[76:79], a[128:131], v[104:107]
 ds_read_b64_tr_b16 v[72:73], v23 offset:57344
 ds_read_b64_tr_b16 v[74:75], v23 offset:59392
 v_mfma_f32_16x16x32_bf16 v[108:111], v[76:79], a[132:135], v[108:111]
 buffer_load_dwordx4 v4, s[8:11], s65 offen offset:1024  lds
 v_mfma_f32_16x16x32_bf16 v[112:115], v[80:83], a[128:131], v[112:115]
 s_waitcnt lgkmcnt(6)
 ds_read_b64_tr_b16 v[76:77], v24 offset:57344
 ds_read_b64_tr_b16 v[78:79], v24 offset:59392
 v_mfma_f32_16x16x32_bf16 v[116:119], v[80:83], a[132:135], v[116:119]
 buffer_load_dwordx4 v5, s[8:11], s65 offen offset:2048  lds
 v_mfma_f32_16x16x32_bf16 v[120:123], v[84:87], a[128:131], v[120:123]
 s_waitcnt vmcnt(9)
 ds_read_b64_tr_b16 v[80:81], v25 offset:57344
 ds_read_b64_tr_b16 v[82:83], v25 offset:59392
 v_mfma_f32_16x16x32_bf16 v[124:127], v[84:87], a[132:135], v[124:127]
 buffer_load_dwordx4 v6, s[8:11], s65 offen offset:3072  lds
 s_bitcmp1_b64 s[32:33], 49
 s_cbranch_scc0 mk_x40
 v_accvgpr_read_b32 v60, a138
 v_accvgpr_read_b32 v61, a139
 v_accvgpr_mov_b32 a138, a140
 v_accvgpr_mov_b32 a139, a141
 v_accvgpr_write_b32 a140, v60
 v_accvgpr_write_b32 a141, v61
 s_nop 1
mk_x40:
 v_mfma_f32_16x16x32_bf16 v[96:99], v[88:91], a[136:139], v[96:99]
 ds_read_b64_tr_b16 v[84:85], v26 offset:57344
 ds_read_b64_tr_b16 v[86:87], v26 offset:59392
 v_mfma_f32_16x16x32_bf16 v[100:103], v[88:91], a[140:143], v[100:103]
 v_mfma_f32_16x16x32_bf16 v[104:107], v[92:95], a[136:139], v[104:107]
 s_waitcnt lgkmcnt(6)
 ds_read_b64_tr_b16 v[88:89], v23 offset:61440
 ds_read_b64_tr_b16 v[90:91], v23 offset:63488
 v_mfma_f32_16x16x32_bf16 v[108:111], v[92:95], a[140:143], v[108:111]
 buffer_load_dwordx4 a[168:171], v14, s[4:7], s64 offen offset:0 sc1
 v_mfma_f32_16x16x32_bf16 v[112:115], v[64:67], a[136:139], v[112:115]
 s_waitcnt vmcnt(9)
 ds_read_b64_tr_b16 v[92:93], v24 offset:61440
 ds_read_b64_tr_b16 v[94:95], v24 offset:63488
 v_mfma_f32_16x16x32_bf16 v[116:119], v[64:67], a[140:143], v[116:119]
 buffer_load_dwordx4 a[172:175], v14, s[4:7], s64 offen offset:2048 sc1
 v_mfma_f32_16x16x32_bf16 v[120:123], v[68:71], a[136:139], v[120:123]
 ds_read_b64_tr_b16 v[64:65], v25 offset:61440
 ds_read_b64_tr_b16 v[66:67], v25 offset:63488
 v_mfma_f32_16x16x32_bf16 v[124:127], v[68:71], a[140:143], v[124:127]
 s_add_u32 s64, s64, 0x80000
 v_mfma_f32_16x16x32_bf16 v[96:99], v[72:75], a[144:147], v[96:99]
 s_waitcnt lgkmcnt(6)
 ds_read_b64_tr_b16 v[68:69], v26 offset:61440
 ds_read_b64_tr_b16 v[70:71], v26 offset:63488
 v_mfma_f32_16x16x32_bf16 v[100:103], v[72:75], a[148:151], v[100:103]
 v_mfma_f32_16x16x32_bf16 v[104:107], v[76:79], a[144:147], v[104:107]
 s_barrier
 ds_read_b64_tr_b16 v[72:73], v27 offset:0
 ds_read_b64_tr_b16 v[74:75], v27 offset:2048
 v_mfma_f32_16x16x32_bf16 v[108:111], v[76:79], a[148:151], v[108:111]
 buffer_load_dwordx4 a[176:179], v11, s[4:7], s64 offen offset:0 sc1
 v_mfma_f32_16x16x32_bf16 v[112:115], v[80:83], a[144:147], v[112:115]
 s_waitcnt vmcnt(9)
 ds_read_b64_tr_b16 v[76:77], v28 offset:0
 ds_read_b64_tr_b16 v[78:79], v28 offset:2048
 v_mfma_f32_16x16x32_bf16 v[116:119], v[80:83], a[148:151], v[116:119]
 buffer_load_dwordx4 a[180:183], v11, s[4:7], s64 offen offset:2048 sc1
 v_mfma_f32_16x16x32_bf16 v[120:123], v[84:87], a[144:147], v[120:123]
 s_waitcnt lgkmcnt(6)
 ds_read_b64_tr_b16 v[80:81], v27 offset:4096
 ds_read_b64_tr_b16 v[82:83], v27 offset:6144
 v_mfma_f32_16x16x32_bf16 v[124:127], v[84:87], a[148:151], v[124:127]
 v_mfma_f32_16x16x32_bf16 v[96:99], v[88:91], a[152:155], v[96:99]
 ds_read_b64_tr_b16 v[84:85], v28 offset:4096
 ds_read_b64_tr_b16 v[86:87], v28 offset:6144
 v_mfma_f32_16x16x32_bf16 v[100:103], v[88:91], a[156:159], v[100:103]
 v_mfma_f32_16x16x32_bf16 v[104:107], v[92:95], a[152:155], v[104:107]
 ds_read_b64_tr_b16 v[88:89], v27 offset:8192
 ds_read_b64_tr_b16 v[90:91], v27 offset:10240
 v_mfma_f32_16x16x32_bf16 v[108:111], v[92:95], a[156:159], v[108:111]
 buffer_load_dwordx4 a[184:187], v14, s[4:7], s64 offen offset:0 sc1
 v_mfma_f32_16x16x32_bf16 v[112:115], v[64:67], a[152:155], v[112:115]
 s_waitcnt lgkmcnt(6)
 ds_read_b64_tr_b16 v[92:93], v28 offset:8192
 ds_read_b64_tr_b16 v[94:95], v28 offset:10240
 v_mfma_f32_16x16x32_bf16 v[116:119], v[64:67], a[156:159], v[116:119]
 buffer_load_dwordx4 a[188:191], v14, s[4:7], s64 offen offset:2048 sc1
 v_mfma_f32_16x16x32_bf16 v[120:123], v[68:71], a[152:155], v[120:123]
 s_waitcnt vmcnt(10)
 ds_read_b64_tr_b16 v[64:65], v27 offset:12288
 ds_read_b64_tr_b16 v[66:67], v27 offset:14336
 v_mfma_f32_16x16x32_bf16 v[124:127], v[68:71], a[156:159], v[124:127]
 s_add_u32 m0, s60, 0x4000
 s_bfe_u32 s65, s84, 0x40004
 s_mul_i32 s65, s65, 0x60000
 s_bitcmp1_b64 s[32:33], 52
 s_cbranch_scc0 mk_x41
 v_accvgpr_read_b32 v60, a162
 v_accvgpr_read_b32 v61, a163
 v_accvgpr_mov_b32 a162, a164
 v_accvgpr_mov_b32 a163, a165
 v_accvgpr_write_b32 a164, v60
 v_accvgpr_write_b32 a165, v61
 s_nop 1
mk_x41:
 v_mfma_f32_16x16x32_bf16 v[96:99], v[72:75], a[160:163], v[96:99]
 s_waitcnt vmcnt(4)
 ds_read_b64_tr_b16 v[68:69], v28 offset:12288
 ds_read_b64_tr_b16 v[70:71], v28 offset:14336
 v_mfma_f32_16x16x32_bf16 v[100:103], v[72:75], a[164:167], v[100:103]
 s_add_u32 s65, s65, s61
 v_mfma_f32_16x16x32_bf16 v[104:107], v[76:79], a[160:163], v[104:107]
 s_waitcnt lgkmcnt(6)
 ds_read_b64_tr_b16 v[72:73], v29 offset:0
 ds_read_b64_tr_b16 v[74:75], v29 offset:2048
 v_mfma_f32_16x16x32_bf16 v[108:111], v[76:79], a[164:167], v[108:111]
 buffer_load_dwordx4 v3, s[8:11], s65 offen offset:0  lds
 v_mfma_f32_16x16x32_bf16 v[96:99], v[80:83], a[168:171], v[96:99]
 s_waitcnt vmcnt(3)
 ds_read_b64_tr_b16 v[76:77], v30 offset:0
 ds_read_b64_tr_b16 v[78:79], v30 offset:2048
 v_mfma_f32_16x16x32_bf16 v[100:103], v[80:83], a[172:175], v[100:103]
 buffer_load_dwordx4 v4, s[8:11], s65 offen offset:1024  lds
 v_mfma_f32_16x16x32_bf16 v[104:107], v[84:87], a[168:171], v[104:107]
 ds_read_b64_tr_b16 v[80:81], v29 offset:4096
 ds_read_b64_tr_b16 v[82:83], v29 offset:6144
 v_mfma_f32_16x16x32_bf16 v[108:111], v[84:87], a[172:175], v[108:111]
 buffer_load_dwordx4 v5, s[8:11], s65 offen offset:2048  lds
 v_mfma_f32_16x16x32_bf16 v[96:99], v[88:91], a[176:179], v[96:99]
 s_waitcnt lgkmcnt(6)
 ds_read_b64_tr_b16 v[84:85], v30 offset:4096
 ds_read_b64_tr_b16 v[86:87], v30 offset:6144
 v_mfma_f32_16x16x32_bf16 v[100:103], v[88:91], a[180:183], v[100:103]
 buffer_load_dwordx4 v6, s[8:11], s65 offen offset:3072  lds
 v_mfma_f32_16x16x32_bf16 v[104:107], v[92:95], a[176:179], v[104:107]
 s_waitcnt vmcnt(4)
 ds_read_b64_tr_b16 v[88:89], v29 offset:8192
 ds_read_b64_tr_b16 v[90:91], v29 offset:10240
 v_mfma_f32_16x16x32_bf16 v[108:111], v[92:95], a[180:183], v[108:111]
 v_mfma_f32_16x16x32_bf16 v[96:99], v[64:67], a[184:187], v[96:99]
 ds_read_b64_tr_b16 v[92:93], v30 offset:8192
 ds_read_b64_tr_b16 v[94:95], v30 offset:10240
 v_mfma_f32_16x16x32_bf16 v[100:103], v[64:67], a[188:191], v[100:103]
 v_mfma_f32_16x16x32_bf16 v[104:107], v[68:71], a[184:187], v[104:107]
 s_waitcnt lgkmcnt(6)
 ds_read_b64_tr_b16 v[64:65], v29 offset:12288
 ds_read_b64_tr_b16 v[66:67], v29 offset:14336
 v_mfma_f32_16x16x32_bf16 v[108:111], v[68:71], a[188:191], v[108:111]
 v_mfma_f32_16x16x32_bf16 v[112:115], v[72:75], a[160:163], v[112:115]
 ds_read_b64_tr_b16 v[68:69], v30 offset:12288
 ds_read_b64_tr_b16 v[70:71], v30 offset:14336
 v_mfma_f32_16x16x32_bf16 v[116:119], v[72:75], a[164:167], v[116:119]
 v_mfma_f32_16x16x32_bf16 v[120:123], v[76:79], a[160:163], v[120:123]
 v_mfma_f32_16x16x32_bf16 v[124:127], v[76:79], a[164:167], v[124:127]
 v_cvt_pk_bf16_f32 v224, v96, v97
 v_cvt_pk_bf16_f32 v225, v98, v99
 v_cvt_pk_bf16_f32 v226, v104, v105
 v_cvt_pk_bf16_f32 v227, v106, v107
 v_cvt_pk_bf16_f32 v228, v100, v101
 v_cvt_pk_bf16_f32 v229, v102, v103
 v_cvt_pk_bf16_f32 v230, v108, v109
 v_cvt_pk_bf16_f32 v231, v110, v111
 s_cmp_lg_u32 s41, 1
 s_cbranch_scc1 mk_o42
 v_and_b32 v59, 15, v0
 v_lshlrev_b32 v59, 11, v59
 v_bfe_u32 v60, v0, 4, 1
 v_lshl_add_u32 v59, v60, 5, v59
 v_lshrrev_b32 v60, 5, v0
 v_lshl_add_u32 v59, v60, 4, v59
 s_add_u32 s66, s53, 0x8000
 v_permlane16_swap_b32 v224, v226
 v_permlane16_swap_b32 v225, v227
 v_permlane16_swap_b32 v228, v230
 v_permlane16_swap_b32 v229, v231
 buffer_store_dwordx4 v[224:227], v59, s[28:31], s53 offen offset:0 sc1
 buffer_store_dwordx4 v[228:231], v59, s[28:31], s66 offen offset:0 sc1
 s_branch mk_o43
mk_o42:
 s_add_u32 s69, s43, 0x4000000
 buffer_store_dwordx4 v[224:227], v11, s[4:7], s69 offen offset:0 sc1
 v_pk_mul_f32 v[244:245], v[96:97], v[96:97]
 v_pk_add_f32 v[240:241], v[96:97], v[98:99]
 v_pk_fma_f32 v[244:245], v[98:99], v[98:99], v[244:245]
 v_pk_mul_f32 v[246:247], v[100:101], v[100:101]
 v_pk_add_f32 v[242:243], v[100:101], v[102:103]
 v_pk_fma_f32 v[246:247], v[102:103], v[102:103], v[246:247]
 buffer_store_dwordx4 v[228:231], v11, s[4:7], s69 offen offset:2048 sc1
 v_pk_fma_f32 v[244:245], v[104:105], v[104:105], v[244:245]
 v_pk_add_f32 v[240:241], v[240:241], v[104:105]
 v_pk_fma_f32 v[244:245], v[106:107], v[106:107], v[244:245]
 v_pk_add_f32 v[240:241], v[240:241], v[106:107]
 v_pk_fma_f32 v[246:247], v[108:109], v[108:109], v[246:247]
 v_pk_add_f32 v[242:243], v[242:243], v[108:109]
 v_pk_fma_f32 v[246:247], v[110:111], v[110:111], v[246:247]
 v_pk_add_f32 v[242:243], v[242:243], v[110:111]
 s_nop 1
mk_o43:
 v_mfma_f32_16x16x32_bf16 v[112:115], v[80:83], a[168:171], v[112:115]
 s_waitcnt lgkmcnt(4)
 v_mfma_f32_16x16x32_bf16 v[116:119], v[80:83], a[172:175], v[116:119]
 v_mfma_f32_16x16x32_bf16 v[120:123], v[84:87], a[168:171], v[120:123]
 v_mfma_f32_16x16x32_bf16 v[124:127], v[84:87], a[172:175], v[124:127]
 v_mfma_f32_16x16x32_bf16 v[112:115], v[88:91], a[176:179], v[112:115]
 v_mfma_f32_16x16x32_bf16 v[116:119], v[88:91], a[180:183], v[116:119]
 v_mfma_f32_16x16x32_bf16 v[120:123], v[92:95], a[176:179], v[120:123]
 s_waitcnt lgkmcnt(0)
 v_mfma_f32_16x16x32_bf16 v[124:127], v[92:95], a[180:183], v[124:127]
 v_mfma_f32_16x16x32_bf16 v[112:115], v[64:67], a[184:187], v[112:115]
 v_mfma_f32_16x16x32_bf16 v[116:119], v[64:67], a[188:191], v[116:119]
 v_mfma_f32_16x16x32_bf16 v[120:123], v[68:71], a[184:187], v[120:123]
 v_mfma_f32_16x16x32_bf16 v[124:127], v[68:71], a[188:191], v[124:127]
 s_barrier
 s_nop 3
 v_cvt_pk_bf16_f32 v232, v112, v113
 v_cvt_pk_bf16_f32 v233, v114, v115
 v_cvt_pk_bf16_f32 v234, v120, v121
 v_cvt_pk_bf16_f32 v235, v122, v123
 v_cvt_pk_bf16_f32 v236, v116, v117
 v_cvt_pk_bf16_f32 v237, v118, v119
 v_cvt_pk_bf16_f32 v238, v124, v125
 v_cvt_pk_bf16_f32 v239, v126, v127
 s_cmp_lg_u32 s41, 1
 s_cbranch_scc1 mk_o44
 s_add_u32 s66, s53, 0x8000
 v_permlane16_swap_b32 v232, v234
 v_permlane16_swap_b32 v233, v235
 v_permlane16_swap_b32 v236, v238
 v_permlane16_swap_b32 v237, v239
 buffer_store_dwordx4 v[232:235], v59, s[28:31], s53 offen offset:64 sc1
 buffer_store_dwordx4 v[236:239], v59, s[28:31], s66 offen offset:64 sc1
 s_branch mk_fin
mk_o44:
 s_add_u32 s69, s43, 0x4000000
 buffer_store_dwordx4 v[232:235], v14, s[4:7], s69 offen offset:0 sc1
 v_pk_fma_f32 v[244:245], v[112:113], v[112:113], v[244:245]
 v_pk_add_f32 v[240:241], v[240:241], v[112:113]
 v_pk_fma_f32 v[244:245], v[114:115], v[114:115], v[244:245]
 v_pk_add_f32 v[240:241], v[240:241], v[114:115]
 v_pk_fma_f32 v[246:247], v[116:117], v[116:117], v[246:247]
 v_pk_add_f32 v[242:243], v[242:243], v[116:117]
 v_pk_fma_f32 v[246:247], v[118:119], v[118:119], v[246:247]
 v_pk_add_f32 v[242:243], v[242:243], v[118:119]
 buffer_store_dwordx4 v[236:239], v14, s[4:7], s69 offen offset:2048 sc1
 v_pk_fma_f32 v[244:245], v[120:121], v[120:121], v[244:245]
 v_pk_add_f32 v[240:241], v[240:241], v[120:121]
 v_pk_fma_f32 v[244:245], v[122:123], v[122:123], v[244:245]
 v_pk_add_f32 v[240:241], v[240:241], v[122:123]
 v_pk_fma_f32 v[246:247], v[124:125], v[124:125], v[246:247]
 v_pk_add_f32 v[242:243], v[242:243], v[124:125]
 v_pk_fma_f32 v[246:247], v[126:127], v[126:127], v[246:247]
 v_pk_add_f32 v[242:243], v[242:243], v[126:127]
 v_and_b32 v60, 15, v0
 v_lshlrev_b32 v60, 4, v60
 v_lshrrev_b32 v61, 4, v0
 v_lshl_add_u32 v60, v61, 2, v60
 v_add_f32 v240, v240, v241
 v_add_f32 v242, v242, v243
 v_add_f32 v244, v244, v245
 v_add_f32 v246, v246, v247
 v_permlane16_swap_b32 v240, v242
 s_nop 0
 v_permlane16_swap_b32 v244, v246
 v_add_f32 v240, v240, v242
 v_add_f32 v244, v244, v246
 s_nop 1
 v_permlane32_swap_b32 v240, v244
 v_add_f32 v240, v240, v244
 s_add_u32 s69, s51, 0x7800000
 buffer_store_dword v240, v60, s[4:7], s69 offen sc1
 s_add_u32 m0, s60, 0x8000
 s_bfe_u32 s65, s84, 0x40008
 s_mul_i32 s65, s65, 0x60000
 s_add_u32 s65, s65, s61
 buffer_load_dwordx4 v3, s[8:11], s65 offen offset:0  lds
 buffer_load_dwordx4 v4, s[8:11], s65 offen offset:1024  lds
 s_waitcnt vmcnt(2)
 s_atomic_add s93, s[54:55], 1024
 buffer_load_dwordx4 v5, s[8:11], s65 offen offset:2048  lds
 buffer_load_dwordx4 v6, s[8:11], s65 offen offset:3072  lds
 s_mov_b32 s79, 0
 s_atomic_add s79, s[54:55], 1024 glc
 v_accvgpr_write_b32 a0, v224
 v_accvgpr_write_b32 a1, v225
 v_accvgpr_write_b32 a2, v226
 v_accvgpr_write_b32 a3, v227
 v_accvgpr_write_b32 a4, v228
 v_accvgpr_write_b32 a5, v229
 v_accvgpr_write_b32 a6, v230
 v_accvgpr_write_b32 a7, v231
 v_accvgpr_write_b32 a8, v232
 v_accvgpr_write_b32 a9, v233
 v_accvgpr_write_b32 a10, v234
 v_accvgpr_write_b32 a11, v235
 v_accvgpr_write_b32 a12, v236
 v_accvgpr_write_b32 a13, v237
 v_accvgpr_write_b32 a14, v238
 v_accvgpr_write_b32 a15, v239
 s_add_u32 s42, s42, 0x4000000
 s_add_u32 s3, s3, 0x4000000
 s_add_u32 s43, s43, 0x4000000
 s_add_u32 s44, s44, 0x4000000
 s_add_u32 s45, s45, 0x4000000
 s_add_u32 s46, s46, 0x4000000
 s_add_u32 s47, s47, 0x4000000
 s_add_u32 s48, s48, 0x4000000
 s_add_u32 s49, s49, 0x4000000
 s_add_u32 s51, s51, 0x4000000
 s_add_u32 s50, s50, 0x4000000
 s_add_u32 s52, s52, 0x4000000
 s_add_u32 s98, s98, 0x4000000
 s_add_u32 s99, s99, 0x4000000
 s_add_u32 s54, s54, 2048
 s_addc_u32 s55, s55, 0
 s_add_u32 s56, s56, 2048
 s_addc_u32 s57, s57, 0
 s_add_u32 s58, s58, 2048
 s_addc_u32 s59, s59, 0
 s_add_u32 s41, s41, 1
 s_branch mk_top
mk_fin:
 s_or_b32 s66, s2, s38
 s_cmp_lg_u32 s66, 0
 s_cbranch_scc1 mk_e46
 v_mov_b32 v60, s96
 s_mov_b32 s66, 0xc280000
 buffer_store_dword v60, v2, s[4:7], s66 offen
mk_e46:
mk_exit:
 s_waitcnt vmcnt(0)
mk_end:
 s_endpgm
.section .rodata,"a"
.p2align 6
.amdhsa_kernel interleave_layers__linear_attn_block__mixer_gmlp__prompt_kernel
  .amdhsa_next_free_vgpr 512
  .amdhsa_next_free_sgpr 102
  .amdhsa_accum_offset 256
  .amdhsa_group_segment_fixed_size 0
  .amdhsa_kernarg_size 88
  .amdhsa_user_sgpr_count 2
  .amdhsa_user_sgpr_kernarg_segment_ptr 1
  .amdhsa_system_sgpr_workgroup_id_x 1
  .amdhsa_float_denorm_mode_32 3
.end_amdhsa_kernel
```
